```python
import torch

def _softmax(x, axis=-1):
    return torch.softmax(x, dim=axis)
def _gelu(x):
    return torch.nn.functional.gelu(x, approximate="tanh")
def _silu(x):
    return torch.nn.functional.silu(x)
def _sigmoid(x):
    return torch.sigmoid(x)
def _layernorm(x, axis=-1, eps=1e-5):
    m = x.mean(dim=axis, keepdim=True)
    v = x.var(dim=axis, keepdim=True, unbiased=False)
    return (x - m) / torch.sqrt(v + eps)
def _scatter_add(tgt, idx, src, axis=0):
    return tgt.clone().index_add_(axis, idx, src)
def _segment_sum(src, seg, n):
    out = torch.zeros((n,) + src.shape[1:], dtype=src.dtype)
    return out.index_add_(0, seg, src)
def _pad(x, pw):
    flat = tuple(v for pair in reversed(pw) for v in pair)
    return torch.nn.functional.pad(x, flat)

kernel_name = 'gated_mix__ssm_conv_h3__compressed_kv_cla__prompt'

def setup_inputs():

    _w = (lambda a: (lambda t: t.to(torch.bfloat16) if t.is_floating_point() else t)(torch.as_tensor(a)))
    def _A_setup():
        B, S, D = 1, 2048, 640
        ks = 4
        return {
            "q": _w((lambda *s: torch.randn(*s, dtype=torch.bfloat16) * 0.05)(B, S, D)),
            "k": _w((lambda *s: torch.randn(*s, dtype=torch.bfloat16) * 0.4)(B, S, D)),
            "v": _w((lambda *s: torch.randn(*s, dtype=torch.bfloat16) * 0.4)(B, S, D)),
            "shift_k": _w((lambda *s: torch.randn(*s, dtype=torch.bfloat16) * 0.4)(D, ks) * 0.5),
            "ssm_k": _w((lambda *s: torch.randn(*s, dtype=torch.bfloat16) * 0.8)(D, S) * (1.0 / S ** 0.5)),
            "ssm_D": _w((lambda *s: torch.randn(*s, dtype=torch.bfloat16) * 0.4)(D)),
        }
    _A_in = _A_setup()

    def _B_setup():
        B, H, Sq, Sk, D, M = 1, 32, 2048, 2048, 128, 640
        Dc = 4 * D
        return {
            "x": _w((lambda *s: torch.randn(*s, dtype=torch.bfloat16) * 0.05)(B, Sq, M)),
            "c_kv": _w((lambda *s: torch.randn(*s, dtype=torch.bfloat16) * 0.4)(B, Sk, Dc)),
            "w_q": _w((lambda *s: torch.randn(*s, dtype=torch.bfloat16) * 6.4)(M, H, D) * (M ** -0.5)),
            "w_uk": _w((lambda *s: torch.randn(*s, dtype=torch.bfloat16) * 6.4)(Dc, H, D) * (Dc ** -0.5)),
            "w_uv": _w((lambda *s: torch.randn(*s, dtype=torch.bfloat16) * 0.4)(Dc, H, D) * (Dc ** -0.5)),
            "w_o": _w((lambda *s: torch.randn(*s, dtype=torch.bfloat16) * 0.4)(H, D, M) * ((H * D) ** -0.5)),
        }
    _B_in = _B_setup()

    return {
        "A_q": _A_in["q"],
        "A_k": _A_in["k"],
        "A_v": _A_in["v"],
        "A_shift_k": _A_in["shift_k"],
        "A_ssm_k": _A_in["ssm_k"],
        "A_ssm_D": _A_in["ssm_D"],
        "B_x": _B_in["x"],
        "B_c_kv": _B_in["c_kv"],
        "B_w_q": _B_in["w_q"],
        "B_w_uk": _B_in["w_uk"],
        "B_w_uv": _B_in["w_uv"],
        "B_w_o": _B_in["w_o"],
        "gate_w": _w((lambda *s: torch.randn(*s, dtype=torch.bfloat16) * 0.05)(640) * 16.0),
    }

def reference(A_q, A_k, A_v, A_shift_k, A_ssm_k, A_ssm_D, B_x, B_c_kv, B_w_q, B_w_uk, B_w_uv, B_w_o, gate_w):
    def _A_ref(q, k, v, shift_k, ssm_k, ssm_D):
        B, S, D = q.shape
        ks = shift_k.shape[-1]
        k_pad = _pad(k, ((0, 0), (ks - 1, 0), (0, 0)))
        k_shift = torch.zeros_like(k)
        for t in range(ks):
            k_shift = k_shift + k_pad[:, t:t + S, :] * shift_k[:, ks - 1 - t][None, None, :]
        kv = k_shift * v
        L = 2 * S
        kv_pad = _pad(kv, ((0, 0), (0, S), (0, 0)))
        kf_pad = _pad(ssm_k, ((0, 0), (0, S)))
        kv_f = (lambda x, axes=(-2,-1): torch.fft.rfft2(x.float(), dim=axes))(kv_pad[:, None, :, :], axes=(1, 2))
        kf_f = (lambda x, axes=(-2,-1): torch.fft.rfft2(x.float(), dim=axes))(kf_pad[:, None, :], axes=(1, 2))
        kf_f = (lambda x, *d: x.permute(*d))(kf_f, 1, 2, 0)
        y_f = kv_f * kf_f[None, :, :, :]
        y = (lambda x, s, axes=(-2,-1): torch.fft.irfft2(x, s=s, dim=axes).to(torch.bfloat16))(y_f, (1, L), axes=(1, 2))[:, 0, :S, :]
        y = y + kv * ssm_D[None, None, :]
        return q * y

    def _B_ref(x, c_kv, w_q, w_uk, w_uv, w_o):
        B, Sq, M = x.shape[0], x.shape[1], x.shape[2]
        Sk = c_kv.shape[1]
        H, D = w_q.shape[1], w_q.shape[2]
        q = torch.einsum("bqm,mhd->bhqd", x, w_q)
        k = torch.einsum("bkc,chd->bhkd", c_kv, w_uk)
        v = torch.einsum("bkc,chd->bhkd", c_kv, w_uv)
        scores = torch.einsum("bhqd,bhkd->bhqk", q, k) * (D ** -0.5)
        off = Sk - Sq
        qi = torch.arange(Sq)[:, None]
        kj = torch.arange(Sk)[None, :]
        cmask = kj <= (qi + off)
        scores = torch.where(cmask[None, None], scores, -1e9)
        p = _softmax(scores, axis=-1)
        ctx = torch.einsum("bhqk,bhkd->bhqd", p, v)
        return torch.einsum("bhqd,hdm->bqm", ctx, w_o)

    x = A_q
    g = _sigmoid((x * gate_w).sum(-1, keepdims=True))
    a = _A_ref(x, A_k, A_v, A_shift_k, A_ssm_k, A_ssm_D)
    b = _B_ref(x, B_c_kv, B_w_q, B_w_uk, B_w_uv, B_w_o)
    return g * a + (1 - g) * b
```

```asm
; @launch grid=(256,1,1) block=(512,1,1) lds=163840
.amdgcn_target "amdgcn-amd-amdhsa--gfx950"
.text
.globl gated_mix__ssm_conv_h3__compressed_kv_cla__prompt_kernel
.p2align 8
.type gated_mix__ssm_conv_h3__compressed_kv_cla__prompt_kernel,@function
gated_mix__ssm_conv_h3__compressed_kv_cla__prompt_kernel:
    s_cmp_ge_u32 s2, 256
    s_cbranch_scc1 M_END
    s_load_dwordx2 s[44:45], s[0:1], 56
    s_load_dwordx4 s[48:51], s[0:1], 72
    v_lshrrev_b32 v1, 6, v0
    v_mov_b32 v31, v0
    v_and_b32 v0, 63, v0
    v_readfirstlane_b32 s32, v1
    s_and_b32 s33, s2, 7
    s_lshr_b32 s3, s2, 6
    s_lshl_b32 s3, s3, 3
    s_add_u32 s33, s33, s3
    s_bfe_u32 s34, s2, 0x30003
    s_lshr_b32 s35, s32, 2
    v_lshrrev_b32 v24, 3, v0
    v_and_b32 v25, 7, v0
    v_lshrrev_b32 v26, 4, v0
    v_xor_b32 v25, v25, v26
    v_lshlrev_b32 v25, 4, v25
    v_xor_b32 v27, 64, v25
    v_lshl_add_u32 v2, v24, 10, v25
    v_lshl_add_u32 v3, v24, 10, v27
    v_add_u32 v3, 7168, v3
    v_add_u32 v4, 14336, v2
    v_add_u32 v5, 14336, v3
    v_and_b32 v28, 15, v0
    v_lshlrev_b32 v29, 1, v26
    v_xor_b32 v28, v28, v29
    v_lshlrev_b32 v28, 4, v28
    v_lshl_add_u32 v6, v26, 13, v28
    v_add_u32 v7, 31744, v6
    v_xor_b32 v8, 128, v6
    v_add_u32 v8, 63488, v8
    v_add_u32 v9, 31744, v8
    s_and_b32 s36, s32, 3
    s_lshl_b32 s39, s34, 18
    s_lshl_b32 s37, s32, 15
    s_add_u32 s39, s39, s37
    s_lshl_b32 s40, s36, 17
    s_lshl_b32 s37, s33, 8
    s_add_u32 s40, s40, s37
    s_lshl_b32 s41, s32, 12
    s_add_u32 s42, s41, 65536
    s_waitcnt lgkmcnt(0)
    s_mov_b32 s4, s44
    s_mov_b32 s5, s45
    s_mov_b32 s6, 2097152
    s_mov_b32 s7, 0x00020000
    s_cmp_eq_u32 s35, 0
    s_cselect_b32 s8, s48, s50
    s_cselect_b32 s9, s49, s51
    s_mov_b32 s10, 4194304
    s_mov_b32 s11, 0x00020000
    s_add_u32 m0, s41, 0
    s_add_u32 s37, s39, 0
    buffer_load_dwordx4 v2, s[4:7], s37 offen lds
    buffer_load_dwordx4 v3, s[4:7], s37 offen offset:1024 lds
    buffer_load_dwordx4 v4, s[4:7], s37 offen offset:2048 lds
    buffer_load_dwordx4 v5, s[4:7], s37 offen offset:3072 lds
    s_add_u32 m0, s42, 0
    s_add_u32 s37, s40, 0
    buffer_load_dwordx4 v6, s[8:11], s37 offen lds
    buffer_load_dwordx4 v7, s[8:11], s37 offen offset:1024 lds
    buffer_load_dwordx4 v8, s[8:11], s37 offen offset:2048 lds
    buffer_load_dwordx4 v9, s[8:11], s37 offen offset:3072 lds
    s_load_dwordx2 s[44:45], s[0:1], 0
    s_load_dwordx2 s[46:47], s[0:1], 64
    s_load_dwordx4 s[48:51], s[0:1], 112
    s_load_dwordx4 s[64:67], s[0:1], 8
    s_load_dwordx4 s[68:71], s[0:1], 24
    s_load_dwordx4 s[72:75], s[0:1], 88
    v_lshlrev_b32 v1, 4, v0
    v_mul_u32_u24 v28, 1280, v24
    v_add_u32 v16, v28, v25
    v_add_u32 v17, v28, v27
    v_add_u32 v17, 9216, v17
    v_add_u32 v18, 18432, v16
    v_add_u32 v19, 18432, v17
    s_and_b32 s3, s32, 1
    s_lshl_b32 s3, s3, 7
    v_xor_b32 v20, s3, v6
    v_add_u32 v21, 31744, v20
    s_add_u32 m0, s41, 32768
    s_add_u32 s37, s39, 128
    buffer_load_dwordx4 v2, s[4:7], s37 offen lds
    buffer_load_dwordx4 v3, s[4:7], s37 offen offset:1024 lds
    buffer_load_dwordx4 v4, s[4:7], s37 offen offset:2048 lds
    buffer_load_dwordx4 v5, s[4:7], s37 offen offset:3072 lds
    s_add_u32 m0, s42, 32768
    s_add_u32 s37, s40, 524288
    buffer_load_dwordx4 v6, s[8:11], s37 offen lds
    buffer_load_dwordx4 v7, s[8:11], s37 offen offset:1024 lds
    buffer_load_dwordx4 v8, s[8:11], s37 offen offset:2048 lds
    buffer_load_dwordx4 v9, s[8:11], s37 offen offset:3072 lds
    v_lshlrev_b32 v116, 7, v0
    v_lshrrev_b32 v24, 1, v0
    v_and_b32 v25, 1, v0
    v_lshlrev_b32 v25, 7, v25
    v_lshl_add_u32 v115, v24, 13, v25
    s_lshl_b32 s3, s2, 13
    s_lshl_b32 s37, s32, 10
    s_add_u32 s3, s3, s37
    s_mov_b64 exec, 0xff
    buffer_load_dword v117, v116, s[4:7], s3 offen sc1
    s_lshl_b32 s3, s34, 2
    s_add_u32 s3, s3, s36
    s_mul_i32 s3, s3, 49152
    s_lshl_b32 s37, s33, 8
    s_add_u32 s3, s3, s37
    s_add_u32 s3, s3, 1048576
    s_add_u32 s61, s3, 1572864
    s_mov_b32 exec_lo, 0xfff
    buffer_load_dword v117, v115, s[8:11], s3 offen sc1
    s_mov_b64 exec, -1
    s_and_b32 s37, s32, 1
    s_lshl_b32 s37, s37, 14
    s_and_b32 s38, s32, 2
    s_lshl_b32 s38, s38, 1
    s_lshl_b32 s3, s35, 14
    s_add_u32 s3, s3, 65536
    v_and_b32 v24, 15, v0
    v_lshrrev_b32 v25, 4, v0
    v_bfe_u32 v26, v0, 1, 3
    v_xor_b32 v26, v26, v25
    v_lshlrev_b32 v26, 4, v26
    v_lshl_add_u32 v26, v24, 7, v26
    v_add_u32 v10, s37, v26
    v_xor_b32 v11, 64, v10
    v_bfe_u32 v24, v0, 2, 2
    v_lshl_add_u32 v26, v25, 3, v24
    v_lshlrev_b32 v26, 8, v26
    v_and_b32 v27, 3, v0
    v_lshl_add_u32 v26, v27, 3, v26
    v_add_u32 v26, s3, v26
    v_and_b32 v25, 1, v25
    v_lshl_add_u32 v24, v25, 2, v24
    v_xor_b32 v24, s38, v24
    v_xor_b32 v25, 0, v24
    v_lshl_add_u32 v12, v25, 5, v26
    v_xor_b32 v25, 1, v24
    v_lshl_add_u32 v13, v25, 5, v26
    v_xor_b32 v25, 2, v24
    v_lshl_add_u32 v14, v25, 5, v26
    v_xor_b32 v25, 3, v24
    v_lshl_add_u32 v15, v25, 5, v26
    v_lshrrev_b32 v24, 2, v0
    v_mul_u32_u24 v24, 672, v24
    v_and_b32 v25, 3, v0
    v_lshl_add_u32 v24, v25, 3, v24
    s_lshl_b32 s37, s32, 5
    s_add_u32 s37, s37, 131072
    v_add_u32 v22, s37, v24
    v_mul_u32_u24 v25, 1639, v31
    v_lshrrev_b32 v25, 16, v25
    v_mul_u32_u24 v26, 40, v25
    v_sub_u32 v26, v31, v26
    v_mul_u32_u24 v29, 1280, v25
    v_lshl_add_u32 v29, v26, 2, v29
    v_add_u32 v29, 131072, v29
    v_and_b32 v27, 7, v26
    v_xor_b32 v27, v27, v25
    v_lshlrev_b32 v27, 4, v27
    v_lshl_add_u32 v23, v26, 8, v27
    v_add_u32 v23, 153600, v23
    s_and_b32 s38, s2, 7
    s_mul_i32 s37, s38, 40
    v_add_lshl_u32 v26, v26, s37, 4
    v_mul_u32_u24 v25, 205, v0
    v_lshrrev_b32 v25, 11, v25
    v_mul_u32_u24 v27, 1120, v25
    v_lshl_add_u32 v27, v0, 4, v27
    s_lshr_b32 s37, s2, 3
    s_mul_i32 s37, s37, 81920
    s_mul_i32 s38, s38, 160
    s_add_u32 s37, s37, s38
    s_sub_u32 s37, s37, 3840
    v_add_u32 v27, s37, v27
    v_mov_b32 v30, 0x80000000
    v_mul_u32_u24 v24, 20, v0
    s_waitcnt lgkmcnt(0)
    s_mov_b32 s12, s50
    s_mov_b32 s13, s51
    s_mov_b32 s14, 67108864
    s_mov_b32 s15, 0x00020000
    s_add_u32 s16, s50, 16777216
    s_addc_u32 s17, s51, 0
    s_mov_b32 s18, 16777216
    s_mov_b32 s19, 0x00020000
    s_mov_b32 s20, s44
    s_mov_b32 s21, s45
    s_mov_b32 s22, 2621440
    s_mov_b32 s23, 0x00020000
    s_mov_b32 s24, s46
    s_mov_b32 s25, s47
    s_mov_b32 s26, 5242880
    s_mov_b32 s27, 0x00020000
    s_mov_b32 s28, s48
    s_mov_b32 s29, s49
    s_mov_b32 s30, 256
    s_mov_b32 s31, 0x00020000
    s_sub_u32 s37, 15, s34
    s_lshl_b32 s38, s36, 5
    s_lshl_b32 s55, s37, 7
    s_add_u32 s55, s55, s38
    s_lshl_b32 s54, s34, 7
    s_add_u32 s54, s54, s38
    s_cmp_eq_u32 s35, 0
    s_cselect_b32 s44, s54, s55
    s_mul_i32 s45, s44, 1280
    s_lshl_b32 s46, s32, 16
    s_lshl_b32 s37, s33, 8
    s_add_u32 s46, s46, s37
    s_lshl_b32 s37, s33, 12
    s_add_u32 s37, s37, 33554432
    s_lshl_b32 s38, s36, 4
    s_sub_u32 s54, s54, s38
    s_mul_i32 s54, s54, 8256
    s_add_u32 s54, s54, s37
    s_sub_u32 s55, s55, s38
    s_mul_i32 s55, s55, 8256
    s_add_u32 s55, s55, s37
    s_lshl_b32 s43, s33, 6
    s_lshl_b32 s37, s34, 3
    s_add_u32 s43, s43, s37
    s_and_b32 s37, s32, 1
    s_lshl_b32 s37, s37, 2
    s_add_u32 s43, s43, s37
    s_lshl_b32 s43, s43, 13
    s_bfe_u32 s37, s32, 0x10001
    s_add_u32 s38, s35, 11
    s_lshl_b32 s37, s37, s38
    s_add_u32 s43, s43, s37
    s_lshl_b32 s37, s35, 24
    s_add_u32 s43, s43, s37
    s_lshl_b32 s47, s34, 2
    s_add_u32 s47, s47, 4
    s_lshl_b32 s57, s33, 19
    s_lshl_b32 s37, s36, 11
    s_add_u32 s57, s57, s37
    s_lshl_b32 s51, s32, 11
    s_add_u32 s52, s51, 65536
    s_sub_u32 s38, s47, 4
    s_sub_u32 s56, s47, 2
    s_sub_u32 s56, s56, s35
    s_mov_b32 s53, 8192
    s_cmp_eq_u32 s35, 0
    s_cselect_b32 s49, s38, 99
    s_cselect_b32 s47, s47, 100
    s_add_u32 s58, s57, 8192
    s_add_u32 s59, s57, 16384
    s_mov_b64 s[62:63], 127
    s_add_u32 s37, s49, 1
    s_lshl_b64 s[62:63], s[62:63], s37
    s_mul_i32 s76, s35, 45
    s_mov_b32 s77, 0
    s_lshl_b64 s[76:77], s[76:77], s56
    s_or_b64 s[62:63], s[62:63], s[76:77]
    s_cmp_eq_u32 s35, 0
    s_cselect_b32 s18, s18, 0
    s_bitset1_b64 s[62:63], s56
    s_or_b32 s62, s62, 0x80000002
    s_or_b32 s63, s63, 6
    s_mov_b32 s50, 0x40004000
    s_mov_b32 s79, 0x00020000
    s_lshl_b32 s3, s2, 3
    s_add_u32 s3, s3, s32
    s_mul_i32 s3, s3, 1280
    buffer_load_dwordx4 v[80:83], v24, s[20:23], s3 offen
    buffer_load_dword v84, v24, s[20:23], s3 offen offset:16
    s_mov_b32 s76, s74
    s_mov_b32 s77, s75
    s_mov_b32 s78, 1280
    buffer_load_dwordx4 v[86:89], v24, s[76:79], 0 offen
    buffer_load_dword v85, v24, s[76:79], 0 offen offset:16
    s_cmp_lg_u32 s32, 6
    s_cbranch_scc1 ONLY_1
    s_getpc_b64 s[80:81]
    s_lshr_b32 s3, s2, 3
    s_mul_i32 s3, s3, 3072
    v_lshl_add_u32 v118, v0, 7, s3
    v_min_u32 v118, 77000, v118
    v_mov_b32 v119, s81
    v_add_co_u32 v118, vcc, s80, v118
    s_nop 1
    v_addc_co_u32 v119, vcc, 0, v119, vcc
    s_mov_b64 exec, 0xffffff
    global_load_dword v120, v[118:119], off sc1
    s_mov_b64 exec, -1
ONLY_1:
M_IPF:
    s_waitcnt vmcnt(14)
    s_barrier
    s_cmp_lg_u32 s35, 0
    s_cbranch_scc1 M_KVV
    ds_read_b64_tr_b16 v[32:33], v12 offset:0
    ds_read_b64_tr_b16 v[34:35], v12 offset:1024
    ds_read_b64_tr_b16 v[36:37], v13 offset:0
    ds_read_b64_tr_b16 v[38:39], v13 offset:1024
    ds_read_b64_tr_b16 v[40:41], v14 offset:0
    ds_read_b64_tr_b16 v[42:43], v14 offset:1024
    ds_read_b64_tr_b16 v[44:45], v15 offset:0
    ds_read_b64_tr_b16 v[46:47], v15 offset:1024
    ds_read_b128 v[64:67], v10 offset:0
    s_waitcnt lgkmcnt(0)
    v_mfma_f32_16x16x32_bf16 v[128:131], v[32:35], v[64:67], 0
    ds_read_b128 v[68:71], v10 offset:2048
    ds_read_b128 v[72:75], v10 offset:4096
    v_mfma_f32_16x16x32_bf16 v[132:135], v[36:39], v[64:67], 0
    ds_read_b128 v[76:79], v10 offset:6144
    v_mfma_f32_16x16x32_bf16 v[136:139], v[40:43], v[64:67], 0
    v_mfma_f32_16x16x32_bf16 v[140:143], v[44:47], v[64:67], 0
    s_waitcnt lgkmcnt(2)
    v_mfma_f32_16x16x32_bf16 v[144:147], v[32:35], v[68:71], 0
    ds_read_b128 v[64:67], v10 offset:8192
    v_mfma_f32_16x16x32_bf16 v[148:151], v[36:39], v[68:71], 0
    v_mfma_f32_16x16x32_bf16 v[152:155], v[40:43], v[68:71], 0
    v_mfma_f32_16x16x32_bf16 v[156:159], v[44:47], v[68:71], 0
    s_waitcnt lgkmcnt(2)
    v_mfma_f32_16x16x32_bf16 v[160:163], v[32:35], v[72:75], 0
    ds_read_b128 v[68:71], v10 offset:10240
    v_mfma_f32_16x16x32_bf16 v[164:167], v[36:39], v[72:75], 0
    v_mfma_f32_16x16x32_bf16 v[168:171], v[40:43], v[72:75], 0
    v_mfma_f32_16x16x32_bf16 v[172:175], v[44:47], v[72:75], 0
    s_waitcnt lgkmcnt(2)
    v_mfma_f32_16x16x32_bf16 v[176:179], v[32:35], v[76:79], 0
    ds_read_b128 v[72:75], v10 offset:12288
    v_mfma_f32_16x16x32_bf16 v[180:183], v[36:39], v[76:79], 0
    v_mfma_f32_16x16x32_bf16 v[184:187], v[40:43], v[76:79], 0
    ds_read_b64_tr_b16 v[48:49], v12 offset:8192
    ds_read_b64_tr_b16 v[50:51], v12 offset:9216
    v_mfma_f32_16x16x32_bf16 v[188:191], v[44:47], v[76:79], 0
    ds_read_b64_tr_b16 v[52:53], v13 offset:8192
    ds_read_b64_tr_b16 v[54:55], v13 offset:9216
    s_waitcnt lgkmcnt(6)
    v_mfma_f32_16x16x32_bf16 v[192:195], v[32:35], v[64:67], 0
    ds_read_b128 v[76:79], v10 offset:14336
    ds_read_b64_tr_b16 v[56:57], v14 offset:8192
    v_mfma_f32_16x16x32_bf16 v[196:199], v[36:39], v[64:67], 0
    ds_read_b64_tr_b16 v[58:59], v14 offset:9216
    ds_read_b64_tr_b16 v[60:61], v15 offset:8192
    v_mfma_f32_16x16x32_bf16 v[200:203], v[40:43], v[64:67], 0
    ds_read_b64_tr_b16 v[62:63], v15 offset:9216
    v_mfma_f32_16x16x32_bf16 v[204:207], v[44:47], v[64:67], 0
    s_waitcnt lgkmcnt(10)
    v_mfma_f32_16x16x32_bf16 v[208:211], v[32:35], v[68:71], 0
    ds_read_b128 v[64:67], v11 offset:0
    s_cmp_lg_u32 s32, 3
    s_cbranch_scc1 ONLY_2
    s_cmp_lg_u32 s34, 0
    s_cbranch_scc1 ONLY_2
    s_lshl_b32 s3, s33, 12
    s_add_u32 s3, s3, 131072
    v_lshl_add_u32 v116, v0, 2, s3
    s_lshl_b32 s3, s33, 2
    s_add_u32 s3, s3, 196608
    v_lshl_add_u32 v118, v0, 12, s3
    v_cmp_le_u32 vcc, 16, v0
    v_and_b32 v119, 7, v0
    v_lshl_add_u32 v119, v119, 3, s2
    v_cndmask_b32 v116, v116, v118, vcc
    v_lshrrev_b32 v118, 5, v119
    v_and_b32 v119, 31, v119
    v_lshlrev_b32 v119, 2, v119
    v_lshl_add_u32 v118, v118, 12, v119
    v_cmp_le_u32 vcc, 32, v0
    v_mov_b32 v31, 0
    s_mov_b32 s3, 66584576
    v_cndmask_b32 v116, v116, v118, vcc
    buffer_store_dword v31, v116, s[12:15], s3 offen sc1
ONLY_2:
    v_mfma_f32_16x16x32_bf16 v[212:215], v[36:39], v[68:71], 0
    v_mfma_f32_16x16x32_bf16 v[216:219], v[40:43], v[68:71], 0
    v_mfma_f32_16x16x32_bf16 v[220:223], v[44:47], v[68:71], 0
    s_waitcnt lgkmcnt(10)
    v_mfma_f32_16x16x32_bf16 v[224:227], v[32:35], v[72:75], 0
    ds_read_b128 v[68:71], v11 offset:2048
    v_mfma_f32_16x16x32_bf16 v[228:231], v[36:39], v[72:75], 0
    v_mfma_f32_16x16x32_bf16 v[232:235], v[40:43], v[72:75], 0
    v_mfma_f32_16x16x32_bf16 v[236:239], v[44:47], v[72:75], 0
    s_waitcnt lgkmcnt(6)
    v_mfma_f32_16x16x32_bf16 v[240:243], v[32:35], v[76:79], 0
    ds_read_b128 v[72:75], v11 offset:4096
    v_mfma_f32_16x16x32_bf16 v[244:247], v[36:39], v[76:79], 0
    v_mfma_f32_16x16x32_bf16 v[248:251], v[40:43], v[76:79], 0
    v_mfma_f32_16x16x32_bf16 v[252:255], v[44:47], v[76:79], 0
    s_waitcnt lgkmcnt(2)
    v_mfma_f32_16x16x32_bf16 v[128:131], v[48:51], v[64:67], v[128:131]
    ds_read_b128 v[76:79], v11 offset:6144
    v_mfma_f32_16x16x32_bf16 v[132:135], v[52:55], v[64:67], v[132:135]
    v_mfma_f32_16x16x32_bf16 v[136:139], v[56:59], v[64:67], v[136:139]
    v_mfma_f32_16x16x32_bf16 v[140:143], v[60:63], v[64:67], v[140:143]
    s_waitcnt lgkmcnt(2)
    v_mfma_f32_16x16x32_bf16 v[144:147], v[48:51], v[68:71], v[144:147]
    ds_read_b128 v[64:67], v11 offset:8192
    v_mfma_f32_16x16x32_bf16 v[148:151], v[52:55], v[68:71], v[148:151]
    v_mfma_f32_16x16x32_bf16 v[152:155], v[56:59], v[68:71], v[152:155]
    v_mfma_f32_16x16x32_bf16 v[156:159], v[60:63], v[68:71], v[156:159]
    s_waitcnt lgkmcnt(2)
    v_mfma_f32_16x16x32_bf16 v[160:163], v[48:51], v[72:75], v[160:163]
    ds_read_b128 v[68:71], v11 offset:10240
    v_mfma_f32_16x16x32_bf16 v[164:167], v[52:55], v[72:75], v[164:167]
    v_mfma_f32_16x16x32_bf16 v[168:171], v[56:59], v[72:75], v[168:171]
    v_mfma_f32_16x16x32_bf16 v[172:175], v[60:63], v[72:75], v[172:175]
    s_waitcnt lgkmcnt(2)
    v_mfma_f32_16x16x32_bf16 v[176:179], v[48:51], v[76:79], v[176:179]
    ds_read_b128 v[72:75], v11 offset:12288
    v_mfma_f32_16x16x32_bf16 v[180:183], v[52:55], v[76:79], v[180:183]
    v_mfma_f32_16x16x32_bf16 v[184:187], v[56:59], v[76:79], v[184:187]
    v_mfma_f32_16x16x32_bf16 v[188:191], v[60:63], v[76:79], v[188:191]
    s_waitcnt lgkmcnt(2)
    v_mfma_f32_16x16x32_bf16 v[192:195], v[48:51], v[64:67], v[192:195]
    ds_read_b128 v[76:79], v11 offset:14336
    v_mfma_f32_16x16x32_bf16 v[196:199], v[52:55], v[64:67], v[196:199]
    v_mfma_f32_16x16x32_bf16 v[200:203], v[56:59], v[64:67], v[200:203]
    v_mfma_f32_16x16x32_bf16 v[204:207], v[60:63], v[64:67], v[204:207]
    s_waitcnt lgkmcnt(0)
    s_waitcnt vmcnt(6)
    s_barrier
    ds_read_b64_tr_b16 v[32:33], v12 offset:32768
    ds_read_b64_tr_b16 v[34:35], v12 offset:33792
    v_mfma_f32_16x16x32_bf16 v[208:211], v[48:51], v[68:71], v[208:211]
    ds_read_b64_tr_b16 v[36:37], v13 offset:32768
    ds_read_b64_tr_b16 v[38:39], v13 offset:33792
    s_add_u32 m0, s41, 0
    s_add_u32 s37, s39, 256
    buffer_load_dwordx4 v2, s[4:7], s37 offen lds
    v_mfma_f32_16x16x32_bf16 v[212:215], v[52:55], v[68:71], v[212:215]
    ds_read_b64_tr_b16 v[40:41], v14 offset:32768
    ds_read_b64_tr_b16 v[42:43], v14 offset:33792
    buffer_load_dwordx4 v3, s[4:7], s37 offen offset:1024 lds
    v_mfma_f32_16x16x32_bf16 v[216:219], v[56:59], v[68:71], v[216:219]
    ds_read_b64_tr_b16 v[44:45], v15 offset:32768
    ds_read_b64_tr_b16 v[46:47], v15 offset:33792
    buffer_load_dwordx4 v4, s[4:7], s37 offen offset:2048 lds
    v_mfma_f32_16x16x32_bf16 v[220:223], v[60:63], v[68:71], v[220:223]
    ds_read_b128 v[64:67], v10 offset:32768
    buffer_load_dwordx4 v5, s[4:7], s37 offen offset:3072 lds
    v_mfma_f32_16x16x32_bf16 v[224:227], v[48:51], v[72:75], v[224:227]
    ds_read_b128 v[68:71], v10 offset:34816
    s_add_u32 m0, s42, 0
    s_add_u32 s37, s40, 1048576
    buffer_load_dwordx4 v6, s[8:11], s37 offen lds
    v_mfma_f32_16x16x32_bf16 v[228:231], v[52:55], v[72:75], v[228:231]
    buffer_load_dwordx4 v7, s[8:11], s37 offen offset:1024 lds
    v_mfma_f32_16x16x32_bf16 v[232:235], v[56:59], v[72:75], v[232:235]
    buffer_load_dwordx4 v8, s[8:11], s37 offen offset:2048 lds
    v_mfma_f32_16x16x32_bf16 v[236:239], v[60:63], v[72:75], v[236:239]
    buffer_load_dwordx4 v9, s[8:11], s37 offen offset:3072 lds
    v_mfma_f32_16x16x32_bf16 v[240:243], v[48:51], v[76:79], v[240:243]
    ds_read_b128 v[72:75], v10 offset:36864
    s_mov_b64 exec, 0xfff
    buffer_load_dword v117, v115, s[8:11], s61 offen sc1
    s_mov_b64 exec, -1
    v_mfma_f32_16x16x32_bf16 v[244:247], v[52:55], v[76:79], v[244:247]
    s_mov_b32 s76, s64
    s_mov_b32 s77, s65
    s_mov_b32 s78, 2621440
    s_mul_i32 s3, s32, 7680
    s_add_u32 s3, s3, 0
    v_add_u32 v28, s3, v27
    s_mul_i32 s3, s32, 960
    s_add_u32 m0, s3, 131072
    s_mov_b32 exec_hi, 0xfffffff
    buffer_load_dwordx4 v28, s[76:79], 0 offen lds
    s_mov_b32 exec_hi, -1
    v_mfma_f32_16x16x32_bf16 v[248:251], v[56:59], v[76:79], v[248:251]
    s_mov_b32 s76, s64
    s_mov_b32 s77, s65
    s_mov_b32 s78, 2621440
    s_mul_i32 s3, s32, 7680
    s_add_u32 s3, s3, 61440
    v_add_u32 v28, s3, v27
    s_mul_i32 s3, s32, 960
    s_add_u32 m0, s3, 138752
    s_mov_b32 exec_hi, 0xfffffff
    buffer_load_dwordx4 v28, s[76:79], 0 offen lds
    s_mov_b32 exec_hi, -1
    v_mfma_f32_16x16x32_bf16 v[252:255], v[60:63], v[76:79], v[252:255]
    s_mov_b32 s76, s66
    s_mov_b32 s77, s67
    s_mov_b32 s78, 2621440
    s_mul_i32 s3, s32, 7680
    s_add_u32 s3, s3, 34560
    v_add_u32 v28, s3, v27
    s_mul_i32 s3, s32, 960
    s_add_u32 m0, s3, 146432
    s_mov_b32 exec_hi, 0xfffffff
    buffer_load_dwordx4 v28, s[76:79], 0 offen lds
    s_mov_b32 exec_hi, -1
    s_waitcnt lgkmcnt(2)
    v_mfma_f32_16x16x32_bf16 v[128:131], v[32:35], v[64:67], v[128:131]
    ds_read_b128 v[76:79], v10 offset:38912
    s_mov_b32 s76, s68
    s_mov_b32 s77, s69
    s_mov_b32 s78, 5120
    buffer_load_dwordx4 v[110:113], v26, s[76:79], 0 offen
    v_mfma_f32_16x16x32_bf16 v[132:135], v[36:39], v[64:67], v[132:135]
    v_mfma_f32_16x16x32_bf16 v[136:139], v[40:43], v[64:67], v[136:139]
    v_mfma_f32_16x16x32_bf16 v[140:143], v[44:47], v[64:67], v[140:143]
    s_waitcnt lgkmcnt(2)
    v_mfma_f32_16x16x32_bf16 v[144:147], v[32:35], v[68:71], v[144:147]
    ds_read_b128 v[64:67], v10 offset:40960
    v_mfma_f32_16x16x32_bf16 v[148:151], v[36:39], v[68:71], v[148:151]
    v_mfma_f32_16x16x32_bf16 v[152:155], v[40:43], v[68:71], v[152:155]
    v_mfma_f32_16x16x32_bf16 v[156:159], v[44:47], v[68:71], v[156:159]
    s_waitcnt lgkmcnt(2)
    v_mfma_f32_16x16x32_bf16 v[160:163], v[32:35], v[72:75], v[160:163]
    ds_read_b128 v[68:71], v10 offset:43008
    v_mfma_f32_16x16x32_bf16 v[164:167], v[36:39], v[72:75], v[164:167]
    v_mfma_f32_16x16x32_bf16 v[168:171], v[40:43], v[72:75], v[168:171]
    v_mfma_f32_16x16x32_bf16 v[172:175], v[44:47], v[72:75], v[172:175]
    s_waitcnt lgkmcnt(2)
    v_mfma_f32_16x16x32_bf16 v[176:179], v[32:35], v[76:79], v[176:179]
    ds_read_b128 v[72:75], v10 offset:45056
    v_mfma_f32_16x16x32_bf16 v[180:183], v[36:39], v[76:79], v[180:183]
    v_mfma_f32_16x16x32_bf16 v[184:187], v[40:43], v[76:79], v[184:187]
    ds_read_b64_tr_b16 v[48:49], v12 offset:40960
    ds_read_b64_tr_b16 v[50:51], v12 offset:41984
    v_mfma_f32_16x16x32_bf16 v[188:191], v[44:47], v[76:79], v[188:191]
    ds_read_b64_tr_b16 v[52:53], v13 offset:40960
    ds_read_b64_tr_b16 v[54:55], v13 offset:41984
    s_waitcnt lgkmcnt(6)
    v_mfma_f32_16x16x32_bf16 v[192:195], v[32:35], v[64:67], v[192:195]
    ds_read_b128 v[76:79], v10 offset:47104
    ds_read_b64_tr_b16 v[56:57], v14 offset:40960
    v_mfma_f32_16x16x32_bf16 v[196:199], v[36:39], v[64:67], v[196:199]
    ds_read_b64_tr_b16 v[58:59], v14 offset:41984
    ds_read_b64_tr_b16 v[60:61], v15 offset:40960
    v_mfma_f32_16x16x32_bf16 v[200:203], v[40:43], v[64:67], v[200:203]
    ds_read_b64_tr_b16 v[62:63], v15 offset:41984
    v_mfma_f32_16x16x32_bf16 v[204:207], v[44:47], v[64:67], v[204:207]
    s_waitcnt lgkmcnt(10)
    v_mfma_f32_16x16x32_bf16 v[208:211], v[32:35], v[68:71], v[208:211]
    ds_read_b128 v[64:67], v11 offset:32768
    v_mfma_f32_16x16x32_bf16 v[212:215], v[36:39], v[68:71], v[212:215]
    v_mfma_f32_16x16x32_bf16 v[216:219], v[40:43], v[68:71], v[216:219]
    v_mfma_f32_16x16x32_bf16 v[220:223], v[44:47], v[68:71], v[220:223]
    s_waitcnt lgkmcnt(10)
    v_mfma_f32_16x16x32_bf16 v[224:227], v[32:35], v[72:75], v[224:227]
    ds_read_b128 v[68:71], v11 offset:34816
    v_mfma_f32_16x16x32_bf16 v[228:231], v[36:39], v[72:75], v[228:231]
    v_mfma_f32_16x16x32_bf16 v[232:235], v[40:43], v[72:75], v[232:235]
    v_mfma_f32_16x16x32_bf16 v[236:239], v[44:47], v[72:75], v[236:239]
    s_waitcnt lgkmcnt(6)
    v_mfma_f32_16x16x32_bf16 v[240:243], v[32:35], v[76:79], v[240:243]
    ds_read_b128 v[72:75], v11 offset:36864
    v_mfma_f32_16x16x32_bf16 v[244:247], v[36:39], v[76:79], v[244:247]
    v_mfma_f32_16x16x32_bf16 v[248:251], v[40:43], v[76:79], v[248:251]
    v_mfma_f32_16x16x32_bf16 v[252:255], v[44:47], v[76:79], v[252:255]
    s_waitcnt lgkmcnt(2)
    v_mfma_f32_16x16x32_bf16 v[128:131], v[48:51], v[64:67], v[128:131]
    ds_read_b128 v[76:79], v11 offset:38912
    v_mfma_f32_16x16x32_bf16 v[132:135], v[52:55], v[64:67], v[132:135]
    v_mfma_f32_16x16x32_bf16 v[136:139], v[56:59], v[64:67], v[136:139]
    v_mfma_f32_16x16x32_bf16 v[140:143], v[60:63], v[64:67], v[140:143]
    s_waitcnt lgkmcnt(2)
    v_mfma_f32_16x16x32_bf16 v[144:147], v[48:51], v[68:71], v[144:147]
    ds_read_b128 v[64:67], v11 offset:40960
    v_mfma_f32_16x16x32_bf16 v[148:151], v[52:55], v[68:71], v[148:151]
    v_mfma_f32_16x16x32_bf16 v[152:155], v[56:59], v[68:71], v[152:155]
    v_mfma_f32_16x16x32_bf16 v[156:159], v[60:63], v[68:71], v[156:159]
    s_waitcnt lgkmcnt(2)
    v_mfma_f32_16x16x32_bf16 v[160:163], v[48:51], v[72:75], v[160:163]
    ds_read_b128 v[68:71], v11 offset:43008
    v_mfma_f32_16x16x32_bf16 v[164:167], v[52:55], v[72:75], v[164:167]
    v_mfma_f32_16x16x32_bf16 v[168:171], v[56:59], v[72:75], v[168:171]
    v_mfma_f32_16x16x32_bf16 v[172:175], v[60:63], v[72:75], v[172:175]
    s_waitcnt lgkmcnt(2)
    v_mfma_f32_16x16x32_bf16 v[176:179], v[48:51], v[76:79], v[176:179]
    ds_read_b128 v[72:75], v11 offset:45056
    v_mfma_f32_16x16x32_bf16 v[180:183], v[52:55], v[76:79], v[180:183]
    v_mfma_f32_16x16x32_bf16 v[184:187], v[56:59], v[76:79], v[184:187]
    v_mfma_f32_16x16x32_bf16 v[188:191], v[60:63], v[76:79], v[188:191]
    s_waitcnt lgkmcnt(2)
    v_mfma_f32_16x16x32_bf16 v[192:195], v[48:51], v[64:67], v[192:195]
    ds_read_b128 v[76:79], v11 offset:47104
    v_mfma_f32_16x16x32_bf16 v[196:199], v[52:55], v[64:67], v[196:199]
    v_mfma_f32_16x16x32_bf16 v[200:203], v[56:59], v[64:67], v[200:203]
    v_mfma_f32_16x16x32_bf16 v[204:207], v[60:63], v[64:67], v[204:207]
    s_waitcnt lgkmcnt(0)
    s_waitcnt vmcnt(5)
    s_barrier
    ds_read_b64_tr_b16 v[32:33], v12 offset:0
    ds_read_b64_tr_b16 v[34:35], v12 offset:1024
    v_mfma_f32_16x16x32_bf16 v[208:211], v[48:51], v[68:71], v[208:211]
    ds_read_b64_tr_b16 v[36:37], v13 offset:0
    ds_read_b64_tr_b16 v[38:39], v13 offset:1024
    s_cmp_lg_u32 s32, 3
    s_cbranch_scc1 ONLY_3
    s_cmp_lg_u32 s34, 0
    s_cbranch_scc1 ONLY_3
    s_mov_b64 exec, 1
    v_mov_b32 v119, 1
    s_lshl_b32 s3, s33, 2
    buffer_store_dword v119, v31, s[28:31], s3 offen offset:128 sc1
    s_mov_b64 exec, -1
ONLY_3:
    v_mfma_f32_16x16x32_bf16 v[212:215], v[52:55], v[68:71], v[212:215]
    ds_read_b64_tr_b16 v[40:41], v14 offset:0
    ds_read_b64_tr_b16 v[42:43], v14 offset:1024
    s_add_u32 m0, s41, 32768
    s_add_u32 s37, s39, 384
    buffer_load_dwordx4 v2, s[4:7], s37 offen lds
    v_mfma_f32_16x16x32_bf16 v[216:219], v[56:59], v[68:71], v[216:219]
    ds_read_b64_tr_b16 v[44:45], v15 offset:0
    ds_read_b64_tr_b16 v[46:47], v15 offset:1024
    buffer_load_dwordx4 v3, s[4:7], s37 offen offset:1024 lds
    v_mfma_f32_16x16x32_bf16 v[220:223], v[60:63], v[68:71], v[220:223]
    ds_read_b128 v[64:67], v10 offset:0
    buffer_load_dwordx4 v4, s[4:7], s37 offen offset:2048 lds
    v_mfma_f32_16x16x32_bf16 v[224:227], v[48:51], v[72:75], v[224:227]
    ds_read_b128 v[68:71], v10 offset:2048
    buffer_load_dwordx4 v5, s[4:7], s37 offen offset:3072 lds
    v_mfma_f32_16x16x32_bf16 v[228:231], v[52:55], v[72:75], v[228:231]
    s_add_u32 m0, s42, 32768
    s_add_u32 s37, s40, 1572864
    buffer_load_dwordx4 v6, s[8:11], s37 offen lds
    v_mfma_f32_16x16x32_bf16 v[232:235], v[56:59], v[72:75], v[232:235]
    buffer_load_dwordx4 v7, s[8:11], s37 offen offset:1024 lds
    v_mfma_f32_16x16x32_bf16 v[236:239], v[60:63], v[72:75], v[236:239]
    buffer_load_dwordx4 v8, s[8:11], s37 offen offset:2048 lds
    v_mfma_f32_16x16x32_bf16 v[240:243], v[48:51], v[76:79], v[240:243]
    ds_read_b128 v[72:75], v10 offset:4096
    buffer_load_dwordx4 v9, s[8:11], s37 offen offset:3072 lds
    v_mfma_f32_16x16x32_bf16 v[244:247], v[52:55], v[76:79], v[244:247]
    v_mov_b32 v24, 0
    v_lshlrev_b32 v25, 16, v80
    v_and_b32 v26, 0xffff0000, v80
    v_lshlrev_b32 v27, 16, v86
    v_and_b32 v28, 0xffff0000, v86
    v_mul_f32 v25, v25, v27
    v_mfma_f32_16x16x32_bf16 v[248:251], v[56:59], v[76:79], v[248:251]
    v_mul_f32 v26, v26, v28
    v_cvt_pk_bf16_f32 v27, v25, v26
    v_mfma_f32_16x16x32_bf16 v[252:255], v[60:63], v[76:79], v[252:255]
    v_lshlrev_b32 v25, 16, v27
    v_and_b32 v26, 0xffff0000, v27
    s_waitcnt lgkmcnt(2)
    v_mfma_f32_16x16x32_bf16 v[128:131], v[32:35], v[64:67], v[128:131]
    ds_read_b128 v[76:79], v10 offset:6144
    v_add_f32 v24, v24, v25
    v_add_f32 v24, v24, v26
    v_mfma_f32_16x16x32_bf16 v[132:135], v[36:39], v[64:67], v[132:135]
    v_lshlrev_b32 v25, 16, v81
    v_and_b32 v26, 0xffff0000, v81
    v_mfma_f32_16x16x32_bf16 v[136:139], v[40:43], v[64:67], v[136:139]
    v_lshlrev_b32 v27, 16, v87
    v_and_b32 v28, 0xffff0000, v87
    v_mfma_f32_16x16x32_bf16 v[140:143], v[44:47], v[64:67], v[140:143]
    v_mul_f32 v25, v25, v27
    v_mul_f32 v26, v26, v28
    s_waitcnt lgkmcnt(2)
    v_mfma_f32_16x16x32_bf16 v[144:147], v[32:35], v[68:71], v[144:147]
    ds_read_b128 v[64:67], v10 offset:8192
    v_cvt_pk_bf16_f32 v27, v25, v26
    v_lshlrev_b32 v25, 16, v27
    v_mfma_f32_16x16x32_bf16 v[148:151], v[36:39], v[68:71], v[148:151]
    v_and_b32 v26, 0xffff0000, v27
    v_add_f32 v24, v24, v25
    v_mfma_f32_16x16x32_bf16 v[152:155], v[40:43], v[68:71], v[152:155]
    v_add_f32 v24, v24, v26
    v_lshlrev_b32 v25, 16, v82
    v_mfma_f32_16x16x32_bf16 v[156:159], v[44:47], v[68:71], v[156:159]
    v_and_b32 v26, 0xffff0000, v82
    v_lshlrev_b32 v27, 16, v88
    s_waitcnt lgkmcnt(2)
    v_mfma_f32_16x16x32_bf16 v[160:163], v[32:35], v[72:75], v[160:163]
    ds_read_b128 v[68:71], v10 offset:10240
    v_and_b32 v28, 0xffff0000, v88
    v_mul_f32 v25, v25, v27
    v_mfma_f32_16x16x32_bf16 v[164:167], v[36:39], v[72:75], v[164:167]
    v_mul_f32 v26, v26, v28
    v_cvt_pk_bf16_f32 v27, v25, v26
    v_mfma_f32_16x16x32_bf16 v[168:171], v[40:43], v[72:75], v[168:171]
    v_lshlrev_b32 v25, 16, v27
    v_and_b32 v26, 0xffff0000, v27
    v_mfma_f32_16x16x32_bf16 v[172:175], v[44:47], v[72:75], v[172:175]
    v_add_f32 v24, v24, v25
    v_add_f32 v24, v24, v26
    s_waitcnt lgkmcnt(2)
    v_mfma_f32_16x16x32_bf16 v[176:179], v[32:35], v[76:79], v[176:179]
    ds_read_b128 v[72:75], v10 offset:12288
    v_lshlrev_b32 v25, 16, v83
    v_and_b32 v26, 0xffff0000, v83
    v_mfma_f32_16x16x32_bf16 v[180:183], v[36:39], v[76:79], v[180:183]
    v_lshlrev_b32 v27, 16, v89
    v_and_b32 v28, 0xffff0000, v89
    v_mfma_f32_16x16x32_bf16 v[184:187], v[40:43], v[76:79], v[184:187]
    ds_read_b64_tr_b16 v[48:49], v12 offset:8192
    ds_read_b64_tr_b16 v[50:51], v12 offset:9216
    v_mul_f32 v25, v25, v27
    v_mul_f32 v26, v26, v28
    v_mfma_f32_16x16x32_bf16 v[188:191], v[44:47], v[76:79], v[188:191]
    ds_read_b64_tr_b16 v[52:53], v13 offset:8192
    ds_read_b64_tr_b16 v[54:55], v13 offset:9216
    v_cvt_pk_bf16_f32 v27, v25, v26
    v_lshlrev_b32 v25, 16, v27
    s_waitcnt lgkmcnt(6)
    v_mfma_f32_16x16x32_bf16 v[192:195], v[32:35], v[64:67], v[192:195]
    ds_read_b128 v[76:79], v10 offset:14336
    ds_read_b64_tr_b16 v[56:57], v14 offset:8192
    v_and_b32 v26, 0xffff0000, v27
    v_add_f32 v24, v24, v25
    v_mfma_f32_16x16x32_bf16 v[196:199], v[36:39], v[64:67], v[196:199]
    ds_read_b64_tr_b16 v[58:59], v14 offset:9216
    ds_read_b64_tr_b16 v[60:61], v15 offset:8192
    v_add_f32 v24, v24, v26
    v_lshlrev_b32 v25, 16, v84
    v_mfma_f32_16x16x32_bf16 v[200:203], v[40:43], v[64:67], v[200:203]
    ds_read_b64_tr_b16 v[62:63], v15 offset:9216
    v_and_b32 v26, 0xffff0000, v84
    v_lshlrev_b32 v27, 16, v85
    v_mfma_f32_16x16x32_bf16 v[204:207], v[44:47], v[64:67], v[204:207]
    v_and_b32 v28, 0xffff0000, v85
    v_mul_f32 v25, v25, v27
    s_waitcnt lgkmcnt(10)
    v_mfma_f32_16x16x32_bf16 v[208:211], v[32:35], v[68:71], v[208:211]
    ds_read_b128 v[64:67], v11 offset:0
    v_mul_f32 v26, v26, v28
    v_cvt_pk_bf16_f32 v27, v25, v26
    v_mfma_f32_16x16x32_bf16 v[212:215], v[36:39], v[68:71], v[212:215]
    v_lshlrev_b32 v25, 16, v27
    v_and_b32 v26, 0xffff0000, v27
    v_mfma_f32_16x16x32_bf16 v[216:219], v[40:43], v[68:71], v[216:219]
    v_add_f32 v24, v24, v25
    v_add_f32 v24, v24, v26
    v_mfma_f32_16x16x32_bf16 v[220:223], v[44:47], v[68:71], v[220:223]
    s_nop 0
    v_add_f32_dpp v24, v24, v24 row_shr:1 row_mask:0xf bank_mask:0xf bound_ctrl:0
    s_nop 1
    v_add_f32_dpp v24, v24, v24 row_shr:2 row_mask:0xf bank_mask:0xf bound_ctrl:0
    s_waitcnt lgkmcnt(10)
    v_mfma_f32_16x16x32_bf16 v[224:227], v[32:35], v[72:75], v[224:227]
    ds_read_b128 v[68:71], v11 offset:2048
    v_add_f32_dpp v24, v24, v24 row_shr:4 row_mask:0xf bank_mask:0xf bound_ctrl:0
    s_nop 1
    v_add_f32_dpp v24, v24, v24 row_shr:8 row_mask:0xf bank_mask:0xf bound_ctrl:0
    v_mfma_f32_16x16x32_bf16 v[228:231], v[36:39], v[72:75], v[228:231]
    s_nop 0
    v_add_f32_dpp v24, v24, v24 row_bcast:15 row_mask:0xa bank_mask:0xf
    s_nop 1
    v_add_f32_dpp v24, v24, v24 row_bcast:31 row_mask:0xc bank_mask:0xf
    v_mfma_f32_16x16x32_bf16 v[232:235], v[40:43], v[72:75], v[232:235]
    v_cvt_pk_bf16_f32 v25, v24, v24
    v_lshlrev_b32 v24, 16, v25
    v_mfma_f32_16x16x32_bf16 v[236:239], v[44:47], v[72:75], v[236:239]
    v_mul_f32 v24, 0xbfb8aa3b, v24
    v_exp_f32 v24, v24
    s_waitcnt lgkmcnt(6)
    v_mfma_f32_16x16x32_bf16 v[240:243], v[32:35], v[76:79], v[240:243]
    ds_read_b128 v[72:75], v11 offset:4096
    v_cmp_eq_u32 vcc, 63, v0
    v_add_f32 v24, 1.0, v24
    v_mfma_f32_16x16x32_bf16 v[244:247], v[36:39], v[76:79], v[244:247]
    v_rcp_f32 v24, v24
    v_cndmask_b32 v26, v30, 0, vcc
    v_mfma_f32_16x16x32_bf16 v[248:251], v[40:43], v[76:79], v[248:251]
    v_cvt_pk_bf16_f32 v25, v24, v24
    v_lshlrev_b32 v24, 16, v25
    v_mfma_f32_16x16x32_bf16 v[252:255], v[44:47], v[76:79], v[252:255]
    s_lshl_b32 s3, s2, 3
    s_add_u32 s3, s3, s32
    s_lshl_b32 s3, s3, 2
    s_add_u32 s3, s3, 66060288
    buffer_store_dword v24, v26, s[12:15], s3 offen sc1
    s_waitcnt lgkmcnt(2)
    v_mfma_f32_16x16x32_bf16 v[128:131], v[48:51], v[64:67], v[128:131]
    ds_read_b128 v[76:79], v11 offset:6144
    v_mfma_f32_16x16x32_bf16 v[132:135], v[52:55], v[64:67], v[132:135]
    v_mfma_f32_16x16x32_bf16 v[136:139], v[56:59], v[64:67], v[136:139]
    v_mfma_f32_16x16x32_bf16 v[140:143], v[60:63], v[64:67], v[140:143]
    s_waitcnt lgkmcnt(2)
    v_mfma_f32_16x16x32_bf16 v[144:147], v[48:51], v[68:71], v[144:147]
    ds_read_b128 v[64:67], v11 offset:8192
    v_mfma_f32_16x16x32_bf16 v[148:151], v[52:55], v[68:71], v[148:151]
    v_mfma_f32_16x16x32_bf16 v[152:155], v[56:59], v[68:71], v[152:155]
    v_mfma_f32_16x16x32_bf16 v[156:159], v[60:63], v[68:71], v[156:159]
    s_waitcnt lgkmcnt(2)
    v_mfma_f32_16x16x32_bf16 v[160:163], v[48:51], v[72:75], v[160:163]
    ds_read_b128 v[68:71], v11 offset:10240
    v_mfma_f32_16x16x32_bf16 v[164:167], v[52:55], v[72:75], v[164:167]
    v_mfma_f32_16x16x32_bf16 v[168:171], v[56:59], v[72:75], v[168:171]
    v_mfma_f32_16x16x32_bf16 v[172:175], v[60:63], v[72:75], v[172:175]
    s_waitcnt lgkmcnt(2)
    v_mfma_f32_16x16x32_bf16 v[176:179], v[48:51], v[76:79], v[176:179]
    ds_read_b128 v[72:75], v11 offset:12288
    v_mfma_f32_16x16x32_bf16 v[180:183], v[52:55], v[76:79], v[180:183]
    v_mfma_f32_16x16x32_bf16 v[184:187], v[56:59], v[76:79], v[184:187]
    v_mfma_f32_16x16x32_bf16 v[188:191], v[60:63], v[76:79], v[188:191]
    s_waitcnt lgkmcnt(2)
    v_mfma_f32_16x16x32_bf16 v[192:195], v[48:51], v[64:67], v[192:195]
    ds_read_b128 v[76:79], v11 offset:14336
    v_mfma_f32_16x16x32_bf16 v[196:199], v[52:55], v[64:67], v[196:199]
    v_mfma_f32_16x16x32_bf16 v[200:203], v[56:59], v[64:67], v[200:203]
    v_mfma_f32_16x16x32_bf16 v[204:207], v[60:63], v[64:67], v[204:207]
    s_waitcnt lgkmcnt(0)
    s_waitcnt vmcnt(1)
    s_barrier
    ds_read_b64_tr_b16 v[32:33], v12 offset:32768
    ds_read_b64_tr_b16 v[34:35], v12 offset:33792
    v_mfma_f32_16x16x32_bf16 v[208:211], v[48:51], v[68:71], v[208:211]
    ds_read_b64_tr_b16 v[36:37], v13 offset:32768
    ds_read_b64_tr_b16 v[38:39], v13 offset:33792
    s_add_u32 m0, s41, 0
    s_add_u32 s37, s39, 512
    buffer_load_dwordx4 v2, s[4:7], s37 offen lds
    v_mfma_f32_16x16x32_bf16 v[212:215], v[52:55], v[68:71], v[212:215]
    ds_read_b64_tr_b16 v[40:41], v14 offset:32768
    ds_read_b64_tr_b16 v[42:43], v14 offset:33792
    buffer_load_dwordx4 v3, s[4:7], s37 offen offset:1024 lds
    v_mfma_f32_16x16x32_bf16 v[216:219], v[56:59], v[68:71], v[216:219]
    ds_read_b64_tr_b16 v[44:45], v15 offset:32768
    ds_read_b64_tr_b16 v[46:47], v15 offset:33792
    buffer_load_dwordx4 v4, s[4:7], s37 offen offset:2048 lds
    v_mfma_f32_16x16x32_bf16 v[220:223], v[60:63], v[68:71], v[220:223]
    ds_read_b128 v[64:67], v10 offset:32768
    buffer_load_dwordx4 v5, s[4:7], s37 offen offset:3072 lds
    v_mfma_f32_16x16x32_bf16 v[224:227], v[48:51], v[72:75], v[224:227]
    ds_read_b128 v[68:71], v10 offset:34816
    s_add_u32 m0, s42, 0
    s_add_u32 s37, s40, 2097152
    buffer_load_dwordx4 v6, s[8:11], s37 offen lds
    v_mfma_f32_16x16x32_bf16 v[228:231], v[52:55], v[72:75], v[228:231]
    buffer_load_dwordx4 v7, s[8:11], s37 offen offset:1024 lds
    v_mfma_f32_16x16x32_bf16 v[232:235], v[56:59], v[72:75], v[232:235]
    buffer_load_dwordx4 v8, s[8:11], s37 offen offset:2048 lds
    v_mfma_f32_16x16x32_bf16 v[236:239], v[60:63], v[72:75], v[236:239]
    buffer_load_dwordx4 v9, s[8:11], s37 offen offset:3072 lds
    v_mfma_f32_16x16x32_bf16 v[240:243], v[48:51], v[76:79], v[240:243]
    ds_read_b128 v[72:75], v10 offset:36864
    ds_read_b32 v90, v29 offset:0
    v_mfma_f32_16x16x32_bf16 v[244:247], v[52:55], v[76:79], v[244:247]
    ds_read_b32 v91, v29 offset:160
    v_mfma_f32_16x16x32_bf16 v[248:251], v[56:59], v[76:79], v[248:251]
    ds_read_b32 v92, v29 offset:320
    v_mfma_f32_16x16x32_bf16 v[252:255], v[60:63], v[76:79], v[252:255]
    ds_read_b32 v93, v29 offset:480
    s_waitcnt lgkmcnt(2)
    v_mfma_f32_16x16x32_bf16 v[128:131], v[32:35], v[64:67], v[128:131]
    ds_read_b128 v[76:79], v10 offset:38912
    ds_read_b32 v94, v29 offset:640
    v_mfma_f32_16x16x32_bf16 v[132:135], v[36:39], v[64:67], v[132:135]
    ds_read_b32 v95, v29 offset:800
    v_mfma_f32_16x16x32_bf16 v[136:139], v[40:43], v[64:67], v[136:139]
    ds_read_b32 v96, v29 offset:960
    v_mfma_f32_16x16x32_bf16 v[140:143], v[44:47], v[64:67], v[140:143]
    ds_read_b32 v97, v29 offset:1120
    s_waitcnt lgkmcnt(2)
    v_mfma_f32_16x16x32_bf16 v[144:147], v[32:35], v[68:71], v[144:147]
    ds_read_b128 v[64:67], v10 offset:40960
    ds_read_b32 v98, v29 offset:1280
    v_mfma_f32_16x16x32_bf16 v[148:151], v[36:39], v[68:71], v[148:151]
    ds_read_b32 v99, v29 offset:1440
    v_mfma_f32_16x16x32_bf16 v[152:155], v[40:43], v[68:71], v[152:155]
    ds_read_b32 v100, v29 offset:1600
    v_mfma_f32_16x16x32_bf16 v[156:159], v[44:47], v[68:71], v[156:159]
    ds_read_b32 v101, v29 offset:11520
    s_waitcnt lgkmcnt(2)
    v_mfma_f32_16x16x32_bf16 v[160:163], v[32:35], v[72:75], v[160:163]
    ds_read_b128 v[68:71], v10 offset:43008
    ds_read_b32 v102, v29 offset:11680
    v_mfma_f32_16x16x32_bf16 v[164:167], v[36:39], v[72:75], v[164:167]
    ds_read_b32 v103, v29 offset:11840
    v_mfma_f32_16x16x32_bf16 v[168:171], v[40:43], v[72:75], v[168:171]
    ds_read_b32 v104, v29 offset:12000
    v_mfma_f32_16x16x32_bf16 v[172:175], v[44:47], v[72:75], v[172:175]
    ds_read_b32 v105, v29 offset:12160
    s_waitcnt lgkmcnt(2)
    v_mfma_f32_16x16x32_bf16 v[176:179], v[32:35], v[76:79], v[176:179]
    ds_read_b128 v[72:75], v10 offset:45056
    ds_read_b32 v106, v29 offset:12320
    v_mfma_f32_16x16x32_bf16 v[180:183], v[36:39], v[76:79], v[180:183]
    ds_read_b32 v107, v29 offset:12480
    v_mfma_f32_16x16x32_bf16 v[184:187], v[40:43], v[76:79], v[184:187]
    ds_read_b64_tr_b16 v[48:49], v12 offset:40960
    ds_read_b64_tr_b16 v[50:51], v12 offset:41984
    ds_read_b32 v108, v29 offset:12640
    v_mfma_f32_16x16x32_bf16 v[188:191], v[44:47], v[76:79], v[188:191]
    ds_read_b64_tr_b16 v[52:53], v13 offset:40960
    ds_read_b64_tr_b16 v[54:55], v13 offset:41984
    s_lshl_b32 s3, s34, 3
    s_add_u32 s3, s3, s32
    s_mul_i32 s3, s3, 81920
    s_lshl_b32 s38, s33, 8
    s_add_u32 s3, s3, s38
    s_mov_b64 exec, 0xfffff
    buffer_load_dword v115, v115, s[24:27], s3 offen sc1
    s_mov_b64 exec, -1
    s_waitcnt lgkmcnt(6)
    v_mfma_f32_16x16x32_bf16 v[192:195], v[32:35], v[64:67], v[192:195]
    ds_read_b128 v[76:79], v10 offset:47104
    ds_read_b64_tr_b16 v[56:57], v14 offset:40960
    v_mfma_f32_16x16x32_bf16 v[196:199], v[36:39], v[64:67], v[196:199]
    ds_read_b64_tr_b16 v[58:59], v14 offset:41984
    ds_read_b64_tr_b16 v[60:61], v15 offset:40960
    v_mfma_f32_16x16x32_bf16 v[200:203], v[40:43], v[64:67], v[200:203]
    ds_read_b64_tr_b16 v[62:63], v15 offset:41984
    v_mfma_f32_16x16x32_bf16 v[204:207], v[44:47], v[64:67], v[204:207]
    s_waitcnt lgkmcnt(10)
    v_mfma_f32_16x16x32_bf16 v[208:211], v[32:35], v[68:71], v[208:211]
    ds_read_b128 v[64:67], v11 offset:32768
    v_mfma_f32_16x16x32_bf16 v[212:215], v[36:39], v[68:71], v[212:215]
    v_mfma_f32_16x16x32_bf16 v[216:219], v[40:43], v[68:71], v[216:219]
    v_mfma_f32_16x16x32_bf16 v[220:223], v[44:47], v[68:71], v[220:223]
    s_waitcnt lgkmcnt(10)
    v_mfma_f32_16x16x32_bf16 v[224:227], v[32:35], v[72:75], v[224:227]
    ds_read_b128 v[68:71], v11 offset:34816
    v_lshlrev_b32 v80, 16, v110
    v_and_b32 v81, 0xffff0000, v110
    v_lshlrev_b32 v82, 16, v111
    v_and_b32 v83, 0xffff0000, v111
    v_lshlrev_b32 v84, 16, v112
    v_and_b32 v85, 0xffff0000, v112
    v_mfma_f32_16x16x32_bf16 v[228:231], v[36:39], v[72:75], v[228:231]
    v_lshlrev_b32 v86, 16, v113
    v_and_b32 v87, 0xffff0000, v113
    v_mfma_f32_16x16x32_bf16 v[232:235], v[40:43], v[72:75], v[232:235]
    v_lshlrev_b32 v110, 16, v90
    v_and_b32 v88, 0xffff0000, v90
    v_mfma_f32_16x16x32_bf16 v[236:239], v[44:47], v[72:75], v[236:239]
    v_lshlrev_b32 v111, 16, v91
    v_and_b32 v89, 0xffff0000, v91
    s_waitcnt lgkmcnt(6)
    v_mfma_f32_16x16x32_bf16 v[240:243], v[32:35], v[76:79], v[240:243]
    ds_read_b128 v[72:75], v11 offset:36864
    v_lshlrev_b32 v112, 16, v92
    v_and_b32 v109, 0xffff0000, v92
    v_mfma_f32_16x16x32_bf16 v[244:247], v[36:39], v[76:79], v[244:247]
    v_lshlrev_b32 v113, 16, v93
    v_and_b32 v114, 0xffff0000, v93
    v_mfma_f32_16x16x32_bf16 v[248:251], v[40:43], v[76:79], v[248:251]
    v_mul_f32 v24, v110, v83
    v_mul_f32 v25, v88, v87
    v_mfma_f32_16x16x32_bf16 v[252:255], v[44:47], v[76:79], v[252:255]
    v_fmac_f32 v24, v111, v82
    v_fmac_f32 v25, v89, v86
    s_waitcnt lgkmcnt(2)
    v_mfma_f32_16x16x32_bf16 v[128:131], v[48:51], v[64:67], v[128:131]
    ds_read_b128 v[76:79], v11 offset:38912
    v_fmac_f32 v24, v112, v81
    v_fmac_f32 v25, v109, v85
    v_mfma_f32_16x16x32_bf16 v[132:135], v[52:55], v[64:67], v[132:135]
    v_fmac_f32 v24, v113, v80
    v_fmac_f32 v25, v114, v84
    v_mfma_f32_16x16x32_bf16 v[136:139], v[56:59], v[64:67], v[136:139]
    v_lshlrev_b32 v27, 16, v101
    v_and_b32 v28, 0xffff0000, v101
    v_mfma_f32_16x16x32_bf16 v[140:143], v[60:63], v[64:67], v[140:143]
    v_mul_f32 v118, v24, v27
    v_mul_f32 v119, v25, v28
    s_waitcnt lgkmcnt(2)
    v_mfma_f32_16x16x32_bf16 v[144:147], v[48:51], v[68:71], v[144:147]
    ds_read_b128 v[64:67], v11 offset:40960
    v_lshlrev_b32 v110, 16, v94
    v_and_b32 v88, 0xffff0000, v94
    v_mfma_f32_16x16x32_bf16 v[148:151], v[52:55], v[68:71], v[148:151]
    v_mul_f32 v24, v111, v83
    v_mul_f32 v25, v89, v87
    v_mfma_f32_16x16x32_bf16 v[152:155], v[56:59], v[68:71], v[152:155]
    v_fmac_f32 v24, v112, v82
    v_fmac_f32 v25, v109, v86
    v_mfma_f32_16x16x32_bf16 v[156:159], v[60:63], v[68:71], v[156:159]
    v_fmac_f32 v24, v113, v81
    v_fmac_f32 v25, v114, v85
    s_waitcnt lgkmcnt(2)
    v_mfma_f32_16x16x32_bf16 v[160:163], v[48:51], v[72:75], v[160:163]
    ds_read_b128 v[68:71], v11 offset:43008
    v_fmac_f32 v24, v110, v80
    v_fmac_f32 v25, v88, v84
    v_mfma_f32_16x16x32_bf16 v[164:167], v[52:55], v[72:75], v[164:167]
    v_lshlrev_b32 v27, 16, v102
    v_and_b32 v28, 0xffff0000, v102
    v_mfma_f32_16x16x32_bf16 v[168:171], v[56:59], v[72:75], v[168:171]
    v_mul_f32 v24, v24, v27
    v_mul_f32 v25, v25, v28
    v_mfma_f32_16x16x32_bf16 v[172:175], v[60:63], v[72:75], v[172:175]
    v_cvt_pk_bf16_f32 v120, v118, v24
    v_cvt_pk_bf16_f32 v124, v119, v25
    s_waitcnt lgkmcnt(2)
    v_mfma_f32_16x16x32_bf16 v[176:179], v[48:51], v[76:79], v[176:179]
    ds_read_b128 v[72:75], v11 offset:45056
    v_lshlrev_b32 v111, 16, v95
    v_and_b32 v89, 0xffff0000, v95
    v_mfma_f32_16x16x32_bf16 v[180:183], v[52:55], v[76:79], v[180:183]
    v_mul_f32 v24, v112, v83
    v_mul_f32 v25, v109, v87
    v_mfma_f32_16x16x32_bf16 v[184:187], v[56:59], v[76:79], v[184:187]
    v_fmac_f32 v24, v113, v82
    v_fmac_f32 v25, v114, v86
    v_mfma_f32_16x16x32_bf16 v[188:191], v[60:63], v[76:79], v[188:191]
    v_fmac_f32 v24, v110, v81
    v_fmac_f32 v25, v88, v85
    s_waitcnt lgkmcnt(2)
    v_mfma_f32_16x16x32_bf16 v[192:195], v[48:51], v[64:67], v[192:195]
    ds_read_b128 v[76:79], v11 offset:47104
    v_fmac_f32 v24, v111, v80
    v_fmac_f32 v25, v89, v84
    v_mfma_f32_16x16x32_bf16 v[196:199], v[52:55], v[64:67], v[196:199]
    v_lshlrev_b32 v27, 16, v103
    v_and_b32 v28, 0xffff0000, v103
    v_mfma_f32_16x16x32_bf16 v[200:203], v[56:59], v[64:67], v[200:203]
    v_mul_f32 v118, v24, v27
    v_mul_f32 v119, v25, v28
    v_mfma_f32_16x16x32_bf16 v[204:207], v[60:63], v[64:67], v[204:207]
    s_waitcnt lgkmcnt(0)
    s_waitcnt vmcnt(1)
    s_barrier
    ds_read_b64_tr_b16 v[32:33], v12 offset:0
    ds_read_b64_tr_b16 v[34:35], v12 offset:1024
    v_mfma_f32_16x16x32_bf16 v[208:211], v[48:51], v[68:71], v[208:211]
    ds_read_b64_tr_b16 v[36:37], v13 offset:0
    ds_read_b64_tr_b16 v[38:39], v13 offset:1024
    s_add_u32 m0, s41, 32768
    s_add_u32 s37, s39, 640
    buffer_load_dwordx4 v2, s[4:7], s37 offen lds
    v_mfma_f32_16x16x32_bf16 v[212:215], v[52:55], v[68:71], v[212:215]
    ds_read_b64_tr_b16 v[40:41], v14 offset:0
    ds_read_b64_tr_b16 v[42:43], v14 offset:1024
    buffer_load_dwordx4 v3, s[4:7], s37 offen offset:1024 lds
    v_mfma_f32_16x16x32_bf16 v[216:219], v[56:59], v[68:71], v[216:219]
    ds_read_b64_tr_b16 v[44:45], v15 offset:0
    ds_read_b64_tr_b16 v[46:47], v15 offset:1024
    buffer_load_dwordx4 v4, s[4:7], s37 offen offset:2048 lds
    v_mfma_f32_16x16x32_bf16 v[220:223], v[60:63], v[68:71], v[220:223]
    ds_read_b128 v[64:67], v10 offset:0
    buffer_load_dwordx4 v5, s[4:7], s37 offen offset:3072 lds
    v_mfma_f32_16x16x32_bf16 v[224:227], v[48:51], v[72:75], v[224:227]
    ds_read_b128 v[68:71], v10 offset:2048
    s_add_u32 m0, s42, 32768
    s_add_u32 s37, s40, 2621440
    buffer_load_dwordx4 v6, s[8:11], s37 offen lds
    v_mfma_f32_16x16x32_bf16 v[228:231], v[52:55], v[72:75], v[228:231]
    buffer_load_dwordx4 v7, s[8:11], s37 offen offset:1024 lds
    v_mfma_f32_16x16x32_bf16 v[232:235], v[56:59], v[72:75], v[232:235]
    buffer_load_dwordx4 v8, s[8:11], s37 offen offset:2048 lds
    v_mfma_f32_16x16x32_bf16 v[236:239], v[60:63], v[72:75], v[236:239]
    buffer_load_dwordx4 v9, s[8:11], s37 offen offset:3072 lds
    v_mfma_f32_16x16x32_bf16 v[240:243], v[48:51], v[76:79], v[240:243]
    ds_read_b128 v[72:75], v10 offset:4096
    s_mov_b32 s76, s72
    s_mov_b32 s77, s73
    s_mov_b32 s78, 5242880
    s_lshr_b32 s3, s2, 1
    s_lshl_b32 s3, s3, 5
    s_lshl_b32 s38, s32, 2
    s_add_u32 s3, s3, s38
    s_mul_i32 s3, s3, 1280
    s_and_b32 s48, s2, 1
    s_mul_i32 s48, s48, 640
    s_add_u32 s3, s3, s48
    s_mul_i32 s38, s38, 672
    s_mov_b32 exec_hi, 0xff
    s_add_u32 m0, s38, 131072
    s_add_u32 s48, s3, 0
    buffer_load_dwordx4 v1, s[76:79], s48 offen lds
    s_mov_b32 exec_hi, -1
    v_mfma_f32_16x16x32_bf16 v[244:247], v[52:55], v[76:79], v[244:247]
    s_mov_b32 s76, s72
    s_mov_b32 s77, s73
    s_mov_b32 s78, 5242880
    s_lshr_b32 s3, s2, 1
    s_lshl_b32 s3, s3, 5
    s_lshl_b32 s38, s32, 2
    s_add_u32 s3, s3, s38
    s_mul_i32 s3, s3, 1280
    s_and_b32 s48, s2, 1
    s_mul_i32 s48, s48, 640
    s_add_u32 s3, s3, s48
    s_mul_i32 s38, s38, 672
    s_mov_b32 exec_hi, 0xff
    s_add_u32 m0, s38, 131744
    s_add_u32 s48, s3, 1280
    buffer_load_dwordx4 v1, s[76:79], s48 offen lds
    s_mov_b32 exec_hi, -1
    v_mfma_f32_16x16x32_bf16 v[248:251], v[56:59], v[76:79], v[248:251]
    s_mov_b32 s76, s72
    s_mov_b32 s77, s73
    s_mov_b32 s78, 5242880
    s_lshr_b32 s3, s2, 1
    s_lshl_b32 s3, s3, 5
    s_lshl_b32 s38, s32, 2
    s_add_u32 s3, s3, s38
    s_mul_i32 s3, s3, 1280
    s_and_b32 s48, s2, 1
    s_mul_i32 s48, s48, 640
    s_add_u32 s3, s3, s48
    s_mul_i32 s38, s38, 672
    s_mov_b32 exec_hi, 0xff
    s_add_u32 m0, s38, 132416
    s_add_u32 s48, s3, 2560
    buffer_load_dwordx4 v1, s[76:79], s48 offen lds
    s_mov_b32 exec_hi, -1
    v_mfma_f32_16x16x32_bf16 v[252:255], v[60:63], v[76:79], v[252:255]
    s_mov_b32 s76, s72
    s_mov_b32 s77, s73
    s_mov_b32 s78, 5242880
    s_lshr_b32 s3, s2, 1
    s_lshl_b32 s3, s3, 5
    s_lshl_b32 s38, s32, 2
    s_add_u32 s3, s3, s38
    s_mul_i32 s3, s3, 1280
    s_and_b32 s48, s2, 1
    s_mul_i32 s48, s48, 640
    s_add_u32 s3, s3, s48
    s_mul_i32 s38, s38, 672
    s_mov_b32 exec_hi, 0xff
    s_add_u32 m0, s38, 133088
    s_add_u32 s48, s3, 3840
    buffer_load_dwordx4 v1, s[76:79], s48 offen lds
    s_mov_b32 exec_hi, -1
    s_waitcnt lgkmcnt(2)
    v_mfma_f32_16x16x32_bf16 v[128:131], v[32:35], v[64:67], v[128:131]
    ds_read_b128 v[76:79], v10 offset:6144
    v_lshlrev_b32 v112, 16, v96
    v_and_b32 v109, 0xffff0000, v96
    v_mfma_f32_16x16x32_bf16 v[132:135], v[36:39], v[64:67], v[132:135]
    v_mul_f32 v24, v113, v83
    v_mul_f32 v25, v114, v87
    v_mfma_f32_16x16x32_bf16 v[136:139], v[40:43], v[64:67], v[136:139]
    v_fmac_f32 v24, v110, v82
    v_fmac_f32 v25, v88, v86
    v_mfma_f32_16x16x32_bf16 v[140:143], v[44:47], v[64:67], v[140:143]
    v_fmac_f32 v24, v111, v81
    v_fmac_f32 v25, v89, v85
    s_waitcnt lgkmcnt(2)
    v_mfma_f32_16x16x32_bf16 v[144:147], v[32:35], v[68:71], v[144:147]
    ds_read_b128 v[64:67], v10 offset:8192
    v_fmac_f32 v24, v112, v80
    v_fmac_f32 v25, v109, v84
    v_mfma_f32_16x16x32_bf16 v[148:151], v[36:39], v[68:71], v[148:151]
    v_lshlrev_b32 v27, 16, v104
    v_and_b32 v28, 0xffff0000, v104
    v_mfma_f32_16x16x32_bf16 v[152:155], v[40:43], v[68:71], v[152:155]
    v_mul_f32 v24, v24, v27
    v_mul_f32 v25, v25, v28
    v_mfma_f32_16x16x32_bf16 v[156:159], v[44:47], v[68:71], v[156:159]
    v_cvt_pk_bf16_f32 v121, v118, v24
    v_cvt_pk_bf16_f32 v125, v119, v25
    s_waitcnt lgkmcnt(2)
    v_mfma_f32_16x16x32_bf16 v[160:163], v[32:35], v[72:75], v[160:163]
    ds_read_b128 v[68:71], v10 offset:10240
    v_lshlrev_b32 v113, 16, v97
    v_and_b32 v114, 0xffff0000, v97
    v_mfma_f32_16x16x32_bf16 v[164:167], v[36:39], v[72:75], v[164:167]
    v_mul_f32 v24, v110, v83
    v_mul_f32 v25, v88, v87
    v_mfma_f32_16x16x32_bf16 v[168:171], v[40:43], v[72:75], v[168:171]
    v_fmac_f32 v24, v111, v82
    v_fmac_f32 v25, v89, v86
    v_mfma_f32_16x16x32_bf16 v[172:175], v[44:47], v[72:75], v[172:175]
    v_fmac_f32 v24, v112, v81
    v_fmac_f32 v25, v109, v85
    s_waitcnt lgkmcnt(2)
    v_mfma_f32_16x16x32_bf16 v[176:179], v[32:35], v[76:79], v[176:179]
    ds_read_b128 v[72:75], v10 offset:12288
    v_fmac_f32 v24, v113, v80
    v_fmac_f32 v25, v114, v84
    v_mfma_f32_16x16x32_bf16 v[180:183], v[36:39], v[76:79], v[180:183]
    v_lshlrev_b32 v27, 16, v105
    v_and_b32 v28, 0xffff0000, v105
    v_mfma_f32_16x16x32_bf16 v[184:187], v[40:43], v[76:79], v[184:187]
    ds_read_b64_tr_b16 v[48:49], v12 offset:8192
    ds_read_b64_tr_b16 v[50:51], v12 offset:9216
    v_mul_f32 v118, v24, v27
    v_mul_f32 v119, v25, v28
    v_mfma_f32_16x16x32_bf16 v[188:191], v[44:47], v[76:79], v[188:191]
    ds_read_b64_tr_b16 v[52:53], v13 offset:8192
    ds_read_b64_tr_b16 v[54:55], v13 offset:9216
    v_lshlrev_b32 v110, 16, v98
    v_and_b32 v88, 0xffff0000, v98
    s_waitcnt lgkmcnt(6)
    v_mfma_f32_16x16x32_bf16 v[192:195], v[32:35], v[64:67], v[192:195]
    ds_read_b128 v[76:79], v10 offset:14336
    ds_read_b64_tr_b16 v[56:57], v14 offset:8192
    v_mul_f32 v24, v111, v83
    v_mul_f32 v25, v89, v87
    v_mfma_f32_16x16x32_bf16 v[196:199], v[36:39], v[64:67], v[196:199]
    ds_read_b64_tr_b16 v[58:59], v14 offset:9216
    ds_read_b64_tr_b16 v[60:61], v15 offset:8192
    v_fmac_f32 v24, v112, v82
    v_fmac_f32 v25, v109, v86
    v_mfma_f32_16x16x32_bf16 v[200:203], v[40:43], v[64:67], v[200:203]
    ds_read_b64_tr_b16 v[62:63], v15 offset:9216
    v_fmac_f32 v24, v113, v81
    v_fmac_f32 v25, v114, v85
    v_mfma_f32_16x16x32_bf16 v[204:207], v[44:47], v[64:67], v[204:207]
    v_fmac_f32 v24, v110, v80
    v_fmac_f32 v25, v88, v84
    s_waitcnt lgkmcnt(10)
    v_mfma_f32_16x16x32_bf16 v[208:211], v[32:35], v[68:71], v[208:211]
    ds_read_b128 v[64:67], v11 offset:0
    v_lshlrev_b32 v27, 16, v106
    v_and_b32 v28, 0xffff0000, v106
    v_mfma_f32_16x16x32_bf16 v[212:215], v[36:39], v[68:71], v[212:215]
    v_mul_f32 v24, v24, v27
    v_mul_f32 v25, v25, v28
    v_mfma_f32_16x16x32_bf16 v[216:219], v[40:43], v[68:71], v[216:219]
    v_cvt_pk_bf16_f32 v122, v118, v24
    v_cvt_pk_bf16_f32 v126, v119, v25
    v_mfma_f32_16x16x32_bf16 v[220:223], v[44:47], v[68:71], v[220:223]
    v_lshlrev_b32 v111, 16, v99
    v_and_b32 v89, 0xffff0000, v99
    s_waitcnt lgkmcnt(10)
    v_mfma_f32_16x16x32_bf16 v[224:227], v[32:35], v[72:75], v[224:227]
    ds_read_b128 v[68:71], v11 offset:2048
    v_mul_f32 v24, v112, v83
    v_mul_f32 v25, v109, v87
    v_mfma_f32_16x16x32_bf16 v[228:231], v[36:39], v[72:75], v[228:231]
    v_fmac_f32 v24, v113, v82
    v_fmac_f32 v25, v114, v86
    v_mfma_f32_16x16x32_bf16 v[232:235], v[40:43], v[72:75], v[232:235]
    v_fmac_f32 v24, v110, v81
    v_fmac_f32 v25, v88, v85
    v_mfma_f32_16x16x32_bf16 v[236:239], v[44:47], v[72:75], v[236:239]
    v_fmac_f32 v24, v111, v80
    v_fmac_f32 v25, v89, v84
    s_waitcnt lgkmcnt(6)
    v_mfma_f32_16x16x32_bf16 v[240:243], v[32:35], v[76:79], v[240:243]
    ds_read_b128 v[72:75], v11 offset:4096
    v_lshlrev_b32 v27, 16, v107
    v_and_b32 v28, 0xffff0000, v107
    v_mfma_f32_16x16x32_bf16 v[244:247], v[36:39], v[76:79], v[244:247]
    v_mul_f32 v118, v24, v27
    v_mul_f32 v119, v25, v28
    v_mfma_f32_16x16x32_bf16 v[248:251], v[40:43], v[76:79], v[248:251]
    v_lshlrev_b32 v112, 16, v100
    v_and_b32 v109, 0xffff0000, v100
    v_mfma_f32_16x16x32_bf16 v[252:255], v[44:47], v[76:79], v[252:255]
    v_mul_f32 v24, v113, v83
    v_mul_f32 v25, v114, v87
    s_waitcnt lgkmcnt(2)
    v_mfma_f32_16x16x32_bf16 v[128:131], v[48:51], v[64:67], v[128:131]
    ds_read_b128 v[76:79], v11 offset:6144
    v_fmac_f32 v24, v110, v82
    v_fmac_f32 v25, v88, v86
    v_mfma_f32_16x16x32_bf16 v[132:135], v[52:55], v[64:67], v[132:135]
    v_fmac_f32 v24, v111, v81
    v_fmac_f32 v25, v89, v85
    v_mfma_f32_16x16x32_bf16 v[136:139], v[56:59], v[64:67], v[136:139]
    v_fmac_f32 v24, v112, v80
    v_fmac_f32 v25, v109, v84
    v_mfma_f32_16x16x32_bf16 v[140:143], v[60:63], v[64:67], v[140:143]
    v_lshlrev_b32 v27, 16, v108
    v_and_b32 v28, 0xffff0000, v108
    s_waitcnt lgkmcnt(2)
    v_mfma_f32_16x16x32_bf16 v[144:147], v[48:51], v[68:71], v[144:147]
    ds_read_b128 v[64:67], v11 offset:8192
    v_mul_f32 v24, v24, v27
    v_mul_f32 v25, v25, v28
    v_mfma_f32_16x16x32_bf16 v[148:151], v[52:55], v[68:71], v[148:151]
    v_cvt_pk_bf16_f32 v123, v118, v24
    v_cvt_pk_bf16_f32 v127, v119, v25
    v_mfma_f32_16x16x32_bf16 v[152:155], v[56:59], v[68:71], v[152:155]
    s_cmp_lt_u32 s32, 5
    s_cselect_b64 exec, -1, 0
    ds_write_b128 v23, v[120:123]
    ds_write_b128 v23, v[124:127] offset:128
    s_mov_b64 exec, -1
    v_lshrrev_b32 v26, 3, v0
    v_mfma_f32_16x16x32_bf16 v[156:159], v[60:63], v[68:71], v[156:159]
    v_and_b32 v27, 7, v0
    v_lshrrev_b32 v28, 4, v0
    s_waitcnt lgkmcnt(2)
    v_mfma_f32_16x16x32_bf16 v[160:163], v[48:51], v[72:75], v[160:163]
    ds_read_b128 v[68:71], v11 offset:10240
    v_xor_b32 v28, v28, v27
    v_lshlrev_b32 v28, 4, v28
    v_mfma_f32_16x16x32_bf16 v[164:167], v[52:55], v[72:75], v[164:167]
    v_lshl_add_u32 v24, v26, 7, v28
    v_lshlrev_b32 v27, 4, v27
    v_mfma_f32_16x16x32_bf16 v[168:171], v[56:59], v[72:75], v[168:171]
    v_mul_u32_u24 v25, 4224, v26
    v_add_u32 v25, v25, v27
    v_mfma_f32_16x16x32_bf16 v[172:175], v[60:63], v[72:75], v[172:175]
    s_and_b32 s3, s32, 1
    s_lshl_b32 s3, s3, 6
    v_xor_b32 v24, s3, v24
    s_lshl_b32 s3, s32, 10
    s_add_u32 s3, s3, 153600
    v_add_u32 v24, s3, v24
    s_waitcnt lgkmcnt(2)
    v_mfma_f32_16x16x32_bf16 v[176:179], v[48:51], v[76:79], v[176:179]
    ds_read_b128 v[72:75], v11 offset:12288
    v_mfma_f32_16x16x32_bf16 v[180:183], v[52:55], v[76:79], v[180:183]
    v_mfma_f32_16x16x32_bf16 v[184:187], v[56:59], v[76:79], v[184:187]
    v_mfma_f32_16x16x32_bf16 v[188:191], v[60:63], v[76:79], v[188:191]
    s_waitcnt lgkmcnt(2)
    v_mfma_f32_16x16x32_bf16 v[192:195], v[48:51], v[64:67], v[192:195]
    ds_read_b128 v[76:79], v11 offset:14336
    v_mfma_f32_16x16x32_bf16 v[196:199], v[52:55], v[64:67], v[196:199]
    v_mfma_f32_16x16x32_bf16 v[200:203], v[56:59], v[64:67], v[200:203]
    v_mfma_f32_16x16x32_bf16 v[204:207], v[60:63], v[64:67], v[204:207]
    s_waitcnt lgkmcnt(0)
    s_waitcnt vmcnt(4)
    s_barrier
    ds_read_b64_tr_b16 v[32:33], v12 offset:32768
    ds_read_b64_tr_b16 v[34:35], v12 offset:33792
    v_mfma_f32_16x16x32_bf16 v[208:211], v[48:51], v[68:71], v[208:211]
    ds_read_b64_tr_b16 v[36:37], v13 offset:32768
    ds_read_b64_tr_b16 v[38:39], v13 offset:33792
    s_add_u32 m0, s41, 0
    s_add_u32 s37, s39, 768
    buffer_load_dwordx4 v2, s[4:7], s37 offen lds
    v_mfma_f32_16x16x32_bf16 v[212:215], v[52:55], v[68:71], v[212:215]
    ds_read_b64_tr_b16 v[40:41], v14 offset:32768
    ds_read_b64_tr_b16 v[42:43], v14 offset:33792
    buffer_load_dwordx4 v3, s[4:7], s37 offen offset:1024 lds
    v_mfma_f32_16x16x32_bf16 v[216:219], v[56:59], v[68:71], v[216:219]
    ds_read_b64_tr_b16 v[44:45], v15 offset:32768
    ds_read_b64_tr_b16 v[46:47], v15 offset:33792
    buffer_load_dwordx4 v4, s[4:7], s37 offen offset:2048 lds
    v_mfma_f32_16x16x32_bf16 v[220:223], v[60:63], v[68:71], v[220:223]
    ds_read_b128 v[64:67], v10 offset:32768
    buffer_load_dwordx4 v5, s[4:7], s37 offen offset:3072 lds
    v_mfma_f32_16x16x32_bf16 v[224:227], v[48:51], v[72:75], v[224:227]
    ds_read_b128 v[68:71], v10 offset:34816
    s_add_u32 m0, s42, 0
    s_add_u32 s37, s40, 3145728
    buffer_load_dwordx4 v6, s[8:11], s37 offen lds
    v_mfma_f32_16x16x32_bf16 v[228:231], v[52:55], v[72:75], v[228:231]
    buffer_load_dwordx4 v7, s[8:11], s37 offen offset:1024 lds
    v_mfma_f32_16x16x32_bf16 v[232:235], v[56:59], v[72:75], v[232:235]
    buffer_load_dwordx4 v8, s[8:11], s37 offen offset:2048 lds
    v_mfma_f32_16x16x32_bf16 v[236:239], v[60:63], v[72:75], v[236:239]
    buffer_load_dwordx4 v9, s[8:11], s37 offen offset:3072 lds
    v_mfma_f32_16x16x32_bf16 v[240:243], v[48:51], v[76:79], v[240:243]
    ds_read_b128 v[72:75], v10 offset:36864
    s_mov_b32 s76, s70
    s_mov_b32 s77, s71
    s_mov_b32 s78, 2621440
    s_lshr_b32 s3, s2, 1
    s_mul_i32 s3, s3, 5
    s_and_b32 s38, s2, 1
    s_mul_i32 s38, s38, 3
    s_add_u32 s3, s3, s38
    s_add_u32 s3, s3, s32
    s_lshl_b32 s3, s3, 12
    s_cmp_ge_u32 s32, 3
    s_cselect_b32 s3, 0x80000000, s3
    v_lshlrev_b32 v29, 7, v0
    s_mov_b32 exec_hi, 0
    buffer_load_dword v29, v29, s[76:79], s3 offen sc1
    s_mov_b32 exec_hi, -1
    v_mfma_f32_16x16x32_bf16 v[244:247], v[52:55], v[76:79], v[244:247]
    v_mfma_f32_16x16x32_bf16 v[248:251], v[56:59], v[76:79], v[248:251]
    v_mfma_f32_16x16x32_bf16 v[252:255], v[60:63], v[76:79], v[252:255]
    s_waitcnt lgkmcnt(2)
    v_mfma_f32_16x16x32_bf16 v[128:131], v[32:35], v[64:67], v[128:131]
    ds_read_b128 v[76:79], v10 offset:38912
    v_mfma_f32_16x16x32_bf16 v[132:135], v[36:39], v[64:67], v[132:135]
    v_mfma_f32_16x16x32_bf16 v[136:139], v[40:43], v[64:67], v[136:139]
    v_mfma_f32_16x16x32_bf16 v[140:143], v[44:47], v[64:67], v[140:143]
    s_waitcnt lgkmcnt(2)
    v_mfma_f32_16x16x32_bf16 v[144:147], v[32:35], v[68:71], v[144:147]
    ds_read_b128 v[64:67], v10 offset:40960
    v_mfma_f32_16x16x32_bf16 v[148:151], v[36:39], v[68:71], v[148:151]
    v_mfma_f32_16x16x32_bf16 v[152:155], v[40:43], v[68:71], v[152:155]
    v_mfma_f32_16x16x32_bf16 v[156:159], v[44:47], v[68:71], v[156:159]
    s_waitcnt lgkmcnt(2)
    v_mfma_f32_16x16x32_bf16 v[160:163], v[32:35], v[72:75], v[160:163]
    ds_read_b128 v[68:71], v10 offset:43008
    v_mfma_f32_16x16x32_bf16 v[164:167], v[36:39], v[72:75], v[164:167]
    v_mfma_f32_16x16x32_bf16 v[168:171], v[40:43], v[72:75], v[168:171]
    v_mfma_f32_16x16x32_bf16 v[172:175], v[44:47], v[72:75], v[172:175]
    s_waitcnt lgkmcnt(2)
    v_mfma_f32_16x16x32_bf16 v[176:179], v[32:35], v[76:79], v[176:179]
    ds_read_b128 v[72:75], v10 offset:45056
    v_mfma_f32_16x16x32_bf16 v[180:183], v[36:39], v[76:79], v[180:183]
    v_mfma_f32_16x16x32_bf16 v[184:187], v[40:43], v[76:79], v[184:187]
    ds_read_b64_tr_b16 v[48:49], v12 offset:40960
    ds_read_b64_tr_b16 v[50:51], v12 offset:41984
    v_mfma_f32_16x16x32_bf16 v[188:191], v[44:47], v[76:79], v[188:191]
    ds_read_b64_tr_b16 v[52:53], v13 offset:40960
    ds_read_b64_tr_b16 v[54:55], v13 offset:41984
    s_waitcnt lgkmcnt(6)
    v_mfma_f32_16x16x32_bf16 v[192:195], v[32:35], v[64:67], v[192:195]
    ds_read_b128 v[76:79], v10 offset:47104
    ds_read_b64_tr_b16 v[56:57], v14 offset:40960
    v_mfma_f32_16x16x32_bf16 v[196:199], v[36:39], v[64:67], v[196:199]
    ds_read_b64_tr_b16 v[58:59], v14 offset:41984
    ds_read_b64_tr_b16 v[60:61], v15 offset:40960
    v_mfma_f32_16x16x32_bf16 v[200:203], v[40:43], v[64:67], v[200:203]
    ds_read_b64_tr_b16 v[62:63], v15 offset:41984
    v_mfma_f32_16x16x32_bf16 v[204:207], v[44:47], v[64:67], v[204:207]
    s_waitcnt lgkmcnt(10)
    v_mfma_f32_16x16x32_bf16 v[208:211], v[32:35], v[68:71], v[208:211]
    ds_read_b128 v[64:67], v11 offset:32768
    v_mfma_f32_16x16x32_bf16 v[212:215], v[36:39], v[68:71], v[212:215]
    v_mfma_f32_16x16x32_bf16 v[216:219], v[40:43], v[68:71], v[216:219]
    v_mfma_f32_16x16x32_bf16 v[220:223], v[44:47], v[68:71], v[220:223]
    s_waitcnt lgkmcnt(10)
    v_mfma_f32_16x16x32_bf16 v[224:227], v[32:35], v[72:75], v[224:227]
    ds_read_b128 v[68:71], v11 offset:34816
    v_mfma_f32_16x16x32_bf16 v[228:231], v[36:39], v[72:75], v[228:231]
    v_mfma_f32_16x16x32_bf16 v[232:235], v[40:43], v[72:75], v[232:235]
    v_mfma_f32_16x16x32_bf16 v[236:239], v[44:47], v[72:75], v[236:239]
    s_waitcnt lgkmcnt(6)
    v_mfma_f32_16x16x32_bf16 v[240:243], v[32:35], v[76:79], v[240:243]
    ds_read_b128 v[72:75], v11 offset:36864
    v_mfma_f32_16x16x32_bf16 v[244:247], v[36:39], v[76:79], v[244:247]
    v_mfma_f32_16x16x32_bf16 v[248:251], v[40:43], v[76:79], v[248:251]
    v_mfma_f32_16x16x32_bf16 v[252:255], v[44:47], v[76:79], v[252:255]
    s_waitcnt lgkmcnt(2)
    v_mfma_f32_16x16x32_bf16 v[128:131], v[48:51], v[64:67], v[128:131]
    ds_read_b128 v[76:79], v11 offset:38912
    v_mfma_f32_16x16x32_bf16 v[132:135], v[52:55], v[64:67], v[132:135]
    v_mfma_f32_16x16x32_bf16 v[136:139], v[56:59], v[64:67], v[136:139]
    v_mfma_f32_16x16x32_bf16 v[140:143], v[60:63], v[64:67], v[140:143]
    s_waitcnt lgkmcnt(2)
    v_mfma_f32_16x16x32_bf16 v[144:147], v[48:51], v[68:71], v[144:147]
    ds_read_b128 v[64:67], v11 offset:40960
    v_mfma_f32_16x16x32_bf16 v[148:151], v[52:55], v[68:71], v[148:151]
    v_mfma_f32_16x16x32_bf16 v[152:155], v[56:59], v[68:71], v[152:155]
    v_mfma_f32_16x16x32_bf16 v[156:159], v[60:63], v[68:71], v[156:159]
    s_waitcnt lgkmcnt(2)
    v_mfma_f32_16x16x32_bf16 v[160:163], v[48:51], v[72:75], v[160:163]
    ds_read_b128 v[68:71], v11 offset:43008
    v_mfma_f32_16x16x32_bf16 v[164:167], v[52:55], v[72:75], v[164:167]
    v_mfma_f32_16x16x32_bf16 v[168:171], v[56:59], v[72:75], v[168:171]
    v_mfma_f32_16x16x32_bf16 v[172:175], v[60:63], v[72:75], v[172:175]
    s_waitcnt lgkmcnt(2)
    v_mfma_f32_16x16x32_bf16 v[176:179], v[48:51], v[76:79], v[176:179]
    ds_read_b128 v[72:75], v11 offset:45056
    v_mfma_f32_16x16x32_bf16 v[180:183], v[52:55], v[76:79], v[180:183]
    v_mfma_f32_16x16x32_bf16 v[184:187], v[56:59], v[76:79], v[184:187]
    v_mfma_f32_16x16x32_bf16 v[188:191], v[60:63], v[76:79], v[188:191]
    s_waitcnt lgkmcnt(2)
    v_mfma_f32_16x16x32_bf16 v[192:195], v[48:51], v[64:67], v[192:195]
    ds_read_b128 v[76:79], v11 offset:47104
    v_mfma_f32_16x16x32_bf16 v[196:199], v[52:55], v[64:67], v[196:199]
    v_mfma_f32_16x16x32_bf16 v[200:203], v[56:59], v[64:67], v[200:203]
    v_mfma_f32_16x16x32_bf16 v[204:207], v[60:63], v[64:67], v[204:207]
    s_waitcnt lgkmcnt(0)
    s_waitcnt lgkmcnt(0)
    s_waitcnt vmcnt(1)
    s_barrier
    ds_read_b64_tr_b16 v[32:33], v12 offset:0
    ds_read_b64_tr_b16 v[34:35], v12 offset:1024
    v_mfma_f32_16x16x32_bf16 v[208:211], v[48:51], v[68:71], v[208:211]
    ds_read_b64_tr_b16 v[36:37], v13 offset:0
    ds_read_b64_tr_b16 v[38:39], v13 offset:1024
    s_add_u32 m0, s41, 32768
    s_add_u32 s37, s39, 896
    buffer_load_dwordx4 v2, s[4:7], s37 offen lds
    v_mfma_f32_16x16x32_bf16 v[212:215], v[52:55], v[68:71], v[212:215]
    ds_read_b64_tr_b16 v[40:41], v14 offset:0
    ds_read_b64_tr_b16 v[42:43], v14 offset:1024
    buffer_load_dwordx4 v3, s[4:7], s37 offen offset:1024 lds
    v_mfma_f32_16x16x32_bf16 v[216:219], v[56:59], v[68:71], v[216:219]
    ds_read_b64_tr_b16 v[44:45], v15 offset:0
    ds_read_b64_tr_b16 v[46:47], v15 offset:1024
    buffer_load_dwordx4 v4, s[4:7], s37 offen offset:2048 lds
    v_mfma_f32_16x16x32_bf16 v[220:223], v[60:63], v[68:71], v[220:223]
    ds_read_b128 v[64:67], v10 offset:0
    buffer_load_dwordx4 v5, s[4:7], s37 offen offset:3072 lds
    v_mfma_f32_16x16x32_bf16 v[224:227], v[48:51], v[72:75], v[224:227]
    ds_read_b128 v[68:71], v10 offset:2048
    s_add_u32 m0, s42, 32768
    s_add_u32 s37, s40, 3670016
    buffer_load_dwordx4 v6, s[8:11], s37 offen lds
    v_mfma_f32_16x16x32_bf16 v[228:231], v[52:55], v[72:75], v[228:231]
    buffer_load_dwordx4 v7, s[8:11], s37 offen offset:1024 lds
    v_mfma_f32_16x16x32_bf16 v[232:235], v[56:59], v[72:75], v[232:235]
    buffer_load_dwordx4 v8, s[8:11], s37 offen offset:2048 lds
    v_mfma_f32_16x16x32_bf16 v[236:239], v[60:63], v[72:75], v[236:239]
    buffer_load_dwordx4 v9, s[8:11], s37 offen offset:3072 lds
    v_mfma_f32_16x16x32_bf16 v[240:243], v[48:51], v[76:79], v[240:243]
    ds_read_b128 v[72:75], v10 offset:4096
    ds_read_b64_tr_b16 v[116:117], v22 offset:0
    v_mfma_f32_16x16x32_bf16 v[244:247], v[52:55], v[76:79], v[244:247]
    ds_read_b64_tr_b16 v[118:119], v22 offset:10752
    v_mfma_f32_16x16x32_bf16 v[248:251], v[56:59], v[76:79], v[248:251]
    ds_read_b64_tr_b16 v[120:121], v22 offset:256
    v_mfma_f32_16x16x32_bf16 v[252:255], v[60:63], v[76:79], v[252:255]
    ds_read_b64_tr_b16 v[122:123], v22 offset:11008
    s_waitcnt lgkmcnt(2)
    v_mfma_f32_16x16x32_bf16 v[128:131], v[32:35], v[64:67], v[128:131]
    ds_read_b128 v[76:79], v10 offset:6144
    ds_read_b64_tr_b16 v[124:125], v22 offset:512
    v_mfma_f32_16x16x32_bf16 v[132:135], v[36:39], v[64:67], v[132:135]
    ds_read_b64_tr_b16 v[126:127], v22 offset:11264
    v_mfma_f32_16x16x32_bf16 v[136:139], v[40:43], v[64:67], v[136:139]
    ds_read_b128 v[90:93], v24
    v_mfma_f32_16x16x32_bf16 v[140:143], v[44:47], v[64:67], v[140:143]
    ds_read_b128 v[94:97], v24 offset:8192
    s_waitcnt lgkmcnt(2)
    v_mfma_f32_16x16x32_bf16 v[144:147], v[32:35], v[68:71], v[144:147]
    ds_read_b128 v[64:67], v10 offset:8192
    v_mfma_f32_16x16x32_bf16 v[148:151], v[36:39], v[68:71], v[148:151]
    v_mfma_f32_16x16x32_bf16 v[152:155], v[40:43], v[68:71], v[152:155]
    v_mfma_f32_16x16x32_bf16 v[156:159], v[44:47], v[68:71], v[156:159]
    s_waitcnt lgkmcnt(2)
    v_mfma_f32_16x16x32_bf16 v[160:163], v[32:35], v[72:75], v[160:163]
    ds_read_b128 v[68:71], v10 offset:10240
    v_mfma_f32_16x16x32_bf16 v[164:167], v[36:39], v[72:75], v[164:167]
    v_mfma_f32_16x16x32_bf16 v[168:171], v[40:43], v[72:75], v[168:171]
    v_mfma_f32_16x16x32_bf16 v[172:175], v[44:47], v[72:75], v[172:175]
    s_waitcnt lgkmcnt(2)
    v_mfma_f32_16x16x32_bf16 v[176:179], v[32:35], v[76:79], v[176:179]
    ds_read_b128 v[72:75], v10 offset:12288
    v_mfma_f32_16x16x32_bf16 v[180:183], v[36:39], v[76:79], v[180:183]
    v_mfma_f32_16x16x32_bf16 v[184:187], v[40:43], v[76:79], v[184:187]
    ds_read_b64_tr_b16 v[48:49], v12 offset:8192
    ds_read_b64_tr_b16 v[50:51], v12 offset:9216
    v_mfma_f32_16x16x32_bf16 v[188:191], v[44:47], v[76:79], v[188:191]
    ds_read_b64_tr_b16 v[52:53], v13 offset:8192
    ds_read_b64_tr_b16 v[54:55], v13 offset:9216
    s_waitcnt lgkmcnt(6)
    v_mfma_f32_16x16x32_bf16 v[192:195], v[32:35], v[64:67], v[192:195]
    ds_read_b128 v[76:79], v10 offset:14336
    ds_read_b64_tr_b16 v[56:57], v14 offset:8192
    s_and_b32 s3, s2, 1
    s_mul_i32 s3, s3, 20
    s_add_u32 s3, s3, s32
    s_mul_i32 s3, s3, 132096
    s_lshr_b32 s38, s2, 1
    s_lshl_b32 s38, s38, 10
    s_add_u32 s3, s3, s38
    s_add_u32 s48, s3, 51380224
    buffer_store_dwordx4 v[116:119], v1, s[12:15], s48 offen sc1
    v_mfma_f32_16x16x32_bf16 v[196:199], v[36:39], v[64:67], v[196:199]
    ds_read_b64_tr_b16 v[58:59], v14 offset:9216
    ds_read_b64_tr_b16 v[60:61], v15 offset:8192
    v_mfma_f32_16x16x32_bf16 v[200:203], v[40:43], v[64:67], v[200:203]
    ds_read_b64_tr_b16 v[62:63], v15 offset:9216
    v_mfma_f32_16x16x32_bf16 v[204:207], v[44:47], v[64:67], v[204:207]
    s_waitcnt lgkmcnt(10)
    v_mfma_f32_16x16x32_bf16 v[208:211], v[32:35], v[68:71], v[208:211]
    ds_read_b128 v[64:67], v11 offset:0
    v_mfma_f32_16x16x32_bf16 v[212:215], v[36:39], v[68:71], v[212:215]
    v_mfma_f32_16x16x32_bf16 v[216:219], v[40:43], v[68:71], v[216:219]
    v_mfma_f32_16x16x32_bf16 v[220:223], v[44:47], v[68:71], v[220:223]
    s_waitcnt lgkmcnt(10)
    v_mfma_f32_16x16x32_bf16 v[224:227], v[32:35], v[72:75], v[224:227]
    ds_read_b128 v[68:71], v11 offset:2048
    v_mfma_f32_16x16x32_bf16 v[228:231], v[36:39], v[72:75], v[228:231]
    v_mfma_f32_16x16x32_bf16 v[232:235], v[40:43], v[72:75], v[232:235]
    v_mfma_f32_16x16x32_bf16 v[236:239], v[44:47], v[72:75], v[236:239]
    s_waitcnt lgkmcnt(6)
    v_mfma_f32_16x16x32_bf16 v[240:243], v[32:35], v[76:79], v[240:243]
    ds_read_b128 v[72:75], v11 offset:4096
    v_mfma_f32_16x16x32_bf16 v[244:247], v[36:39], v[76:79], v[244:247]
    v_mfma_f32_16x16x32_bf16 v[248:251], v[40:43], v[76:79], v[248:251]
    v_mfma_f32_16x16x32_bf16 v[252:255], v[44:47], v[76:79], v[252:255]
    s_waitcnt lgkmcnt(2)
    v_mfma_f32_16x16x32_bf16 v[128:131], v[48:51], v[64:67], v[128:131]
    ds_read_b128 v[76:79], v11 offset:6144
    v_mfma_f32_16x16x32_bf16 v[132:135], v[52:55], v[64:67], v[132:135]
    v_mfma_f32_16x16x32_bf16 v[136:139], v[56:59], v[64:67], v[136:139]
    v_mfma_f32_16x16x32_bf16 v[140:143], v[60:63], v[64:67], v[140:143]
    s_waitcnt lgkmcnt(2)
    v_mfma_f32_16x16x32_bf16 v[144:147], v[48:51], v[68:71], v[144:147]
    ds_read_b128 v[64:67], v11 offset:8192
    s_add_u32 s48, s48, 1056768
    buffer_store_dwordx4 v[120:123], v1, s[12:15], s48 offen sc1
    v_mfma_f32_16x16x32_bf16 v[148:151], v[52:55], v[68:71], v[148:151]
    v_mfma_f32_16x16x32_bf16 v[152:155], v[56:59], v[68:71], v[152:155]
    v_mfma_f32_16x16x32_bf16 v[156:159], v[60:63], v[68:71], v[156:159]
    s_waitcnt lgkmcnt(2)
    v_mfma_f32_16x16x32_bf16 v[160:163], v[48:51], v[72:75], v[160:163]
    ds_read_b128 v[68:71], v11 offset:10240
    v_mfma_f32_16x16x32_bf16 v[164:167], v[52:55], v[72:75], v[164:167]
    v_mfma_f32_16x16x32_bf16 v[168:171], v[56:59], v[72:75], v[168:171]
    v_mfma_f32_16x16x32_bf16 v[172:175], v[60:63], v[72:75], v[172:175]
    s_waitcnt lgkmcnt(2)
    v_mfma_f32_16x16x32_bf16 v[176:179], v[48:51], v[76:79], v[176:179]
    ds_read_b128 v[72:75], v11 offset:12288
    v_mfma_f32_16x16x32_bf16 v[180:183], v[52:55], v[76:79], v[180:183]
    v_mfma_f32_16x16x32_bf16 v[184:187], v[56:59], v[76:79], v[184:187]
    v_mfma_f32_16x16x32_bf16 v[188:191], v[60:63], v[76:79], v[188:191]
    s_waitcnt lgkmcnt(2)
    v_mfma_f32_16x16x32_bf16 v[192:195], v[48:51], v[64:67], v[192:195]
    ds_read_b128 v[76:79], v11 offset:14336
    v_mfma_f32_16x16x32_bf16 v[196:199], v[52:55], v[64:67], v[196:199]
    v_mfma_f32_16x16x32_bf16 v[200:203], v[56:59], v[64:67], v[200:203]
    v_mfma_f32_16x16x32_bf16 v[204:207], v[60:63], v[64:67], v[204:207]
    s_waitcnt lgkmcnt(0)
    s_waitcnt vmcnt(2)
    s_barrier
    ds_read_b64_tr_b16 v[32:33], v12 offset:32768
    ds_read_b64_tr_b16 v[34:35], v12 offset:33792
    v_mfma_f32_16x16x32_bf16 v[208:211], v[48:51], v[68:71], v[208:211]
    ds_read_b64_tr_b16 v[36:37], v13 offset:32768
    ds_read_b64_tr_b16 v[38:39], v13 offset:33792
    s_add_u32 m0, s41, 131072
    s_add_u32 s37, s45, 0
    buffer_load_dwordx4 v16, s[20:23], s37 offen lds
    v_mfma_f32_16x16x32_bf16 v[212:215], v[52:55], v[68:71], v[212:215]
    ds_read_b64_tr_b16 v[40:41], v14 offset:32768
    ds_read_b64_tr_b16 v[42:43], v14 offset:33792
    buffer_load_dwordx4 v17, s[20:23], s37 offen offset:1024 lds
    v_mfma_f32_16x16x32_bf16 v[216:219], v[56:59], v[68:71], v[216:219]
    ds_read_b64_tr_b16 v[44:45], v15 offset:32768
    ds_read_b64_tr_b16 v[46:47], v15 offset:33792
    buffer_load_dwordx4 v18, s[20:23], s37 offen offset:2048 lds
    v_mfma_f32_16x16x32_bf16 v[220:223], v[60:63], v[68:71], v[220:223]
    ds_read_b128 v[64:67], v10 offset:32768
    buffer_load_dwordx4 v19, s[20:23], s37 offen offset:3072 lds
    v_mfma_f32_16x16x32_bf16 v[224:227], v[48:51], v[72:75], v[224:227]
    ds_read_b128 v[68:71], v10 offset:34816
    s_add_u32 m0, s52, 0
    s_add_u32 s37, s46, 0
    buffer_load_dwordx4 v20, s[24:27], s37 offen lds
    v_mfma_f32_16x16x32_bf16 v[228:231], v[52:55], v[72:75], v[228:231]
    buffer_load_dwordx4 v21, s[24:27], s37 offen offset:1024 lds
    v_mfma_f32_16x16x32_bf16 v[232:235], v[56:59], v[72:75], v[232:235]
    s_add_u32 m0, s41, 0
    s_add_u32 s37, s45, 128
    buffer_load_dwordx4 v16, s[20:23], s37 offen lds
    v_mfma_f32_16x16x32_bf16 v[236:239], v[60:63], v[72:75], v[236:239]
    buffer_load_dwordx4 v17, s[20:23], s37 offen offset:1024 lds
    v_mfma_f32_16x16x32_bf16 v[240:243], v[48:51], v[76:79], v[240:243]
    ds_read_b128 v[72:75], v10 offset:36864
    buffer_load_dwordx4 v18, s[20:23], s37 offen offset:2048 lds
    v_mfma_f32_16x16x32_bf16 v[244:247], v[52:55], v[76:79], v[244:247]
    buffer_load_dwordx4 v19, s[20:23], s37 offen offset:3072 lds
    v_mfma_f32_16x16x32_bf16 v[248:251], v[56:59], v[76:79], v[248:251]
    s_add_u32 m0, s52, 16384
    s_add_u32 s37, s46, 524288
    buffer_load_dwordx4 v20, s[24:27], s37 offen lds
    v_mfma_f32_16x16x32_bf16 v[252:255], v[60:63], v[76:79], v[252:255]
    buffer_load_dwordx4 v21, s[24:27], s37 offen offset:1024 lds
    s_waitcnt lgkmcnt(2)
    v_mfma_f32_16x16x32_bf16 v[128:131], v[32:35], v[64:67], v[128:131]
    ds_read_b128 v[76:79], v10 offset:38912
    s_bfe_u32 s38, s2, 0x10003
    s_cmp_lg_u32 s32, 2
    s_cbranch_scc1 ONLY_4
    s_cmp_lg_u32 s38, 0
    s_cbranch_scc1 ONLY_4
    v_and_b32 v31, 31, v0
    v_lshlrev_b32 v31, 2, v31
    buffer_load_dword v31, v31, s[28:31], 0 offen offset:128 sc1
ONLY_4:
    v_mfma_f32_16x16x32_bf16 v[132:135], v[36:39], v[64:67], v[132:135]
    s_add_u32 s48, s48, 1056768
    s_cmp_ge_u32 s32, 4
    s_cselect_b32 s48, 0x80000000, s48
    buffer_store_dwordx4 v[124:127], v1, s[12:15], s48 offen sc1
    v_mfma_f32_16x16x32_bf16 v[136:139], v[40:43], v[64:67], v[136:139]
    v_mfma_f32_16x16x32_bf16 v[140:143], v[44:47], v[64:67], v[140:143]
    s_waitcnt lgkmcnt(2)
    v_mfma_f32_16x16x32_bf16 v[144:147], v[32:35], v[68:71], v[144:147]
    ds_read_b128 v[64:67], v10 offset:40960
    v_mfma_f32_16x16x32_bf16 v[148:151], v[36:39], v[68:71], v[148:151]
    v_mfma_f32_16x16x32_bf16 v[152:155], v[40:43], v[68:71], v[152:155]
    v_mfma_f32_16x16x32_bf16 v[156:159], v[44:47], v[68:71], v[156:159]
    s_waitcnt lgkmcnt(2)
    v_mfma_f32_16x16x32_bf16 v[160:163], v[32:35], v[72:75], v[160:163]
    ds_read_b128 v[68:71], v10 offset:43008
    v_mfma_f32_16x16x32_bf16 v[164:167], v[36:39], v[72:75], v[164:167]
    v_mfma_f32_16x16x32_bf16 v[168:171], v[40:43], v[72:75], v[168:171]
    v_mfma_f32_16x16x32_bf16 v[172:175], v[44:47], v[72:75], v[172:175]
    s_waitcnt lgkmcnt(2)
    v_mfma_f32_16x16x32_bf16 v[176:179], v[32:35], v[76:79], v[176:179]
    ds_read_b128 v[72:75], v10 offset:45056
    s_and_b32 s3, s2, 7
    s_mul_i32 s3, s3, 337920
    s_lshr_b32 s38, s2, 3
    s_lshl_b32 s38, s38, 7
    s_add_u32 s3, s3, s38
    s_mul_i32 s38, s32, 33792
    s_add_u32 s3, s3, s38
    s_add_u32 s48, s3, 58720256
    buffer_store_dwordx4 v[90:93], v25, s[12:15], s48 offen sc1
    v_mfma_f32_16x16x32_bf16 v[180:183], v[36:39], v[76:79], v[180:183]
    v_mfma_f32_16x16x32_bf16 v[184:187], v[40:43], v[76:79], v[184:187]
    ds_read_b64_tr_b16 v[48:49], v12 offset:40960
    ds_read_b64_tr_b16 v[50:51], v12 offset:41984
    v_mfma_f32_16x16x32_bf16 v[188:191], v[44:47], v[76:79], v[188:191]
    ds_read_b64_tr_b16 v[52:53], v13 offset:40960
    ds_read_b64_tr_b16 v[54:55], v13 offset:41984
    s_waitcnt lgkmcnt(6)
    v_mfma_f32_16x16x32_bf16 v[192:195], v[32:35], v[64:67], v[192:195]
    ds_read_b128 v[76:79], v10 offset:47104
    ds_read_b64_tr_b16 v[56:57], v14 offset:40960
    v_mfma_f32_16x16x32_bf16 v[196:199], v[36:39], v[64:67], v[196:199]
    ds_read_b64_tr_b16 v[58:59], v14 offset:41984
    ds_read_b64_tr_b16 v[60:61], v15 offset:40960
    v_mfma_f32_16x16x32_bf16 v[200:203], v[40:43], v[64:67], v[200:203]
    ds_read_b64_tr_b16 v[62:63], v15 offset:41984
    v_mfma_f32_16x16x32_bf16 v[204:207], v[44:47], v[64:67], v[204:207]
    s_waitcnt lgkmcnt(10)
    v_mfma_f32_16x16x32_bf16 v[208:211], v[32:35], v[68:71], v[208:211]
    ds_read_b128 v[64:67], v11 offset:32768
    v_mfma_f32_16x16x32_bf16 v[212:215], v[36:39], v[68:71], v[212:215]
    v_mfma_f32_16x16x32_bf16 v[216:219], v[40:43], v[68:71], v[216:219]
    v_mfma_f32_16x16x32_bf16 v[220:223], v[44:47], v[68:71], v[220:223]
    s_waitcnt lgkmcnt(10)
    v_mfma_f32_16x16x32_bf16 v[224:227], v[32:35], v[72:75], v[224:227]
    ds_read_b128 v[68:71], v11 offset:34816
    v_mfma_f32_16x16x32_bf16 v[228:231], v[36:39], v[72:75], v[228:231]
    v_mfma_f32_16x16x32_bf16 v[232:235], v[40:43], v[72:75], v[232:235]
    v_mfma_f32_16x16x32_bf16 v[236:239], v[44:47], v[72:75], v[236:239]
    s_waitcnt lgkmcnt(6)
    v_mfma_f32_16x16x32_bf16 v[240:243], v[32:35], v[76:79], v[240:243]
    ds_read_b128 v[72:75], v11 offset:36864
    v_mfma_f32_16x16x32_bf16 v[244:247], v[36:39], v[76:79], v[244:247]
    v_mfma_f32_16x16x32_bf16 v[248:251], v[40:43], v[76:79], v[248:251]
    v_mfma_f32_16x16x32_bf16 v[252:255], v[44:47], v[76:79], v[252:255]
    s_waitcnt lgkmcnt(2)
    v_mfma_f32_16x16x32_bf16 v[128:131], v[48:51], v[64:67], v[128:131]
    ds_read_b128 v[76:79], v11 offset:38912
    s_add_u32 s48, s48, 270336
    s_cmp_ge_u32 s32, 2
    s_cselect_b32 s48, 0x80000000, s48
    buffer_store_dwordx4 v[94:97], v25, s[12:15], s48 offen sc1
    v_mfma_f32_16x16x32_bf16 v[132:135], v[52:55], v[64:67], v[132:135]
    v_mfma_f32_16x16x32_bf16 v[136:139], v[56:59], v[64:67], v[136:139]
    v_mfma_f32_16x16x32_bf16 v[140:143], v[60:63], v[64:67], v[140:143]
    s_waitcnt lgkmcnt(2)
    v_mfma_f32_16x16x32_bf16 v[144:147], v[48:51], v[68:71], v[144:147]
    ds_read_b128 v[64:67], v11 offset:40960
    v_mfma_f32_16x16x32_bf16 v[148:151], v[52:55], v[68:71], v[148:151]
    v_mfma_f32_16x16x32_bf16 v[152:155], v[56:59], v[68:71], v[152:155]
    v_mfma_f32_16x16x32_bf16 v[156:159], v[60:63], v[68:71], v[156:159]
    s_waitcnt lgkmcnt(2)
    v_mfma_f32_16x16x32_bf16 v[160:163], v[48:51], v[72:75], v[160:163]
    ds_read_b128 v[68:71], v11 offset:43008
    v_mfma_f32_16x16x32_bf16 v[164:167], v[52:55], v[72:75], v[164:167]
    v_mfma_f32_16x16x32_bf16 v[168:171], v[56:59], v[72:75], v[168:171]
    v_mfma_f32_16x16x32_bf16 v[172:175], v[60:63], v[72:75], v[172:175]
    s_waitcnt lgkmcnt(2)
    v_mfma_f32_16x16x32_bf16 v[176:179], v[48:51], v[76:79], v[176:179]
    ds_read_b128 v[72:75], v11 offset:45056
    v_mfma_f32_16x16x32_bf16 v[180:183], v[52:55], v[76:79], v[180:183]
    v_mfma_f32_16x16x32_bf16 v[184:187], v[56:59], v[76:79], v[184:187]
    v_mfma_f32_16x16x32_bf16 v[188:191], v[60:63], v[76:79], v[188:191]
    s_waitcnt lgkmcnt(2)
    v_mfma_f32_16x16x32_bf16 v[192:195], v[48:51], v[64:67], v[192:195]
    ds_read_b128 v[76:79], v11 offset:47104
    v_mfma_f32_16x16x32_bf16 v[196:199], v[52:55], v[64:67], v[196:199]
    v_mfma_f32_16x16x32_bf16 v[200:203], v[56:59], v[64:67], v[200:203]
    v_mfma_f32_16x16x32_bf16 v[204:207], v[60:63], v[64:67], v[204:207]
    s_waitcnt lgkmcnt(0)
    s_waitcnt vmcnt(9)
    s_barrier
    v_mfma_f32_16x16x32_bf16 v[208:211], v[48:51], v[68:71], v[208:211]
    s_add_u32 m0, s41, 32768
    s_add_u32 s37, s45, 256
    buffer_load_dwordx4 v16, s[20:23], s37 offen lds
    v_mfma_f32_16x16x32_bf16 v[212:215], v[52:55], v[68:71], v[212:215]
    buffer_load_dwordx4 v17, s[20:23], s37 offen offset:1024 lds
    v_mfma_f32_16x16x32_bf16 v[216:219], v[56:59], v[68:71], v[216:219]
    buffer_load_dwordx4 v18, s[20:23], s37 offen offset:2048 lds
    v_mfma_f32_16x16x32_bf16 v[220:223], v[60:63], v[68:71], v[220:223]
    buffer_load_dwordx4 v19, s[20:23], s37 offen offset:3072 lds
    v_mfma_f32_16x16x32_bf16 v[224:227], v[48:51], v[72:75], v[224:227]
    s_add_u32 m0, s52, 32768
    s_add_u32 s37, s46, 1048576
    buffer_load_dwordx4 v20, s[24:27], s37 offen lds
    v_mfma_f32_16x16x32_bf16 v[228:231], v[52:55], v[72:75], v[228:231]
    buffer_load_dwordx4 v21, s[24:27], s37 offen offset:1024 lds
    v_mfma_f32_16x16x32_bf16 v[232:235], v[56:59], v[72:75], v[232:235]
    s_bfe_u32 s38, s2, 0x10003
    s_cmp_lg_u32 s32, 2
    s_cbranch_scc1 ONLY_5
    s_cmp_lg_u32 s38, 1
    s_cbranch_scc1 ONLY_5
    v_and_b32 v31, 31, v0
    v_lshlrev_b32 v31, 2, v31
    buffer_load_dword v31, v31, s[28:31], 0 offen offset:128 sc1
ONLY_5:
    v_mfma_f32_16x16x32_bf16 v[236:239], v[60:63], v[72:75], v[236:239]
    v_mfma_f32_16x16x32_bf16 v[240:243], v[48:51], v[76:79], v[240:243]
    v_mfma_f32_16x16x32_bf16 v[244:247], v[52:55], v[76:79], v[244:247]
    v_mfma_f32_16x16x32_bf16 v[248:251], v[56:59], v[76:79], v[248:251]
    v_mfma_f32_16x16x32_bf16 v[252:255], v[60:63], v[76:79], v[252:255]
    s_lshr_b32 s37, s32, 1
    s_lshl_b32 s37, s37, 13
    s_and_b32 s38, s32, 1
    s_lshl_b32 s38, s38, 2
    s_mov_b32 s3, 65536
    v_and_b32 v24, 15, v0
    v_lshrrev_b32 v25, 4, v0
    v_bfe_u32 v26, v0, 1, 3
    v_xor_b32 v26, v26, v25
    v_lshlrev_b32 v26, 4, v26
    v_lshl_add_u32 v26, v24, 7, v26
    v_add_u32 v2, s37, v26
    v_xor_b32 v3, 64, v2
    v_bfe_u32 v24, v0, 2, 2
    v_lshl_add_u32 v26, v25, 3, v24
    v_lshlrev_b32 v26, 8, v26
    v_and_b32 v27, 3, v0
    v_lshl_add_u32 v26, v27, 3, v26
    v_add_u32 v26, s3, v26
    v_and_b32 v25, 1, v25
    v_lshl_add_u32 v24, v25, 2, v24
    v_xor_b32 v24, s38, v24
    v_xor_b32 v25, 0, v24
    v_lshl_add_u32 v6, v25, 5, v26
    v_xor_b32 v25, 1, v24
    v_lshl_add_u32 v7, v25, 5, v26
    v_xor_b32 v25, 2, v24
    v_lshl_add_u32 v8, v25, 5, v26
    v_xor_b32 v25, 3, v24
    v_lshl_add_u32 v9, v25, 5, v26
    v_add_u32 v4, 131072, v2
    v_add_u32 v5, 131072, v3
    ds_read_b64_tr_b16 v[32:33], v6 offset:0
    ds_read_b64_tr_b16 v[34:35], v6 offset:1024
    ds_read_b64_tr_b16 v[36:37], v7 offset:0
    ds_read_b64_tr_b16 v[38:39], v7 offset:1024
    ds_read_b64_tr_b16 v[40:41], v8 offset:0
    ds_read_b64_tr_b16 v[42:43], v8 offset:1024
    ds_read_b64_tr_b16 v[44:45], v9 offset:0
    ds_read_b64_tr_b16 v[46:47], v9 offset:1024
    ds_read_b128 v[64:67], v4 offset:0
    ds_read_b128 v[68:71], v4 offset:2048
    v_add_u32 v10, 4096, v1
    v_mov_b32 v25, 0
    v_and_b32 v26, 31, v0
    v_lshlrev_b32 v26, 2, v26
    v_cvt_pk_bf16_f32 v80, v160, v161
    v_cvt_pk_bf16_f32 v81, v162, v163
    v_cvt_pk_bf16_f32 v82, v164, v165
    v_cvt_pk_bf16_f32 v83, v166, v167
    v_cvt_pk_bf16_f32 v84, v168, v169
    v_cvt_pk_bf16_f32 v85, v170, v171
    v_cvt_pk_bf16_f32 v86, v172, v173
    v_cvt_pk_bf16_f32 v87, v174, v175
    v_cvt_pk_bf16_f32 v88, v176, v177
    v_cvt_pk_bf16_f32 v89, v178, v179
    v_cvt_pk_bf16_f32 v90, v180, v181
    v_cvt_pk_bf16_f32 v91, v182, v183
    v_cvt_pk_bf16_f32 v92, v184, v185
    v_cvt_pk_bf16_f32 v93, v186, v187
    v_cvt_pk_bf16_f32 v94, v188, v189
    v_cvt_pk_bf16_f32 v95, v190, v191
    v_cvt_pk_bf16_f32 v96, v192, v193
    v_cvt_pk_bf16_f32 v97, v194, v195
    v_cvt_pk_bf16_f32 v98, v196, v197
    v_cvt_pk_bf16_f32 v99, v198, v199
    v_cvt_pk_bf16_f32 v100, v200, v201
    v_cvt_pk_bf16_f32 v101, v202, v203
    v_cvt_pk_bf16_f32 v102, v204, v205
    v_cvt_pk_bf16_f32 v103, v206, v207
    v_cvt_pk_bf16_f32 v104, v208, v209
    v_cvt_pk_bf16_f32 v105, v210, v211
    v_cvt_pk_bf16_f32 v106, v212, v213
    v_cvt_pk_bf16_f32 v107, v214, v215
    v_cvt_pk_bf16_f32 v108, v216, v217
    v_cvt_pk_bf16_f32 v109, v218, v219
    v_cvt_pk_bf16_f32 v110, v220, v221
    v_cvt_pk_bf16_f32 v111, v222, v223
    v_cvt_pk_bf16_f32 v112, v224, v225
    v_cvt_pk_bf16_f32 v113, v226, v227
    v_cvt_pk_bf16_f32 v114, v228, v229
    v_cvt_pk_bf16_f32 v115, v230, v231
    v_cvt_pk_bf16_f32 v116, v232, v233
    v_cvt_pk_bf16_f32 v117, v234, v235
    v_cvt_pk_bf16_f32 v118, v236, v237
    v_cvt_pk_bf16_f32 v119, v238, v239
    v_cvt_pk_bf16_f32 v120, v240, v241
    v_cvt_pk_bf16_f32 v121, v242, v243
    v_cvt_pk_bf16_f32 v122, v244, v245
    v_cvt_pk_bf16_f32 v123, v246, v247
    v_cvt_pk_bf16_f32 v124, v248, v249
    v_cvt_pk_bf16_f32 v125, v250, v251
    v_cvt_pk_bf16_f32 v126, v252, v253
    v_cvt_pk_bf16_f32 v127, v254, v255
    v_cvt_pk_bf16_f32 v240, v128, v129
    v_cvt_pk_bf16_f32 v241, v130, v131
    v_cvt_pk_bf16_f32 v242, v132, v133
    v_cvt_pk_bf16_f32 v243, v134, v135
    v_cvt_pk_bf16_f32 v244, v136, v137
    v_cvt_pk_bf16_f32 v245, v138, v139
    v_cvt_pk_bf16_f32 v246, v140, v141
    v_cvt_pk_bf16_f32 v247, v142, v143
    v_cvt_pk_bf16_f32 v248, v144, v145
    v_cvt_pk_bf16_f32 v249, v146, v147
    v_cvt_pk_bf16_f32 v250, v148, v149
    v_cvt_pk_bf16_f32 v251, v150, v151
    v_cvt_pk_bf16_f32 v252, v152, v153
    v_cvt_pk_bf16_f32 v253, v154, v155
    v_cvt_pk_bf16_f32 v254, v156, v157
    v_cvt_pk_bf16_f32 v255, v158, v159
    s_waitcnt lgkmcnt(1)
    v_mfma_f32_16x16x32_bf16 v[128:131], v[32:35], v[64:67], 0
    ds_read_b128 v[72:75], v4 offset:4096
    v_mfma_f32_16x16x32_bf16 v[132:135], v[36:39], v[64:67], 0
    ds_read_b64_tr_b16 v[48:49], v6 offset:8192
    ds_read_b64_tr_b16 v[50:51], v6 offset:9216
    v_mfma_f32_16x16x32_bf16 v[136:139], v[40:43], v[64:67], 0
    ds_read_b128 v[76:79], v4 offset:6144
    ds_read_b64_tr_b16 v[52:53], v7 offset:8192
    s_add_u32 s3, s43, 0
    buffer_store_dwordx4 v[240:243], v1, s[12:15], s3 offen offset:0 sc1
    v_mfma_f32_16x16x32_bf16 v[140:143], v[44:47], v[64:67], 0
    ds_read_b64_tr_b16 v[54:55], v7 offset:9216
    ds_read_b64_tr_b16 v[56:57], v8 offset:8192
    s_waitcnt lgkmcnt(7)
    v_mfma_f32_16x16x32_bf16 v[144:147], v[32:35], v[68:71], 0
    ds_read_b64_tr_b16 v[58:59], v8 offset:9216
    ds_read_b64_tr_b16 v[60:61], v9 offset:8192
    v_mfma_f32_16x16x32_bf16 v[148:151], v[36:39], v[68:71], 0
    ds_read_b64_tr_b16 v[62:63], v9 offset:9216
    v_mfma_f32_16x16x32_bf16 v[152:155], v[40:43], v[68:71], 0
    ds_read_b128 v[64:67], v5 offset:0
    v_mfma_f32_16x16x32_bf16 v[156:159], v[44:47], v[68:71], 0
    s_add_u32 s3, s43, 0
    buffer_store_dwordx4 v[244:247], v1, s[12:15], s3 offen offset:1024 sc1
    s_waitcnt lgkmcnt(10)
    v_mfma_f32_16x16x32_bf16 v[160:163], v[32:35], v[72:75], 0
    v_mfma_f32_16x16x32_bf16 v[164:167], v[36:39], v[72:75], 0
    v_mfma_f32_16x16x32_bf16 v[168:171], v[40:43], v[72:75], 0
    ds_read_b128 v[68:71], v5 offset:2048
    v_mfma_f32_16x16x32_bf16 v[172:175], v[44:47], v[72:75], 0
    s_waitcnt lgkmcnt(8)
    v_mfma_f32_16x16x32_bf16 v[176:179], v[32:35], v[76:79], 0
    s_add_u32 s3, s43, 0
    buffer_store_dwordx4 v[248:251], v10, s[12:15], s3 offen offset:0 sc1
    v_mfma_f32_16x16x32_bf16 v[180:183], v[36:39], v[76:79], 0
    v_mfma_f32_16x16x32_bf16 v[184:187], v[40:43], v[76:79], 0
    ds_read_b128 v[72:75], v5 offset:4096
    v_mfma_f32_16x16x32_bf16 v[188:191], v[44:47], v[76:79], 0
    s_waitcnt lgkmcnt(2)
    v_mfma_f32_16x16x32_bf16 v[128:131], v[48:51], v[64:67], v[128:131]
    v_mfma_f32_16x16x32_bf16 v[132:135], v[52:55], v[64:67], v[132:135]
    s_add_u32 s3, s43, 0
    buffer_store_dwordx4 v[252:255], v10, s[12:15], s3 offen offset:1024 sc1
    v_mfma_f32_16x16x32_bf16 v[136:139], v[56:59], v[64:67], v[136:139]
    ds_read_b128 v[76:79], v5 offset:6144
    v_mfma_f32_16x16x32_bf16 v[140:143], v[60:63], v[64:67], v[140:143]
    s_waitcnt lgkmcnt(2)
    v_mfma_f32_16x16x32_bf16 v[144:147], v[48:51], v[68:71], v[144:147]
    v_mfma_f32_16x16x32_bf16 v[148:151], v[52:55], v[68:71], v[148:151]
    s_waitcnt lgkmcnt(0)
    s_waitcnt vmcnt(13)
    s_barrier
    ds_read_b64_tr_b16 v[32:33], v6 offset:16384
    ds_read_b64_tr_b16 v[34:35], v6 offset:17408
    v_mfma_f32_16x16x32_bf16 v[152:155], v[56:59], v[68:71], v[152:155]
    ds_read_b64_tr_b16 v[36:37], v7 offset:16384
    ds_read_b64_tr_b16 v[38:39], v7 offset:17408
    s_add_u32 m0, s41, 131072
    s_add_u32 s37, s45, 384
    buffer_load_dwordx4 v16, s[20:23], s37 offen lds
    v_mfma_f32_16x16x32_bf16 v[156:159], v[60:63], v[68:71], v[156:159]
    ds_read_b64_tr_b16 v[40:41], v8 offset:16384
    ds_read_b64_tr_b16 v[42:43], v8 offset:17408
    buffer_load_dwordx4 v17, s[20:23], s37 offen offset:1024 lds
    v_mfma_f32_16x16x32_bf16 v[160:163], v[48:51], v[72:75], v[160:163]
    ds_read_b64_tr_b16 v[44:45], v9 offset:16384
    ds_read_b64_tr_b16 v[46:47], v9 offset:17408
    buffer_load_dwordx4 v18, s[20:23], s37 offen offset:2048 lds
    v_mfma_f32_16x16x32_bf16 v[164:167], v[52:55], v[72:75], v[164:167]
    ds_read_b128 v[64:67], v2 offset:0
    buffer_load_dwordx4 v19, s[20:23], s37 offen offset:3072 lds
    v_mfma_f32_16x16x32_bf16 v[168:171], v[56:59], v[72:75], v[168:171]
    ds_read_b128 v[68:71], v2 offset:2048
    s_add_u32 m0, s52, 0
    s_add_u32 s37, s46, 1572864
    buffer_load_dwordx4 v20, s[24:27], s37 offen lds
    v_mfma_f32_16x16x32_bf16 v[172:175], v[60:63], v[72:75], v[172:175]
    buffer_load_dwordx4 v21, s[24:27], s37 offen offset:1024 lds
    v_mfma_f32_16x16x32_bf16 v[176:179], v[48:51], v[76:79], v[176:179]
    s_add_u32 s3, s43, 8192
    buffer_store_dwordx4 v[80:83], v1, s[12:15], s3 offen offset:0 sc1
    s_add_u32 s3, s43, 8192
    buffer_store_dwordx4 v[84:87], v1, s[12:15], s3 offen offset:1024 sc1
    v_mfma_f32_16x16x32_bf16 v[180:183], v[52:55], v[76:79], v[180:183]
    v_mfma_f32_16x16x32_bf16 v[184:187], v[56:59], v[76:79], v[184:187]
    ds_read_b128 v[72:75], v2 offset:4096
    v_mfma_f32_16x16x32_bf16 v[188:191], v[60:63], v[76:79], v[188:191]
    s_waitcnt lgkmcnt(2)
    v_mfma_f32_16x16x32_bf16 v[128:131], v[32:35], v[64:67], v[128:131]
    s_add_u32 s3, s43, 8192
    buffer_store_dwordx4 v[88:91], v10, s[12:15], s3 offen offset:0 sc1
    v_mfma_f32_16x16x32_bf16 v[132:135], v[36:39], v[64:67], v[132:135]
    ds_read_b64_tr_b16 v[48:49], v6 offset:24576
    ds_read_b64_tr_b16 v[50:51], v6 offset:25600
    v_mfma_f32_16x16x32_bf16 v[136:139], v[40:43], v[64:67], v[136:139]
    ds_read_b128 v[76:79], v2 offset:6144
    ds_read_b64_tr_b16 v[52:53], v7 offset:24576
    v_mfma_f32_16x16x32_bf16 v[140:143], v[44:47], v[64:67], v[140:143]
    ds_read_b64_tr_b16 v[54:55], v7 offset:25600
    ds_read_b64_tr_b16 v[56:57], v8 offset:24576
    s_waitcnt lgkmcnt(7)
    v_mfma_f32_16x16x32_bf16 v[144:147], v[32:35], v[68:71], v[144:147]
    ds_read_b64_tr_b16 v[58:59], v8 offset:25600
    ds_read_b64_tr_b16 v[60:61], v9 offset:24576
    v_mfma_f32_16x16x32_bf16 v[148:151], v[36:39], v[68:71], v[148:151]
    ds_read_b64_tr_b16 v[62:63], v9 offset:25600
    s_add_u32 s3, s43, 8192
    buffer_store_dwordx4 v[92:95], v10, s[12:15], s3 offen offset:1024 sc1
    v_mfma_f32_16x16x32_bf16 v[152:155], v[40:43], v[68:71], v[152:155]
    ds_read_b128 v[64:67], v3 offset:0
    v_mfma_f32_16x16x32_bf16 v[156:159], v[44:47], v[68:71], v[156:159]
    s_waitcnt lgkmcnt(10)
    v_mfma_f32_16x16x32_bf16 v[160:163], v[32:35], v[72:75], v[160:163]
    v_mfma_f32_16x16x32_bf16 v[164:167], v[36:39], v[72:75], v[164:167]
    v_mfma_f32_16x16x32_bf16 v[168:171], v[40:43], v[72:75], v[168:171]
    ds_read_b128 v[68:71], v3 offset:2048
    s_add_u32 s3, s43, 16384
    buffer_store_dwordx4 v[96:99], v1, s[12:15], s3 offen offset:0 sc1
    v_mfma_f32_16x16x32_bf16 v[172:175], v[44:47], v[72:75], v[172:175]
    s_waitcnt lgkmcnt(8)
    v_mfma_f32_16x16x32_bf16 v[176:179], v[32:35], v[76:79], v[176:179]
    v_mfma_f32_16x16x32_bf16 v[180:183], v[36:39], v[76:79], v[180:183]
    v_mfma_f32_16x16x32_bf16 v[184:187], v[40:43], v[76:79], v[184:187]
    ds_read_b128 v[72:75], v3 offset:4096
    v_mfma_f32_16x16x32_bf16 v[188:191], v[44:47], v[76:79], v[188:191]
    s_add_u32 s3, s43, 16384
    buffer_store_dwordx4 v[100:103], v1, s[12:15], s3 offen offset:1024 sc1
    s_waitcnt lgkmcnt(2)
    v_mfma_f32_16x16x32_bf16 v[128:131], v[48:51], v[64:67], v[128:131]
    v_mfma_f32_16x16x32_bf16 v[132:135], v[52:55], v[64:67], v[132:135]
    v_mfma_f32_16x16x32_bf16 v[136:139], v[56:59], v[64:67], v[136:139]
    ds_read_b128 v[76:79], v3 offset:6144
    v_mfma_f32_16x16x32_bf16 v[140:143], v[60:63], v[64:67], v[140:143]
    s_waitcnt lgkmcnt(2)
    v_mfma_f32_16x16x32_bf16 v[144:147], v[48:51], v[68:71], v[144:147]
    s_add_u32 s3, s43, 16384
    buffer_store_dwordx4 v[104:107], v10, s[12:15], s3 offen offset:0 sc1
    v_mfma_f32_16x16x32_bf16 v[148:151], v[52:55], v[68:71], v[148:151]
    s_waitcnt lgkmcnt(0)
    s_waitcnt vmcnt(17)
    s_barrier
    ds_read_b64_tr_b16 v[32:33], v6 offset:32768
    ds_read_b64_tr_b16 v[34:35], v6 offset:33792
    v_mfma_f32_16x16x32_bf16 v[152:155], v[56:59], v[68:71], v[152:155]
    ds_read_b64_tr_b16 v[36:37], v7 offset:32768
    ds_read_b64_tr_b16 v[38:39], v7 offset:33792
    s_add_u32 m0, s41, 0
    s_add_u32 s37, s45, 512
    buffer_load_dwordx4 v16, s[20:23], s37 offen lds
    v_mfma_f32_16x16x32_bf16 v[156:159], v[60:63], v[68:71], v[156:159]
    ds_read_b64_tr_b16 v[40:41], v8 offset:32768
    ds_read_b64_tr_b16 v[42:43], v8 offset:33792
    buffer_load_dwordx4 v17, s[20:23], s37 offen offset:1024 lds
    v_mfma_f32_16x16x32_bf16 v[160:163], v[48:51], v[72:75], v[160:163]
    ds_read_b64_tr_b16 v[44:45], v9 offset:32768
    ds_read_b64_tr_b16 v[46:47], v9 offset:33792
    buffer_load_dwordx4 v18, s[20:23], s37 offen offset:2048 lds
    v_mfma_f32_16x16x32_bf16 v[164:167], v[52:55], v[72:75], v[164:167]
    ds_read_b128 v[64:67], v2 offset:32768
    buffer_load_dwordx4 v19, s[20:23], s37 offen offset:3072 lds
    v_mfma_f32_16x16x32_bf16 v[168:171], v[56:59], v[72:75], v[168:171]
    ds_read_b128 v[68:71], v2 offset:34816
    s_add_u32 m0, s52, 16384
    s_add_u32 s37, s46, 2097152
    buffer_load_dwordx4 v20, s[24:27], s37 offen lds
    v_mfma_f32_16x16x32_bf16 v[172:175], v[60:63], v[72:75], v[172:175]
    buffer_load_dwordx4 v21, s[24:27], s37 offen offset:1024 lds
    v_mfma_f32_16x16x32_bf16 v[176:179], v[48:51], v[76:79], v[176:179]
    s_add_u32 s3, s43, 16384
    buffer_store_dwordx4 v[108:111], v10, s[12:15], s3 offen offset:1024 sc1
    v_mfma_f32_16x16x32_bf16 v[180:183], v[52:55], v[76:79], v[180:183]
    v_mfma_f32_16x16x32_bf16 v[184:187], v[56:59], v[76:79], v[184:187]
    ds_read_b128 v[72:75], v2 offset:36864
    s_add_u32 s3, s43, 24576
    buffer_store_dwordx4 v[112:115], v1, s[12:15], s3 offen offset:0 sc1
    v_mfma_f32_16x16x32_bf16 v[188:191], v[60:63], v[76:79], v[188:191]
    s_waitcnt lgkmcnt(2)
    v_mfma_f32_16x16x32_bf16 v[128:131], v[32:35], v[64:67], v[128:131]
    v_mfma_f32_16x16x32_bf16 v[132:135], v[36:39], v[64:67], v[132:135]
    ds_read_b64_tr_b16 v[48:49], v6 offset:40960
    ds_read_b64_tr_b16 v[50:51], v6 offset:41984
    v_mfma_f32_16x16x32_bf16 v[136:139], v[40:43], v[64:67], v[136:139]
    ds_read_b128 v[76:79], v2 offset:38912
    ds_read_b64_tr_b16 v[52:53], v7 offset:40960
    v_mfma_f32_16x16x32_bf16 v[140:143], v[44:47], v[64:67], v[140:143]
    ds_read_b64_tr_b16 v[54:55], v7 offset:41984
    ds_read_b64_tr_b16 v[56:57], v8 offset:40960
    s_add_u32 s3, s43, 24576
    buffer_store_dwordx4 v[116:119], v1, s[12:15], s3 offen offset:1024 sc1
    s_waitcnt lgkmcnt(7)
    v_mfma_f32_16x16x32_bf16 v[144:147], v[32:35], v[68:71], v[144:147]
    ds_read_b64_tr_b16 v[58:59], v8 offset:41984
    ds_read_b64_tr_b16 v[60:61], v9 offset:40960
    v_mfma_f32_16x16x32_bf16 v[148:151], v[36:39], v[68:71], v[148:151]
    ds_read_b64_tr_b16 v[62:63], v9 offset:41984
    v_mfma_f32_16x16x32_bf16 v[152:155], v[40:43], v[68:71], v[152:155]
    ds_read_b128 v[64:67], v3 offset:32768
    v_mfma_f32_16x16x32_bf16 v[156:159], v[44:47], v[68:71], v[156:159]
    s_waitcnt lgkmcnt(10)
    v_mfma_f32_16x16x32_bf16 v[160:163], v[32:35], v[72:75], v[160:163]
    s_add_u32 s3, s43, 24576
    buffer_store_dwordx4 v[120:123], v10, s[12:15], s3 offen offset:0 sc1
    v_mfma_f32_16x16x32_bf16 v[164:167], v[36:39], v[72:75], v[164:167]
    v_mfma_f32_16x16x32_bf16 v[168:171], v[40:43], v[72:75], v[168:171]
    ds_read_b128 v[68:71], v3 offset:34816
    v_mfma_f32_16x16x32_bf16 v[172:175], v[44:47], v[72:75], v[172:175]
    s_waitcnt lgkmcnt(8)
    v_mfma_f32_16x16x32_bf16 v[176:179], v[32:35], v[76:79], v[176:179]
    v_mfma_f32_16x16x32_bf16 v[180:183], v[36:39], v[76:79], v[180:183]
    s_add_u32 s3, s43, 24576
    buffer_store_dwordx4 v[124:127], v10, s[12:15], s3 offen offset:1024 sc1
    v_mfma_f32_16x16x32_bf16 v[184:187], v[40:43], v[76:79], v[184:187]
    ds_read_b128 v[72:75], v3 offset:36864
    v_mfma_f32_16x16x32_bf16 v[188:191], v[44:47], v[76:79], v[188:191]
    s_waitcnt lgkmcnt(2)
    v_mfma_f32_16x16x32_bf16 v[128:131], v[48:51], v[64:67], v[128:131]
    v_mfma_f32_16x16x32_bf16 v[132:135], v[52:55], v[64:67], v[132:135]
    v_mfma_f32_16x16x32_bf16 v[136:139], v[56:59], v[64:67], v[136:139]
    ds_read_b128 v[76:79], v3 offset:38912
    v_mfma_f32_16x16x32_bf16 v[140:143], v[60:63], v[64:67], v[140:143]
    s_waitcnt lgkmcnt(2)
    v_mfma_f32_16x16x32_bf16 v[144:147], v[48:51], v[68:71], v[144:147]
    v_mfma_f32_16x16x32_bf16 v[148:151], v[52:55], v[68:71], v[148:151]
    s_waitcnt lgkmcnt(0)
    s_waitcnt vmcnt(18)
    s_barrier
    ds_read_b64_tr_b16 v[32:33], v6 offset:0
    ds_read_b64_tr_b16 v[34:35], v6 offset:1024
    v_mfma_f32_16x16x32_bf16 v[152:155], v[56:59], v[68:71], v[152:155]
    ds_read_b64_tr_b16 v[36:37], v7 offset:0
    ds_read_b64_tr_b16 v[38:39], v7 offset:1024
    s_add_u32 m0, s41, 32768
    s_add_u32 s37, s45, 640
    buffer_load_dwordx4 v16, s[20:23], s37 offen lds
    v_mfma_f32_16x16x32_bf16 v[156:159], v[60:63], v[68:71], v[156:159]
    ds_read_b64_tr_b16 v[40:41], v8 offset:0
    ds_read_b64_tr_b16 v[42:43], v8 offset:1024
    buffer_load_dwordx4 v17, s[20:23], s37 offen offset:1024 lds
    v_mfma_f32_16x16x32_bf16 v[160:163], v[48:51], v[72:75], v[160:163]
    ds_read_b64_tr_b16 v[44:45], v9 offset:0
    ds_read_b64_tr_b16 v[46:47], v9 offset:1024
    buffer_load_dwordx4 v18, s[20:23], s37 offen offset:2048 lds
    v_mfma_f32_16x16x32_bf16 v[164:167], v[52:55], v[72:75], v[164:167]
    ds_read_b128 v[64:67], v4 offset:0
    buffer_load_dwordx4 v19, s[20:23], s37 offen offset:3072 lds
    v_mfma_f32_16x16x32_bf16 v[168:171], v[56:59], v[72:75], v[168:171]
    ds_read_b128 v[68:71], v4 offset:2048
    s_add_u32 m0, s52, 32768
    s_add_u32 s37, s46, 2621440
    buffer_load_dwordx4 v20, s[24:27], s37 offen lds
    v_mfma_f32_16x16x32_bf16 v[172:175], v[60:63], v[72:75], v[172:175]
    buffer_load_dwordx4 v21, s[24:27], s37 offen offset:1024 lds
    v_mfma_f32_16x16x32_bf16 v[176:179], v[48:51], v[76:79], v[176:179]
    v_mfma_f32_16x16x32_bf16 v[180:183], v[52:55], v[76:79], v[180:183]
    v_mfma_f32_16x16x32_bf16 v[184:187], v[56:59], v[76:79], v[184:187]
    ds_read_b128 v[72:75], v4 offset:4096
    v_mfma_f32_16x16x32_bf16 v[188:191], v[60:63], v[76:79], v[188:191]
    s_waitcnt lgkmcnt(2)
    v_mfma_f32_16x16x32_bf16 v[128:131], v[32:35], v[64:67], v[128:131]
    v_mfma_f32_16x16x32_bf16 v[132:135], v[36:39], v[64:67], v[132:135]
    ds_read_b64_tr_b16 v[48:49], v6 offset:8192
    ds_read_b64_tr_b16 v[50:51], v6 offset:9216
    v_mfma_f32_16x16x32_bf16 v[136:139], v[40:43], v[64:67], v[136:139]
    ds_read_b128 v[76:79], v4 offset:6144
    ds_read_b64_tr_b16 v[52:53], v7 offset:8192
    v_mfma_f32_16x16x32_bf16 v[140:143], v[44:47], v[64:67], v[140:143]
    ds_read_b64_tr_b16 v[54:55], v7 offset:9216
    ds_read_b64_tr_b16 v[56:57], v8 offset:8192
    s_waitcnt lgkmcnt(7)
    v_mfma_f32_16x16x32_bf16 v[144:147], v[32:35], v[68:71], v[144:147]
    ds_read_b64_tr_b16 v[58:59], v8 offset:9216
    ds_read_b64_tr_b16 v[60:61], v9 offset:8192
    v_mfma_f32_16x16x32_bf16 v[148:151], v[36:39], v[68:71], v[148:151]
    ds_read_b64_tr_b16 v[62:63], v9 offset:9216
    v_mfma_f32_16x16x32_bf16 v[152:155], v[40:43], v[68:71], v[152:155]
    ds_read_b128 v[64:67], v5 offset:0
    v_mfma_f32_16x16x32_bf16 v[156:159], v[44:47], v[68:71], v[156:159]
    s_waitcnt lgkmcnt(10)
    v_mfma_f32_16x16x32_bf16 v[160:163], v[32:35], v[72:75], v[160:163]
    v_mfma_f32_16x16x32_bf16 v[164:167], v[36:39], v[72:75], v[164:167]
    v_mfma_f32_16x16x32_bf16 v[168:171], v[40:43], v[72:75], v[168:171]
    ds_read_b128 v[68:71], v5 offset:2048
    v_mfma_f32_16x16x32_bf16 v[172:175], v[44:47], v[72:75], v[172:175]
    s_waitcnt lgkmcnt(8)
    v_mfma_f32_16x16x32_bf16 v[176:179], v[32:35], v[76:79], v[176:179]
    v_mfma_f32_16x16x32_bf16 v[180:183], v[36:39], v[76:79], v[180:183]
    v_mfma_f32_16x16x32_bf16 v[184:187], v[40:43], v[76:79], v[184:187]
    ds_read_b128 v[72:75], v5 offset:4096
    v_mfma_f32_16x16x32_bf16 v[188:191], v[44:47], v[76:79], v[188:191]
    s_waitcnt lgkmcnt(2)
    v_mfma_f32_16x16x32_bf16 v[128:131], v[48:51], v[64:67], v[128:131]
    v_mfma_f32_16x16x32_bf16 v[132:135], v[52:55], v[64:67], v[132:135]
    v_mfma_f32_16x16x32_bf16 v[136:139], v[56:59], v[64:67], v[136:139]
    ds_read_b128 v[76:79], v5 offset:6144
    v_mfma_f32_16x16x32_bf16 v[140:143], v[60:63], v[64:67], v[140:143]
    s_waitcnt lgkmcnt(2)
    v_mfma_f32_16x16x32_bf16 v[144:147], v[48:51], v[68:71], v[144:147]
    v_mfma_f32_16x16x32_bf16 v[148:151], v[52:55], v[68:71], v[148:151]
    s_waitcnt lgkmcnt(0)
    s_cmp_lg_u32 s32, 2
    s_cbranch_scc1 CLN_6D
    s_mov_b32 s38, 0
    s_branch CLN_6C
CLN_6:
    s_sleep 32
    buffer_load_dword v31, v26, s[28:31], 0 offen offset:128 sc1
    s_waitcnt vmcnt(0)
CLN_6C:
    v_cmp_eq_u32 vcc, 0, v31
    s_add_u32 s38, s38, 1
    s_cbranch_vccz CLN_6D
    s_cmp_lt_u32 s38, 100000
    s_cbranch_scc1 CLN_6
CLN_6D:
    s_waitcnt vmcnt(11)
    s_barrier
    ds_read_b64_tr_b16 v[32:33], v6 offset:16384
    ds_read_b64_tr_b16 v[34:35], v6 offset:17408
    v_mfma_f32_16x16x32_bf16 v[152:155], v[56:59], v[68:71], v[152:155]
    ds_read_b64_tr_b16 v[36:37], v7 offset:16384
    ds_read_b64_tr_b16 v[38:39], v7 offset:17408
    s_add_u32 m0, s41, 131072
    s_add_u32 s37, s45, 768
    buffer_load_dwordx4 v16, s[20:23], s37 offen lds
    v_mfma_f32_16x16x32_bf16 v[156:159], v[60:63], v[68:71], v[156:159]
    ds_read_b64_tr_b16 v[40:41], v8 offset:16384
    ds_read_b64_tr_b16 v[42:43], v8 offset:17408
    buffer_load_dwordx4 v17, s[20:23], s37 offen offset:1024 lds
    v_mfma_f32_16x16x32_bf16 v[160:163], v[48:51], v[72:75], v[160:163]
    ds_read_b64_tr_b16 v[44:45], v9 offset:16384
    ds_read_b64_tr_b16 v[46:47], v9 offset:17408
    buffer_load_dwordx4 v18, s[20:23], s37 offen offset:2048 lds
    v_mfma_f32_16x16x32_bf16 v[164:167], v[52:55], v[72:75], v[164:167]
    ds_read_b128 v[64:67], v2 offset:0
    buffer_load_dwordx4 v19, s[20:23], s37 offen offset:3072 lds
    v_mfma_f32_16x16x32_bf16 v[168:171], v[56:59], v[72:75], v[168:171]
    ds_read_b128 v[68:71], v2 offset:2048
    s_add_u32 m0, s52, 0
    s_add_u32 s37, s46, 3145728
    buffer_load_dwordx4 v20, s[24:27], s37 offen lds
    v_mfma_f32_16x16x32_bf16 v[172:175], v[60:63], v[72:75], v[172:175]
    buffer_load_dwordx4 v21, s[24:27], s37 offen offset:1024 lds
    v_mfma_f32_16x16x32_bf16 v[176:179], v[48:51], v[76:79], v[176:179]
    v_mfma_f32_16x16x32_bf16 v[180:183], v[52:55], v[76:79], v[180:183]
    v_mfma_f32_16x16x32_bf16 v[184:187], v[56:59], v[76:79], v[184:187]
    ds_read_b128 v[72:75], v2 offset:4096
    v_mfma_f32_16x16x32_bf16 v[188:191], v[60:63], v[76:79], v[188:191]
    s_waitcnt lgkmcnt(2)
    v_mfma_f32_16x16x32_bf16 v[128:131], v[32:35], v[64:67], v[128:131]
    v_mfma_f32_16x16x32_bf16 v[132:135], v[36:39], v[64:67], v[132:135]
    ds_read_b64_tr_b16 v[48:49], v6 offset:24576
    ds_read_b64_tr_b16 v[50:51], v6 offset:25600
    v_mfma_f32_16x16x32_bf16 v[136:139], v[40:43], v[64:67], v[136:139]
    ds_read_b128 v[76:79], v2 offset:6144
    ds_read_b64_tr_b16 v[52:53], v7 offset:24576
    v_mfma_f32_16x16x32_bf16 v[140:143], v[44:47], v[64:67], v[140:143]
    ds_read_b64_tr_b16 v[54:55], v7 offset:25600
    ds_read_b64_tr_b16 v[56:57], v8 offset:24576
    s_waitcnt lgkmcnt(7)
    v_mfma_f32_16x16x32_bf16 v[144:147], v[32:35], v[68:71], v[144:147]
    ds_read_b64_tr_b16 v[58:59], v8 offset:25600
    ds_read_b64_tr_b16 v[60:61], v9 offset:24576
    v_mfma_f32_16x16x32_bf16 v[148:151], v[36:39], v[68:71], v[148:151]
    ds_read_b64_tr_b16 v[62:63], v9 offset:25600
    v_mfma_f32_16x16x32_bf16 v[152:155], v[40:43], v[68:71], v[152:155]
    ds_read_b128 v[64:67], v3 offset:0
    v_mfma_f32_16x16x32_bf16 v[156:159], v[44:47], v[68:71], v[156:159]
    s_waitcnt lgkmcnt(10)
    v_mfma_f32_16x16x32_bf16 v[160:163], v[32:35], v[72:75], v[160:163]
    v_mfma_f32_16x16x32_bf16 v[164:167], v[36:39], v[72:75], v[164:167]
    v_mfma_f32_16x16x32_bf16 v[168:171], v[40:43], v[72:75], v[168:171]
    ds_read_b128 v[68:71], v3 offset:2048
    v_mfma_f32_16x16x32_bf16 v[172:175], v[44:47], v[72:75], v[172:175]
    s_waitcnt lgkmcnt(8)
    v_mfma_f32_16x16x32_bf16 v[176:179], v[32:35], v[76:79], v[176:179]
    v_mfma_f32_16x16x32_bf16 v[180:183], v[36:39], v[76:79], v[180:183]
    v_mfma_f32_16x16x32_bf16 v[184:187], v[40:43], v[76:79], v[184:187]
    ds_read_b128 v[72:75], v3 offset:4096
    v_mfma_f32_16x16x32_bf16 v[188:191], v[44:47], v[76:79], v[188:191]
    s_waitcnt lgkmcnt(2)
    v_mfma_f32_16x16x32_bf16 v[128:131], v[48:51], v[64:67], v[128:131]
    v_mfma_f32_16x16x32_bf16 v[132:135], v[52:55], v[64:67], v[132:135]
    v_mfma_f32_16x16x32_bf16 v[136:139], v[56:59], v[64:67], v[136:139]
    ds_read_b128 v[76:79], v3 offset:6144
    v_mfma_f32_16x16x32_bf16 v[140:143], v[60:63], v[64:67], v[140:143]
    s_waitcnt lgkmcnt(2)
    v_mfma_f32_16x16x32_bf16 v[144:147], v[48:51], v[68:71], v[144:147]
    v_mfma_f32_16x16x32_bf16 v[148:151], v[52:55], v[68:71], v[148:151]
    s_waitcnt lgkmcnt(0)
    s_waitcnt vmcnt(6)
    s_barrier
    ds_read_b64_tr_b16 v[32:33], v6 offset:32768
    ds_read_b64_tr_b16 v[34:35], v6 offset:33792
    v_mfma_f32_16x16x32_bf16 v[152:155], v[56:59], v[68:71], v[152:155]
    ds_read_b64_tr_b16 v[36:37], v7 offset:32768
    ds_read_b64_tr_b16 v[38:39], v7 offset:33792
    s_cmp_lg_u32 s32, 0
    s_cbranch_scc1 ONLY_7
    s_mov_b64 exec, 1
    v_mov_b32 v24, 1
    s_lshl_b32 s3, s33, 10
    s_add_u32 s3, s3, s34
    s_lshl_b32 s3, s3, 2
    s_add_u32 s3, s3, 66715648
    buffer_store_dword v24, v25, s[12:15], s3 offen sc1
    s_mov_b64 exec, -1
ONLY_7:
    v_mfma_f32_16x16x32_bf16 v[156:159], v[60:63], v[68:71], v[156:159]
    ds_read_b64_tr_b16 v[40:41], v8 offset:32768
    ds_read_b64_tr_b16 v[42:43], v8 offset:33792
    s_add_u32 m0, s41, 0
    s_add_u32 s37, s45, 896
    buffer_load_dwordx4 v16, s[20:23], s37 offen lds
    v_mfma_f32_16x16x32_bf16 v[160:163], v[48:51], v[72:75], v[160:163]
    ds_read_b64_tr_b16 v[44:45], v9 offset:32768
    ds_read_b64_tr_b16 v[46:47], v9 offset:33792
    buffer_load_dwordx4 v17, s[20:23], s37 offen offset:1024 lds
    v_mfma_f32_16x16x32_bf16 v[164:167], v[52:55], v[72:75], v[164:167]
    ds_read_b128 v[64:67], v2 offset:32768
    buffer_load_dwordx4 v18, s[20:23], s37 offen offset:2048 lds
    v_mfma_f32_16x16x32_bf16 v[168:171], v[56:59], v[72:75], v[168:171]
    ds_read_b128 v[68:71], v2 offset:34816
    buffer_load_dwordx4 v19, s[20:23], s37 offen offset:3072 lds
    v_mfma_f32_16x16x32_bf16 v[172:175], v[60:63], v[72:75], v[172:175]
    s_add_u32 m0, s52, 16384
    s_add_u32 s37, s46, 3670016
    buffer_load_dwordx4 v20, s[24:27], s37 offen lds
    v_mfma_f32_16x16x32_bf16 v[176:179], v[48:51], v[76:79], v[176:179]
    buffer_load_dwordx4 v21, s[24:27], s37 offen offset:1024 lds
    v_mfma_f32_16x16x32_bf16 v[180:183], v[52:55], v[76:79], v[180:183]
    v_mfma_f32_16x16x32_bf16 v[184:187], v[56:59], v[76:79], v[184:187]
    ds_read_b128 v[72:75], v2 offset:36864
    v_mfma_f32_16x16x32_bf16 v[188:191], v[60:63], v[76:79], v[188:191]
    s_waitcnt lgkmcnt(2)
    v_mfma_f32_16x16x32_bf16 v[128:131], v[32:35], v[64:67], v[128:131]
    v_mfma_f32_16x16x32_bf16 v[132:135], v[36:39], v[64:67], v[132:135]
    ds_read_b64_tr_b16 v[48:49], v6 offset:40960
    ds_read_b64_tr_b16 v[50:51], v6 offset:41984
    v_mfma_f32_16x16x32_bf16 v[136:139], v[40:43], v[64:67], v[136:139]
    ds_read_b128 v[76:79], v2 offset:38912
    ds_read_b64_tr_b16 v[52:53], v7 offset:40960
    v_mfma_f32_16x16x32_bf16 v[140:143], v[44:47], v[64:67], v[140:143]
    ds_read_b64_tr_b16 v[54:55], v7 offset:41984
    ds_read_b64_tr_b16 v[56:57], v8 offset:40960
    s_waitcnt lgkmcnt(7)
    v_mfma_f32_16x16x32_bf16 v[144:147], v[32:35], v[68:71], v[144:147]
    ds_read_b64_tr_b16 v[58:59], v8 offset:41984
    ds_read_b64_tr_b16 v[60:61], v9 offset:40960
    v_mfma_f32_16x16x32_bf16 v[148:151], v[36:39], v[68:71], v[148:151]
    ds_read_b64_tr_b16 v[62:63], v9 offset:41984
    v_mfma_f32_16x16x32_bf16 v[152:155], v[40:43], v[68:71], v[152:155]
    ds_read_b128 v[64:67], v3 offset:32768
    v_mfma_f32_16x16x32_bf16 v[156:159], v[44:47], v[68:71], v[156:159]
    s_waitcnt lgkmcnt(10)
    v_mfma_f32_16x16x32_bf16 v[160:163], v[32:35], v[72:75], v[160:163]
    v_mfma_f32_16x16x32_bf16 v[164:167], v[36:39], v[72:75], v[164:167]
    v_mfma_f32_16x16x32_bf16 v[168:171], v[40:43], v[72:75], v[168:171]
    ds_read_b128 v[68:71], v3 offset:34816
    v_mfma_f32_16x16x32_bf16 v[172:175], v[44:47], v[72:75], v[172:175]
    s_waitcnt lgkmcnt(8)
    v_mfma_f32_16x16x32_bf16 v[176:179], v[32:35], v[76:79], v[176:179]
    v_mfma_f32_16x16x32_bf16 v[180:183], v[36:39], v[76:79], v[180:183]
    v_mfma_f32_16x16x32_bf16 v[184:187], v[40:43], v[76:79], v[184:187]
    ds_read_b128 v[72:75], v3 offset:36864
    v_mfma_f32_16x16x32_bf16 v[188:191], v[44:47], v[76:79], v[188:191]
    s_waitcnt lgkmcnt(2)
    v_mfma_f32_16x16x32_bf16 v[128:131], v[48:51], v[64:67], v[128:131]
    v_mfma_f32_16x16x32_bf16 v[132:135], v[52:55], v[64:67], v[132:135]
    v_mfma_f32_16x16x32_bf16 v[136:139], v[56:59], v[64:67], v[136:139]
    ds_read_b128 v[76:79], v3 offset:38912
    v_mfma_f32_16x16x32_bf16 v[140:143], v[60:63], v[64:67], v[140:143]
    s_waitcnt lgkmcnt(2)
    v_mfma_f32_16x16x32_bf16 v[144:147], v[48:51], v[68:71], v[144:147]
    v_mfma_f32_16x16x32_bf16 v[148:151], v[52:55], v[68:71], v[148:151]
    s_waitcnt lgkmcnt(0)
    s_waitcnt vmcnt(6)
    s_barrier
    ds_read_b64_tr_b16 v[32:33], v6 offset:0
    ds_read_b64_tr_b16 v[34:35], v6 offset:1024
    v_mfma_f32_16x16x32_bf16 v[152:155], v[56:59], v[68:71], v[152:155]
    ds_read_b64_tr_b16 v[36:37], v7 offset:0
    ds_read_b64_tr_b16 v[38:39], v7 offset:1024
    s_add_u32 m0, s41, 32768
    s_add_u32 s37, s45, 1024
    buffer_load_dwordx4 v16, s[20:23], s37 offen lds
    v_mfma_f32_16x16x32_bf16 v[156:159], v[60:63], v[68:71], v[156:159]
    ds_read_b64_tr_b16 v[40:41], v8 offset:0
    ds_read_b64_tr_b16 v[42:43], v8 offset:1024
    buffer_load_dwordx4 v17, s[20:23], s37 offen offset:1024 lds
    v_mfma_f32_16x16x32_bf16 v[160:163], v[48:51], v[72:75], v[160:163]
    ds_read_b64_tr_b16 v[44:45], v9 offset:0
    ds_read_b64_tr_b16 v[46:47], v9 offset:1024
    buffer_load_dwordx4 v18, s[20:23], s37 offen offset:2048 lds
    v_mfma_f32_16x16x32_bf16 v[164:167], v[52:55], v[72:75], v[164:167]
    ds_read_b128 v[64:67], v4 offset:0
    buffer_load_dwordx4 v19, s[20:23], s37 offen offset:3072 lds
    v_mfma_f32_16x16x32_bf16 v[168:171], v[56:59], v[72:75], v[168:171]
    ds_read_b128 v[68:71], v4 offset:2048
    s_add_u32 m0, s52, 32768
    s_add_u32 s37, s46, 4194304
    buffer_load_dwordx4 v20, s[24:27], s37 offen lds
    v_mfma_f32_16x16x32_bf16 v[172:175], v[60:63], v[72:75], v[172:175]
    buffer_load_dwordx4 v21, s[24:27], s37 offen offset:1024 lds
    v_mfma_f32_16x16x32_bf16 v[176:179], v[48:51], v[76:79], v[176:179]
    v_mfma_f32_16x16x32_bf16 v[180:183], v[52:55], v[76:79], v[180:183]
    v_mfma_f32_16x16x32_bf16 v[184:187], v[56:59], v[76:79], v[184:187]
    ds_read_b128 v[72:75], v4 offset:4096
    v_mfma_f32_16x16x32_bf16 v[188:191], v[60:63], v[76:79], v[188:191]
    s_waitcnt lgkmcnt(2)
    v_mfma_f32_16x16x32_bf16 v[128:131], v[32:35], v[64:67], v[128:131]
    v_mfma_f32_16x16x32_bf16 v[132:135], v[36:39], v[64:67], v[132:135]
    ds_read_b64_tr_b16 v[48:49], v6 offset:8192
    ds_read_b64_tr_b16 v[50:51], v6 offset:9216
    v_mfma_f32_16x16x32_bf16 v[136:139], v[40:43], v[64:67], v[136:139]
    ds_read_b128 v[76:79], v4 offset:6144
    ds_read_b64_tr_b16 v[52:53], v7 offset:8192
    v_mfma_f32_16x16x32_bf16 v[140:143], v[44:47], v[64:67], v[140:143]
    ds_read_b64_tr_b16 v[54:55], v7 offset:9216
    ds_read_b64_tr_b16 v[56:57], v8 offset:8192
    s_waitcnt lgkmcnt(7)
    v_mfma_f32_16x16x32_bf16 v[144:147], v[32:35], v[68:71], v[144:147]
    ds_read_b64_tr_b16 v[58:59], v8 offset:9216
    ds_read_b64_tr_b16 v[60:61], v9 offset:8192
    v_mfma_f32_16x16x32_bf16 v[148:151], v[36:39], v[68:71], v[148:151]
    ds_read_b64_tr_b16 v[62:63], v9 offset:9216
    v_mfma_f32_16x16x32_bf16 v[152:155], v[40:43], v[68:71], v[152:155]
    ds_read_b128 v[64:67], v5 offset:0
    v_mfma_f32_16x16x32_bf16 v[156:159], v[44:47], v[68:71], v[156:159]
    s_waitcnt lgkmcnt(10)
    v_mfma_f32_16x16x32_bf16 v[160:163], v[32:35], v[72:75], v[160:163]
    v_mfma_f32_16x16x32_bf16 v[164:167], v[36:39], v[72:75], v[164:167]
    v_mfma_f32_16x16x32_bf16 v[168:171], v[40:43], v[72:75], v[168:171]
    ds_read_b128 v[68:71], v5 offset:2048
    v_mfma_f32_16x16x32_bf16 v[172:175], v[44:47], v[72:75], v[172:175]
    s_waitcnt lgkmcnt(8)
    v_mfma_f32_16x16x32_bf16 v[176:179], v[32:35], v[76:79], v[176:179]
    v_mfma_f32_16x16x32_bf16 v[180:183], v[36:39], v[76:79], v[180:183]
    v_mfma_f32_16x16x32_bf16 v[184:187], v[40:43], v[76:79], v[184:187]
    ds_read_b128 v[72:75], v5 offset:4096
    v_mfma_f32_16x16x32_bf16 v[188:191], v[44:47], v[76:79], v[188:191]
    s_waitcnt lgkmcnt(2)
    v_mfma_f32_16x16x32_bf16 v[128:131], v[48:51], v[64:67], v[128:131]
    v_mfma_f32_16x16x32_bf16 v[132:135], v[52:55], v[64:67], v[132:135]
    v_mfma_f32_16x16x32_bf16 v[136:139], v[56:59], v[64:67], v[136:139]
    ds_read_b128 v[76:79], v5 offset:6144
    v_mfma_f32_16x16x32_bf16 v[140:143], v[60:63], v[64:67], v[140:143]
    s_waitcnt lgkmcnt(2)
    v_mfma_f32_16x16x32_bf16 v[144:147], v[48:51], v[68:71], v[144:147]
    v_mfma_f32_16x16x32_bf16 v[148:151], v[52:55], v[68:71], v[148:151]
    s_waitcnt lgkmcnt(0)
    s_waitcnt vmcnt(6)
    s_barrier
    ds_read_b64_tr_b16 v[32:33], v6 offset:16384
    ds_read_b64_tr_b16 v[34:35], v6 offset:17408
    v_mfma_f32_16x16x32_bf16 v[152:155], v[56:59], v[68:71], v[152:155]
    ds_read_b64_tr_b16 v[36:37], v7 offset:16384
    ds_read_b64_tr_b16 v[38:39], v7 offset:17408
    s_cmp_lg_u32 s32, 1
    s_cbranch_scc1 ONLY_8
    s_lshl_b32 s3, s33, 12
    s_add_u32 s3, s3, 66715648
    buffer_load_dword v24, v26, s[12:15], s3 offen sc1
ONLY_8:
    v_mfma_f32_16x16x32_bf16 v[156:159], v[60:63], v[68:71], v[156:159]
    ds_read_b64_tr_b16 v[40:41], v8 offset:16384
    ds_read_b64_tr_b16 v[42:43], v8 offset:17408
    s_add_u32 m0, s41, 131072
    s_add_u32 s37, s45, 1152
    buffer_load_dwordx4 v16, s[20:23], s37 offen lds
    v_mfma_f32_16x16x32_bf16 v[160:163], v[48:51], v[72:75], v[160:163]
    ds_read_b64_tr_b16 v[44:45], v9 offset:16384
    ds_read_b64_tr_b16 v[46:47], v9 offset:17408
    buffer_load_dwordx4 v17, s[20:23], s37 offen offset:1024 lds
    v_mfma_f32_16x16x32_bf16 v[164:167], v[52:55], v[72:75], v[164:167]
    ds_read_b128 v[64:67], v2 offset:0
    buffer_load_dwordx4 v18, s[20:23], s37 offen offset:2048 lds
    v_mfma_f32_16x16x32_bf16 v[168:171], v[56:59], v[72:75], v[168:171]
    ds_read_b128 v[68:71], v2 offset:2048
    buffer_load_dwordx4 v19, s[20:23], s37 offen offset:3072 lds
    v_mfma_f32_16x16x32_bf16 v[172:175], v[60:63], v[72:75], v[172:175]
    s_add_u32 m0, s52, 0
    s_add_u32 s37, s46, 4718592
    buffer_load_dwordx4 v20, s[24:27], s37 offen lds
    v_mfma_f32_16x16x32_bf16 v[176:179], v[48:51], v[76:79], v[176:179]
    buffer_load_dwordx4 v21, s[24:27], s37 offen offset:1024 lds
    v_mfma_f32_16x16x32_bf16 v[180:183], v[52:55], v[76:79], v[180:183]
    v_mfma_f32_16x16x32_bf16 v[184:187], v[56:59], v[76:79], v[184:187]
    ds_read_b128 v[72:75], v2 offset:4096
    v_mfma_f32_16x16x32_bf16 v[188:191], v[60:63], v[76:79], v[188:191]
    s_waitcnt lgkmcnt(2)
    v_mfma_f32_16x16x32_bf16 v[128:131], v[32:35], v[64:67], v[128:131]
    v_mfma_f32_16x16x32_bf16 v[132:135], v[36:39], v[64:67], v[132:135]
    ds_read_b64_tr_b16 v[48:49], v6 offset:24576
    ds_read_b64_tr_b16 v[50:51], v6 offset:25600
    v_mfma_f32_16x16x32_bf16 v[136:139], v[40:43], v[64:67], v[136:139]
    ds_read_b128 v[76:79], v2 offset:6144
    ds_read_b64_tr_b16 v[52:53], v7 offset:24576
    v_mfma_f32_16x16x32_bf16 v[140:143], v[44:47], v[64:67], v[140:143]
    ds_read_b64_tr_b16 v[54:55], v7 offset:25600
    ds_read_b64_tr_b16 v[56:57], v8 offset:24576
    s_waitcnt lgkmcnt(7)
    v_mfma_f32_16x16x32_bf16 v[144:147], v[32:35], v[68:71], v[144:147]
    ds_read_b64_tr_b16 v[58:59], v8 offset:25600
    ds_read_b64_tr_b16 v[60:61], v9 offset:24576
    v_mfma_f32_16x16x32_bf16 v[148:151], v[36:39], v[68:71], v[148:151]
    ds_read_b64_tr_b16 v[62:63], v9 offset:25600
    v_mfma_f32_16x16x32_bf16 v[152:155], v[40:43], v[68:71], v[152:155]
    ds_read_b128 v[64:67], v3 offset:0
    v_mfma_f32_16x16x32_bf16 v[156:159], v[44:47], v[68:71], v[156:159]
    s_waitcnt lgkmcnt(10)
    v_mfma_f32_16x16x32_bf16 v[160:163], v[32:35], v[72:75], v[160:163]
    v_mfma_f32_16x16x32_bf16 v[164:167], v[36:39], v[72:75], v[164:167]
    v_mfma_f32_16x16x32_bf16 v[168:171], v[40:43], v[72:75], v[168:171]
    ds_read_b128 v[68:71], v3 offset:2048
    v_mfma_f32_16x16x32_bf16 v[172:175], v[44:47], v[72:75], v[172:175]
    s_waitcnt lgkmcnt(8)
    v_mfma_f32_16x16x32_bf16 v[176:179], v[32:35], v[76:79], v[176:179]
    v_mfma_f32_16x16x32_bf16 v[180:183], v[36:39], v[76:79], v[180:183]
    v_mfma_f32_16x16x32_bf16 v[184:187], v[40:43], v[76:79], v[184:187]
    ds_read_b128 v[72:75], v3 offset:4096
    v_mfma_f32_16x16x32_bf16 v[188:191], v[44:47], v[76:79], v[188:191]
    s_waitcnt lgkmcnt(2)
    v_mfma_f32_16x16x32_bf16 v[128:131], v[48:51], v[64:67], v[128:131]
    v_mfma_f32_16x16x32_bf16 v[132:135], v[52:55], v[64:67], v[132:135]
    v_mfma_f32_16x16x32_bf16 v[136:139], v[56:59], v[64:67], v[136:139]
    ds_read_b128 v[76:79], v3 offset:6144
    v_mfma_f32_16x16x32_bf16 v[140:143], v[60:63], v[64:67], v[140:143]
    s_waitcnt lgkmcnt(2)
    v_mfma_f32_16x16x32_bf16 v[144:147], v[48:51], v[68:71], v[144:147]
    v_mfma_f32_16x16x32_bf16 v[148:151], v[52:55], v[68:71], v[148:151]
    s_waitcnt lgkmcnt(0)
    s_cmp_lg_u32 s32, 1
    s_cbranch_scc1 POLL_9D
    s_lshl_b32 s3, s33, 12
    s_add_u32 s3, s3, 66715648
    s_mov_b32 s38, 0
    s_waitcnt vmcnt(6)
    s_branch POLL_9C
POLL_9:
    s_sleep 8
    buffer_load_dword v24, v26, s[12:15], s3 offen sc1
    s_waitcnt vmcnt(0)
POLL_9C:
    v_cmp_eq_u32 vcc, 0, v24
    s_add_u32 s38, s38, 1
    s_and_b32 s76, vcc_lo, 1
    s_cbranch_scc0 POLL_9D
    s_cmp_lt_u32 s38, 100000
    s_cbranch_scc1 POLL_9
POLL_9D:
    s_waitcnt vmcnt(6)
    s_barrier
    ds_read_b64_tr_b16 v[32:33], v6 offset:32768
    ds_read_b64_tr_b16 v[34:35], v6 offset:33792
    v_mfma_f32_16x16x32_bf16 v[152:155], v[56:59], v[68:71], v[152:155]
    ds_read_b64_tr_b16 v[36:37], v7 offset:32768
    ds_read_b64_tr_b16 v[38:39], v7 offset:33792
    s_mov_b32 s20, s12
    s_mov_b32 s21, s13
    s_mov_b32 s22, s18
    v_mfma_f32_16x16x32_bf16 v[156:159], v[60:63], v[68:71], v[156:159]
    ds_read_b64_tr_b16 v[40:41], v8 offset:32768
    ds_read_b64_tr_b16 v[42:43], v8 offset:33792
    s_add_u32 m0, s51, 0
    s_nop 0
    buffer_load_dwordx4 v1, s[20:23], s57 offen sc1 lds
    v_mfma_f32_16x16x32_bf16 v[160:163], v[48:51], v[72:75], v[160:163]
    ds_read_b64_tr_b16 v[44:45], v9 offset:32768
    ds_read_b64_tr_b16 v[46:47], v9 offset:33792
    buffer_load_dwordx4 v1, s[20:23], s57 offen offset:1024 sc1 lds
    v_mfma_f32_16x16x32_bf16 v[164:167], v[52:55], v[72:75], v[164:167]
    ds_read_b128 v[64:67], v2 offset:32768
    s_add_u32 m0, s51, 16384
    s_nop 0
    buffer_load_dwordx4 v1, s[20:23], s58 offen sc1 lds
    v_mfma_f32_16x16x32_bf16 v[168:171], v[56:59], v[72:75], v[168:171]
    ds_read_b128 v[68:71], v2 offset:34816
    buffer_load_dwordx4 v1, s[20:23], s58 offen offset:1024 sc1 lds
    v_mfma_f32_16x16x32_bf16 v[172:175], v[60:63], v[72:75], v[172:175]
    v_mfma_f32_16x16x32_bf16 v[176:179], v[48:51], v[76:79], v[176:179]
    v_mfma_f32_16x16x32_bf16 v[180:183], v[52:55], v[76:79], v[180:183]
    v_mfma_f32_16x16x32_bf16 v[184:187], v[56:59], v[76:79], v[184:187]
    ds_read_b128 v[72:75], v2 offset:36864
    v_mfma_f32_16x16x32_bf16 v[188:191], v[60:63], v[76:79], v[188:191]
    s_waitcnt lgkmcnt(2)
    v_mfma_f32_16x16x32_bf16 v[128:131], v[32:35], v[64:67], v[128:131]
    v_mfma_f32_16x16x32_bf16 v[132:135], v[36:39], v[64:67], v[132:135]
    ds_read_b64_tr_b16 v[48:49], v6 offset:40960
    ds_read_b64_tr_b16 v[50:51], v6 offset:41984
    v_mfma_f32_16x16x32_bf16 v[136:139], v[40:43], v[64:67], v[136:139]
    ds_read_b128 v[76:79], v2 offset:38912
    ds_read_b64_tr_b16 v[52:53], v7 offset:40960
    v_mfma_f32_16x16x32_bf16 v[140:143], v[44:47], v[64:67], v[140:143]
    ds_read_b64_tr_b16 v[54:55], v7 offset:41984
    ds_read_b64_tr_b16 v[56:57], v8 offset:40960
    s_waitcnt lgkmcnt(7)
    v_mfma_f32_16x16x32_bf16 v[144:147], v[32:35], v[68:71], v[144:147]
    ds_read_b64_tr_b16 v[58:59], v8 offset:41984
    ds_read_b64_tr_b16 v[60:61], v9 offset:40960
    v_mfma_f32_16x16x32_bf16 v[148:151], v[36:39], v[68:71], v[148:151]
    ds_read_b64_tr_b16 v[62:63], v9 offset:41984
    v_mfma_f32_16x16x32_bf16 v[152:155], v[40:43], v[68:71], v[152:155]
    ds_read_b128 v[64:67], v3 offset:32768
    v_mfma_f32_16x16x32_bf16 v[156:159], v[44:47], v[68:71], v[156:159]
    s_waitcnt lgkmcnt(10)
    v_mfma_f32_16x16x32_bf16 v[160:163], v[32:35], v[72:75], v[160:163]
    v_mfma_f32_16x16x32_bf16 v[164:167], v[36:39], v[72:75], v[164:167]
    v_mfma_f32_16x16x32_bf16 v[168:171], v[40:43], v[72:75], v[168:171]
    ds_read_b128 v[68:71], v3 offset:34816
    v_mfma_f32_16x16x32_bf16 v[172:175], v[44:47], v[72:75], v[172:175]
    s_waitcnt lgkmcnt(8)
    v_mfma_f32_16x16x32_bf16 v[176:179], v[32:35], v[76:79], v[176:179]
    v_mfma_f32_16x16x32_bf16 v[180:183], v[36:39], v[76:79], v[180:183]
    v_mfma_f32_16x16x32_bf16 v[184:187], v[40:43], v[76:79], v[184:187]
    ds_read_b128 v[72:75], v3 offset:36864
    v_mfma_f32_16x16x32_bf16 v[188:191], v[44:47], v[76:79], v[188:191]
    s_waitcnt lgkmcnt(2)
    v_mfma_f32_16x16x32_bf16 v[128:131], v[48:51], v[64:67], v[128:131]
    v_mfma_f32_16x16x32_bf16 v[132:135], v[52:55], v[64:67], v[132:135]
    v_mfma_f32_16x16x32_bf16 v[136:139], v[56:59], v[64:67], v[136:139]
    ds_read_b128 v[76:79], v3 offset:38912
    v_mfma_f32_16x16x32_bf16 v[140:143], v[60:63], v[64:67], v[140:143]
    s_waitcnt lgkmcnt(2)
    v_mfma_f32_16x16x32_bf16 v[144:147], v[48:51], v[68:71], v[144:147]
    v_mfma_f32_16x16x32_bf16 v[148:151], v[52:55], v[68:71], v[148:151]
    s_waitcnt lgkmcnt(0)
    s_waitcnt vmcnt(4)
    s_barrier
    ds_read_b64_tr_b16 v[32:33], v6 offset:0
    ds_read_b64_tr_b16 v[34:35], v6 offset:1024
    v_mfma_f32_16x16x32_bf16 v[152:155], v[56:59], v[68:71], v[152:155]
    ds_read_b64_tr_b16 v[36:37], v7 offset:0
    ds_read_b64_tr_b16 v[38:39], v7 offset:1024
    s_add_u32 m0, s51, 32768
    s_nop 0
    buffer_load_dwordx4 v1, s[20:23], s59 offen sc1 lds
    v_mfma_f32_16x16x32_bf16 v[156:159], v[60:63], v[68:71], v[156:159]
    ds_read_b64_tr_b16 v[40:41], v8 offset:0
    ds_read_b64_tr_b16 v[42:43], v8 offset:1024
    buffer_load_dwordx4 v1, s[20:23], s59 offen offset:1024 sc1 lds
    v_mfma_f32_16x16x32_bf16 v[160:163], v[48:51], v[72:75], v[160:163]
    ds_read_b64_tr_b16 v[44:45], v9 offset:0
    ds_read_b64_tr_b16 v[46:47], v9 offset:1024
    v_mfma_f32_16x16x32_bf16 v[164:167], v[52:55], v[72:75], v[164:167]
    ds_read_b128 v[64:67], v4 offset:0
    v_mfma_f32_16x16x32_bf16 v[168:171], v[56:59], v[72:75], v[168:171]
    ds_read_b128 v[68:71], v4 offset:2048
    v_mfma_f32_16x16x32_bf16 v[172:175], v[60:63], v[72:75], v[172:175]
    v_mfma_f32_16x16x32_bf16 v[176:179], v[48:51], v[76:79], v[176:179]
    v_mfma_f32_16x16x32_bf16 v[180:183], v[52:55], v[76:79], v[180:183]
    v_mfma_f32_16x16x32_bf16 v[184:187], v[56:59], v[76:79], v[184:187]
    ds_read_b128 v[72:75], v4 offset:4096
    v_mfma_f32_16x16x32_bf16 v[188:191], v[60:63], v[76:79], v[188:191]
    s_waitcnt lgkmcnt(2)
    v_mfma_f32_16x16x32_bf16 v[128:131], v[32:35], v[64:67], v[128:131]
    v_mfma_f32_16x16x32_bf16 v[132:135], v[36:39], v[64:67], v[132:135]
    ds_read_b64_tr_b16 v[48:49], v6 offset:8192
    ds_read_b64_tr_b16 v[50:51], v6 offset:9216
    v_mfma_f32_16x16x32_bf16 v[136:139], v[40:43], v[64:67], v[136:139]
    ds_read_b128 v[76:79], v4 offset:6144
    ds_read_b64_tr_b16 v[52:53], v7 offset:8192
    v_mfma_f32_16x16x32_bf16 v[140:143], v[44:47], v[64:67], v[140:143]
    ds_read_b64_tr_b16 v[54:55], v7 offset:9216
    ds_read_b64_tr_b16 v[56:57], v8 offset:8192
    s_waitcnt lgkmcnt(7)
    v_mfma_f32_16x16x32_bf16 v[144:147], v[32:35], v[68:71], v[144:147]
    ds_read_b64_tr_b16 v[58:59], v8 offset:9216
    ds_read_b64_tr_b16 v[60:61], v9 offset:8192
    v_mfma_f32_16x16x32_bf16 v[148:151], v[36:39], v[68:71], v[148:151]
    ds_read_b64_tr_b16 v[62:63], v9 offset:9216
    v_mfma_f32_16x16x32_bf16 v[152:155], v[40:43], v[68:71], v[152:155]
    ds_read_b128 v[64:67], v5 offset:0
    v_mfma_f32_16x16x32_bf16 v[156:159], v[44:47], v[68:71], v[156:159]
    s_waitcnt lgkmcnt(10)
    v_mfma_f32_16x16x32_bf16 v[160:163], v[32:35], v[72:75], v[160:163]
    v_mfma_f32_16x16x32_bf16 v[164:167], v[36:39], v[72:75], v[164:167]
    v_mfma_f32_16x16x32_bf16 v[168:171], v[40:43], v[72:75], v[168:171]
    ds_read_b128 v[68:71], v5 offset:2048
    v_mfma_f32_16x16x32_bf16 v[172:175], v[44:47], v[72:75], v[172:175]
    s_waitcnt lgkmcnt(8)
    v_mfma_f32_16x16x32_bf16 v[176:179], v[32:35], v[76:79], v[176:179]
    v_mfma_f32_16x16x32_bf16 v[180:183], v[36:39], v[76:79], v[180:183]
    v_mfma_f32_16x16x32_bf16 v[184:187], v[40:43], v[76:79], v[184:187]
    ds_read_b128 v[72:75], v5 offset:4096
    v_mfma_f32_16x16x32_bf16 v[188:191], v[44:47], v[76:79], v[188:191]
    s_waitcnt lgkmcnt(2)
    v_mfma_f32_16x16x32_bf16 v[128:131], v[48:51], v[64:67], v[128:131]
    v_mfma_f32_16x16x32_bf16 v[132:135], v[52:55], v[64:67], v[132:135]
    v_mfma_f32_16x16x32_bf16 v[136:139], v[56:59], v[64:67], v[136:139]
    ds_read_b128 v[76:79], v5 offset:6144
    v_mfma_f32_16x16x32_bf16 v[140:143], v[60:63], v[64:67], v[140:143]
    s_waitcnt lgkmcnt(2)
    v_mfma_f32_16x16x32_bf16 v[144:147], v[48:51], v[68:71], v[144:147]
    v_mfma_f32_16x16x32_bf16 v[148:151], v[52:55], v[68:71], v[148:151]
    s_waitcnt lgkmcnt(0)
    s_barrier
    v_mfma_f32_16x16x32_bf16 v[152:155], v[56:59], v[68:71], v[152:155]
    v_mfma_f32_16x16x32_bf16 v[156:159], v[60:63], v[68:71], v[156:159]
    v_mfma_f32_16x16x32_bf16 v[160:163], v[48:51], v[72:75], v[160:163]
    v_mfma_f32_16x16x32_bf16 v[164:167], v[52:55], v[72:75], v[164:167]
    v_mfma_f32_16x16x32_bf16 v[168:171], v[56:59], v[72:75], v[168:171]
    v_mfma_f32_16x16x32_bf16 v[172:175], v[60:63], v[72:75], v[172:175]
    v_mfma_f32_16x16x32_bf16 v[176:179], v[48:51], v[76:79], v[176:179]
    v_mfma_f32_16x16x32_bf16 v[180:183], v[52:55], v[76:79], v[180:183]
    v_mfma_f32_16x16x32_bf16 v[184:187], v[56:59], v[76:79], v[184:187]
    v_mfma_f32_16x16x32_bf16 v[188:191], v[60:63], v[76:79], v[188:191]
    s_branch M_KVD
M_KVV:
    ds_read_b64_tr_b16 v[32:33], v12 offset:0
    ds_read_b64_tr_b16 v[34:35], v12 offset:1024
    ds_read_b64_tr_b16 v[36:37], v13 offset:0
    ds_read_b64_tr_b16 v[38:39], v13 offset:1024
    ds_read_b64_tr_b16 v[40:41], v14 offset:0
    ds_read_b64_tr_b16 v[42:43], v14 offset:1024
    ds_read_b64_tr_b16 v[44:45], v15 offset:0
    ds_read_b64_tr_b16 v[46:47], v15 offset:1024
    ds_read_b128 v[64:67], v10 offset:0
    s_waitcnt lgkmcnt(0)
    v_mfma_f32_16x16x32_bf16 v[128:131], v[64:67], v[32:35], 0
    ds_read_b128 v[68:71], v10 offset:2048
    ds_read_b128 v[72:75], v10 offset:4096
    v_mfma_f32_16x16x32_bf16 v[136:139], v[64:67], v[36:39], 0
    ds_read_b128 v[76:79], v10 offset:6144
    v_mfma_f32_16x16x32_bf16 v[144:147], v[64:67], v[40:43], 0
    v_mfma_f32_16x16x32_bf16 v[152:155], v[64:67], v[44:47], 0
    s_waitcnt lgkmcnt(2)
    v_mfma_f32_16x16x32_bf16 v[132:135], v[68:71], v[32:35], 0
    ds_read_b128 v[64:67], v10 offset:8192
    v_mfma_f32_16x16x32_bf16 v[140:143], v[68:71], v[36:39], 0
    v_mfma_f32_16x16x32_bf16 v[148:151], v[68:71], v[40:43], 0
    v_mfma_f32_16x16x32_bf16 v[156:159], v[68:71], v[44:47], 0
    s_waitcnt lgkmcnt(2)
    v_mfma_f32_16x16x32_bf16 v[160:163], v[72:75], v[32:35], 0
    ds_read_b128 v[68:71], v10 offset:10240
    v_mfma_f32_16x16x32_bf16 v[168:171], v[72:75], v[36:39], 0
    v_mfma_f32_16x16x32_bf16 v[176:179], v[72:75], v[40:43], 0
    v_mfma_f32_16x16x32_bf16 v[184:187], v[72:75], v[44:47], 0
    s_waitcnt lgkmcnt(2)
    v_mfma_f32_16x16x32_bf16 v[164:167], v[76:79], v[32:35], 0
    ds_read_b128 v[72:75], v10 offset:12288
    v_mfma_f32_16x16x32_bf16 v[172:175], v[76:79], v[36:39], 0
    v_mfma_f32_16x16x32_bf16 v[180:183], v[76:79], v[40:43], 0
    ds_read_b64_tr_b16 v[48:49], v12 offset:8192
    ds_read_b64_tr_b16 v[50:51], v12 offset:9216
    v_mfma_f32_16x16x32_bf16 v[188:191], v[76:79], v[44:47], 0
    ds_read_b64_tr_b16 v[52:53], v13 offset:8192
    ds_read_b64_tr_b16 v[54:55], v13 offset:9216
    s_waitcnt lgkmcnt(6)
    v_mfma_f32_16x16x32_bf16 v[192:195], v[64:67], v[32:35], 0
    ds_read_b128 v[76:79], v10 offset:14336
    ds_read_b64_tr_b16 v[56:57], v14 offset:8192
    v_mfma_f32_16x16x32_bf16 v[200:203], v[64:67], v[36:39], 0
    ds_read_b64_tr_b16 v[58:59], v14 offset:9216
    ds_read_b64_tr_b16 v[60:61], v15 offset:8192
    v_mfma_f32_16x16x32_bf16 v[208:211], v[64:67], v[40:43], 0
    ds_read_b64_tr_b16 v[62:63], v15 offset:9216
    v_mfma_f32_16x16x32_bf16 v[216:219], v[64:67], v[44:47], 0
    s_waitcnt lgkmcnt(10)
    v_mfma_f32_16x16x32_bf16 v[196:199], v[68:71], v[32:35], 0
    ds_read_b128 v[64:67], v11 offset:0
    v_mfma_f32_16x16x32_bf16 v[204:207], v[68:71], v[36:39], 0
    v_mfma_f32_16x16x32_bf16 v[212:215], v[68:71], v[40:43], 0
    v_mfma_f32_16x16x32_bf16 v[220:223], v[68:71], v[44:47], 0
    s_waitcnt lgkmcnt(10)
    v_mfma_f32_16x16x32_bf16 v[224:227], v[72:75], v[32:35], 0
    ds_read_b128 v[68:71], v11 offset:2048
    v_mfma_f32_16x16x32_bf16 v[232:235], v[72:75], v[36:39], 0
    v_mfma_f32_16x16x32_bf16 v[240:243], v[72:75], v[40:43], 0
    v_mfma_f32_16x16x32_bf16 v[248:251], v[72:75], v[44:47], 0
    s_waitcnt lgkmcnt(6)
    v_mfma_f32_16x16x32_bf16 v[228:231], v[76:79], v[32:35], 0
    ds_read_b128 v[72:75], v11 offset:4096
    v_mfma_f32_16x16x32_bf16 v[236:239], v[76:79], v[36:39], 0
    v_mfma_f32_16x16x32_bf16 v[244:247], v[76:79], v[40:43], 0
    v_mfma_f32_16x16x32_bf16 v[252:255], v[76:79], v[44:47], 0
    s_waitcnt lgkmcnt(2)
    v_mfma_f32_16x16x32_bf16 v[128:131], v[64:67], v[48:51], v[128:131]
    ds_read_b128 v[76:79], v11 offset:6144
    v_mfma_f32_16x16x32_bf16 v[136:139], v[64:67], v[52:55], v[136:139]
    v_mfma_f32_16x16x32_bf16 v[144:147], v[64:67], v[56:59], v[144:147]
    v_mfma_f32_16x16x32_bf16 v[152:155], v[64:67], v[60:63], v[152:155]
    s_waitcnt lgkmcnt(2)
    v_mfma_f32_16x16x32_bf16 v[132:135], v[68:71], v[48:51], v[132:135]
    ds_read_b128 v[64:67], v11 offset:8192
    v_mfma_f32_16x16x32_bf16 v[140:143], v[68:71], v[52:55], v[140:143]
    v_mfma_f32_16x16x32_bf16 v[148:151], v[68:71], v[56:59], v[148:151]
    v_mfma_f32_16x16x32_bf16 v[156:159], v[68:71], v[60:63], v[156:159]
    s_waitcnt lgkmcnt(2)
    v_mfma_f32_16x16x32_bf16 v[160:163], v[72:75], v[48:51], v[160:163]
    ds_read_b128 v[68:71], v11 offset:10240
    v_mfma_f32_16x16x32_bf16 v[168:171], v[72:75], v[52:55], v[168:171]
    v_mfma_f32_16x16x32_bf16 v[176:179], v[72:75], v[56:59], v[176:179]
    v_mfma_f32_16x16x32_bf16 v[184:187], v[72:75], v[60:63], v[184:187]
    s_waitcnt lgkmcnt(2)
    v_mfma_f32_16x16x32_bf16 v[164:167], v[76:79], v[48:51], v[164:167]
    ds_read_b128 v[72:75], v11 offset:12288
    v_mfma_f32_16x16x32_bf16 v[172:175], v[76:79], v[52:55], v[172:175]
    v_mfma_f32_16x16x32_bf16 v[180:183], v[76:79], v[56:59], v[180:183]
    v_mfma_f32_16x16x32_bf16 v[188:191], v[76:79], v[60:63], v[188:191]
    s_waitcnt lgkmcnt(2)
    v_mfma_f32_16x16x32_bf16 v[192:195], v[64:67], v[48:51], v[192:195]
    ds_read_b128 v[76:79], v11 offset:14336
    v_mfma_f32_16x16x32_bf16 v[200:203], v[64:67], v[52:55], v[200:203]
    v_mfma_f32_16x16x32_bf16 v[208:211], v[64:67], v[56:59], v[208:211]
    v_mfma_f32_16x16x32_bf16 v[216:219], v[64:67], v[60:63], v[216:219]
    s_waitcnt lgkmcnt(0)
    s_waitcnt vmcnt(6)
    s_barrier
    ds_read_b64_tr_b16 v[32:33], v12 offset:32768
    ds_read_b64_tr_b16 v[34:35], v12 offset:33792
    v_mfma_f32_16x16x32_bf16 v[196:199], v[68:71], v[48:51], v[196:199]
    ds_read_b64_tr_b16 v[36:37], v13 offset:32768
    ds_read_b64_tr_b16 v[38:39], v13 offset:33792
    v_mfma_f32_16x16x32_bf16 v[204:207], v[68:71], v[52:55], v[204:207]
    ds_read_b64_tr_b16 v[40:41], v14 offset:32768
    ds_read_b64_tr_b16 v[42:43], v14 offset:33792
    v_mfma_f32_16x16x32_bf16 v[212:215], v[68:71], v[56:59], v[212:215]
    ds_read_b64_tr_b16 v[44:45], v15 offset:32768
    ds_read_b64_tr_b16 v[46:47], v15 offset:33792
    v_mfma_f32_16x16x32_bf16 v[220:223], v[68:71], v[60:63], v[220:223]
    ds_read_b128 v[64:67], v10 offset:32768
    v_mfma_f32_16x16x32_bf16 v[224:227], v[72:75], v[48:51], v[224:227]
    ds_read_b128 v[68:71], v10 offset:34816
    v_mfma_f32_16x16x32_bf16 v[232:235], v[72:75], v[52:55], v[232:235]
    v_mfma_f32_16x16x32_bf16 v[240:243], v[72:75], v[56:59], v[240:243]
    v_mfma_f32_16x16x32_bf16 v[248:251], v[72:75], v[60:63], v[248:251]
    v_mfma_f32_16x16x32_bf16 v[228:231], v[76:79], v[48:51], v[228:231]
    ds_read_b128 v[72:75], v10 offset:36864
    v_mfma_f32_16x16x32_bf16 v[236:239], v[76:79], v[52:55], v[236:239]
    v_mfma_f32_16x16x32_bf16 v[244:247], v[76:79], v[56:59], v[244:247]
    v_mfma_f32_16x16x32_bf16 v[252:255], v[76:79], v[60:63], v[252:255]
    s_waitcnt lgkmcnt(2)
    v_mfma_f32_16x16x32_bf16 v[128:131], v[64:67], v[32:35], v[128:131]
    ds_read_b128 v[76:79], v10 offset:38912
    v_mfma_f32_16x16x32_bf16 v[136:139], v[64:67], v[36:39], v[136:139]
    v_mfma_f32_16x16x32_bf16 v[144:147], v[64:67], v[40:43], v[144:147]
    s_add_u32 m0, s41, 0
    s_add_u32 s37, s39, 256
    buffer_load_dwordx4 v2, s[4:7], s37 offen lds
    v_mfma_f32_16x16x32_bf16 v[152:155], v[64:67], v[44:47], v[152:155]
    buffer_load_dwordx4 v3, s[4:7], s37 offen offset:1024 lds
    s_waitcnt lgkmcnt(2)
    v_mfma_f32_16x16x32_bf16 v[132:135], v[68:71], v[32:35], v[132:135]
    ds_read_b128 v[64:67], v10 offset:40960
    buffer_load_dwordx4 v4, s[4:7], s37 offen offset:2048 lds
    v_mfma_f32_16x16x32_bf16 v[140:143], v[68:71], v[36:39], v[140:143]
    buffer_load_dwordx4 v5, s[4:7], s37 offen offset:3072 lds
    v_mfma_f32_16x16x32_bf16 v[148:151], v[68:71], v[40:43], v[148:151]
    s_add_u32 m0, s42, 0
    s_add_u32 s37, s40, 1048576
    buffer_load_dwordx4 v6, s[8:11], s37 offen lds
    v_mfma_f32_16x16x32_bf16 v[156:159], v[68:71], v[44:47], v[156:159]
    buffer_load_dwordx4 v7, s[8:11], s37 offen offset:1024 lds
    s_waitcnt lgkmcnt(2)
    v_mfma_f32_16x16x32_bf16 v[160:163], v[72:75], v[32:35], v[160:163]
    ds_read_b128 v[68:71], v10 offset:43008
    buffer_load_dwordx4 v8, s[8:11], s37 offen offset:2048 lds
    v_mfma_f32_16x16x32_bf16 v[168:171], v[72:75], v[36:39], v[168:171]
    buffer_load_dwordx4 v9, s[8:11], s37 offen offset:3072 lds
    v_mfma_f32_16x16x32_bf16 v[176:179], v[72:75], v[40:43], v[176:179]
    s_mov_b64 exec, 0xfff
    buffer_load_dword v117, v115, s[8:11], s61 offen sc1
    s_mov_b64 exec, -1
    v_mfma_f32_16x16x32_bf16 v[184:187], v[72:75], v[44:47], v[184:187]
    s_mov_b32 s76, s64
    s_mov_b32 s77, s65
    s_mov_b32 s78, 2621440
    s_mul_i32 s3, s32, 7680
    s_add_u32 s3, s3, 0
    v_add_u32 v28, s3, v27
    s_mul_i32 s3, s32, 960
    s_add_u32 m0, s3, 131072
    s_mov_b32 exec_hi, 0xfffffff
    buffer_load_dwordx4 v28, s[76:79], 0 offen lds
    s_mov_b32 exec_hi, -1
    s_waitcnt lgkmcnt(2)
    v_mfma_f32_16x16x32_bf16 v[164:167], v[76:79], v[32:35], v[164:167]
    ds_read_b128 v[72:75], v10 offset:45056
    s_mov_b32 s76, s66
    s_mov_b32 s77, s67
    s_mov_b32 s78, 2621440
    s_mul_i32 s3, s32, 7680
    s_add_u32 s3, s3, -26880
    v_add_u32 v28, s3, v27
    s_mul_i32 s3, s32, 960
    s_add_u32 m0, s3, 138752
    s_mov_b32 exec_hi, 0xfffffff
    buffer_load_dwordx4 v28, s[76:79], 0 offen lds
    s_mov_b32 exec_hi, -1
    v_mfma_f32_16x16x32_bf16 v[172:175], v[76:79], v[36:39], v[172:175]
    s_mov_b32 s76, s66
    s_mov_b32 s77, s67
    s_mov_b32 s78, 2621440
    s_mul_i32 s3, s32, 7680
    s_add_u32 s3, s3, 34560
    v_add_u32 v28, s3, v27
    s_mul_i32 s3, s32, 960
    s_add_u32 m0, s3, 146432
    s_mov_b32 exec_hi, 0xfffffff
    buffer_load_dwordx4 v28, s[76:79], 0 offen lds
    s_mov_b32 exec_hi, -1
    v_mfma_f32_16x16x32_bf16 v[180:183], v[76:79], v[40:43], v[180:183]
    ds_read_b64_tr_b16 v[48:49], v12 offset:40960
    ds_read_b64_tr_b16 v[50:51], v12 offset:41984
    s_mov_b32 s76, s68
    s_mov_b32 s77, s69
    s_mov_b32 s78, 5120
    buffer_load_dwordx4 v[110:113], v26, s[76:79], 0 offen
    v_mfma_f32_16x16x32_bf16 v[188:191], v[76:79], v[44:47], v[188:191]
    ds_read_b64_tr_b16 v[52:53], v13 offset:40960
    ds_read_b64_tr_b16 v[54:55], v13 offset:41984
    s_waitcnt lgkmcnt(6)
    v_mfma_f32_16x16x32_bf16 v[192:195], v[64:67], v[32:35], v[192:195]
    ds_read_b128 v[76:79], v10 offset:47104
    ds_read_b64_tr_b16 v[56:57], v14 offset:40960
    v_mfma_f32_16x16x32_bf16 v[200:203], v[64:67], v[36:39], v[200:203]
    ds_read_b64_tr_b16 v[58:59], v14 offset:41984
    ds_read_b64_tr_b16 v[60:61], v15 offset:40960
    v_mfma_f32_16x16x32_bf16 v[208:211], v[64:67], v[40:43], v[208:211]
    ds_read_b64_tr_b16 v[62:63], v15 offset:41984
    v_mfma_f32_16x16x32_bf16 v[216:219], v[64:67], v[44:47], v[216:219]
    s_waitcnt lgkmcnt(10)
    v_mfma_f32_16x16x32_bf16 v[196:199], v[68:71], v[32:35], v[196:199]
    ds_read_b128 v[64:67], v11 offset:32768
    v_mfma_f32_16x16x32_bf16 v[204:207], v[68:71], v[36:39], v[204:207]
    v_mfma_f32_16x16x32_bf16 v[212:215], v[68:71], v[40:43], v[212:215]
    v_mfma_f32_16x16x32_bf16 v[220:223], v[68:71], v[44:47], v[220:223]
    s_waitcnt lgkmcnt(10)
    v_mfma_f32_16x16x32_bf16 v[224:227], v[72:75], v[32:35], v[224:227]
    ds_read_b128 v[68:71], v11 offset:34816
    v_mfma_f32_16x16x32_bf16 v[232:235], v[72:75], v[36:39], v[232:235]
    v_mfma_f32_16x16x32_bf16 v[240:243], v[72:75], v[40:43], v[240:243]
    v_mfma_f32_16x16x32_bf16 v[248:251], v[72:75], v[44:47], v[248:251]
    s_waitcnt lgkmcnt(6)
    v_mfma_f32_16x16x32_bf16 v[228:231], v[76:79], v[32:35], v[228:231]
    ds_read_b128 v[72:75], v11 offset:36864
    v_mfma_f32_16x16x32_bf16 v[236:239], v[76:79], v[36:39], v[236:239]
    v_mfma_f32_16x16x32_bf16 v[244:247], v[76:79], v[40:43], v[244:247]
    v_mfma_f32_16x16x32_bf16 v[252:255], v[76:79], v[44:47], v[252:255]
    s_waitcnt lgkmcnt(2)
    v_mfma_f32_16x16x32_bf16 v[128:131], v[64:67], v[48:51], v[128:131]
    ds_read_b128 v[76:79], v11 offset:38912
    v_mfma_f32_16x16x32_bf16 v[136:139], v[64:67], v[52:55], v[136:139]
    v_mfma_f32_16x16x32_bf16 v[144:147], v[64:67], v[56:59], v[144:147]
    v_mfma_f32_16x16x32_bf16 v[152:155], v[64:67], v[60:63], v[152:155]
    s_waitcnt lgkmcnt(2)
    v_mfma_f32_16x16x32_bf16 v[132:135], v[68:71], v[48:51], v[132:135]
    ds_read_b128 v[64:67], v11 offset:40960
    v_mfma_f32_16x16x32_bf16 v[140:143], v[68:71], v[52:55], v[140:143]
    v_mfma_f32_16x16x32_bf16 v[148:151], v[68:71], v[56:59], v[148:151]
    v_mfma_f32_16x16x32_bf16 v[156:159], v[68:71], v[60:63], v[156:159]
    s_waitcnt lgkmcnt(2)
    v_mfma_f32_16x16x32_bf16 v[160:163], v[72:75], v[48:51], v[160:163]
    ds_read_b128 v[68:71], v11 offset:43008
    v_mfma_f32_16x16x32_bf16 v[168:171], v[72:75], v[52:55], v[168:171]
    v_mfma_f32_16x16x32_bf16 v[176:179], v[72:75], v[56:59], v[176:179]
    v_mfma_f32_16x16x32_bf16 v[184:187], v[72:75], v[60:63], v[184:187]
    s_waitcnt lgkmcnt(2)
    v_mfma_f32_16x16x32_bf16 v[164:167], v[76:79], v[48:51], v[164:167]
    ds_read_b128 v[72:75], v11 offset:45056
    v_mfma_f32_16x16x32_bf16 v[172:175], v[76:79], v[52:55], v[172:175]
    v_mfma_f32_16x16x32_bf16 v[180:183], v[76:79], v[56:59], v[180:183]
    v_mfma_f32_16x16x32_bf16 v[188:191], v[76:79], v[60:63], v[188:191]
    s_waitcnt lgkmcnt(2)
    v_mfma_f32_16x16x32_bf16 v[192:195], v[64:67], v[48:51], v[192:195]
    ds_read_b128 v[76:79], v11 offset:47104
    v_mfma_f32_16x16x32_bf16 v[200:203], v[64:67], v[52:55], v[200:203]
    v_mfma_f32_16x16x32_bf16 v[208:211], v[64:67], v[56:59], v[208:211]
    v_mfma_f32_16x16x32_bf16 v[216:219], v[64:67], v[60:63], v[216:219]
    s_waitcnt lgkmcnt(0)
    s_waitcnt vmcnt(5)
    s_barrier
    ds_read_b64_tr_b16 v[32:33], v12 offset:0
    ds_read_b64_tr_b16 v[34:35], v12 offset:1024
    v_mfma_f32_16x16x32_bf16 v[196:199], v[68:71], v[48:51], v[196:199]
    ds_read_b64_tr_b16 v[36:37], v13 offset:0
    ds_read_b64_tr_b16 v[38:39], v13 offset:1024
    v_mfma_f32_16x16x32_bf16 v[204:207], v[68:71], v[52:55], v[204:207]
    ds_read_b64_tr_b16 v[40:41], v14 offset:0
    ds_read_b64_tr_b16 v[42:43], v14 offset:1024
    v_mfma_f32_16x16x32_bf16 v[212:215], v[68:71], v[56:59], v[212:215]
    ds_read_b64_tr_b16 v[44:45], v15 offset:0
    ds_read_b64_tr_b16 v[46:47], v15 offset:1024
    v_mfma_f32_16x16x32_bf16 v[220:223], v[68:71], v[60:63], v[220:223]
    ds_read_b128 v[64:67], v10 offset:0
    v_mfma_f32_16x16x32_bf16 v[224:227], v[72:75], v[48:51], v[224:227]
    ds_read_b128 v[68:71], v10 offset:2048
    v_mfma_f32_16x16x32_bf16 v[232:235], v[72:75], v[52:55], v[232:235]
    v_mfma_f32_16x16x32_bf16 v[240:243], v[72:75], v[56:59], v[240:243]
    v_mfma_f32_16x16x32_bf16 v[248:251], v[72:75], v[60:63], v[248:251]
    v_mfma_f32_16x16x32_bf16 v[228:231], v[76:79], v[48:51], v[228:231]
    ds_read_b128 v[72:75], v10 offset:4096
    v_mfma_f32_16x16x32_bf16 v[236:239], v[76:79], v[52:55], v[236:239]
    v_mfma_f32_16x16x32_bf16 v[244:247], v[76:79], v[56:59], v[244:247]
    v_mfma_f32_16x16x32_bf16 v[252:255], v[76:79], v[60:63], v[252:255]
    s_waitcnt lgkmcnt(2)
    v_mfma_f32_16x16x32_bf16 v[128:131], v[64:67], v[32:35], v[128:131]
    ds_read_b128 v[76:79], v10 offset:6144
    v_mfma_f32_16x16x32_bf16 v[136:139], v[64:67], v[36:39], v[136:139]
    v_mfma_f32_16x16x32_bf16 v[144:147], v[64:67], v[40:43], v[144:147]
    s_add_u32 m0, s41, 32768
    s_add_u32 s37, s39, 384
    buffer_load_dwordx4 v2, s[4:7], s37 offen lds
    v_mfma_f32_16x16x32_bf16 v[152:155], v[64:67], v[44:47], v[152:155]
    buffer_load_dwordx4 v3, s[4:7], s37 offen offset:1024 lds
    s_waitcnt lgkmcnt(2)
    v_mfma_f32_16x16x32_bf16 v[132:135], v[68:71], v[32:35], v[132:135]
    ds_read_b128 v[64:67], v10 offset:8192
    buffer_load_dwordx4 v4, s[4:7], s37 offen offset:2048 lds
    v_mfma_f32_16x16x32_bf16 v[140:143], v[68:71], v[36:39], v[140:143]
    buffer_load_dwordx4 v5, s[4:7], s37 offen offset:3072 lds
    v_mfma_f32_16x16x32_bf16 v[148:151], v[68:71], v[40:43], v[148:151]
    s_add_u32 m0, s42, 32768
    s_add_u32 s37, s40, 1572864
    buffer_load_dwordx4 v6, s[8:11], s37 offen lds
    v_mfma_f32_16x16x32_bf16 v[156:159], v[68:71], v[44:47], v[156:159]
    buffer_load_dwordx4 v7, s[8:11], s37 offen offset:1024 lds
    s_waitcnt lgkmcnt(2)
    v_mfma_f32_16x16x32_bf16 v[160:163], v[72:75], v[32:35], v[160:163]
    ds_read_b128 v[68:71], v10 offset:10240
    buffer_load_dwordx4 v8, s[8:11], s37 offen offset:2048 lds
    v_mfma_f32_16x16x32_bf16 v[168:171], v[72:75], v[36:39], v[168:171]
    buffer_load_dwordx4 v9, s[8:11], s37 offen offset:3072 lds
    v_mfma_f32_16x16x32_bf16 v[176:179], v[72:75], v[40:43], v[176:179]
    v_mov_b32 v24, 0
    v_lshlrev_b32 v25, 16, v80
    v_and_b32 v26, 0xffff0000, v80
    v_lshlrev_b32 v27, 16, v86
    v_and_b32 v28, 0xffff0000, v86
    v_mul_f32 v25, v25, v27
    v_mfma_f32_16x16x32_bf16 v[184:187], v[72:75], v[44:47], v[184:187]
    v_mul_f32 v26, v26, v28
    v_cvt_pk_bf16_f32 v27, v25, v26
    s_waitcnt lgkmcnt(2)
    v_mfma_f32_16x16x32_bf16 v[164:167], v[76:79], v[32:35], v[164:167]
    ds_read_b128 v[72:75], v10 offset:12288
    v_lshlrev_b32 v25, 16, v27
    v_and_b32 v26, 0xffff0000, v27
    v_mfma_f32_16x16x32_bf16 v[172:175], v[76:79], v[36:39], v[172:175]
    v_add_f32 v24, v24, v25
    v_add_f32 v24, v24, v26
    v_mfma_f32_16x16x32_bf16 v[180:183], v[76:79], v[40:43], v[180:183]
    ds_read_b64_tr_b16 v[48:49], v12 offset:8192
    ds_read_b64_tr_b16 v[50:51], v12 offset:9216
    v_lshlrev_b32 v25, 16, v81
    v_and_b32 v26, 0xffff0000, v81
    v_mfma_f32_16x16x32_bf16 v[188:191], v[76:79], v[44:47], v[188:191]
    ds_read_b64_tr_b16 v[52:53], v13 offset:8192
    ds_read_b64_tr_b16 v[54:55], v13 offset:9216
    v_lshlrev_b32 v27, 16, v87
    v_and_b32 v28, 0xffff0000, v87
    s_waitcnt lgkmcnt(6)
    v_mfma_f32_16x16x32_bf16 v[192:195], v[64:67], v[32:35], v[192:195]
    ds_read_b128 v[76:79], v10 offset:14336
    ds_read_b64_tr_b16 v[56:57], v14 offset:8192
    v_mul_f32 v25, v25, v27
    v_mul_f32 v26, v26, v28
    v_mfma_f32_16x16x32_bf16 v[200:203], v[64:67], v[36:39], v[200:203]
    ds_read_b64_tr_b16 v[58:59], v14 offset:9216
    ds_read_b64_tr_b16 v[60:61], v15 offset:8192
    v_cvt_pk_bf16_f32 v27, v25, v26
    v_lshlrev_b32 v25, 16, v27
    v_mfma_f32_16x16x32_bf16 v[208:211], v[64:67], v[40:43], v[208:211]
    ds_read_b64_tr_b16 v[62:63], v15 offset:9216
    v_and_b32 v26, 0xffff0000, v27
    v_add_f32 v24, v24, v25
    v_mfma_f32_16x16x32_bf16 v[216:219], v[64:67], v[44:47], v[216:219]
    v_add_f32 v24, v24, v26
    v_lshlrev_b32 v25, 16, v82
    s_waitcnt lgkmcnt(10)
    v_mfma_f32_16x16x32_bf16 v[196:199], v[68:71], v[32:35], v[196:199]
    ds_read_b128 v[64:67], v11 offset:0
    v_and_b32 v26, 0xffff0000, v82
    v_lshlrev_b32 v27, 16, v88
    v_mfma_f32_16x16x32_bf16 v[204:207], v[68:71], v[36:39], v[204:207]
    v_and_b32 v28, 0xffff0000, v88
    v_mul_f32 v25, v25, v27
    v_mfma_f32_16x16x32_bf16 v[212:215], v[68:71], v[40:43], v[212:215]
    v_mul_f32 v26, v26, v28
    v_cvt_pk_bf16_f32 v27, v25, v26
    v_mfma_f32_16x16x32_bf16 v[220:223], v[68:71], v[44:47], v[220:223]
    v_lshlrev_b32 v25, 16, v27
    v_and_b32 v26, 0xffff0000, v27
    s_waitcnt lgkmcnt(10)
    v_mfma_f32_16x16x32_bf16 v[224:227], v[72:75], v[32:35], v[224:227]
    ds_read_b128 v[68:71], v11 offset:2048
    v_add_f32 v24, v24, v25
    v_add_f32 v24, v24, v26
    v_mfma_f32_16x16x32_bf16 v[232:235], v[72:75], v[36:39], v[232:235]
    v_lshlrev_b32 v25, 16, v83
    v_and_b32 v26, 0xffff0000, v83
    v_mfma_f32_16x16x32_bf16 v[240:243], v[72:75], v[40:43], v[240:243]
    v_lshlrev_b32 v27, 16, v89
    v_and_b32 v28, 0xffff0000, v89
    v_mfma_f32_16x16x32_bf16 v[248:251], v[72:75], v[44:47], v[248:251]
    v_mul_f32 v25, v25, v27
    v_mul_f32 v26, v26, v28
    s_waitcnt lgkmcnt(6)
    v_mfma_f32_16x16x32_bf16 v[228:231], v[76:79], v[32:35], v[228:231]
    ds_read_b128 v[72:75], v11 offset:4096
    v_cvt_pk_bf16_f32 v27, v25, v26
    v_lshlrev_b32 v25, 16, v27
    v_mfma_f32_16x16x32_bf16 v[236:239], v[76:79], v[36:39], v[236:239]
    v_and_b32 v26, 0xffff0000, v27
    v_add_f32 v24, v24, v25
    v_mfma_f32_16x16x32_bf16 v[244:247], v[76:79], v[40:43], v[244:247]
    v_add_f32 v24, v24, v26
    v_lshlrev_b32 v25, 16, v84
    v_mfma_f32_16x16x32_bf16 v[252:255], v[76:79], v[44:47], v[252:255]
    v_and_b32 v26, 0xffff0000, v84
    v_lshlrev_b32 v27, 16, v85
    s_waitcnt lgkmcnt(2)
    v_mfma_f32_16x16x32_bf16 v[128:131], v[64:67], v[48:51], v[128:131]
    ds_read_b128 v[76:79], v11 offset:6144
    v_and_b32 v28, 0xffff0000, v85
    v_mul_f32 v25, v25, v27
    v_mfma_f32_16x16x32_bf16 v[136:139], v[64:67], v[52:55], v[136:139]
    v_mul_f32 v26, v26, v28
    v_cvt_pk_bf16_f32 v27, v25, v26
    v_mfma_f32_16x16x32_bf16 v[144:147], v[64:67], v[56:59], v[144:147]
    v_lshlrev_b32 v25, 16, v27
    v_and_b32 v26, 0xffff0000, v27
    v_mfma_f32_16x16x32_bf16 v[152:155], v[64:67], v[60:63], v[152:155]
    v_add_f32 v24, v24, v25
    v_add_f32 v24, v24, v26
    s_waitcnt lgkmcnt(2)
    v_mfma_f32_16x16x32_bf16 v[132:135], v[68:71], v[48:51], v[132:135]
    ds_read_b128 v[64:67], v11 offset:8192
    v_add_f32_dpp v24, v24, v24 row_shr:1 row_mask:0xf bank_mask:0xf bound_ctrl:0
    s_nop 1
    v_add_f32_dpp v24, v24, v24 row_shr:2 row_mask:0xf bank_mask:0xf bound_ctrl:0
    v_mfma_f32_16x16x32_bf16 v[140:143], v[68:71], v[52:55], v[140:143]
    s_nop 0
    v_add_f32_dpp v24, v24, v24 row_shr:4 row_mask:0xf bank_mask:0xf bound_ctrl:0
    s_nop 1
    v_add_f32_dpp v24, v24, v24 row_shr:8 row_mask:0xf bank_mask:0xf bound_ctrl:0
    v_mfma_f32_16x16x32_bf16 v[148:151], v[68:71], v[56:59], v[148:151]
    s_nop 0
    v_add_f32_dpp v24, v24, v24 row_bcast:15 row_mask:0xa bank_mask:0xf
    s_nop 1
    v_add_f32_dpp v24, v24, v24 row_bcast:31 row_mask:0xc bank_mask:0xf
    v_mfma_f32_16x16x32_bf16 v[156:159], v[68:71], v[60:63], v[156:159]
    v_cvt_pk_bf16_f32 v25, v24, v24
    v_lshlrev_b32 v24, 16, v25
    s_waitcnt lgkmcnt(2)
    v_mfma_f32_16x16x32_bf16 v[160:163], v[72:75], v[48:51], v[160:163]
    ds_read_b128 v[68:71], v11 offset:10240
    v_mul_f32 v24, 0xbfb8aa3b, v24
    v_exp_f32 v24, v24
    v_mfma_f32_16x16x32_bf16 v[168:171], v[72:75], v[52:55], v[168:171]
    v_cmp_eq_u32 vcc, 63, v0
    v_add_f32 v24, 1.0, v24
    v_mfma_f32_16x16x32_bf16 v[176:179], v[72:75], v[56:59], v[176:179]
    v_rcp_f32 v24, v24
    v_cndmask_b32 v26, v30, 0, vcc
    v_mfma_f32_16x16x32_bf16 v[184:187], v[72:75], v[60:63], v[184:187]
    v_cvt_pk_bf16_f32 v25, v24, v24
    v_lshlrev_b32 v24, 16, v25
    s_waitcnt lgkmcnt(2)
    v_mfma_f32_16x16x32_bf16 v[164:167], v[76:79], v[48:51], v[164:167]
    ds_read_b128 v[72:75], v11 offset:12288
    s_lshl_b32 s3, s2, 3
    s_add_u32 s3, s3, s32
    s_lshl_b32 s3, s3, 2
    s_add_u32 s3, s3, 66060288
    buffer_store_dword v24, v26, s[12:15], s3 offen sc1
    v_mfma_f32_16x16x32_bf16 v[172:175], v[76:79], v[52:55], v[172:175]
    v_mfma_f32_16x16x32_bf16 v[180:183], v[76:79], v[56:59], v[180:183]
    v_mfma_f32_16x16x32_bf16 v[188:191], v[76:79], v[60:63], v[188:191]
    s_waitcnt lgkmcnt(2)
    v_mfma_f32_16x16x32_bf16 v[192:195], v[64:67], v[48:51], v[192:195]
    ds_read_b128 v[76:79], v11 offset:14336
    v_mfma_f32_16x16x32_bf16 v[200:203], v[64:67], v[52:55], v[200:203]
    v_mfma_f32_16x16x32_bf16 v[208:211], v[64:67], v[56:59], v[208:211]
    v_mfma_f32_16x16x32_bf16 v[216:219], v[64:67], v[60:63], v[216:219]
    s_waitcnt lgkmcnt(0)
    s_waitcnt vmcnt(1)
    s_barrier
    ds_read_b64_tr_b16 v[32:33], v12 offset:32768
    ds_read_b64_tr_b16 v[34:35], v12 offset:33792
    v_mfma_f32_16x16x32_bf16 v[196:199], v[68:71], v[48:51], v[196:199]
    ds_read_b64_tr_b16 v[36:37], v13 offset:32768
    ds_read_b64_tr_b16 v[38:39], v13 offset:33792
    ds_read_b32 v90, v29 offset:0
    v_mfma_f32_16x16x32_bf16 v[204:207], v[68:71], v[52:55], v[204:207]
    ds_read_b64_tr_b16 v[40:41], v14 offset:32768
    ds_read_b64_tr_b16 v[42:43], v14 offset:33792
    ds_read_b32 v91, v29 offset:160
    v_mfma_f32_16x16x32_bf16 v[212:215], v[68:71], v[56:59], v[212:215]
    ds_read_b64_tr_b16 v[44:45], v15 offset:32768
    ds_read_b64_tr_b16 v[46:47], v15 offset:33792
    ds_read_b32 v92, v29 offset:320
    v_mfma_f32_16x16x32_bf16 v[220:223], v[68:71], v[60:63], v[220:223]
    ds_read_b128 v[64:67], v10 offset:32768
    ds_read_b32 v93, v29 offset:480
    v_mfma_f32_16x16x32_bf16 v[224:227], v[72:75], v[48:51], v[224:227]
    ds_read_b128 v[68:71], v10 offset:34816
    ds_read_b32 v94, v29 offset:640
    v_mfma_f32_16x16x32_bf16 v[232:235], v[72:75], v[52:55], v[232:235]
    ds_read_b32 v95, v29 offset:800
    v_mfma_f32_16x16x32_bf16 v[240:243], v[72:75], v[56:59], v[240:243]
    ds_read_b32 v96, v29 offset:960
    v_mfma_f32_16x16x32_bf16 v[248:251], v[72:75], v[60:63], v[248:251]
    ds_read_b32 v97, v29 offset:1120
    v_mfma_f32_16x16x32_bf16 v[228:231], v[76:79], v[48:51], v[228:231]
    ds_read_b128 v[72:75], v10 offset:36864
    ds_read_b32 v98, v29 offset:1280
    v_mfma_f32_16x16x32_bf16 v[236:239], v[76:79], v[52:55], v[236:239]
    ds_read_b32 v99, v29 offset:1440
    v_mfma_f32_16x16x32_bf16 v[244:247], v[76:79], v[56:59], v[244:247]
    ds_read_b32 v100, v29 offset:1600
    v_mfma_f32_16x16x32_bf16 v[252:255], v[76:79], v[60:63], v[252:255]
    ds_read_b32 v101, v29 offset:11520
    s_waitcnt lgkmcnt(2)
    v_mfma_f32_16x16x32_bf16 v[128:131], v[64:67], v[32:35], v[128:131]
    ds_read_b128 v[76:79], v10 offset:38912
    ds_read_b32 v102, v29 offset:11680
    v_mfma_f32_16x16x32_bf16 v[136:139], v[64:67], v[36:39], v[136:139]
    ds_read_b32 v103, v29 offset:11840
    v_mfma_f32_16x16x32_bf16 v[144:147], v[64:67], v[40:43], v[144:147]
    ds_read_b32 v104, v29 offset:12000
    v_mfma_f32_16x16x32_bf16 v[152:155], v[64:67], v[44:47], v[152:155]
    ds_read_b32 v105, v29 offset:12160
    s_waitcnt lgkmcnt(2)
    v_mfma_f32_16x16x32_bf16 v[132:135], v[68:71], v[32:35], v[132:135]
    ds_read_b128 v[64:67], v10 offset:40960
    ds_read_b32 v106, v29 offset:12320
    v_mfma_f32_16x16x32_bf16 v[140:143], v[68:71], v[36:39], v[140:143]
    ds_read_b32 v107, v29 offset:12480
    v_mfma_f32_16x16x32_bf16 v[148:151], v[68:71], v[40:43], v[148:151]
    ds_read_b32 v108, v29 offset:12640
    v_mfma_f32_16x16x32_bf16 v[156:159], v[68:71], v[44:47], v[156:159]
    s_add_u32 m0, s41, 0
    s_add_u32 s37, s39, 512
    buffer_load_dwordx4 v2, s[4:7], s37 offen lds
    s_waitcnt lgkmcnt(2)
    v_mfma_f32_16x16x32_bf16 v[160:163], v[72:75], v[32:35], v[160:163]
    ds_read_b128 v[68:71], v10 offset:43008
    buffer_load_dwordx4 v3, s[4:7], s37 offen offset:1024 lds
    v_mfma_f32_16x16x32_bf16 v[168:171], v[72:75], v[36:39], v[168:171]
    buffer_load_dwordx4 v4, s[4:7], s37 offen offset:2048 lds
    v_mfma_f32_16x16x32_bf16 v[176:179], v[72:75], v[40:43], v[176:179]
    buffer_load_dwordx4 v5, s[4:7], s37 offen offset:3072 lds
    v_mfma_f32_16x16x32_bf16 v[184:187], v[72:75], v[44:47], v[184:187]
    s_add_u32 m0, s42, 0
    s_add_u32 s37, s40, 2097152
    buffer_load_dwordx4 v6, s[8:11], s37 offen lds
    s_waitcnt lgkmcnt(2)
    v_mfma_f32_16x16x32_bf16 v[164:167], v[76:79], v[32:35], v[164:167]
    ds_read_b128 v[72:75], v10 offset:45056
    buffer_load_dwordx4 v7, s[8:11], s37 offen offset:1024 lds
    v_mfma_f32_16x16x32_bf16 v[172:175], v[76:79], v[36:39], v[172:175]
    buffer_load_dwordx4 v8, s[8:11], s37 offen offset:2048 lds
    v_mfma_f32_16x16x32_bf16 v[180:183], v[76:79], v[40:43], v[180:183]
    ds_read_b64_tr_b16 v[48:49], v12 offset:40960
    ds_read_b64_tr_b16 v[50:51], v12 offset:41984
    buffer_load_dwordx4 v9, s[8:11], s37 offen offset:3072 lds
    v_mfma_f32_16x16x32_bf16 v[188:191], v[76:79], v[44:47], v[188:191]
    ds_read_b64_tr_b16 v[52:53], v13 offset:40960
    ds_read_b64_tr_b16 v[54:55], v13 offset:41984
    s_lshl_b32 s3, s34, 3
    s_add_u32 s3, s3, s32
    s_mul_i32 s3, s3, 81920
    s_lshl_b32 s38, s33, 8
    s_add_u32 s3, s3, s38
    s_mov_b64 exec, 0xfffff
    buffer_load_dword v115, v115, s[24:27], s3 offen sc1
    s_mov_b64 exec, -1
    s_waitcnt lgkmcnt(6)
    v_mfma_f32_16x16x32_bf16 v[192:195], v[64:67], v[32:35], v[192:195]
    ds_read_b128 v[76:79], v10 offset:47104
    ds_read_b64_tr_b16 v[56:57], v14 offset:40960
    v_mfma_f32_16x16x32_bf16 v[200:203], v[64:67], v[36:39], v[200:203]
    ds_read_b64_tr_b16 v[58:59], v14 offset:41984
    ds_read_b64_tr_b16 v[60:61], v15 offset:40960
    v_mfma_f32_16x16x32_bf16 v[208:211], v[64:67], v[40:43], v[208:211]
    ds_read_b64_tr_b16 v[62:63], v15 offset:41984
    v_mfma_f32_16x16x32_bf16 v[216:219], v[64:67], v[44:47], v[216:219]
    s_waitcnt lgkmcnt(10)
    v_mfma_f32_16x16x32_bf16 v[196:199], v[68:71], v[32:35], v[196:199]
    ds_read_b128 v[64:67], v11 offset:32768
    v_mfma_f32_16x16x32_bf16 v[204:207], v[68:71], v[36:39], v[204:207]
    v_mfma_f32_16x16x32_bf16 v[212:215], v[68:71], v[40:43], v[212:215]
    v_mfma_f32_16x16x32_bf16 v[220:223], v[68:71], v[44:47], v[220:223]
    s_waitcnt lgkmcnt(10)
    v_mfma_f32_16x16x32_bf16 v[224:227], v[72:75], v[32:35], v[224:227]
    ds_read_b128 v[68:71], v11 offset:34816
    v_lshlrev_b32 v80, 16, v110
    v_and_b32 v81, 0xffff0000, v110
    v_lshlrev_b32 v82, 16, v111
    v_and_b32 v83, 0xffff0000, v111
    v_lshlrev_b32 v84, 16, v112
    v_and_b32 v85, 0xffff0000, v112
    v_mfma_f32_16x16x32_bf16 v[232:235], v[72:75], v[36:39], v[232:235]
    v_lshlrev_b32 v86, 16, v113
    v_and_b32 v87, 0xffff0000, v113
    v_mfma_f32_16x16x32_bf16 v[240:243], v[72:75], v[40:43], v[240:243]
    v_lshlrev_b32 v110, 16, v90
    v_and_b32 v88, 0xffff0000, v90
    v_mfma_f32_16x16x32_bf16 v[248:251], v[72:75], v[44:47], v[248:251]
    v_lshlrev_b32 v111, 16, v91
    v_and_b32 v89, 0xffff0000, v91
    s_waitcnt lgkmcnt(6)
    v_mfma_f32_16x16x32_bf16 v[228:231], v[76:79], v[32:35], v[228:231]
    ds_read_b128 v[72:75], v11 offset:36864
    v_lshlrev_b32 v112, 16, v92
    v_and_b32 v109, 0xffff0000, v92
    v_mfma_f32_16x16x32_bf16 v[236:239], v[76:79], v[36:39], v[236:239]
    v_lshlrev_b32 v113, 16, v93
    v_and_b32 v114, 0xffff0000, v93
    v_mfma_f32_16x16x32_bf16 v[244:247], v[76:79], v[40:43], v[244:247]
    v_mul_f32 v24, v110, v83
    v_mul_f32 v25, v88, v87
    v_mfma_f32_16x16x32_bf16 v[252:255], v[76:79], v[44:47], v[252:255]
    v_fmac_f32 v24, v111, v82
    v_fmac_f32 v25, v89, v86
    s_waitcnt lgkmcnt(2)
    v_mfma_f32_16x16x32_bf16 v[128:131], v[64:67], v[48:51], v[128:131]
    ds_read_b128 v[76:79], v11 offset:38912
    v_fmac_f32 v24, v112, v81
    v_fmac_f32 v25, v109, v85
    v_mfma_f32_16x16x32_bf16 v[136:139], v[64:67], v[52:55], v[136:139]
    v_fmac_f32 v24, v113, v80
    v_fmac_f32 v25, v114, v84
    v_mfma_f32_16x16x32_bf16 v[144:147], v[64:67], v[56:59], v[144:147]
    v_lshlrev_b32 v27, 16, v101
    v_and_b32 v28, 0xffff0000, v101
    v_mfma_f32_16x16x32_bf16 v[152:155], v[64:67], v[60:63], v[152:155]
    v_mul_f32 v118, v24, v27
    v_mul_f32 v119, v25, v28
    s_waitcnt lgkmcnt(2)
    v_mfma_f32_16x16x32_bf16 v[132:135], v[68:71], v[48:51], v[132:135]
    ds_read_b128 v[64:67], v11 offset:40960
    v_lshlrev_b32 v110, 16, v94
    v_and_b32 v88, 0xffff0000, v94
    v_mfma_f32_16x16x32_bf16 v[140:143], v[68:71], v[52:55], v[140:143]
    v_mul_f32 v24, v111, v83
    v_mul_f32 v25, v89, v87
    v_mfma_f32_16x16x32_bf16 v[148:151], v[68:71], v[56:59], v[148:151]
    v_fmac_f32 v24, v112, v82
    v_fmac_f32 v25, v109, v86
    v_mfma_f32_16x16x32_bf16 v[156:159], v[68:71], v[60:63], v[156:159]
    v_fmac_f32 v24, v113, v81
    v_fmac_f32 v25, v114, v85
    s_waitcnt lgkmcnt(2)
    v_mfma_f32_16x16x32_bf16 v[160:163], v[72:75], v[48:51], v[160:163]
    ds_read_b128 v[68:71], v11 offset:43008
    v_fmac_f32 v24, v110, v80
    v_fmac_f32 v25, v88, v84
    v_mfma_f32_16x16x32_bf16 v[168:171], v[72:75], v[52:55], v[168:171]
    v_lshlrev_b32 v27, 16, v102
    v_and_b32 v28, 0xffff0000, v102
    v_mfma_f32_16x16x32_bf16 v[176:179], v[72:75], v[56:59], v[176:179]
    v_mul_f32 v24, v24, v27
    v_mul_f32 v25, v25, v28
    v_mfma_f32_16x16x32_bf16 v[184:187], v[72:75], v[60:63], v[184:187]
    v_cvt_pk_bf16_f32 v120, v118, v24
    v_cvt_pk_bf16_f32 v124, v119, v25
    s_waitcnt lgkmcnt(2)
    v_mfma_f32_16x16x32_bf16 v[164:167], v[76:79], v[48:51], v[164:167]
    ds_read_b128 v[72:75], v11 offset:45056
    v_lshlrev_b32 v111, 16, v95
    v_and_b32 v89, 0xffff0000, v95
    v_mfma_f32_16x16x32_bf16 v[172:175], v[76:79], v[52:55], v[172:175]
    v_mul_f32 v24, v112, v83
    v_mul_f32 v25, v109, v87
    v_mfma_f32_16x16x32_bf16 v[180:183], v[76:79], v[56:59], v[180:183]
    v_fmac_f32 v24, v113, v82
    v_fmac_f32 v25, v114, v86
    v_mfma_f32_16x16x32_bf16 v[188:191], v[76:79], v[60:63], v[188:191]
    v_fmac_f32 v24, v110, v81
    v_fmac_f32 v25, v88, v85
    s_waitcnt lgkmcnt(2)
    v_mfma_f32_16x16x32_bf16 v[192:195], v[64:67], v[48:51], v[192:195]
    ds_read_b128 v[76:79], v11 offset:47104
    v_fmac_f32 v24, v111, v80
    v_fmac_f32 v25, v89, v84
    v_mfma_f32_16x16x32_bf16 v[200:203], v[64:67], v[52:55], v[200:203]
    v_lshlrev_b32 v27, 16, v103
    v_and_b32 v28, 0xffff0000, v103
    v_mfma_f32_16x16x32_bf16 v[208:211], v[64:67], v[56:59], v[208:211]
    v_mul_f32 v118, v24, v27
    v_mul_f32 v119, v25, v28
    v_mfma_f32_16x16x32_bf16 v[216:219], v[64:67], v[60:63], v[216:219]
    s_waitcnt lgkmcnt(0)
    s_waitcnt vmcnt(1)
    s_barrier
    ds_read_b64_tr_b16 v[32:33], v12 offset:0
    ds_read_b64_tr_b16 v[34:35], v12 offset:1024
    v_mfma_f32_16x16x32_bf16 v[196:199], v[68:71], v[48:51], v[196:199]
    ds_read_b64_tr_b16 v[36:37], v13 offset:0
    ds_read_b64_tr_b16 v[38:39], v13 offset:1024
    v_mfma_f32_16x16x32_bf16 v[204:207], v[68:71], v[52:55], v[204:207]
    ds_read_b64_tr_b16 v[40:41], v14 offset:0
    ds_read_b64_tr_b16 v[42:43], v14 offset:1024
    v_mfma_f32_16x16x32_bf16 v[212:215], v[68:71], v[56:59], v[212:215]
    ds_read_b64_tr_b16 v[44:45], v15 offset:0
    ds_read_b64_tr_b16 v[46:47], v15 offset:1024
    v_mfma_f32_16x16x32_bf16 v[220:223], v[68:71], v[60:63], v[220:223]
    ds_read_b128 v[64:67], v10 offset:0
    v_mfma_f32_16x16x32_bf16 v[224:227], v[72:75], v[48:51], v[224:227]
    ds_read_b128 v[68:71], v10 offset:2048
    v_mfma_f32_16x16x32_bf16 v[232:235], v[72:75], v[52:55], v[232:235]
    v_mfma_f32_16x16x32_bf16 v[240:243], v[72:75], v[56:59], v[240:243]
    v_mfma_f32_16x16x32_bf16 v[248:251], v[72:75], v[60:63], v[248:251]
    v_mfma_f32_16x16x32_bf16 v[228:231], v[76:79], v[48:51], v[228:231]
    ds_read_b128 v[72:75], v10 offset:4096
    v_mfma_f32_16x16x32_bf16 v[236:239], v[76:79], v[52:55], v[236:239]
    v_mfma_f32_16x16x32_bf16 v[244:247], v[76:79], v[56:59], v[244:247]
    v_mfma_f32_16x16x32_bf16 v[252:255], v[76:79], v[60:63], v[252:255]
    s_waitcnt lgkmcnt(2)
    v_mfma_f32_16x16x32_bf16 v[128:131], v[64:67], v[32:35], v[128:131]
    ds_read_b128 v[76:79], v10 offset:6144
    v_mfma_f32_16x16x32_bf16 v[136:139], v[64:67], v[36:39], v[136:139]
    v_mfma_f32_16x16x32_bf16 v[144:147], v[64:67], v[40:43], v[144:147]
    s_add_u32 m0, s41, 32768
    s_add_u32 s37, s39, 640
    buffer_load_dwordx4 v2, s[4:7], s37 offen lds
    v_mfma_f32_16x16x32_bf16 v[152:155], v[64:67], v[44:47], v[152:155]
    buffer_load_dwordx4 v3, s[4:7], s37 offen offset:1024 lds
    s_waitcnt lgkmcnt(2)
    v_mfma_f32_16x16x32_bf16 v[132:135], v[68:71], v[32:35], v[132:135]
    ds_read_b128 v[64:67], v10 offset:8192
    buffer_load_dwordx4 v4, s[4:7], s37 offen offset:2048 lds
    v_mfma_f32_16x16x32_bf16 v[140:143], v[68:71], v[36:39], v[140:143]
    buffer_load_dwordx4 v5, s[4:7], s37 offen offset:3072 lds
    v_mfma_f32_16x16x32_bf16 v[148:151], v[68:71], v[40:43], v[148:151]
    s_add_u32 m0, s42, 32768
    s_add_u32 s37, s40, 2621440
    buffer_load_dwordx4 v6, s[8:11], s37 offen lds
    v_mfma_f32_16x16x32_bf16 v[156:159], v[68:71], v[44:47], v[156:159]
    buffer_load_dwordx4 v7, s[8:11], s37 offen offset:1024 lds
    s_waitcnt lgkmcnt(2)
    v_mfma_f32_16x16x32_bf16 v[160:163], v[72:75], v[32:35], v[160:163]
    ds_read_b128 v[68:71], v10 offset:10240
    buffer_load_dwordx4 v8, s[8:11], s37 offen offset:2048 lds
    v_mfma_f32_16x16x32_bf16 v[168:171], v[72:75], v[36:39], v[168:171]
    buffer_load_dwordx4 v9, s[8:11], s37 offen offset:3072 lds
    v_mfma_f32_16x16x32_bf16 v[176:179], v[72:75], v[40:43], v[176:179]
    s_mov_b32 s76, s72
    s_mov_b32 s77, s73
    s_mov_b32 s78, 5242880
    s_lshr_b32 s3, s2, 1
    s_lshl_b32 s3, s3, 5
    s_lshl_b32 s38, s32, 2
    s_add_u32 s3, s3, s38
    s_mul_i32 s3, s3, 1280
    s_and_b32 s48, s2, 1
    s_mul_i32 s48, s48, 640
    s_add_u32 s3, s3, s48
    s_mul_i32 s38, s38, 672
    s_mov_b32 exec_hi, 0xff
    s_add_u32 m0, s38, 131072
    s_add_u32 s48, s3, 0
    buffer_load_dwordx4 v1, s[76:79], s48 offen lds
    s_mov_b32 exec_hi, -1
    v_mfma_f32_16x16x32_bf16 v[184:187], v[72:75], v[44:47], v[184:187]
    s_mov_b32 s76, s72
    s_mov_b32 s77, s73
    s_mov_b32 s78, 5242880
    s_lshr_b32 s3, s2, 1
    s_lshl_b32 s3, s3, 5
    s_lshl_b32 s38, s32, 2
    s_add_u32 s3, s3, s38
    s_mul_i32 s3, s3, 1280
    s_and_b32 s48, s2, 1
    s_mul_i32 s48, s48, 640
    s_add_u32 s3, s3, s48
    s_mul_i32 s38, s38, 672
    s_mov_b32 exec_hi, 0xff
    s_add_u32 m0, s38, 131744
    s_add_u32 s48, s3, 1280
    buffer_load_dwordx4 v1, s[76:79], s48 offen lds
    s_mov_b32 exec_hi, -1
    s_waitcnt lgkmcnt(2)
    v_mfma_f32_16x16x32_bf16 v[164:167], v[76:79], v[32:35], v[164:167]
    ds_read_b128 v[72:75], v10 offset:12288
    s_mov_b32 s76, s72
    s_mov_b32 s77, s73
    s_mov_b32 s78, 5242880
    s_lshr_b32 s3, s2, 1
    s_lshl_b32 s3, s3, 5
    s_lshl_b32 s38, s32, 2
    s_add_u32 s3, s3, s38
    s_mul_i32 s3, s3, 1280
    s_and_b32 s48, s2, 1
    s_mul_i32 s48, s48, 640
    s_add_u32 s3, s3, s48
    s_mul_i32 s38, s38, 672
    s_mov_b32 exec_hi, 0xff
    s_add_u32 m0, s38, 132416
    s_add_u32 s48, s3, 2560
    buffer_load_dwordx4 v1, s[76:79], s48 offen lds
    s_mov_b32 exec_hi, -1
    v_mfma_f32_16x16x32_bf16 v[172:175], v[76:79], v[36:39], v[172:175]
    s_mov_b32 s76, s72
    s_mov_b32 s77, s73
    s_mov_b32 s78, 5242880
    s_lshr_b32 s3, s2, 1
    s_lshl_b32 s3, s3, 5
    s_lshl_b32 s38, s32, 2
    s_add_u32 s3, s3, s38
    s_mul_i32 s3, s3, 1280
    s_and_b32 s48, s2, 1
    s_mul_i32 s48, s48, 640
    s_add_u32 s3, s3, s48
    s_mul_i32 s38, s38, 672
    s_mov_b32 exec_hi, 0xff
    s_add_u32 m0, s38, 133088
    s_add_u32 s48, s3, 3840
    buffer_load_dwordx4 v1, s[76:79], s48 offen lds
    s_mov_b32 exec_hi, -1
    v_mfma_f32_16x16x32_bf16 v[180:183], v[76:79], v[40:43], v[180:183]
    ds_read_b64_tr_b16 v[48:49], v12 offset:8192
    ds_read_b64_tr_b16 v[50:51], v12 offset:9216
    v_lshlrev_b32 v112, 16, v96
    v_and_b32 v109, 0xffff0000, v96
    v_mfma_f32_16x16x32_bf16 v[188:191], v[76:79], v[44:47], v[188:191]
    ds_read_b64_tr_b16 v[52:53], v13 offset:8192
    ds_read_b64_tr_b16 v[54:55], v13 offset:9216
    v_mul_f32 v24, v113, v83
    v_mul_f32 v25, v114, v87
    s_waitcnt lgkmcnt(6)
    v_mfma_f32_16x16x32_bf16 v[192:195], v[64:67], v[32:35], v[192:195]
    ds_read_b128 v[76:79], v10 offset:14336
    ds_read_b64_tr_b16 v[56:57], v14 offset:8192
    v_fmac_f32 v24, v110, v82
    v_fmac_f32 v25, v88, v86
    v_mfma_f32_16x16x32_bf16 v[200:203], v[64:67], v[36:39], v[200:203]
    ds_read_b64_tr_b16 v[58:59], v14 offset:9216
    ds_read_b64_tr_b16 v[60:61], v15 offset:8192
    v_fmac_f32 v24, v111, v81
    v_fmac_f32 v25, v89, v85
    v_mfma_f32_16x16x32_bf16 v[208:211], v[64:67], v[40:43], v[208:211]
    ds_read_b64_tr_b16 v[62:63], v15 offset:9216
    v_fmac_f32 v24, v112, v80
    v_fmac_f32 v25, v109, v84
    v_mfma_f32_16x16x32_bf16 v[216:219], v[64:67], v[44:47], v[216:219]
    v_lshlrev_b32 v27, 16, v104
    v_and_b32 v28, 0xffff0000, v104
    s_waitcnt lgkmcnt(10)
    v_mfma_f32_16x16x32_bf16 v[196:199], v[68:71], v[32:35], v[196:199]
    ds_read_b128 v[64:67], v11 offset:0
    v_mul_f32 v24, v24, v27
    v_mul_f32 v25, v25, v28
    v_mfma_f32_16x16x32_bf16 v[204:207], v[68:71], v[36:39], v[204:207]
    v_cvt_pk_bf16_f32 v121, v118, v24
    v_cvt_pk_bf16_f32 v125, v119, v25
    v_mfma_f32_16x16x32_bf16 v[212:215], v[68:71], v[40:43], v[212:215]
    v_lshlrev_b32 v113, 16, v97
    v_and_b32 v114, 0xffff0000, v97
    v_mfma_f32_16x16x32_bf16 v[220:223], v[68:71], v[44:47], v[220:223]
    v_mul_f32 v24, v110, v83
    v_mul_f32 v25, v88, v87
    s_waitcnt lgkmcnt(10)
    v_mfma_f32_16x16x32_bf16 v[224:227], v[72:75], v[32:35], v[224:227]
    ds_read_b128 v[68:71], v11 offset:2048
    v_fmac_f32 v24, v111, v82
    v_fmac_f32 v25, v89, v86
    v_mfma_f32_16x16x32_bf16 v[232:235], v[72:75], v[36:39], v[232:235]
    v_fmac_f32 v24, v112, v81
    v_fmac_f32 v25, v109, v85
    v_mfma_f32_16x16x32_bf16 v[240:243], v[72:75], v[40:43], v[240:243]
    v_fmac_f32 v24, v113, v80
    v_fmac_f32 v25, v114, v84
    v_mfma_f32_16x16x32_bf16 v[248:251], v[72:75], v[44:47], v[248:251]
    v_lshlrev_b32 v27, 16, v105
    v_and_b32 v28, 0xffff0000, v105
    s_waitcnt lgkmcnt(6)
    v_mfma_f32_16x16x32_bf16 v[228:231], v[76:79], v[32:35], v[228:231]
    ds_read_b128 v[72:75], v11 offset:4096
    v_mul_f32 v118, v24, v27
    v_mul_f32 v119, v25, v28
    v_mfma_f32_16x16x32_bf16 v[236:239], v[76:79], v[36:39], v[236:239]
    v_lshlrev_b32 v110, 16, v98
    v_and_b32 v88, 0xffff0000, v98
    v_mfma_f32_16x16x32_bf16 v[244:247], v[76:79], v[40:43], v[244:247]
    v_mul_f32 v24, v111, v83
    v_mul_f32 v25, v89, v87
    v_mfma_f32_16x16x32_bf16 v[252:255], v[76:79], v[44:47], v[252:255]
    v_fmac_f32 v24, v112, v82
    v_fmac_f32 v25, v109, v86
    s_waitcnt lgkmcnt(2)
    v_mfma_f32_16x16x32_bf16 v[128:131], v[64:67], v[48:51], v[128:131]
    ds_read_b128 v[76:79], v11 offset:6144
    v_fmac_f32 v24, v113, v81
    v_fmac_f32 v25, v114, v85
    v_mfma_f32_16x16x32_bf16 v[136:139], v[64:67], v[52:55], v[136:139]
    v_fmac_f32 v24, v110, v80
    v_fmac_f32 v25, v88, v84
    v_mfma_f32_16x16x32_bf16 v[144:147], v[64:67], v[56:59], v[144:147]
    v_lshlrev_b32 v27, 16, v106
    v_and_b32 v28, 0xffff0000, v106
    v_mfma_f32_16x16x32_bf16 v[152:155], v[64:67], v[60:63], v[152:155]
    v_mul_f32 v24, v24, v27
    v_mul_f32 v25, v25, v28
    s_waitcnt lgkmcnt(2)
    v_mfma_f32_16x16x32_bf16 v[132:135], v[68:71], v[48:51], v[132:135]
    ds_read_b128 v[64:67], v11 offset:8192
    v_cvt_pk_bf16_f32 v122, v118, v24
    v_cvt_pk_bf16_f32 v126, v119, v25
    v_mfma_f32_16x16x32_bf16 v[140:143], v[68:71], v[52:55], v[140:143]
    v_lshlrev_b32 v111, 16, v99
    v_and_b32 v89, 0xffff0000, v99
    v_mfma_f32_16x16x32_bf16 v[148:151], v[68:71], v[56:59], v[148:151]
    v_mul_f32 v24, v112, v83
    v_mul_f32 v25, v109, v87
    v_mfma_f32_16x16x32_bf16 v[156:159], v[68:71], v[60:63], v[156:159]
    v_fmac_f32 v24, v113, v82
    v_fmac_f32 v25, v114, v86
    s_waitcnt lgkmcnt(2)
    v_mfma_f32_16x16x32_bf16 v[160:163], v[72:75], v[48:51], v[160:163]
    ds_read_b128 v[68:71], v11 offset:10240
    v_fmac_f32 v24, v110, v81
    v_fmac_f32 v25, v88, v85
    v_mfma_f32_16x16x32_bf16 v[168:171], v[72:75], v[52:55], v[168:171]
    v_fmac_f32 v24, v111, v80
    v_fmac_f32 v25, v89, v84
    v_mfma_f32_16x16x32_bf16 v[176:179], v[72:75], v[56:59], v[176:179]
    v_lshlrev_b32 v27, 16, v107
    v_and_b32 v28, 0xffff0000, v107
    v_mfma_f32_16x16x32_bf16 v[184:187], v[72:75], v[60:63], v[184:187]
    v_mul_f32 v118, v24, v27
    v_mul_f32 v119, v25, v28
    s_waitcnt lgkmcnt(2)
    v_mfma_f32_16x16x32_bf16 v[164:167], v[76:79], v[48:51], v[164:167]
    ds_read_b128 v[72:75], v11 offset:12288
    v_lshlrev_b32 v112, 16, v100
    v_and_b32 v109, 0xffff0000, v100
    v_mfma_f32_16x16x32_bf16 v[172:175], v[76:79], v[52:55], v[172:175]
    v_mul_f32 v24, v113, v83
    v_mul_f32 v25, v114, v87
    v_mfma_f32_16x16x32_bf16 v[180:183], v[76:79], v[56:59], v[180:183]
    v_fmac_f32 v24, v110, v82
    v_fmac_f32 v25, v88, v86
    v_mfma_f32_16x16x32_bf16 v[188:191], v[76:79], v[60:63], v[188:191]
    v_fmac_f32 v24, v111, v81
    v_fmac_f32 v25, v89, v85
    s_waitcnt lgkmcnt(2)
    v_mfma_f32_16x16x32_bf16 v[192:195], v[64:67], v[48:51], v[192:195]
    ds_read_b128 v[76:79], v11 offset:14336
    v_fmac_f32 v24, v112, v80
    v_fmac_f32 v25, v109, v84
    v_mfma_f32_16x16x32_bf16 v[200:203], v[64:67], v[52:55], v[200:203]
    v_lshlrev_b32 v27, 16, v108
    v_and_b32 v28, 0xffff0000, v108
    v_mfma_f32_16x16x32_bf16 v[208:211], v[64:67], v[56:59], v[208:211]
    v_mul_f32 v24, v24, v27
    v_mul_f32 v25, v25, v28
    v_mfma_f32_16x16x32_bf16 v[216:219], v[64:67], v[60:63], v[216:219]
    s_waitcnt lgkmcnt(0)
    s_waitcnt vmcnt(4)
    s_barrier
    ds_read_b64_tr_b16 v[32:33], v12 offset:32768
    ds_read_b64_tr_b16 v[34:35], v12 offset:33792
    v_mfma_f32_16x16x32_bf16 v[196:199], v[68:71], v[48:51], v[196:199]
    ds_read_b64_tr_b16 v[36:37], v13 offset:32768
    ds_read_b64_tr_b16 v[38:39], v13 offset:33792
    v_mfma_f32_16x16x32_bf16 v[204:207], v[68:71], v[52:55], v[204:207]
    ds_read_b64_tr_b16 v[40:41], v14 offset:32768
    ds_read_b64_tr_b16 v[42:43], v14 offset:33792
    v_mfma_f32_16x16x32_bf16 v[212:215], v[68:71], v[56:59], v[212:215]
    ds_read_b64_tr_b16 v[44:45], v15 offset:32768
    ds_read_b64_tr_b16 v[46:47], v15 offset:33792
    v_mfma_f32_16x16x32_bf16 v[220:223], v[68:71], v[60:63], v[220:223]
    ds_read_b128 v[64:67], v10 offset:32768
    v_mfma_f32_16x16x32_bf16 v[224:227], v[72:75], v[48:51], v[224:227]
    ds_read_b128 v[68:71], v10 offset:34816
    v_mfma_f32_16x16x32_bf16 v[232:235], v[72:75], v[52:55], v[232:235]
    v_mfma_f32_16x16x32_bf16 v[240:243], v[72:75], v[56:59], v[240:243]
    v_mfma_f32_16x16x32_bf16 v[248:251], v[72:75], v[60:63], v[248:251]
    v_mfma_f32_16x16x32_bf16 v[228:231], v[76:79], v[48:51], v[228:231]
    ds_read_b128 v[72:75], v10 offset:36864
    v_mfma_f32_16x16x32_bf16 v[236:239], v[76:79], v[52:55], v[236:239]
    v_mfma_f32_16x16x32_bf16 v[244:247], v[76:79], v[56:59], v[244:247]
    v_mfma_f32_16x16x32_bf16 v[252:255], v[76:79], v[60:63], v[252:255]
    s_waitcnt lgkmcnt(2)
    v_mfma_f32_16x16x32_bf16 v[128:131], v[64:67], v[32:35], v[128:131]
    ds_read_b128 v[76:79], v10 offset:38912
    v_mfma_f32_16x16x32_bf16 v[136:139], v[64:67], v[36:39], v[136:139]
    v_mfma_f32_16x16x32_bf16 v[144:147], v[64:67], v[40:43], v[144:147]
    s_add_u32 m0, s41, 0
    s_add_u32 s37, s39, 768
    buffer_load_dwordx4 v2, s[4:7], s37 offen lds
    v_mfma_f32_16x16x32_bf16 v[152:155], v[64:67], v[44:47], v[152:155]
    buffer_load_dwordx4 v3, s[4:7], s37 offen offset:1024 lds
    s_waitcnt lgkmcnt(2)
    v_mfma_f32_16x16x32_bf16 v[132:135], v[68:71], v[32:35], v[132:135]
    ds_read_b128 v[64:67], v10 offset:40960
    buffer_load_dwordx4 v4, s[4:7], s37 offen offset:2048 lds
    v_mfma_f32_16x16x32_bf16 v[140:143], v[68:71], v[36:39], v[140:143]
    buffer_load_dwordx4 v5, s[4:7], s37 offen offset:3072 lds
    v_mfma_f32_16x16x32_bf16 v[148:151], v[68:71], v[40:43], v[148:151]
    s_add_u32 m0, s42, 0
    s_add_u32 s37, s40, 3145728
    buffer_load_dwordx4 v6, s[8:11], s37 offen lds
    v_mfma_f32_16x16x32_bf16 v[156:159], v[68:71], v[44:47], v[156:159]
    buffer_load_dwordx4 v7, s[8:11], s37 offen offset:1024 lds
    s_waitcnt lgkmcnt(2)
    v_mfma_f32_16x16x32_bf16 v[160:163], v[72:75], v[32:35], v[160:163]
    ds_read_b128 v[68:71], v10 offset:43008
    buffer_load_dwordx4 v8, s[8:11], s37 offen offset:2048 lds
    v_mfma_f32_16x16x32_bf16 v[168:171], v[72:75], v[36:39], v[168:171]
    buffer_load_dwordx4 v9, s[8:11], s37 offen offset:3072 lds
    v_mfma_f32_16x16x32_bf16 v[176:179], v[72:75], v[40:43], v[176:179]
    s_mov_b32 s76, s70
    s_mov_b32 s77, s71
    s_mov_b32 s78, 2621440
    s_lshr_b32 s3, s2, 1
    s_mul_i32 s3, s3, 5
    s_and_b32 s38, s2, 1
    s_mul_i32 s38, s38, 3
    s_add_u32 s3, s3, s38
    s_add_u32 s3, s3, s32
    s_lshl_b32 s3, s3, 12
    s_cmp_ge_u32 s32, 3
    s_cselect_b32 s3, 0x80000000, s3
    v_lshlrev_b32 v29, 7, v0
    s_mov_b32 exec_hi, 0
    buffer_load_dword v29, v29, s[76:79], s3 offen sc1
    s_mov_b32 exec_hi, -1
    v_mfma_f32_16x16x32_bf16 v[184:187], v[72:75], v[44:47], v[184:187]
    v_cvt_pk_bf16_f32 v123, v118, v24
    v_cvt_pk_bf16_f32 v127, v119, v25
    s_waitcnt lgkmcnt(2)
    v_mfma_f32_16x16x32_bf16 v[164:167], v[76:79], v[32:35], v[164:167]
    ds_read_b128 v[72:75], v10 offset:45056
    s_cmp_lt_u32 s32, 5
    s_cselect_b64 exec, -1, 0
    ds_write_b128 v23, v[120:123]
    ds_write_b128 v23, v[124:127] offset:128
    s_mov_b64 exec, -1
    v_lshrrev_b32 v26, 3, v0
    v_mfma_f32_16x16x32_bf16 v[172:175], v[76:79], v[36:39], v[172:175]
    v_and_b32 v27, 7, v0
    v_lshrrev_b32 v28, 4, v0
    v_mfma_f32_16x16x32_bf16 v[180:183], v[76:79], v[40:43], v[180:183]
    ds_read_b64_tr_b16 v[48:49], v12 offset:40960
    ds_read_b64_tr_b16 v[50:51], v12 offset:41984
    v_xor_b32 v28, v28, v27
    v_lshlrev_b32 v28, 4, v28
    v_mfma_f32_16x16x32_bf16 v[188:191], v[76:79], v[44:47], v[188:191]
    ds_read_b64_tr_b16 v[52:53], v13 offset:40960
    ds_read_b64_tr_b16 v[54:55], v13 offset:41984
    v_lshl_add_u32 v24, v26, 7, v28
    v_lshlrev_b32 v27, 4, v27
    s_waitcnt lgkmcnt(6)
    v_mfma_f32_16x16x32_bf16 v[192:195], v[64:67], v[32:35], v[192:195]
    ds_read_b128 v[76:79], v10 offset:47104
    ds_read_b64_tr_b16 v[56:57], v14 offset:40960
    v_mul_u32_u24 v25, 4224, v26
    v_add_u32 v25, v25, v27
    v_mfma_f32_16x16x32_bf16 v[200:203], v[64:67], v[36:39], v[200:203]
    ds_read_b64_tr_b16 v[58:59], v14 offset:41984
    ds_read_b64_tr_b16 v[60:61], v15 offset:40960
    s_and_b32 s3, s32, 1
    s_lshl_b32 s3, s3, 6
    v_xor_b32 v24, s3, v24
    s_lshl_b32 s3, s32, 10
    s_add_u32 s3, s3, 153600
    v_add_u32 v24, s3, v24
    v_mfma_f32_16x16x32_bf16 v[208:211], v[64:67], v[40:43], v[208:211]
    ds_read_b64_tr_b16 v[62:63], v15 offset:41984
    v_mfma_f32_16x16x32_bf16 v[216:219], v[64:67], v[44:47], v[216:219]
    s_waitcnt lgkmcnt(10)
    v_mfma_f32_16x16x32_bf16 v[196:199], v[68:71], v[32:35], v[196:199]
    ds_read_b128 v[64:67], v11 offset:32768
    v_mfma_f32_16x16x32_bf16 v[204:207], v[68:71], v[36:39], v[204:207]
    v_mfma_f32_16x16x32_bf16 v[212:215], v[68:71], v[40:43], v[212:215]
    v_mfma_f32_16x16x32_bf16 v[220:223], v[68:71], v[44:47], v[220:223]
    s_waitcnt lgkmcnt(10)
    v_mfma_f32_16x16x32_bf16 v[224:227], v[72:75], v[32:35], v[224:227]
    ds_read_b128 v[68:71], v11 offset:34816
    v_mfma_f32_16x16x32_bf16 v[232:235], v[72:75], v[36:39], v[232:235]
    v_mfma_f32_16x16x32_bf16 v[240:243], v[72:75], v[40:43], v[240:243]
    v_mfma_f32_16x16x32_bf16 v[248:251], v[72:75], v[44:47], v[248:251]
    s_waitcnt lgkmcnt(6)
    v_mfma_f32_16x16x32_bf16 v[228:231], v[76:79], v[32:35], v[228:231]
    ds_read_b128 v[72:75], v11 offset:36864
    v_mfma_f32_16x16x32_bf16 v[236:239], v[76:79], v[36:39], v[236:239]
    v_mfma_f32_16x16x32_bf16 v[244:247], v[76:79], v[40:43], v[244:247]
    v_mfma_f32_16x16x32_bf16 v[252:255], v[76:79], v[44:47], v[252:255]
    s_waitcnt lgkmcnt(2)
    v_mfma_f32_16x16x32_bf16 v[128:131], v[64:67], v[48:51], v[128:131]
    ds_read_b128 v[76:79], v11 offset:38912
    v_mfma_f32_16x16x32_bf16 v[136:139], v[64:67], v[52:55], v[136:139]
    v_mfma_f32_16x16x32_bf16 v[144:147], v[64:67], v[56:59], v[144:147]
    v_mfma_f32_16x16x32_bf16 v[152:155], v[64:67], v[60:63], v[152:155]
    s_waitcnt lgkmcnt(2)
    v_mfma_f32_16x16x32_bf16 v[132:135], v[68:71], v[48:51], v[132:135]
    ds_read_b128 v[64:67], v11 offset:40960
    v_mfma_f32_16x16x32_bf16 v[140:143], v[68:71], v[52:55], v[140:143]
    v_mfma_f32_16x16x32_bf16 v[148:151], v[68:71], v[56:59], v[148:151]
    v_mfma_f32_16x16x32_bf16 v[156:159], v[68:71], v[60:63], v[156:159]
    s_waitcnt lgkmcnt(2)
    v_mfma_f32_16x16x32_bf16 v[160:163], v[72:75], v[48:51], v[160:163]
    ds_read_b128 v[68:71], v11 offset:43008
    v_mfma_f32_16x16x32_bf16 v[168:171], v[72:75], v[52:55], v[168:171]
    v_mfma_f32_16x16x32_bf16 v[176:179], v[72:75], v[56:59], v[176:179]
    v_mfma_f32_16x16x32_bf16 v[184:187], v[72:75], v[60:63], v[184:187]
    s_waitcnt lgkmcnt(2)
    v_mfma_f32_16x16x32_bf16 v[164:167], v[76:79], v[48:51], v[164:167]
    ds_read_b128 v[72:75], v11 offset:45056
    v_mfma_f32_16x16x32_bf16 v[172:175], v[76:79], v[52:55], v[172:175]
    v_mfma_f32_16x16x32_bf16 v[180:183], v[76:79], v[56:59], v[180:183]
    v_mfma_f32_16x16x32_bf16 v[188:191], v[76:79], v[60:63], v[188:191]
    s_waitcnt lgkmcnt(2)
    v_mfma_f32_16x16x32_bf16 v[192:195], v[64:67], v[48:51], v[192:195]
    ds_read_b128 v[76:79], v11 offset:47104
    v_mfma_f32_16x16x32_bf16 v[200:203], v[64:67], v[52:55], v[200:203]
    v_mfma_f32_16x16x32_bf16 v[208:211], v[64:67], v[56:59], v[208:211]
    v_mfma_f32_16x16x32_bf16 v[216:219], v[64:67], v[60:63], v[216:219]
    s_waitcnt lgkmcnt(0)
    s_waitcnt lgkmcnt(0)
    s_waitcnt vmcnt(1)
    s_barrier
    ds_read_b64_tr_b16 v[32:33], v12 offset:0
    ds_read_b64_tr_b16 v[34:35], v12 offset:1024
    v_mfma_f32_16x16x32_bf16 v[196:199], v[68:71], v[48:51], v[196:199]
    ds_read_b64_tr_b16 v[36:37], v13 offset:0
    ds_read_b64_tr_b16 v[38:39], v13 offset:1024
    ds_read_b64_tr_b16 v[116:117], v22 offset:0
    v_mfma_f32_16x16x32_bf16 v[204:207], v[68:71], v[52:55], v[204:207]
    ds_read_b64_tr_b16 v[40:41], v14 offset:0
    ds_read_b64_tr_b16 v[42:43], v14 offset:1024
    ds_read_b64_tr_b16 v[118:119], v22 offset:10752
    v_mfma_f32_16x16x32_bf16 v[212:215], v[68:71], v[56:59], v[212:215]
    ds_read_b64_tr_b16 v[44:45], v15 offset:0
    ds_read_b64_tr_b16 v[46:47], v15 offset:1024
    ds_read_b64_tr_b16 v[120:121], v22 offset:256
    v_mfma_f32_16x16x32_bf16 v[220:223], v[68:71], v[60:63], v[220:223]
    ds_read_b128 v[64:67], v10 offset:0
    ds_read_b64_tr_b16 v[122:123], v22 offset:11008
    v_mfma_f32_16x16x32_bf16 v[224:227], v[72:75], v[48:51], v[224:227]
    ds_read_b128 v[68:71], v10 offset:2048
    ds_read_b64_tr_b16 v[124:125], v22 offset:512
    v_mfma_f32_16x16x32_bf16 v[232:235], v[72:75], v[52:55], v[232:235]
    ds_read_b64_tr_b16 v[126:127], v22 offset:11264
    v_mfma_f32_16x16x32_bf16 v[240:243], v[72:75], v[56:59], v[240:243]
    ds_read_b128 v[90:93], v24
    v_mfma_f32_16x16x32_bf16 v[248:251], v[72:75], v[60:63], v[248:251]
    ds_read_b128 v[94:97], v24 offset:8192
    v_mfma_f32_16x16x32_bf16 v[228:231], v[76:79], v[48:51], v[228:231]
    ds_read_b128 v[72:75], v10 offset:4096
    v_mfma_f32_16x16x32_bf16 v[236:239], v[76:79], v[52:55], v[236:239]
    v_mfma_f32_16x16x32_bf16 v[244:247], v[76:79], v[56:59], v[244:247]
    v_mfma_f32_16x16x32_bf16 v[252:255], v[76:79], v[60:63], v[252:255]
    s_waitcnt lgkmcnt(2)
    v_mfma_f32_16x16x32_bf16 v[128:131], v[64:67], v[32:35], v[128:131]
    ds_read_b128 v[76:79], v10 offset:6144
    v_mfma_f32_16x16x32_bf16 v[136:139], v[64:67], v[36:39], v[136:139]
    v_mfma_f32_16x16x32_bf16 v[144:147], v[64:67], v[40:43], v[144:147]
    s_add_u32 m0, s41, 32768
    s_add_u32 s37, s39, 896
    buffer_load_dwordx4 v2, s[4:7], s37 offen lds
    v_mfma_f32_16x16x32_bf16 v[152:155], v[64:67], v[44:47], v[152:155]
    buffer_load_dwordx4 v3, s[4:7], s37 offen offset:1024 lds
    s_waitcnt lgkmcnt(2)
    v_mfma_f32_16x16x32_bf16 v[132:135], v[68:71], v[32:35], v[132:135]
    ds_read_b128 v[64:67], v10 offset:8192
    buffer_load_dwordx4 v4, s[4:7], s37 offen offset:2048 lds
    v_mfma_f32_16x16x32_bf16 v[140:143], v[68:71], v[36:39], v[140:143]
    buffer_load_dwordx4 v5, s[4:7], s37 offen offset:3072 lds
    v_mfma_f32_16x16x32_bf16 v[148:151], v[68:71], v[40:43], v[148:151]
    s_add_u32 m0, s42, 32768
    s_add_u32 s37, s40, 3670016
    buffer_load_dwordx4 v6, s[8:11], s37 offen lds
    v_mfma_f32_16x16x32_bf16 v[156:159], v[68:71], v[44:47], v[156:159]
    buffer_load_dwordx4 v7, s[8:11], s37 offen offset:1024 lds
    s_waitcnt lgkmcnt(2)
    v_mfma_f32_16x16x32_bf16 v[160:163], v[72:75], v[32:35], v[160:163]
    ds_read_b128 v[68:71], v10 offset:10240
    buffer_load_dwordx4 v8, s[8:11], s37 offen offset:2048 lds
    v_mfma_f32_16x16x32_bf16 v[168:171], v[72:75], v[36:39], v[168:171]
    buffer_load_dwordx4 v9, s[8:11], s37 offen offset:3072 lds
    v_mfma_f32_16x16x32_bf16 v[176:179], v[72:75], v[40:43], v[176:179]
    v_mfma_f32_16x16x32_bf16 v[184:187], v[72:75], v[44:47], v[184:187]
    s_waitcnt lgkmcnt(2)
    v_mfma_f32_16x16x32_bf16 v[164:167], v[76:79], v[32:35], v[164:167]
    ds_read_b128 v[72:75], v10 offset:12288
    v_mfma_f32_16x16x32_bf16 v[172:175], v[76:79], v[36:39], v[172:175]
    v_mfma_f32_16x16x32_bf16 v[180:183], v[76:79], v[40:43], v[180:183]
    ds_read_b64_tr_b16 v[48:49], v12 offset:8192
    ds_read_b64_tr_b16 v[50:51], v12 offset:9216
    v_mfma_f32_16x16x32_bf16 v[188:191], v[76:79], v[44:47], v[188:191]
    ds_read_b64_tr_b16 v[52:53], v13 offset:8192
    ds_read_b64_tr_b16 v[54:55], v13 offset:9216
    s_waitcnt lgkmcnt(6)
    v_mfma_f32_16x16x32_bf16 v[192:195], v[64:67], v[32:35], v[192:195]
    ds_read_b128 v[76:79], v10 offset:14336
    ds_read_b64_tr_b16 v[56:57], v14 offset:8192
    v_mfma_f32_16x16x32_bf16 v[200:203], v[64:67], v[36:39], v[200:203]
    ds_read_b64_tr_b16 v[58:59], v14 offset:9216
    ds_read_b64_tr_b16 v[60:61], v15 offset:8192
    v_mfma_f32_16x16x32_bf16 v[208:211], v[64:67], v[40:43], v[208:211]
    ds_read_b64_tr_b16 v[62:63], v15 offset:9216
    v_mfma_f32_16x16x32_bf16 v[216:219], v[64:67], v[44:47], v[216:219]
    s_waitcnt lgkmcnt(10)
    v_mfma_f32_16x16x32_bf16 v[196:199], v[68:71], v[32:35], v[196:199]
    ds_read_b128 v[64:67], v11 offset:0
    v_mfma_f32_16x16x32_bf16 v[204:207], v[68:71], v[36:39], v[204:207]
    v_mfma_f32_16x16x32_bf16 v[212:215], v[68:71], v[40:43], v[212:215]
    v_mfma_f32_16x16x32_bf16 v[220:223], v[68:71], v[44:47], v[220:223]
    s_and_b32 s3, s2, 1
    s_mul_i32 s3, s3, 20
    s_add_u32 s3, s3, s32
    s_mul_i32 s3, s3, 132096
    s_lshr_b32 s38, s2, 1
    s_lshl_b32 s38, s38, 10
    s_add_u32 s3, s3, s38
    s_add_u32 s48, s3, 51380224
    buffer_store_dwordx4 v[116:119], v1, s[12:15], s48 offen sc1
    s_waitcnt lgkmcnt(10)
    v_mfma_f32_16x16x32_bf16 v[224:227], v[72:75], v[32:35], v[224:227]
    ds_read_b128 v[68:71], v11 offset:2048
    v_mfma_f32_16x16x32_bf16 v[232:235], v[72:75], v[36:39], v[232:235]
    v_mfma_f32_16x16x32_bf16 v[240:243], v[72:75], v[40:43], v[240:243]
    v_mfma_f32_16x16x32_bf16 v[248:251], v[72:75], v[44:47], v[248:251]
    s_waitcnt lgkmcnt(6)
    v_mfma_f32_16x16x32_bf16 v[228:231], v[76:79], v[32:35], v[228:231]
    ds_read_b128 v[72:75], v11 offset:4096
    v_mfma_f32_16x16x32_bf16 v[236:239], v[76:79], v[36:39], v[236:239]
    v_mfma_f32_16x16x32_bf16 v[244:247], v[76:79], v[40:43], v[244:247]
    v_mfma_f32_16x16x32_bf16 v[252:255], v[76:79], v[44:47], v[252:255]
    s_waitcnt lgkmcnt(2)
    v_mfma_f32_16x16x32_bf16 v[128:131], v[64:67], v[48:51], v[128:131]
    ds_read_b128 v[76:79], v11 offset:6144
    v_mfma_f32_16x16x32_bf16 v[136:139], v[64:67], v[52:55], v[136:139]
    v_mfma_f32_16x16x32_bf16 v[144:147], v[64:67], v[56:59], v[144:147]
    v_mfma_f32_16x16x32_bf16 v[152:155], v[64:67], v[60:63], v[152:155]
    s_waitcnt lgkmcnt(2)
    v_mfma_f32_16x16x32_bf16 v[132:135], v[68:71], v[48:51], v[132:135]
    ds_read_b128 v[64:67], v11 offset:8192
    v_mfma_f32_16x16x32_bf16 v[140:143], v[68:71], v[52:55], v[140:143]
    v_mfma_f32_16x16x32_bf16 v[148:151], v[68:71], v[56:59], v[148:151]
    v_mfma_f32_16x16x32_bf16 v[156:159], v[68:71], v[60:63], v[156:159]
    s_waitcnt lgkmcnt(2)
    v_mfma_f32_16x16x32_bf16 v[160:163], v[72:75], v[48:51], v[160:163]
    ds_read_b128 v[68:71], v11 offset:10240
    v_mfma_f32_16x16x32_bf16 v[168:171], v[72:75], v[52:55], v[168:171]
    v_mfma_f32_16x16x32_bf16 v[176:179], v[72:75], v[56:59], v[176:179]
    v_mfma_f32_16x16x32_bf16 v[184:187], v[72:75], v[60:63], v[184:187]
    s_add_u32 s48, s48, 1056768
    buffer_store_dwordx4 v[120:123], v1, s[12:15], s48 offen sc1
    s_waitcnt lgkmcnt(2)
    v_mfma_f32_16x16x32_bf16 v[164:167], v[76:79], v[48:51], v[164:167]
    ds_read_b128 v[72:75], v11 offset:12288
    v_mfma_f32_16x16x32_bf16 v[172:175], v[76:79], v[52:55], v[172:175]
    v_mfma_f32_16x16x32_bf16 v[180:183], v[76:79], v[56:59], v[180:183]
    v_mfma_f32_16x16x32_bf16 v[188:191], v[76:79], v[60:63], v[188:191]
    s_waitcnt lgkmcnt(2)
    v_mfma_f32_16x16x32_bf16 v[192:195], v[64:67], v[48:51], v[192:195]
    ds_read_b128 v[76:79], v11 offset:14336
    v_mfma_f32_16x16x32_bf16 v[200:203], v[64:67], v[52:55], v[200:203]
    v_mfma_f32_16x16x32_bf16 v[208:211], v[64:67], v[56:59], v[208:211]
    v_mfma_f32_16x16x32_bf16 v[216:219], v[64:67], v[60:63], v[216:219]
    s_waitcnt lgkmcnt(0)
    s_waitcnt vmcnt(2)
    s_barrier
    ds_read_b64_tr_b16 v[32:33], v12 offset:32768
    ds_read_b64_tr_b16 v[34:35], v12 offset:33792
    v_mfma_f32_16x16x32_bf16 v[196:199], v[68:71], v[48:51], v[196:199]
    ds_read_b64_tr_b16 v[36:37], v13 offset:32768
    ds_read_b64_tr_b16 v[38:39], v13 offset:33792
    v_mfma_f32_16x16x32_bf16 v[204:207], v[68:71], v[52:55], v[204:207]
    ds_read_b64_tr_b16 v[40:41], v14 offset:32768
    ds_read_b64_tr_b16 v[42:43], v14 offset:33792
    v_mfma_f32_16x16x32_bf16 v[212:215], v[68:71], v[56:59], v[212:215]
    ds_read_b64_tr_b16 v[44:45], v15 offset:32768
    ds_read_b64_tr_b16 v[46:47], v15 offset:33792
    v_mfma_f32_16x16x32_bf16 v[220:223], v[68:71], v[60:63], v[220:223]
    ds_read_b128 v[64:67], v10 offset:32768
    v_mfma_f32_16x16x32_bf16 v[224:227], v[72:75], v[48:51], v[224:227]
    ds_read_b128 v[68:71], v10 offset:34816
    v_mfma_f32_16x16x32_bf16 v[232:235], v[72:75], v[52:55], v[232:235]
    v_mfma_f32_16x16x32_bf16 v[240:243], v[72:75], v[56:59], v[240:243]
    v_mfma_f32_16x16x32_bf16 v[248:251], v[72:75], v[60:63], v[248:251]
    v_mfma_f32_16x16x32_bf16 v[228:231], v[76:79], v[48:51], v[228:231]
    ds_read_b128 v[72:75], v10 offset:36864
    v_mfma_f32_16x16x32_bf16 v[236:239], v[76:79], v[52:55], v[236:239]
    v_mfma_f32_16x16x32_bf16 v[244:247], v[76:79], v[56:59], v[244:247]
    v_mfma_f32_16x16x32_bf16 v[252:255], v[76:79], v[60:63], v[252:255]
    s_waitcnt lgkmcnt(2)
    v_mfma_f32_16x16x32_bf16 v[128:131], v[64:67], v[32:35], v[128:131]
    ds_read_b128 v[76:79], v10 offset:38912
    v_mfma_f32_16x16x32_bf16 v[136:139], v[64:67], v[36:39], v[136:139]
    v_mfma_f32_16x16x32_bf16 v[144:147], v[64:67], v[40:43], v[144:147]
    s_add_u32 m0, s41, 131072
    s_add_u32 s37, s45, 0
    buffer_load_dwordx4 v16, s[20:23], s37 offen lds
    v_mfma_f32_16x16x32_bf16 v[152:155], v[64:67], v[44:47], v[152:155]
    buffer_load_dwordx4 v17, s[20:23], s37 offen offset:1024 lds
    s_waitcnt lgkmcnt(2)
    v_mfma_f32_16x16x32_bf16 v[132:135], v[68:71], v[32:35], v[132:135]
    ds_read_b128 v[64:67], v10 offset:40960
    buffer_load_dwordx4 v18, s[20:23], s37 offen offset:2048 lds
    v_mfma_f32_16x16x32_bf16 v[140:143], v[68:71], v[36:39], v[140:143]
    buffer_load_dwordx4 v19, s[20:23], s37 offen offset:3072 lds
    v_mfma_f32_16x16x32_bf16 v[148:151], v[68:71], v[40:43], v[148:151]
    s_add_u32 m0, s52, 0
    s_add_u32 s37, s46, 0
    buffer_load_dwordx4 v20, s[24:27], s37 offen lds
    v_mfma_f32_16x16x32_bf16 v[156:159], v[68:71], v[44:47], v[156:159]
    buffer_load_dwordx4 v21, s[24:27], s37 offen offset:1024 lds
    s_waitcnt lgkmcnt(2)
    v_mfma_f32_16x16x32_bf16 v[160:163], v[72:75], v[32:35], v[160:163]
    ds_read_b128 v[68:71], v10 offset:43008
    s_add_u32 m0, s41, 0
    s_add_u32 s37, s45, 128
    buffer_load_dwordx4 v16, s[20:23], s37 offen lds
    v_mfma_f32_16x16x32_bf16 v[168:171], v[72:75], v[36:39], v[168:171]
    buffer_load_dwordx4 v17, s[20:23], s37 offen offset:1024 lds
    v_mfma_f32_16x16x32_bf16 v[176:179], v[72:75], v[40:43], v[176:179]
    buffer_load_dwordx4 v18, s[20:23], s37 offen offset:2048 lds
    v_mfma_f32_16x16x32_bf16 v[184:187], v[72:75], v[44:47], v[184:187]
    buffer_load_dwordx4 v19, s[20:23], s37 offen offset:3072 lds
    s_waitcnt lgkmcnt(2)
    v_mfma_f32_16x16x32_bf16 v[164:167], v[76:79], v[32:35], v[164:167]
    ds_read_b128 v[72:75], v10 offset:45056
    s_add_u32 m0, s52, 16384
    s_add_u32 s37, s46, 524288
    buffer_load_dwordx4 v20, s[24:27], s37 offen lds
    v_mfma_f32_16x16x32_bf16 v[172:175], v[76:79], v[36:39], v[172:175]
    buffer_load_dwordx4 v21, s[24:27], s37 offen offset:1024 lds
    v_mfma_f32_16x16x32_bf16 v[180:183], v[76:79], v[40:43], v[180:183]
    ds_read_b64_tr_b16 v[48:49], v12 offset:40960
    ds_read_b64_tr_b16 v[50:51], v12 offset:41984
    s_add_u32 s48, s48, 1056768
    s_cmp_ge_u32 s32, 4
    s_cselect_b32 s48, 0x80000000, s48
    buffer_store_dwordx4 v[124:127], v1, s[12:15], s48 offen sc1
    v_mfma_f32_16x16x32_bf16 v[188:191], v[76:79], v[44:47], v[188:191]
    ds_read_b64_tr_b16 v[52:53], v13 offset:40960
    ds_read_b64_tr_b16 v[54:55], v13 offset:41984
    s_waitcnt lgkmcnt(6)
    v_mfma_f32_16x16x32_bf16 v[192:195], v[64:67], v[32:35], v[192:195]
    ds_read_b128 v[76:79], v10 offset:47104
    ds_read_b64_tr_b16 v[56:57], v14 offset:40960
    v_mfma_f32_16x16x32_bf16 v[200:203], v[64:67], v[36:39], v[200:203]
    ds_read_b64_tr_b16 v[58:59], v14 offset:41984
    ds_read_b64_tr_b16 v[60:61], v15 offset:40960
    v_mfma_f32_16x16x32_bf16 v[208:211], v[64:67], v[40:43], v[208:211]
    ds_read_b64_tr_b16 v[62:63], v15 offset:41984
    v_mfma_f32_16x16x32_bf16 v[216:219], v[64:67], v[44:47], v[216:219]
    s_and_b32 s3, s2, 7
    s_mul_i32 s3, s3, 337920
    s_lshr_b32 s38, s2, 3
    s_lshl_b32 s38, s38, 7
    s_add_u32 s3, s3, s38
    s_mul_i32 s38, s32, 33792
    s_add_u32 s3, s3, s38
    s_add_u32 s48, s3, 58720256
    buffer_store_dwordx4 v[90:93], v25, s[12:15], s48 offen sc1
    s_waitcnt lgkmcnt(10)
    v_mfma_f32_16x16x32_bf16 v[196:199], v[68:71], v[32:35], v[196:199]
    ds_read_b128 v[64:67], v11 offset:32768
    v_mfma_f32_16x16x32_bf16 v[204:207], v[68:71], v[36:39], v[204:207]
    v_mfma_f32_16x16x32_bf16 v[212:215], v[68:71], v[40:43], v[212:215]
    v_mfma_f32_16x16x32_bf16 v[220:223], v[68:71], v[44:47], v[220:223]
    s_waitcnt lgkmcnt(10)
    v_mfma_f32_16x16x32_bf16 v[224:227], v[72:75], v[32:35], v[224:227]
    ds_read_b128 v[68:71], v11 offset:34816
    v_mfma_f32_16x16x32_bf16 v[232:235], v[72:75], v[36:39], v[232:235]
    v_mfma_f32_16x16x32_bf16 v[240:243], v[72:75], v[40:43], v[240:243]
    v_mfma_f32_16x16x32_bf16 v[248:251], v[72:75], v[44:47], v[248:251]
    s_waitcnt lgkmcnt(6)
    v_mfma_f32_16x16x32_bf16 v[228:231], v[76:79], v[32:35], v[228:231]
    ds_read_b128 v[72:75], v11 offset:36864
    v_mfma_f32_16x16x32_bf16 v[236:239], v[76:79], v[36:39], v[236:239]
    v_mfma_f32_16x16x32_bf16 v[244:247], v[76:79], v[40:43], v[244:247]
    v_mfma_f32_16x16x32_bf16 v[252:255], v[76:79], v[44:47], v[252:255]
    s_waitcnt lgkmcnt(2)
    v_mfma_f32_16x16x32_bf16 v[128:131], v[64:67], v[48:51], v[128:131]
    ds_read_b128 v[76:79], v11 offset:38912
    v_mfma_f32_16x16x32_bf16 v[136:139], v[64:67], v[52:55], v[136:139]
    v_mfma_f32_16x16x32_bf16 v[144:147], v[64:67], v[56:59], v[144:147]
    v_mfma_f32_16x16x32_bf16 v[152:155], v[64:67], v[60:63], v[152:155]
    s_waitcnt lgkmcnt(2)
    v_mfma_f32_16x16x32_bf16 v[132:135], v[68:71], v[48:51], v[132:135]
    ds_read_b128 v[64:67], v11 offset:40960
    v_mfma_f32_16x16x32_bf16 v[140:143], v[68:71], v[52:55], v[140:143]
    v_mfma_f32_16x16x32_bf16 v[148:151], v[68:71], v[56:59], v[148:151]
    v_mfma_f32_16x16x32_bf16 v[156:159], v[68:71], v[60:63], v[156:159]
    s_add_u32 s48, s48, 270336
    s_cmp_ge_u32 s32, 2
    s_cselect_b32 s48, 0x80000000, s48
    buffer_store_dwordx4 v[94:97], v25, s[12:15], s48 offen sc1
    s_waitcnt lgkmcnt(2)
    v_mfma_f32_16x16x32_bf16 v[160:163], v[72:75], v[48:51], v[160:163]
    ds_read_b128 v[68:71], v11 offset:43008
    v_mfma_f32_16x16x32_bf16 v[168:171], v[72:75], v[52:55], v[168:171]
    v_mfma_f32_16x16x32_bf16 v[176:179], v[72:75], v[56:59], v[176:179]
    v_mfma_f32_16x16x32_bf16 v[184:187], v[72:75], v[60:63], v[184:187]
    s_waitcnt lgkmcnt(2)
    v_mfma_f32_16x16x32_bf16 v[164:167], v[76:79], v[48:51], v[164:167]
    ds_read_b128 v[72:75], v11 offset:45056
    v_mfma_f32_16x16x32_bf16 v[172:175], v[76:79], v[52:55], v[172:175]
    v_mfma_f32_16x16x32_bf16 v[180:183], v[76:79], v[56:59], v[180:183]
    v_mfma_f32_16x16x32_bf16 v[188:191], v[76:79], v[60:63], v[188:191]
    s_waitcnt lgkmcnt(2)
    v_mfma_f32_16x16x32_bf16 v[192:195], v[64:67], v[48:51], v[192:195]
    ds_read_b128 v[76:79], v11 offset:47104
    v_mfma_f32_16x16x32_bf16 v[200:203], v[64:67], v[52:55], v[200:203]
    v_mfma_f32_16x16x32_bf16 v[208:211], v[64:67], v[56:59], v[208:211]
    v_mfma_f32_16x16x32_bf16 v[216:219], v[64:67], v[60:63], v[216:219]
    s_waitcnt lgkmcnt(0)
    s_waitcnt vmcnt(9)
    s_barrier
    v_mfma_f32_16x16x32_bf16 v[196:199], v[68:71], v[48:51], v[196:199]
    v_mfma_f32_16x16x32_bf16 v[204:207], v[68:71], v[52:55], v[204:207]
    v_mfma_f32_16x16x32_bf16 v[212:215], v[68:71], v[56:59], v[212:215]
    v_mfma_f32_16x16x32_bf16 v[220:223], v[68:71], v[60:63], v[220:223]
    v_mfma_f32_16x16x32_bf16 v[224:227], v[72:75], v[48:51], v[224:227]
    v_mfma_f32_16x16x32_bf16 v[232:235], v[72:75], v[52:55], v[232:235]
    v_mfma_f32_16x16x32_bf16 v[240:243], v[72:75], v[56:59], v[240:243]
    v_mfma_f32_16x16x32_bf16 v[248:251], v[72:75], v[60:63], v[248:251]
    v_mfma_f32_16x16x32_bf16 v[228:231], v[76:79], v[48:51], v[228:231]
    v_mfma_f32_16x16x32_bf16 v[236:239], v[76:79], v[52:55], v[236:239]
    v_mfma_f32_16x16x32_bf16 v[244:247], v[76:79], v[56:59], v[244:247]
    v_mfma_f32_16x16x32_bf16 v[252:255], v[76:79], v[60:63], v[252:255]
    s_add_u32 m0, s41, 32768
    s_add_u32 s37, s45, 256
    buffer_load_dwordx4 v16, s[20:23], s37 offen lds
    buffer_load_dwordx4 v17, s[20:23], s37 offen offset:1024 lds
    buffer_load_dwordx4 v18, s[20:23], s37 offen offset:2048 lds
    buffer_load_dwordx4 v19, s[20:23], s37 offen offset:3072 lds
    s_add_u32 m0, s52, 32768
    s_add_u32 s37, s46, 1048576
    buffer_load_dwordx4 v20, s[24:27], s37 offen lds
    buffer_load_dwordx4 v21, s[24:27], s37 offen offset:1024 lds
    s_lshr_b32 s37, s32, 1
    s_lshl_b32 s37, s37, 13
    s_and_b32 s38, s32, 1
    s_lshl_b32 s38, s38, 2
    s_mov_b32 s3, 65536
    v_and_b32 v24, 15, v0
    v_lshrrev_b32 v25, 4, v0
    v_bfe_u32 v26, v0, 1, 3
    v_xor_b32 v26, v26, v25
    v_lshlrev_b32 v26, 4, v26
    v_lshl_add_u32 v26, v24, 7, v26
    v_add_u32 v2, s37, v26
    v_xor_b32 v3, 64, v2
    v_bfe_u32 v24, v0, 2, 2
    v_lshl_add_u32 v26, v25, 3, v24
    v_lshlrev_b32 v26, 8, v26
    v_and_b32 v27, 3, v0
    v_lshl_add_u32 v26, v27, 3, v26
    v_add_u32 v26, s3, v26
    v_and_b32 v25, 1, v25
    v_lshl_add_u32 v24, v25, 2, v24
    v_xor_b32 v24, s38, v24
    v_xor_b32 v25, 0, v24
    v_lshl_add_u32 v6, v25, 5, v26
    v_xor_b32 v25, 1, v24
    v_lshl_add_u32 v7, v25, 5, v26
    v_xor_b32 v25, 2, v24
    v_lshl_add_u32 v8, v25, 5, v26
    v_xor_b32 v25, 3, v24
    v_lshl_add_u32 v9, v25, 5, v26
    v_add_u32 v4, 131072, v2
    v_add_u32 v5, 131072, v3
    ds_read_b64_tr_b16 v[32:33], v6 offset:0
    ds_read_b64_tr_b16 v[34:35], v6 offset:1024
    ds_read_b64_tr_b16 v[36:37], v7 offset:0
    ds_read_b64_tr_b16 v[38:39], v7 offset:1024
    ds_read_b64_tr_b16 v[40:41], v8 offset:0
    ds_read_b64_tr_b16 v[42:43], v8 offset:1024
    ds_read_b64_tr_b16 v[44:45], v9 offset:0
    ds_read_b64_tr_b16 v[46:47], v9 offset:1024
    ds_read_b128 v[64:67], v4 offset:0
    ds_read_b128 v[68:71], v4 offset:2048
    v_add_u32 v10, 2048, v1
    v_mov_b32 v25, 0
    v_and_b32 v26, 31, v0
    v_lshlrev_b32 v26, 2, v26
    v_cvt_pk_bf16_f32 v80, v160, v161
    v_cvt_pk_bf16_f32 v81, v162, v163
    v_cvt_pk_bf16_f32 v82, v164, v165
    v_cvt_pk_bf16_f32 v83, v166, v167
    v_cvt_pk_bf16_f32 v84, v168, v169
    v_cvt_pk_bf16_f32 v85, v170, v171
    v_cvt_pk_bf16_f32 v86, v172, v173
    v_cvt_pk_bf16_f32 v87, v174, v175
    v_cvt_pk_bf16_f32 v88, v176, v177
    v_cvt_pk_bf16_f32 v89, v178, v179
    v_cvt_pk_bf16_f32 v90, v180, v181
    v_cvt_pk_bf16_f32 v91, v182, v183
    v_cvt_pk_bf16_f32 v92, v184, v185
    v_cvt_pk_bf16_f32 v93, v186, v187
    v_cvt_pk_bf16_f32 v94, v188, v189
    v_cvt_pk_bf16_f32 v95, v190, v191
    v_cvt_pk_bf16_f32 v96, v192, v193
    v_cvt_pk_bf16_f32 v97, v194, v195
    v_cvt_pk_bf16_f32 v98, v196, v197
    v_cvt_pk_bf16_f32 v99, v198, v199
    v_cvt_pk_bf16_f32 v100, v200, v201
    v_cvt_pk_bf16_f32 v101, v202, v203
    v_cvt_pk_bf16_f32 v102, v204, v205
    v_cvt_pk_bf16_f32 v103, v206, v207
    v_cvt_pk_bf16_f32 v104, v208, v209
    v_cvt_pk_bf16_f32 v105, v210, v211
    v_cvt_pk_bf16_f32 v106, v212, v213
    v_cvt_pk_bf16_f32 v107, v214, v215
    v_cvt_pk_bf16_f32 v108, v216, v217
    v_cvt_pk_bf16_f32 v109, v218, v219
    v_cvt_pk_bf16_f32 v110, v220, v221
    v_cvt_pk_bf16_f32 v111, v222, v223
    v_cvt_pk_bf16_f32 v112, v224, v225
    v_cvt_pk_bf16_f32 v113, v226, v227
    v_cvt_pk_bf16_f32 v114, v228, v229
    v_cvt_pk_bf16_f32 v115, v230, v231
    v_cvt_pk_bf16_f32 v116, v232, v233
    v_cvt_pk_bf16_f32 v117, v234, v235
    v_cvt_pk_bf16_f32 v118, v236, v237
    v_cvt_pk_bf16_f32 v119, v238, v239
    v_cvt_pk_bf16_f32 v120, v240, v241
    v_cvt_pk_bf16_f32 v121, v242, v243
    v_cvt_pk_bf16_f32 v122, v244, v245
    v_cvt_pk_bf16_f32 v123, v246, v247
    v_cvt_pk_bf16_f32 v124, v248, v249
    v_cvt_pk_bf16_f32 v125, v250, v251
    v_cvt_pk_bf16_f32 v126, v252, v253
    v_cvt_pk_bf16_f32 v127, v254, v255
    v_cvt_pk_bf16_f32 v240, v128, v129
    v_cvt_pk_bf16_f32 v241, v130, v131
    v_cvt_pk_bf16_f32 v242, v132, v133
    v_cvt_pk_bf16_f32 v243, v134, v135
    v_cvt_pk_bf16_f32 v244, v136, v137
    v_cvt_pk_bf16_f32 v245, v138, v139
    v_cvt_pk_bf16_f32 v246, v140, v141
    v_cvt_pk_bf16_f32 v247, v142, v143
    v_cvt_pk_bf16_f32 v248, v144, v145
    v_cvt_pk_bf16_f32 v249, v146, v147
    v_cvt_pk_bf16_f32 v250, v148, v149
    v_cvt_pk_bf16_f32 v251, v150, v151
    v_cvt_pk_bf16_f32 v252, v152, v153
    v_cvt_pk_bf16_f32 v253, v154, v155
    v_cvt_pk_bf16_f32 v254, v156, v157
    v_cvt_pk_bf16_f32 v255, v158, v159
    s_waitcnt lgkmcnt(1)
    v_mfma_f32_16x16x32_bf16 v[128:131], v[32:35], v[64:67], 0
    ds_read_b128 v[72:75], v4 offset:4096
    v_mfma_f32_16x16x32_bf16 v[132:135], v[36:39], v[64:67], 0
    ds_read_b64_tr_b16 v[48:49], v6 offset:8192
    ds_read_b64_tr_b16 v[50:51], v6 offset:9216
    v_mfma_f32_16x16x32_bf16 v[136:139], v[40:43], v[64:67], 0
    ds_read_b128 v[76:79], v4 offset:6144
    ds_read_b64_tr_b16 v[52:53], v7 offset:8192
    v_mfma_f32_16x16x32_bf16 v[140:143], v[44:47], v[64:67], 0
    ds_read_b64_tr_b16 v[54:55], v7 offset:9216
    ds_read_b64_tr_b16 v[56:57], v8 offset:8192
    s_waitcnt lgkmcnt(7)
    v_mfma_f32_16x16x32_bf16 v[144:147], v[32:35], v[68:71], 0
    ds_read_b64_tr_b16 v[58:59], v8 offset:9216
    ds_read_b64_tr_b16 v[60:61], v9 offset:8192
    v_mfma_f32_16x16x32_bf16 v[148:151], v[36:39], v[68:71], 0
    ds_read_b64_tr_b16 v[62:63], v9 offset:9216
    v_mfma_f32_16x16x32_bf16 v[152:155], v[40:43], v[68:71], 0
    ds_read_b128 v[64:67], v5 offset:0
    v_mfma_f32_16x16x32_bf16 v[156:159], v[44:47], v[68:71], 0
    s_waitcnt lgkmcnt(10)
    v_mfma_f32_16x16x32_bf16 v[160:163], v[32:35], v[72:75], 0
    v_mfma_f32_16x16x32_bf16 v[164:167], v[36:39], v[72:75], 0
    v_mfma_f32_16x16x32_bf16 v[168:171], v[40:43], v[72:75], 0
    ds_read_b128 v[68:71], v5 offset:2048
    v_mfma_f32_16x16x32_bf16 v[172:175], v[44:47], v[72:75], 0
    s_waitcnt lgkmcnt(8)
    v_mfma_f32_16x16x32_bf16 v[176:179], v[32:35], v[76:79], 0
    v_mfma_f32_16x16x32_bf16 v[180:183], v[36:39], v[76:79], 0
    v_mfma_f32_16x16x32_bf16 v[184:187], v[40:43], v[76:79], 0
    ds_read_b128 v[72:75], v5 offset:4096
    v_mfma_f32_16x16x32_bf16 v[188:191], v[44:47], v[76:79], 0
    s_waitcnt lgkmcnt(2)
    v_mfma_f32_16x16x32_bf16 v[128:131], v[48:51], v[64:67], v[128:131]
    v_mfma_f32_16x16x32_bf16 v[132:135], v[52:55], v[64:67], v[132:135]
    v_mfma_f32_16x16x32_bf16 v[136:139], v[56:59], v[64:67], v[136:139]
    ds_read_b128 v[76:79], v5 offset:6144
    v_mfma_f32_16x16x32_bf16 v[140:143], v[60:63], v[64:67], v[140:143]
    s_waitcnt lgkmcnt(2)
    v_mfma_f32_16x16x32_bf16 v[144:147], v[48:51], v[68:71], v[144:147]
    v_mfma_f32_16x16x32_bf16 v[148:151], v[52:55], v[68:71], v[148:151]
    s_waitcnt lgkmcnt(0)
    s_waitcnt vmcnt(9)
    s_barrier
    ds_read_b64_tr_b16 v[32:33], v6 offset:16384
    ds_read_b64_tr_b16 v[34:35], v6 offset:17408
    v_mfma_f32_16x16x32_bf16 v[152:155], v[56:59], v[68:71], v[152:155]
    ds_read_b64_tr_b16 v[36:37], v7 offset:16384
    ds_read_b64_tr_b16 v[38:39], v7 offset:17408
    s_add_u32 m0, s41, 131072
    s_add_u32 s37, s45, 384
    buffer_load_dwordx4 v16, s[20:23], s37 offen lds
    v_mfma_f32_16x16x32_bf16 v[156:159], v[60:63], v[68:71], v[156:159]
    ds_read_b64_tr_b16 v[40:41], v8 offset:16384
    ds_read_b64_tr_b16 v[42:43], v8 offset:17408
    buffer_load_dwordx4 v17, s[20:23], s37 offen offset:1024 lds
    v_mfma_f32_16x16x32_bf16 v[160:163], v[48:51], v[72:75], v[160:163]
    ds_read_b64_tr_b16 v[44:45], v9 offset:16384
    ds_read_b64_tr_b16 v[46:47], v9 offset:17408
    buffer_load_dwordx4 v18, s[20:23], s37 offen offset:2048 lds
    v_mfma_f32_16x16x32_bf16 v[164:167], v[52:55], v[72:75], v[164:167]
    ds_read_b128 v[64:67], v2 offset:0
    buffer_load_dwordx4 v19, s[20:23], s37 offen offset:3072 lds
    v_mfma_f32_16x16x32_bf16 v[168:171], v[56:59], v[72:75], v[168:171]
    ds_read_b128 v[68:71], v2 offset:2048
    s_add_u32 m0, s52, 0
    s_add_u32 s37, s46, 1572864
    buffer_load_dwordx4 v20, s[24:27], s37 offen lds
    v_mfma_f32_16x16x32_bf16 v[172:175], v[60:63], v[72:75], v[172:175]
    buffer_load_dwordx4 v21, s[24:27], s37 offen offset:1024 lds
    v_mfma_f32_16x16x32_bf16 v[176:179], v[48:51], v[76:79], v[176:179]
    v_mfma_f32_16x16x32_bf16 v[180:183], v[52:55], v[76:79], v[180:183]
    v_mfma_f32_16x16x32_bf16 v[184:187], v[56:59], v[76:79], v[184:187]
    ds_read_b128 v[72:75], v2 offset:4096
    v_mfma_f32_16x16x32_bf16 v[188:191], v[60:63], v[76:79], v[188:191]
    s_waitcnt lgkmcnt(2)
    v_mfma_f32_16x16x32_bf16 v[128:131], v[32:35], v[64:67], v[128:131]
    v_mfma_f32_16x16x32_bf16 v[132:135], v[36:39], v[64:67], v[132:135]
    ds_read_b64_tr_b16 v[48:49], v6 offset:24576
    ds_read_b64_tr_b16 v[50:51], v6 offset:25600
    v_mfma_f32_16x16x32_bf16 v[136:139], v[40:43], v[64:67], v[136:139]
    ds_read_b128 v[76:79], v2 offset:6144
    ds_read_b64_tr_b16 v[52:53], v7 offset:24576
    v_mfma_f32_16x16x32_bf16 v[140:143], v[44:47], v[64:67], v[140:143]
    ds_read_b64_tr_b16 v[54:55], v7 offset:25600
    ds_read_b64_tr_b16 v[56:57], v8 offset:24576
    s_waitcnt lgkmcnt(7)
    v_mfma_f32_16x16x32_bf16 v[144:147], v[32:35], v[68:71], v[144:147]
    ds_read_b64_tr_b16 v[58:59], v8 offset:25600
    ds_read_b64_tr_b16 v[60:61], v9 offset:24576
    v_mfma_f32_16x16x32_bf16 v[148:151], v[36:39], v[68:71], v[148:151]
    ds_read_b64_tr_b16 v[62:63], v9 offset:25600
    v_mfma_f32_16x16x32_bf16 v[152:155], v[40:43], v[68:71], v[152:155]
    ds_read_b128 v[64:67], v3 offset:0
    v_mfma_f32_16x16x32_bf16 v[156:159], v[44:47], v[68:71], v[156:159]
    s_waitcnt lgkmcnt(10)
    v_mfma_f32_16x16x32_bf16 v[160:163], v[32:35], v[72:75], v[160:163]
    v_mfma_f32_16x16x32_bf16 v[164:167], v[36:39], v[72:75], v[164:167]
    v_mfma_f32_16x16x32_bf16 v[168:171], v[40:43], v[72:75], v[168:171]
    ds_read_b128 v[68:71], v3 offset:2048
    v_mfma_f32_16x16x32_bf16 v[172:175], v[44:47], v[72:75], v[172:175]
    s_waitcnt lgkmcnt(8)
    v_mfma_f32_16x16x32_bf16 v[176:179], v[32:35], v[76:79], v[176:179]
    v_mfma_f32_16x16x32_bf16 v[180:183], v[36:39], v[76:79], v[180:183]
    v_mfma_f32_16x16x32_bf16 v[184:187], v[40:43], v[76:79], v[184:187]
    ds_read_b128 v[72:75], v3 offset:4096
    v_mfma_f32_16x16x32_bf16 v[188:191], v[44:47], v[76:79], v[188:191]
    s_waitcnt lgkmcnt(2)
    v_mfma_f32_16x16x32_bf16 v[128:131], v[48:51], v[64:67], v[128:131]
    v_mfma_f32_16x16x32_bf16 v[132:135], v[52:55], v[64:67], v[132:135]
    v_mfma_f32_16x16x32_bf16 v[136:139], v[56:59], v[64:67], v[136:139]
    ds_read_b128 v[76:79], v3 offset:6144
    v_mfma_f32_16x16x32_bf16 v[140:143], v[60:63], v[64:67], v[140:143]
    s_waitcnt lgkmcnt(2)
    v_mfma_f32_16x16x32_bf16 v[144:147], v[48:51], v[68:71], v[144:147]
    v_mfma_f32_16x16x32_bf16 v[148:151], v[52:55], v[68:71], v[148:151]
    s_waitcnt lgkmcnt(0)
    s_waitcnt vmcnt(6)
    s_barrier
    ds_read_b64_tr_b16 v[32:33], v6 offset:32768
    ds_read_b64_tr_b16 v[34:35], v6 offset:33792
    v_mfma_f32_16x16x32_bf16 v[152:155], v[56:59], v[68:71], v[152:155]
    ds_read_b64_tr_b16 v[36:37], v7 offset:32768
    ds_read_b64_tr_b16 v[38:39], v7 offset:33792
    s_add_u32 m0, s41, 0
    s_add_u32 s37, s45, 512
    buffer_load_dwordx4 v16, s[20:23], s37 offen lds
    v_mfma_f32_16x16x32_bf16 v[156:159], v[60:63], v[68:71], v[156:159]
    ds_read_b64_tr_b16 v[40:41], v8 offset:32768
    ds_read_b64_tr_b16 v[42:43], v8 offset:33792
    buffer_load_dwordx4 v17, s[20:23], s37 offen offset:1024 lds
    v_mfma_f32_16x16x32_bf16 v[160:163], v[48:51], v[72:75], v[160:163]
    ds_read_b64_tr_b16 v[44:45], v9 offset:32768
    ds_read_b64_tr_b16 v[46:47], v9 offset:33792
    buffer_load_dwordx4 v18, s[20:23], s37 offen offset:2048 lds
    v_mfma_f32_16x16x32_bf16 v[164:167], v[52:55], v[72:75], v[164:167]
    ds_read_b128 v[64:67], v2 offset:32768
    buffer_load_dwordx4 v19, s[20:23], s37 offen offset:3072 lds
    v_mfma_f32_16x16x32_bf16 v[168:171], v[56:59], v[72:75], v[168:171]
    ds_read_b128 v[68:71], v2 offset:34816
    s_add_u32 m0, s52, 16384
    s_add_u32 s37, s46, 2097152
    buffer_load_dwordx4 v20, s[24:27], s37 offen lds
    v_mfma_f32_16x16x32_bf16 v[172:175], v[60:63], v[72:75], v[172:175]
    buffer_load_dwordx4 v21, s[24:27], s37 offen offset:1024 lds
    v_mfma_f32_16x16x32_bf16 v[176:179], v[48:51], v[76:79], v[176:179]
    v_mfma_f32_16x16x32_bf16 v[180:183], v[52:55], v[76:79], v[180:183]
    v_mfma_f32_16x16x32_bf16 v[184:187], v[56:59], v[76:79], v[184:187]
    ds_read_b128 v[72:75], v2 offset:36864
    v_mfma_f32_16x16x32_bf16 v[188:191], v[60:63], v[76:79], v[188:191]
    s_waitcnt lgkmcnt(2)
    v_mfma_f32_16x16x32_bf16 v[128:131], v[32:35], v[64:67], v[128:131]
    v_mfma_f32_16x16x32_bf16 v[132:135], v[36:39], v[64:67], v[132:135]
    ds_read_b64_tr_b16 v[48:49], v6 offset:40960
    ds_read_b64_tr_b16 v[50:51], v6 offset:41984
    v_mfma_f32_16x16x32_bf16 v[136:139], v[40:43], v[64:67], v[136:139]
    ds_read_b128 v[76:79], v2 offset:38912
    ds_read_b64_tr_b16 v[52:53], v7 offset:40960
    v_mfma_f32_16x16x32_bf16 v[140:143], v[44:47], v[64:67], v[140:143]
    ds_read_b64_tr_b16 v[54:55], v7 offset:41984
    ds_read_b64_tr_b16 v[56:57], v8 offset:40960
    s_waitcnt lgkmcnt(7)
    v_mfma_f32_16x16x32_bf16 v[144:147], v[32:35], v[68:71], v[144:147]
    ds_read_b64_tr_b16 v[58:59], v8 offset:41984
    ds_read_b64_tr_b16 v[60:61], v9 offset:40960
    v_mfma_f32_16x16x32_bf16 v[148:151], v[36:39], v[68:71], v[148:151]
    ds_read_b64_tr_b16 v[62:63], v9 offset:41984
    v_mfma_f32_16x16x32_bf16 v[152:155], v[40:43], v[68:71], v[152:155]
    ds_read_b128 v[64:67], v3 offset:32768
    v_mfma_f32_16x16x32_bf16 v[156:159], v[44:47], v[68:71], v[156:159]
    s_waitcnt lgkmcnt(10)
    v_mfma_f32_16x16x32_bf16 v[160:163], v[32:35], v[72:75], v[160:163]
    v_mfma_f32_16x16x32_bf16 v[164:167], v[36:39], v[72:75], v[164:167]
    v_mfma_f32_16x16x32_bf16 v[168:171], v[40:43], v[72:75], v[168:171]
    ds_read_b128 v[68:71], v3 offset:34816
    v_mfma_f32_16x16x32_bf16 v[172:175], v[44:47], v[72:75], v[172:175]
    s_waitcnt lgkmcnt(8)
    v_mfma_f32_16x16x32_bf16 v[176:179], v[32:35], v[76:79], v[176:179]
    v_mfma_f32_16x16x32_bf16 v[180:183], v[36:39], v[76:79], v[180:183]
    v_mfma_f32_16x16x32_bf16 v[184:187], v[40:43], v[76:79], v[184:187]
    ds_read_b128 v[72:75], v3 offset:36864
    v_mfma_f32_16x16x32_bf16 v[188:191], v[44:47], v[76:79], v[188:191]
    s_waitcnt lgkmcnt(2)
    v_mfma_f32_16x16x32_bf16 v[128:131], v[48:51], v[64:67], v[128:131]
    v_mfma_f32_16x16x32_bf16 v[132:135], v[52:55], v[64:67], v[132:135]
    v_mfma_f32_16x16x32_bf16 v[136:139], v[56:59], v[64:67], v[136:139]
    ds_read_b128 v[76:79], v3 offset:38912
    v_mfma_f32_16x16x32_bf16 v[140:143], v[60:63], v[64:67], v[140:143]
    s_waitcnt lgkmcnt(2)
    v_mfma_f32_16x16x32_bf16 v[144:147], v[48:51], v[68:71], v[144:147]
    s_add_u32 s3, s43, 0
    buffer_store_dwordx4 v[240:243], v1, s[12:15], s3 offen offset:0 sc1
    v_mfma_f32_16x16x32_bf16 v[148:151], v[52:55], v[68:71], v[148:151]
    s_waitcnt lgkmcnt(0)
    s_waitcnt vmcnt(7)
    s_barrier
    ds_read_b64_tr_b16 v[32:33], v6 offset:0
    ds_read_b64_tr_b16 v[34:35], v6 offset:1024
    v_mfma_f32_16x16x32_bf16 v[152:155], v[56:59], v[68:71], v[152:155]
    ds_read_b64_tr_b16 v[36:37], v7 offset:0
    ds_read_b64_tr_b16 v[38:39], v7 offset:1024
    s_add_u32 m0, s41, 32768
    s_add_u32 s37, s45, 640
    buffer_load_dwordx4 v16, s[20:23], s37 offen lds
    v_mfma_f32_16x16x32_bf16 v[156:159], v[60:63], v[68:71], v[156:159]
    ds_read_b64_tr_b16 v[40:41], v8 offset:0
    ds_read_b64_tr_b16 v[42:43], v8 offset:1024
    buffer_load_dwordx4 v17, s[20:23], s37 offen offset:1024 lds
    v_mfma_f32_16x16x32_bf16 v[160:163], v[48:51], v[72:75], v[160:163]
    ds_read_b64_tr_b16 v[44:45], v9 offset:0
    ds_read_b64_tr_b16 v[46:47], v9 offset:1024
    buffer_load_dwordx4 v18, s[20:23], s37 offen offset:2048 lds
    v_mfma_f32_16x16x32_bf16 v[164:167], v[52:55], v[72:75], v[164:167]
    ds_read_b128 v[64:67], v4 offset:0
    buffer_load_dwordx4 v19, s[20:23], s37 offen offset:3072 lds
    v_mfma_f32_16x16x32_bf16 v[168:171], v[56:59], v[72:75], v[168:171]
    ds_read_b128 v[68:71], v4 offset:2048
    s_add_u32 m0, s52, 32768
    s_add_u32 s37, s46, 2621440
    buffer_load_dwordx4 v20, s[24:27], s37 offen lds
    v_mfma_f32_16x16x32_bf16 v[172:175], v[60:63], v[72:75], v[172:175]
    buffer_load_dwordx4 v21, s[24:27], s37 offen offset:1024 lds
    v_mfma_f32_16x16x32_bf16 v[176:179], v[48:51], v[76:79], v[176:179]
    s_add_u32 s3, s43, 0
    buffer_store_dwordx4 v[244:247], v1, s[12:15], s3 offen offset:1024 sc1
    v_mfma_f32_16x16x32_bf16 v[180:183], v[52:55], v[76:79], v[180:183]
    v_mfma_f32_16x16x32_bf16 v[184:187], v[56:59], v[76:79], v[184:187]
    ds_read_b128 v[72:75], v4 offset:4096
    v_mfma_f32_16x16x32_bf16 v[188:191], v[60:63], v[76:79], v[188:191]
    s_waitcnt lgkmcnt(2)
    v_mfma_f32_16x16x32_bf16 v[128:131], v[32:35], v[64:67], v[128:131]
    v_mfma_f32_16x16x32_bf16 v[132:135], v[36:39], v[64:67], v[132:135]
    ds_read_b64_tr_b16 v[48:49], v6 offset:8192
    ds_read_b64_tr_b16 v[50:51], v6 offset:9216
    v_mfma_f32_16x16x32_bf16 v[136:139], v[40:43], v[64:67], v[136:139]
    ds_read_b128 v[76:79], v4 offset:6144
    ds_read_b64_tr_b16 v[52:53], v7 offset:8192
    v_mfma_f32_16x16x32_bf16 v[140:143], v[44:47], v[64:67], v[140:143]
    ds_read_b64_tr_b16 v[54:55], v7 offset:9216
    ds_read_b64_tr_b16 v[56:57], v8 offset:8192
    s_waitcnt lgkmcnt(7)
    v_mfma_f32_16x16x32_bf16 v[144:147], v[32:35], v[68:71], v[144:147]
    ds_read_b64_tr_b16 v[58:59], v8 offset:9216
    ds_read_b64_tr_b16 v[60:61], v9 offset:8192
    s_add_u32 s3, s43, 0
    buffer_store_dwordx4 v[248:251], v10, s[12:15], s3 offen offset:0 sc1
    v_mfma_f32_16x16x32_bf16 v[148:151], v[36:39], v[68:71], v[148:151]
    ds_read_b64_tr_b16 v[62:63], v9 offset:9216
    v_mfma_f32_16x16x32_bf16 v[152:155], v[40:43], v[68:71], v[152:155]
    ds_read_b128 v[64:67], v5 offset:0
    v_mfma_f32_16x16x32_bf16 v[156:159], v[44:47], v[68:71], v[156:159]
    s_waitcnt lgkmcnt(10)
    v_mfma_f32_16x16x32_bf16 v[160:163], v[32:35], v[72:75], v[160:163]
    v_mfma_f32_16x16x32_bf16 v[164:167], v[36:39], v[72:75], v[164:167]
    v_mfma_f32_16x16x32_bf16 v[168:171], v[40:43], v[72:75], v[168:171]
    ds_read_b128 v[68:71], v5 offset:2048
    v_mfma_f32_16x16x32_bf16 v[172:175], v[44:47], v[72:75], v[172:175]
    s_waitcnt lgkmcnt(8)
    v_mfma_f32_16x16x32_bf16 v[176:179], v[32:35], v[76:79], v[176:179]
    s_add_u32 s3, s43, 0
    buffer_store_dwordx4 v[252:255], v10, s[12:15], s3 offen offset:1024 sc1
    v_mfma_f32_16x16x32_bf16 v[180:183], v[36:39], v[76:79], v[180:183]
    v_mfma_f32_16x16x32_bf16 v[184:187], v[40:43], v[76:79], v[184:187]
    ds_read_b128 v[72:75], v5 offset:4096
    v_mfma_f32_16x16x32_bf16 v[188:191], v[44:47], v[76:79], v[188:191]
    s_waitcnt lgkmcnt(2)
    v_mfma_f32_16x16x32_bf16 v[128:131], v[48:51], v[64:67], v[128:131]
    v_mfma_f32_16x16x32_bf16 v[132:135], v[52:55], v[64:67], v[132:135]
    v_mfma_f32_16x16x32_bf16 v[136:139], v[56:59], v[64:67], v[136:139]
    ds_read_b128 v[76:79], v5 offset:6144
    v_mfma_f32_16x16x32_bf16 v[140:143], v[60:63], v[64:67], v[140:143]
    s_waitcnt lgkmcnt(2)
    v_mfma_f32_16x16x32_bf16 v[144:147], v[48:51], v[68:71], v[144:147]
    s_add_u32 s3, s43, 8192
    buffer_store_dwordx4 v[80:83], v1, s[12:15], s3 offen offset:0 sc1
    v_mfma_f32_16x16x32_bf16 v[148:151], v[52:55], v[68:71], v[148:151]
    s_waitcnt lgkmcnt(0)
    s_waitcnt vmcnt(11)
    s_barrier
    ds_read_b64_tr_b16 v[32:33], v6 offset:16384
    ds_read_b64_tr_b16 v[34:35], v6 offset:17408
    v_mfma_f32_16x16x32_bf16 v[152:155], v[56:59], v[68:71], v[152:155]
    ds_read_b64_tr_b16 v[36:37], v7 offset:16384
    ds_read_b64_tr_b16 v[38:39], v7 offset:17408
    s_add_u32 m0, s41, 131072
    s_add_u32 s37, s45, 768
    buffer_load_dwordx4 v16, s[20:23], s37 offen lds
    v_mfma_f32_16x16x32_bf16 v[156:159], v[60:63], v[68:71], v[156:159]
    ds_read_b64_tr_b16 v[40:41], v8 offset:16384
    ds_read_b64_tr_b16 v[42:43], v8 offset:17408
    buffer_load_dwordx4 v17, s[20:23], s37 offen offset:1024 lds
    v_mfma_f32_16x16x32_bf16 v[160:163], v[48:51], v[72:75], v[160:163]
    ds_read_b64_tr_b16 v[44:45], v9 offset:16384
    ds_read_b64_tr_b16 v[46:47], v9 offset:17408
    buffer_load_dwordx4 v18, s[20:23], s37 offen offset:2048 lds
    v_mfma_f32_16x16x32_bf16 v[164:167], v[52:55], v[72:75], v[164:167]
    ds_read_b128 v[64:67], v2 offset:0
    buffer_load_dwordx4 v19, s[20:23], s37 offen offset:3072 lds
    v_mfma_f32_16x16x32_bf16 v[168:171], v[56:59], v[72:75], v[168:171]
    ds_read_b128 v[68:71], v2 offset:2048
    s_add_u32 m0, s52, 0
    s_add_u32 s37, s46, 3145728
    buffer_load_dwordx4 v20, s[24:27], s37 offen lds
    v_mfma_f32_16x16x32_bf16 v[172:175], v[60:63], v[72:75], v[172:175]
    buffer_load_dwordx4 v21, s[24:27], s37 offen offset:1024 lds
    v_mfma_f32_16x16x32_bf16 v[176:179], v[48:51], v[76:79], v[176:179]
    s_add_u32 s3, s43, 8192
    buffer_store_dwordx4 v[84:87], v1, s[12:15], s3 offen offset:1024 sc1
    v_mfma_f32_16x16x32_bf16 v[180:183], v[52:55], v[76:79], v[180:183]
    v_mfma_f32_16x16x32_bf16 v[184:187], v[56:59], v[76:79], v[184:187]
    ds_read_b128 v[72:75], v2 offset:4096
    v_mfma_f32_16x16x32_bf16 v[188:191], v[60:63], v[76:79], v[188:191]
    s_waitcnt lgkmcnt(2)
    v_mfma_f32_16x16x32_bf16 v[128:131], v[32:35], v[64:67], v[128:131]
    v_mfma_f32_16x16x32_bf16 v[132:135], v[36:39], v[64:67], v[132:135]
    ds_read_b64_tr_b16 v[48:49], v6 offset:24576
    ds_read_b64_tr_b16 v[50:51], v6 offset:25600
    v_mfma_f32_16x16x32_bf16 v[136:139], v[40:43], v[64:67], v[136:139]
    ds_read_b128 v[76:79], v2 offset:6144
    ds_read_b64_tr_b16 v[52:53], v7 offset:24576
    v_mfma_f32_16x16x32_bf16 v[140:143], v[44:47], v[64:67], v[140:143]
    ds_read_b64_tr_b16 v[54:55], v7 offset:25600
    ds_read_b64_tr_b16 v[56:57], v8 offset:24576
    s_waitcnt lgkmcnt(7)
    v_mfma_f32_16x16x32_bf16 v[144:147], v[32:35], v[68:71], v[144:147]
    ds_read_b64_tr_b16 v[58:59], v8 offset:25600
    ds_read_b64_tr_b16 v[60:61], v9 offset:24576
    s_add_u32 s3, s43, 8192
    buffer_store_dwordx4 v[88:91], v10, s[12:15], s3 offen offset:0 sc1
    v_mfma_f32_16x16x32_bf16 v[148:151], v[36:39], v[68:71], v[148:151]
    ds_read_b64_tr_b16 v[62:63], v9 offset:25600
    v_mfma_f32_16x16x32_bf16 v[152:155], v[40:43], v[68:71], v[152:155]
    ds_read_b128 v[64:67], v3 offset:0
    v_mfma_f32_16x16x32_bf16 v[156:159], v[44:47], v[68:71], v[156:159]
    s_waitcnt lgkmcnt(10)
    v_mfma_f32_16x16x32_bf16 v[160:163], v[32:35], v[72:75], v[160:163]
    v_mfma_f32_16x16x32_bf16 v[164:167], v[36:39], v[72:75], v[164:167]
    v_mfma_f32_16x16x32_bf16 v[168:171], v[40:43], v[72:75], v[168:171]
    ds_read_b128 v[68:71], v3 offset:2048
    v_mfma_f32_16x16x32_bf16 v[172:175], v[44:47], v[72:75], v[172:175]
    s_waitcnt lgkmcnt(8)
    v_mfma_f32_16x16x32_bf16 v[176:179], v[32:35], v[76:79], v[176:179]
    s_add_u32 s3, s43, 8192
    buffer_store_dwordx4 v[92:95], v10, s[12:15], s3 offen offset:1024 sc1
    v_mfma_f32_16x16x32_bf16 v[180:183], v[36:39], v[76:79], v[180:183]
    v_mfma_f32_16x16x32_bf16 v[184:187], v[40:43], v[76:79], v[184:187]
    ds_read_b128 v[72:75], v3 offset:4096
    v_mfma_f32_16x16x32_bf16 v[188:191], v[44:47], v[76:79], v[188:191]
    s_waitcnt lgkmcnt(2)
    v_mfma_f32_16x16x32_bf16 v[128:131], v[48:51], v[64:67], v[128:131]
    v_mfma_f32_16x16x32_bf16 v[132:135], v[52:55], v[64:67], v[132:135]
    v_mfma_f32_16x16x32_bf16 v[136:139], v[56:59], v[64:67], v[136:139]
    ds_read_b128 v[76:79], v3 offset:6144
    v_mfma_f32_16x16x32_bf16 v[140:143], v[60:63], v[64:67], v[140:143]
    s_waitcnt lgkmcnt(2)
    v_mfma_f32_16x16x32_bf16 v[144:147], v[48:51], v[68:71], v[144:147]
    s_add_u32 s3, s43, 16384
    buffer_store_dwordx4 v[96:99], v1, s[12:15], s3 offen offset:0 sc1
    v_mfma_f32_16x16x32_bf16 v[148:151], v[52:55], v[68:71], v[148:151]
    s_waitcnt lgkmcnt(0)
    s_waitcnt vmcnt(14)
    s_barrier
    ds_read_b64_tr_b16 v[32:33], v6 offset:32768
    ds_read_b64_tr_b16 v[34:35], v6 offset:33792
    v_mfma_f32_16x16x32_bf16 v[152:155], v[56:59], v[68:71], v[152:155]
    ds_read_b64_tr_b16 v[36:37], v7 offset:32768
    ds_read_b64_tr_b16 v[38:39], v7 offset:33792
    s_add_u32 m0, s41, 0
    s_add_u32 s37, s45, 896
    buffer_load_dwordx4 v16, s[20:23], s37 offen lds
    v_mfma_f32_16x16x32_bf16 v[156:159], v[60:63], v[68:71], v[156:159]
    ds_read_b64_tr_b16 v[40:41], v8 offset:32768
    ds_read_b64_tr_b16 v[42:43], v8 offset:33792
    buffer_load_dwordx4 v17, s[20:23], s37 offen offset:1024 lds
    v_mfma_f32_16x16x32_bf16 v[160:163], v[48:51], v[72:75], v[160:163]
    ds_read_b64_tr_b16 v[44:45], v9 offset:32768
    ds_read_b64_tr_b16 v[46:47], v9 offset:33792
    buffer_load_dwordx4 v18, s[20:23], s37 offen offset:2048 lds
    v_mfma_f32_16x16x32_bf16 v[164:167], v[52:55], v[72:75], v[164:167]
    ds_read_b128 v[64:67], v2 offset:32768
    buffer_load_dwordx4 v19, s[20:23], s37 offen offset:3072 lds
    v_mfma_f32_16x16x32_bf16 v[168:171], v[56:59], v[72:75], v[168:171]
    ds_read_b128 v[68:71], v2 offset:34816
    s_add_u32 m0, s52, 16384
    s_add_u32 s37, s46, 3670016
    buffer_load_dwordx4 v20, s[24:27], s37 offen lds
    v_mfma_f32_16x16x32_bf16 v[172:175], v[60:63], v[72:75], v[172:175]
    buffer_load_dwordx4 v21, s[24:27], s37 offen offset:1024 lds
    v_mfma_f32_16x16x32_bf16 v[176:179], v[48:51], v[76:79], v[176:179]
    s_add_u32 s3, s43, 16384
    buffer_store_dwordx4 v[100:103], v1, s[12:15], s3 offen offset:1024 sc1
    v_mfma_f32_16x16x32_bf16 v[180:183], v[52:55], v[76:79], v[180:183]
    v_mfma_f32_16x16x32_bf16 v[184:187], v[56:59], v[76:79], v[184:187]
    ds_read_b128 v[72:75], v2 offset:36864
    v_mfma_f32_16x16x32_bf16 v[188:191], v[60:63], v[76:79], v[188:191]
    s_waitcnt lgkmcnt(2)
    v_mfma_f32_16x16x32_bf16 v[128:131], v[32:35], v[64:67], v[128:131]
    v_mfma_f32_16x16x32_bf16 v[132:135], v[36:39], v[64:67], v[132:135]
    ds_read_b64_tr_b16 v[48:49], v6 offset:40960
    ds_read_b64_tr_b16 v[50:51], v6 offset:41984
    v_mfma_f32_16x16x32_bf16 v[136:139], v[40:43], v[64:67], v[136:139]
    ds_read_b128 v[76:79], v2 offset:38912
    ds_read_b64_tr_b16 v[52:53], v7 offset:40960
    v_mfma_f32_16x16x32_bf16 v[140:143], v[44:47], v[64:67], v[140:143]
    ds_read_b64_tr_b16 v[54:55], v7 offset:41984
    ds_read_b64_tr_b16 v[56:57], v8 offset:40960
    s_waitcnt lgkmcnt(7)
    v_mfma_f32_16x16x32_bf16 v[144:147], v[32:35], v[68:71], v[144:147]
    ds_read_b64_tr_b16 v[58:59], v8 offset:41984
    ds_read_b64_tr_b16 v[60:61], v9 offset:40960
    s_add_u32 s3, s43, 16384
    buffer_store_dwordx4 v[104:107], v10, s[12:15], s3 offen offset:0 sc1
    v_mfma_f32_16x16x32_bf16 v[148:151], v[36:39], v[68:71], v[148:151]
    ds_read_b64_tr_b16 v[62:63], v9 offset:41984
    v_mfma_f32_16x16x32_bf16 v[152:155], v[40:43], v[68:71], v[152:155]
    ds_read_b128 v[64:67], v3 offset:32768
    v_mfma_f32_16x16x32_bf16 v[156:159], v[44:47], v[68:71], v[156:159]
    s_waitcnt lgkmcnt(10)
    v_mfma_f32_16x16x32_bf16 v[160:163], v[32:35], v[72:75], v[160:163]
    v_mfma_f32_16x16x32_bf16 v[164:167], v[36:39], v[72:75], v[164:167]
    v_mfma_f32_16x16x32_bf16 v[168:171], v[40:43], v[72:75], v[168:171]
    ds_read_b128 v[68:71], v3 offset:34816
    v_mfma_f32_16x16x32_bf16 v[172:175], v[44:47], v[72:75], v[172:175]
    s_waitcnt lgkmcnt(8)
    v_mfma_f32_16x16x32_bf16 v[176:179], v[32:35], v[76:79], v[176:179]
    s_add_u32 s3, s43, 16384
    buffer_store_dwordx4 v[108:111], v10, s[12:15], s3 offen offset:1024 sc1
    v_mfma_f32_16x16x32_bf16 v[180:183], v[36:39], v[76:79], v[180:183]
    v_mfma_f32_16x16x32_bf16 v[184:187], v[40:43], v[76:79], v[184:187]
    ds_read_b128 v[72:75], v3 offset:36864
    v_mfma_f32_16x16x32_bf16 v[188:191], v[44:47], v[76:79], v[188:191]
    s_waitcnt lgkmcnt(2)
    v_mfma_f32_16x16x32_bf16 v[128:131], v[48:51], v[64:67], v[128:131]
    v_mfma_f32_16x16x32_bf16 v[132:135], v[52:55], v[64:67], v[132:135]
    v_mfma_f32_16x16x32_bf16 v[136:139], v[56:59], v[64:67], v[136:139]
    ds_read_b128 v[76:79], v3 offset:38912
    v_mfma_f32_16x16x32_bf16 v[140:143], v[60:63], v[64:67], v[140:143]
    s_waitcnt lgkmcnt(2)
    v_mfma_f32_16x16x32_bf16 v[144:147], v[48:51], v[68:71], v[144:147]
    s_add_u32 s3, s43, 24576
    buffer_store_dwordx4 v[112:115], v1, s[12:15], s3 offen offset:0 sc1
    v_mfma_f32_16x16x32_bf16 v[148:151], v[52:55], v[68:71], v[148:151]
    s_waitcnt lgkmcnt(0)
    s_waitcnt vmcnt(14)
    s_barrier
    ds_read_b64_tr_b16 v[32:33], v6 offset:0
    ds_read_b64_tr_b16 v[34:35], v6 offset:1024
    v_mfma_f32_16x16x32_bf16 v[152:155], v[56:59], v[68:71], v[152:155]
    ds_read_b64_tr_b16 v[36:37], v7 offset:0
    ds_read_b64_tr_b16 v[38:39], v7 offset:1024
    s_add_u32 m0, s41, 32768
    s_add_u32 s37, s45, 1024
    buffer_load_dwordx4 v16, s[20:23], s37 offen lds
    v_mfma_f32_16x16x32_bf16 v[156:159], v[60:63], v[68:71], v[156:159]
    ds_read_b64_tr_b16 v[40:41], v8 offset:0
    ds_read_b64_tr_b16 v[42:43], v8 offset:1024
    buffer_load_dwordx4 v17, s[20:23], s37 offen offset:1024 lds
    v_mfma_f32_16x16x32_bf16 v[160:163], v[48:51], v[72:75], v[160:163]
    ds_read_b64_tr_b16 v[44:45], v9 offset:0
    ds_read_b64_tr_b16 v[46:47], v9 offset:1024
    buffer_load_dwordx4 v18, s[20:23], s37 offen offset:2048 lds
    v_mfma_f32_16x16x32_bf16 v[164:167], v[52:55], v[72:75], v[164:167]
    ds_read_b128 v[64:67], v4 offset:0
    buffer_load_dwordx4 v19, s[20:23], s37 offen offset:3072 lds
    v_mfma_f32_16x16x32_bf16 v[168:171], v[56:59], v[72:75], v[168:171]
    ds_read_b128 v[68:71], v4 offset:2048
    s_add_u32 m0, s52, 32768
    s_add_u32 s37, s46, 4194304
    buffer_load_dwordx4 v20, s[24:27], s37 offen lds
    v_mfma_f32_16x16x32_bf16 v[172:175], v[60:63], v[72:75], v[172:175]
    buffer_load_dwordx4 v21, s[24:27], s37 offen offset:1024 lds
    v_mfma_f32_16x16x32_bf16 v[176:179], v[48:51], v[76:79], v[176:179]
    s_add_u32 s3, s43, 24576
    buffer_store_dwordx4 v[116:119], v1, s[12:15], s3 offen offset:1024 sc1
    v_mfma_f32_16x16x32_bf16 v[180:183], v[52:55], v[76:79], v[180:183]
    v_mfma_f32_16x16x32_bf16 v[184:187], v[56:59], v[76:79], v[184:187]
    ds_read_b128 v[72:75], v4 offset:4096
    v_mfma_f32_16x16x32_bf16 v[188:191], v[60:63], v[76:79], v[188:191]
    s_waitcnt lgkmcnt(2)
    v_mfma_f32_16x16x32_bf16 v[128:131], v[32:35], v[64:67], v[128:131]
    v_mfma_f32_16x16x32_bf16 v[132:135], v[36:39], v[64:67], v[132:135]
    ds_read_b64_tr_b16 v[48:49], v6 offset:8192
    ds_read_b64_tr_b16 v[50:51], v6 offset:9216
    v_mfma_f32_16x16x32_bf16 v[136:139], v[40:43], v[64:67], v[136:139]
    ds_read_b128 v[76:79], v4 offset:6144
    ds_read_b64_tr_b16 v[52:53], v7 offset:8192
    v_mfma_f32_16x16x32_bf16 v[140:143], v[44:47], v[64:67], v[140:143]
    ds_read_b64_tr_b16 v[54:55], v7 offset:9216
    ds_read_b64_tr_b16 v[56:57], v8 offset:8192
    s_waitcnt lgkmcnt(7)
    v_mfma_f32_16x16x32_bf16 v[144:147], v[32:35], v[68:71], v[144:147]
    ds_read_b64_tr_b16 v[58:59], v8 offset:9216
    ds_read_b64_tr_b16 v[60:61], v9 offset:8192
    s_add_u32 s3, s43, 24576
    buffer_store_dwordx4 v[120:123], v10, s[12:15], s3 offen offset:0 sc1
    v_mfma_f32_16x16x32_bf16 v[148:151], v[36:39], v[68:71], v[148:151]
    ds_read_b64_tr_b16 v[62:63], v9 offset:9216
    v_mfma_f32_16x16x32_bf16 v[152:155], v[40:43], v[68:71], v[152:155]
    ds_read_b128 v[64:67], v5 offset:0
    v_mfma_f32_16x16x32_bf16 v[156:159], v[44:47], v[68:71], v[156:159]
    s_waitcnt lgkmcnt(10)
    v_mfma_f32_16x16x32_bf16 v[160:163], v[32:35], v[72:75], v[160:163]
    v_mfma_f32_16x16x32_bf16 v[164:167], v[36:39], v[72:75], v[164:167]
    v_mfma_f32_16x16x32_bf16 v[168:171], v[40:43], v[72:75], v[168:171]
    ds_read_b128 v[68:71], v5 offset:2048
    v_mfma_f32_16x16x32_bf16 v[172:175], v[44:47], v[72:75], v[172:175]
    s_waitcnt lgkmcnt(8)
    v_mfma_f32_16x16x32_bf16 v[176:179], v[32:35], v[76:79], v[176:179]
    s_add_u32 s3, s43, 24576
    buffer_store_dwordx4 v[124:127], v10, s[12:15], s3 offen offset:1024 sc1
    v_mfma_f32_16x16x32_bf16 v[180:183], v[36:39], v[76:79], v[180:183]
    v_mfma_f32_16x16x32_bf16 v[184:187], v[40:43], v[76:79], v[184:187]
    ds_read_b128 v[72:75], v5 offset:4096
    v_mfma_f32_16x16x32_bf16 v[188:191], v[44:47], v[76:79], v[188:191]
    s_waitcnt lgkmcnt(2)
    v_mfma_f32_16x16x32_bf16 v[128:131], v[48:51], v[64:67], v[128:131]
    v_mfma_f32_16x16x32_bf16 v[132:135], v[52:55], v[64:67], v[132:135]
    v_mfma_f32_16x16x32_bf16 v[136:139], v[56:59], v[64:67], v[136:139]
    ds_read_b128 v[76:79], v5 offset:6144
    v_mfma_f32_16x16x32_bf16 v[140:143], v[60:63], v[64:67], v[140:143]
    s_waitcnt lgkmcnt(2)
    v_mfma_f32_16x16x32_bf16 v[144:147], v[48:51], v[68:71], v[144:147]
    v_mfma_f32_16x16x32_bf16 v[148:151], v[52:55], v[68:71], v[148:151]
    s_waitcnt lgkmcnt(0)
    s_waitcnt vmcnt(13)
    s_barrier
    ds_read_b64_tr_b16 v[32:33], v6 offset:16384
    ds_read_b64_tr_b16 v[34:35], v6 offset:17408
    v_mfma_f32_16x16x32_bf16 v[152:155], v[56:59], v[68:71], v[152:155]
    ds_read_b64_tr_b16 v[36:37], v7 offset:16384
    ds_read_b64_tr_b16 v[38:39], v7 offset:17408
    s_add_u32 m0, s41, 131072
    s_add_u32 s37, s45, 1152
    buffer_load_dwordx4 v16, s[20:23], s37 offen lds
    v_mfma_f32_16x16x32_bf16 v[156:159], v[60:63], v[68:71], v[156:159]
    ds_read_b64_tr_b16 v[40:41], v8 offset:16384
    ds_read_b64_tr_b16 v[42:43], v8 offset:17408
    buffer_load_dwordx4 v17, s[20:23], s37 offen offset:1024 lds
    v_mfma_f32_16x16x32_bf16 v[160:163], v[48:51], v[72:75], v[160:163]
    ds_read_b64_tr_b16 v[44:45], v9 offset:16384
    ds_read_b64_tr_b16 v[46:47], v9 offset:17408
    buffer_load_dwordx4 v18, s[20:23], s37 offen offset:2048 lds
    v_mfma_f32_16x16x32_bf16 v[164:167], v[52:55], v[72:75], v[164:167]
    ds_read_b128 v[64:67], v2 offset:0
    buffer_load_dwordx4 v19, s[20:23], s37 offen offset:3072 lds
    v_mfma_f32_16x16x32_bf16 v[168:171], v[56:59], v[72:75], v[168:171]
    ds_read_b128 v[68:71], v2 offset:2048
    s_add_u32 m0, s52, 0
    s_add_u32 s37, s46, 4718592
    buffer_load_dwordx4 v20, s[24:27], s37 offen lds
    v_mfma_f32_16x16x32_bf16 v[172:175], v[60:63], v[72:75], v[172:175]
    buffer_load_dwordx4 v21, s[24:27], s37 offen offset:1024 lds
    v_mfma_f32_16x16x32_bf16 v[176:179], v[48:51], v[76:79], v[176:179]
    v_mfma_f32_16x16x32_bf16 v[180:183], v[52:55], v[76:79], v[180:183]
    v_mfma_f32_16x16x32_bf16 v[184:187], v[56:59], v[76:79], v[184:187]
    ds_read_b128 v[72:75], v2 offset:4096
    v_mfma_f32_16x16x32_bf16 v[188:191], v[60:63], v[76:79], v[188:191]
    s_waitcnt lgkmcnt(2)
    v_mfma_f32_16x16x32_bf16 v[128:131], v[32:35], v[64:67], v[128:131]
    v_mfma_f32_16x16x32_bf16 v[132:135], v[36:39], v[64:67], v[132:135]
    ds_read_b64_tr_b16 v[48:49], v6 offset:24576
    ds_read_b64_tr_b16 v[50:51], v6 offset:25600
    v_mfma_f32_16x16x32_bf16 v[136:139], v[40:43], v[64:67], v[136:139]
    ds_read_b128 v[76:79], v2 offset:6144
    ds_read_b64_tr_b16 v[52:53], v7 offset:24576
    v_mfma_f32_16x16x32_bf16 v[140:143], v[44:47], v[64:67], v[140:143]
    ds_read_b64_tr_b16 v[54:55], v7 offset:25600
    ds_read_b64_tr_b16 v[56:57], v8 offset:24576
    s_waitcnt lgkmcnt(7)
    v_mfma_f32_16x16x32_bf16 v[144:147], v[32:35], v[68:71], v[144:147]
    ds_read_b64_tr_b16 v[58:59], v8 offset:25600
    ds_read_b64_tr_b16 v[60:61], v9 offset:24576
    v_mfma_f32_16x16x32_bf16 v[148:151], v[36:39], v[68:71], v[148:151]
    ds_read_b64_tr_b16 v[62:63], v9 offset:25600
    v_mfma_f32_16x16x32_bf16 v[152:155], v[40:43], v[68:71], v[152:155]
    ds_read_b128 v[64:67], v3 offset:0
    v_mfma_f32_16x16x32_bf16 v[156:159], v[44:47], v[68:71], v[156:159]
    s_waitcnt lgkmcnt(10)
    v_mfma_f32_16x16x32_bf16 v[160:163], v[32:35], v[72:75], v[160:163]
    v_mfma_f32_16x16x32_bf16 v[164:167], v[36:39], v[72:75], v[164:167]
    v_mfma_f32_16x16x32_bf16 v[168:171], v[40:43], v[72:75], v[168:171]
    ds_read_b128 v[68:71], v3 offset:2048
    v_mfma_f32_16x16x32_bf16 v[172:175], v[44:47], v[72:75], v[172:175]
    s_waitcnt lgkmcnt(8)
    v_mfma_f32_16x16x32_bf16 v[176:179], v[32:35], v[76:79], v[176:179]
    v_mfma_f32_16x16x32_bf16 v[180:183], v[36:39], v[76:79], v[180:183]
    v_mfma_f32_16x16x32_bf16 v[184:187], v[40:43], v[76:79], v[184:187]
    ds_read_b128 v[72:75], v3 offset:4096
    v_mfma_f32_16x16x32_bf16 v[188:191], v[44:47], v[76:79], v[188:191]
    s_waitcnt lgkmcnt(2)
    v_mfma_f32_16x16x32_bf16 v[128:131], v[48:51], v[64:67], v[128:131]
    v_mfma_f32_16x16x32_bf16 v[132:135], v[52:55], v[64:67], v[132:135]
    v_mfma_f32_16x16x32_bf16 v[136:139], v[56:59], v[64:67], v[136:139]
    ds_read_b128 v[76:79], v3 offset:6144
    v_mfma_f32_16x16x32_bf16 v[140:143], v[60:63], v[64:67], v[140:143]
    s_waitcnt lgkmcnt(2)
    v_mfma_f32_16x16x32_bf16 v[144:147], v[48:51], v[68:71], v[144:147]
    v_mfma_f32_16x16x32_bf16 v[148:151], v[52:55], v[68:71], v[148:151]
    s_waitcnt lgkmcnt(0)
    s_waitcnt vmcnt(9)
    s_barrier
    ds_read_b64_tr_b16 v[32:33], v6 offset:32768
    ds_read_b64_tr_b16 v[34:35], v6 offset:33792
    v_mfma_f32_16x16x32_bf16 v[152:155], v[56:59], v[68:71], v[152:155]
    ds_read_b64_tr_b16 v[36:37], v7 offset:32768
    ds_read_b64_tr_b16 v[38:39], v7 offset:33792
    s_mov_b32 s20, s12
    s_mov_b32 s21, s13
    s_mov_b32 s22, s18
    v_mfma_f32_16x16x32_bf16 v[156:159], v[60:63], v[68:71], v[156:159]
    ds_read_b64_tr_b16 v[40:41], v8 offset:32768
    ds_read_b64_tr_b16 v[42:43], v8 offset:33792
    s_add_u32 m0, s51, 0
    s_nop 0
    buffer_load_dwordx4 v1, s[20:23], s57 offen sc1 lds
    v_mfma_f32_16x16x32_bf16 v[160:163], v[48:51], v[72:75], v[160:163]
    ds_read_b64_tr_b16 v[44:45], v9 offset:32768
    ds_read_b64_tr_b16 v[46:47], v9 offset:33792
    buffer_load_dwordx4 v1, s[20:23], s57 offen offset:1024 sc1 lds
    v_mfma_f32_16x16x32_bf16 v[164:167], v[52:55], v[72:75], v[164:167]
    ds_read_b128 v[64:67], v2 offset:32768
    s_add_u32 m0, s51, 16384
    s_nop 0
    buffer_load_dwordx4 v1, s[20:23], s58 offen sc1 lds
    v_mfma_f32_16x16x32_bf16 v[168:171], v[56:59], v[72:75], v[168:171]
    ds_read_b128 v[68:71], v2 offset:34816
    buffer_load_dwordx4 v1, s[20:23], s58 offen offset:1024 sc1 lds
    v_mfma_f32_16x16x32_bf16 v[172:175], v[60:63], v[72:75], v[172:175]
    v_mfma_f32_16x16x32_bf16 v[176:179], v[48:51], v[76:79], v[176:179]
    v_mfma_f32_16x16x32_bf16 v[180:183], v[52:55], v[76:79], v[180:183]
    v_mfma_f32_16x16x32_bf16 v[184:187], v[56:59], v[76:79], v[184:187]
    ds_read_b128 v[72:75], v2 offset:36864
    v_mfma_f32_16x16x32_bf16 v[188:191], v[60:63], v[76:79], v[188:191]
    s_waitcnt lgkmcnt(2)
    v_mfma_f32_16x16x32_bf16 v[128:131], v[32:35], v[64:67], v[128:131]
    v_mfma_f32_16x16x32_bf16 v[132:135], v[36:39], v[64:67], v[132:135]
    ds_read_b64_tr_b16 v[48:49], v6 offset:40960
    ds_read_b64_tr_b16 v[50:51], v6 offset:41984
    v_mfma_f32_16x16x32_bf16 v[136:139], v[40:43], v[64:67], v[136:139]
    ds_read_b128 v[76:79], v2 offset:38912
    ds_read_b64_tr_b16 v[52:53], v7 offset:40960
    v_mfma_f32_16x16x32_bf16 v[140:143], v[44:47], v[64:67], v[140:143]
    ds_read_b64_tr_b16 v[54:55], v7 offset:41984
    ds_read_b64_tr_b16 v[56:57], v8 offset:40960
    s_waitcnt lgkmcnt(7)
    v_mfma_f32_16x16x32_bf16 v[144:147], v[32:35], v[68:71], v[144:147]
    ds_read_b64_tr_b16 v[58:59], v8 offset:41984
    ds_read_b64_tr_b16 v[60:61], v9 offset:40960
    v_mfma_f32_16x16x32_bf16 v[148:151], v[36:39], v[68:71], v[148:151]
    ds_read_b64_tr_b16 v[62:63], v9 offset:41984
    v_mfma_f32_16x16x32_bf16 v[152:155], v[40:43], v[68:71], v[152:155]
    ds_read_b128 v[64:67], v3 offset:32768
    v_mfma_f32_16x16x32_bf16 v[156:159], v[44:47], v[68:71], v[156:159]
    s_waitcnt lgkmcnt(10)
    v_mfma_f32_16x16x32_bf16 v[160:163], v[32:35], v[72:75], v[160:163]
    v_mfma_f32_16x16x32_bf16 v[164:167], v[36:39], v[72:75], v[164:167]
    v_mfma_f32_16x16x32_bf16 v[168:171], v[40:43], v[72:75], v[168:171]
    ds_read_b128 v[68:71], v3 offset:34816
    v_mfma_f32_16x16x32_bf16 v[172:175], v[44:47], v[72:75], v[172:175]
    s_waitcnt lgkmcnt(8)
    v_mfma_f32_16x16x32_bf16 v[176:179], v[32:35], v[76:79], v[176:179]
    v_mfma_f32_16x16x32_bf16 v[180:183], v[36:39], v[76:79], v[180:183]
    v_mfma_f32_16x16x32_bf16 v[184:187], v[40:43], v[76:79], v[184:187]
    ds_read_b128 v[72:75], v3 offset:36864
    v_mfma_f32_16x16x32_bf16 v[188:191], v[44:47], v[76:79], v[188:191]
    s_waitcnt lgkmcnt(2)
    v_mfma_f32_16x16x32_bf16 v[128:131], v[48:51], v[64:67], v[128:131]
    v_mfma_f32_16x16x32_bf16 v[132:135], v[52:55], v[64:67], v[132:135]
    v_mfma_f32_16x16x32_bf16 v[136:139], v[56:59], v[64:67], v[136:139]
    ds_read_b128 v[76:79], v3 offset:38912
    v_mfma_f32_16x16x32_bf16 v[140:143], v[60:63], v[64:67], v[140:143]
    s_waitcnt lgkmcnt(2)
    v_mfma_f32_16x16x32_bf16 v[144:147], v[48:51], v[68:71], v[144:147]
    v_mfma_f32_16x16x32_bf16 v[148:151], v[52:55], v[68:71], v[148:151]
    s_waitcnt lgkmcnt(0)
    s_waitcnt vmcnt(4)
    s_barrier
    ds_read_b64_tr_b16 v[32:33], v6 offset:0
    ds_read_b64_tr_b16 v[34:35], v6 offset:1024
    v_mfma_f32_16x16x32_bf16 v[152:155], v[56:59], v[68:71], v[152:155]
    ds_read_b64_tr_b16 v[36:37], v7 offset:0
    ds_read_b64_tr_b16 v[38:39], v7 offset:1024
    s_cmp_lg_u32 s32, 4
    s_cbranch_scc1 ONLY_10
    s_mov_b64 exec, 1
    v_mov_b32 v24, 1
    s_lshl_b32 s3, s33, 10
    s_add_u32 s3, s3, s34
    s_lshl_b32 s3, s3, 2
    s_add_u32 s3, s3, 66715680
    buffer_store_dword v24, v25, s[12:15], s3 offen sc1
    s_mov_b64 exec, -1
ONLY_10:
    v_mfma_f32_16x16x32_bf16 v[156:159], v[60:63], v[68:71], v[156:159]
    ds_read_b64_tr_b16 v[40:41], v8 offset:0
    ds_read_b64_tr_b16 v[42:43], v8 offset:1024
    s_add_u32 m0, s51, 32768
    s_nop 0
    buffer_load_dwordx4 v1, s[20:23], s59 offen sc1 lds
    v_mfma_f32_16x16x32_bf16 v[160:163], v[48:51], v[72:75], v[160:163]
    ds_read_b64_tr_b16 v[44:45], v9 offset:0
    ds_read_b64_tr_b16 v[46:47], v9 offset:1024
    buffer_load_dwordx4 v1, s[20:23], s59 offen offset:1024 sc1 lds
    v_mfma_f32_16x16x32_bf16 v[164:167], v[52:55], v[72:75], v[164:167]
    ds_read_b128 v[64:67], v4 offset:0
    v_mfma_f32_16x16x32_bf16 v[168:171], v[56:59], v[72:75], v[168:171]
    ds_read_b128 v[68:71], v4 offset:2048
    v_mfma_f32_16x16x32_bf16 v[172:175], v[60:63], v[72:75], v[172:175]
    v_mfma_f32_16x16x32_bf16 v[176:179], v[48:51], v[76:79], v[176:179]
    v_mfma_f32_16x16x32_bf16 v[180:183], v[52:55], v[76:79], v[180:183]
    v_mfma_f32_16x16x32_bf16 v[184:187], v[56:59], v[76:79], v[184:187]
    ds_read_b128 v[72:75], v4 offset:4096
    v_mfma_f32_16x16x32_bf16 v[188:191], v[60:63], v[76:79], v[188:191]
    s_waitcnt lgkmcnt(2)
    v_mfma_f32_16x16x32_bf16 v[128:131], v[32:35], v[64:67], v[128:131]
    v_mfma_f32_16x16x32_bf16 v[132:135], v[36:39], v[64:67], v[132:135]
    ds_read_b64_tr_b16 v[48:49], v6 offset:8192
    ds_read_b64_tr_b16 v[50:51], v6 offset:9216
    v_mfma_f32_16x16x32_bf16 v[136:139], v[40:43], v[64:67], v[136:139]
    ds_read_b128 v[76:79], v4 offset:6144
    ds_read_b64_tr_b16 v[52:53], v7 offset:8192
    v_mfma_f32_16x16x32_bf16 v[140:143], v[44:47], v[64:67], v[140:143]
    ds_read_b64_tr_b16 v[54:55], v7 offset:9216
    ds_read_b64_tr_b16 v[56:57], v8 offset:8192
    s_waitcnt lgkmcnt(7)
    v_mfma_f32_16x16x32_bf16 v[144:147], v[32:35], v[68:71], v[144:147]
    ds_read_b64_tr_b16 v[58:59], v8 offset:9216
    ds_read_b64_tr_b16 v[60:61], v9 offset:8192
    v_mfma_f32_16x16x32_bf16 v[148:151], v[36:39], v[68:71], v[148:151]
    ds_read_b64_tr_b16 v[62:63], v9 offset:9216
    v_mfma_f32_16x16x32_bf16 v[152:155], v[40:43], v[68:71], v[152:155]
    ds_read_b128 v[64:67], v5 offset:0
    v_mfma_f32_16x16x32_bf16 v[156:159], v[44:47], v[68:71], v[156:159]
    s_waitcnt lgkmcnt(10)
    v_mfma_f32_16x16x32_bf16 v[160:163], v[32:35], v[72:75], v[160:163]
    v_mfma_f32_16x16x32_bf16 v[164:167], v[36:39], v[72:75], v[164:167]
    v_mfma_f32_16x16x32_bf16 v[168:171], v[40:43], v[72:75], v[168:171]
    ds_read_b128 v[68:71], v5 offset:2048
    v_mfma_f32_16x16x32_bf16 v[172:175], v[44:47], v[72:75], v[172:175]
    s_waitcnt lgkmcnt(8)
    v_mfma_f32_16x16x32_bf16 v[176:179], v[32:35], v[76:79], v[176:179]
    v_mfma_f32_16x16x32_bf16 v[180:183], v[36:39], v[76:79], v[180:183]
    v_mfma_f32_16x16x32_bf16 v[184:187], v[40:43], v[76:79], v[184:187]
    ds_read_b128 v[72:75], v5 offset:4096
    v_mfma_f32_16x16x32_bf16 v[188:191], v[44:47], v[76:79], v[188:191]
    s_waitcnt lgkmcnt(2)
    v_mfma_f32_16x16x32_bf16 v[128:131], v[48:51], v[64:67], v[128:131]
    v_mfma_f32_16x16x32_bf16 v[132:135], v[52:55], v[64:67], v[132:135]
    v_mfma_f32_16x16x32_bf16 v[136:139], v[56:59], v[64:67], v[136:139]
    ds_read_b128 v[76:79], v5 offset:6144
    v_mfma_f32_16x16x32_bf16 v[140:143], v[60:63], v[64:67], v[140:143]
    s_waitcnt lgkmcnt(2)
    v_mfma_f32_16x16x32_bf16 v[144:147], v[48:51], v[68:71], v[144:147]
    v_mfma_f32_16x16x32_bf16 v[148:151], v[52:55], v[68:71], v[148:151]
    s_waitcnt lgkmcnt(0)
    s_barrier
    v_mfma_f32_16x16x32_bf16 v[152:155], v[56:59], v[68:71], v[152:155]
    s_cmp_lg_u32 s32, 5
    s_cbranch_scc1 ONLY_11
    s_lshl_b32 s3, s33, 12
    s_add_u32 s3, s3, 66715648
    buffer_load_dword v24, v26, s[12:15], s3 offen sc1
ONLY_11:
    v_mfma_f32_16x16x32_bf16 v[156:159], v[60:63], v[68:71], v[156:159]
    v_mfma_f32_16x16x32_bf16 v[160:163], v[48:51], v[72:75], v[160:163]
    v_mfma_f32_16x16x32_bf16 v[164:167], v[52:55], v[72:75], v[164:167]
    v_mfma_f32_16x16x32_bf16 v[168:171], v[56:59], v[72:75], v[168:171]
    v_mfma_f32_16x16x32_bf16 v[172:175], v[60:63], v[72:75], v[172:175]
    v_mfma_f32_16x16x32_bf16 v[176:179], v[48:51], v[76:79], v[176:179]
    v_mfma_f32_16x16x32_bf16 v[180:183], v[52:55], v[76:79], v[180:183]
    v_mfma_f32_16x16x32_bf16 v[184:187], v[56:59], v[76:79], v[184:187]
    v_mfma_f32_16x16x32_bf16 v[188:191], v[60:63], v[76:79], v[188:191]
M_KVD:
    s_mov_b32 s37, 0x3e0293ee
    s_lshr_b32 s38, s32, 1
    s_lshl_b32 s38, s38, 14
    s_and_b32 s3, s32, 1
    s_lshl_b32 s3, s3, 11
    s_add_u32 s38, s38, s3
    s_add_u32 s38, s38, 98304
    v_add_u32 v6, s38, v1
    s_lshl_b32 s38, s35, 15
    s_lshl_b32 s3, s36, 12
    s_add_u32 s38, s38, s3
    s_add_u32 s38, s38, 98304
    v_add_u32 v5, s38, v1
    s_lshl_b32 s40, s35, 13
    v_mov_b32 v2, v1
    v_add_u32 v3, 65536, v2
    v_mul_f32 v128, s37, v128
    v_mul_f32 v129, s37, v129
    v_cvt_pk_bf16_f32 v204, v128, v129
    v_mul_f32 v130, s37, v130
    v_mul_f32 v131, s37, v131
    v_cvt_pk_bf16_f32 v205, v130, v131
    v_mul_f32 v132, s37, v132
    v_mul_f32 v133, s37, v133
    v_cvt_pk_bf16_f32 v206, v132, v133
    v_mul_f32 v134, s37, v134
    v_mul_f32 v135, s37, v135
    v_cvt_pk_bf16_f32 v207, v134, v135
    ds_write_b128 v6, v[204:207] offset:0
    v_mul_f32 v136, s37, v136
    v_mul_f32 v137, s37, v137
    v_cvt_pk_bf16_f32 v208, v136, v137
    v_mul_f32 v138, s37, v138
    v_mul_f32 v139, s37, v139
    v_cvt_pk_bf16_f32 v209, v138, v139
    v_mul_f32 v140, s37, v140
    v_mul_f32 v141, s37, v141
    v_cvt_pk_bf16_f32 v210, v140, v141
    v_mul_f32 v142, s37, v142
    v_mul_f32 v143, s37, v143
    v_cvt_pk_bf16_f32 v211, v142, v143
    ds_write_b128 v6, v[208:211] offset:1024
    v_mul_f32 v144, s37, v144
    v_mul_f32 v145, s37, v145
    v_cvt_pk_bf16_f32 v212, v144, v145
    v_mul_f32 v146, s37, v146
    v_mul_f32 v147, s37, v147
    v_cvt_pk_bf16_f32 v213, v146, v147
    v_mul_f32 v148, s37, v148
    v_mul_f32 v149, s37, v149
    v_cvt_pk_bf16_f32 v214, v148, v149
    v_mul_f32 v150, s37, v150
    v_mul_f32 v151, s37, v151
    v_cvt_pk_bf16_f32 v215, v150, v151
    ds_write_b128 v6, v[212:215] offset:4096
    v_mul_f32 v152, s37, v152
    v_mul_f32 v153, s37, v153
    v_cvt_pk_bf16_f32 v216, v152, v153
    v_mul_f32 v154, s37, v154
    v_mul_f32 v155, s37, v155
    v_cvt_pk_bf16_f32 v217, v154, v155
    v_mul_f32 v156, s37, v156
    v_mul_f32 v157, s37, v157
    v_cvt_pk_bf16_f32 v218, v156, v157
    v_mul_f32 v158, s37, v158
    v_mul_f32 v159, s37, v159
    v_cvt_pk_bf16_f32 v219, v158, v159
    ds_write_b128 v6, v[216:219] offset:5120
    v_mul_f32 v160, s37, v160
    v_mul_f32 v161, s37, v161
    v_cvt_pk_bf16_f32 v220, v160, v161
    v_mul_f32 v162, s37, v162
    v_mul_f32 v163, s37, v163
    v_cvt_pk_bf16_f32 v221, v162, v163
    v_mul_f32 v164, s37, v164
    v_mul_f32 v165, s37, v165
    v_cvt_pk_bf16_f32 v222, v164, v165
    v_mul_f32 v166, s37, v166
    v_mul_f32 v167, s37, v167
    v_cvt_pk_bf16_f32 v223, v166, v167
    ds_write_b128 v6, v[220:223] offset:8192
    v_mul_f32 v168, s37, v168
    v_mul_f32 v169, s37, v169
    v_cvt_pk_bf16_f32 v224, v168, v169
    v_mul_f32 v170, s37, v170
    v_mul_f32 v171, s37, v171
    v_cvt_pk_bf16_f32 v225, v170, v171
    v_mul_f32 v172, s37, v172
    v_mul_f32 v173, s37, v173
    v_cvt_pk_bf16_f32 v226, v172, v173
    v_mul_f32 v174, s37, v174
    v_mul_f32 v175, s37, v175
    v_cvt_pk_bf16_f32 v227, v174, v175
    ds_write_b128 v6, v[224:227] offset:9216
    v_mul_f32 v176, s37, v176
    v_mul_f32 v177, s37, v177
    v_cvt_pk_bf16_f32 v228, v176, v177
    v_mul_f32 v178, s37, v178
    v_mul_f32 v179, s37, v179
    v_cvt_pk_bf16_f32 v229, v178, v179
    v_mul_f32 v180, s37, v180
    v_mul_f32 v181, s37, v181
    v_cvt_pk_bf16_f32 v230, v180, v181
    v_mul_f32 v182, s37, v182
    v_mul_f32 v183, s37, v183
    v_cvt_pk_bf16_f32 v231, v182, v183
    ds_write_b128 v6, v[228:231] offset:12288
    v_mul_f32 v184, s37, v184
    v_mul_f32 v185, s37, v185
    v_cvt_pk_bf16_f32 v232, v184, v185
    v_mul_f32 v186, s37, v186
    v_mul_f32 v187, s37, v187
    v_cvt_pk_bf16_f32 v233, v186, v187
    v_mul_f32 v188, s37, v188
    v_mul_f32 v189, s37, v189
    v_cvt_pk_bf16_f32 v234, v188, v189
    v_mul_f32 v190, s37, v190
    v_mul_f32 v191, s37, v191
    v_cvt_pk_bf16_f32 v235, v190, v191
    ds_write_b128 v6, v[232:235] offset:13312
    v_and_b32 v7, 15, v0
    v_lshrrev_b32 v8, 4, v0
    s_lshl_b32 s37, s36, 4
    v_add_u32 v4, s37, v7
    v_lshlrev_b32 v8, 2, v8
    v_sub_u32 v4, v4, v8
    v_mov_b32 v8, 0xff800000
    v_mov_b32 v236, 0
    v_mov_b32 v237, 0
    v_mov_b32 v238, 0
    v_mov_b32 v239, 0
    v_mov_b32 v240, 0
    v_mov_b32 v241, 0
    v_mov_b32 v242, 0
    v_mov_b32 v243, 0
    v_mov_b32 v244, 0x3f803f80
    v_mov_b32 v245, 0x3f803f80
    v_mov_b32 v246, 0x3f803f80
    v_mov_b32 v247, 0x3f803f80
    s_cmp_lg_u32 s32, 5
    s_cbranch_scc1 POLL_12D
    s_lshl_b32 s3, s33, 12
    s_add_u32 s3, s3, 66715648
    s_mov_b32 s38, 0
    s_waitcnt vmcnt(0)
    s_branch POLL_12C
POLL_12:
    s_sleep 8
    buffer_load_dword v24, v26, s[12:15], s3 offen sc1
    s_waitcnt vmcnt(0)
POLL_12C:
    v_cmp_eq_u32 vcc, 0, v24
    s_add_u32 s38, s38, 1
    s_and_b32 s76, vcc_lo, 257
    s_cbranch_scc0 POLL_12D
    s_cmp_lt_u32 s38, 100000
    s_cbranch_scc1 POLL_12
POLL_12D:
    s_waitcnt vmcnt(2) lgkmcnt(0)
    s_barrier
    ds_read_b128 v[204:207], v5 offset:0
    ds_read_b128 v[208:211], v5 offset:1024
    ds_read_b128 v[212:215], v5 offset:2048
    ds_read_b128 v[216:219], v5 offset:3072
    ds_read_b128 v[220:223], v5 offset:16384
    ds_read_b128 v[224:227], v5 offset:17408
    ds_read_b128 v[228:231], v5 offset:18432
    ds_read_b128 v[232:235], v5 offset:19456
    ds_read_b128 v[28:31], v2 offset:0
    ds_read_b128 v[32:35], v2 offset:1024
    ds_read_b128 v[36:39], v2 offset:2048
    ds_read_b128 v[40:43], v2 offset:3072
    ds_read_b128 v[44:47], v2 offset:4096
    ds_read_b128 v[48:51], v2 offset:5120
    ds_read_b128 v[52:55], v2 offset:6144
    ds_read_b128 v[56:59], v2 offset:7168
    s_mov_b32 s48, 0
    s_waitcnt lgkmcnt(0)
AT_S0:
    v_mfma_f32_16x16x32_bf16 v[108:111], v[28:31], v[204:207], v[236:239]
    v_mfma_f32_16x16x32_bf16 v[116:119], v[28:31], v[220:223], v[240:243]
    ds_read_b128 v[28:31], v2 offset:16384
    s_add_u32 m0, s52, 0
    v_mfma_f32_16x16x32_bf16 v[108:111], v[32:35], v[208:211], v[108:111]
    v_mfma_f32_16x16x32_bf16 v[116:119], v[32:35], v[224:227], v[116:119]
    ds_read_b128 v[32:35], v2 offset:17408
    buffer_load_dwordx4 v1, s[16:19], s57 offen sc1 lds
    v_mfma_f32_16x16x32_bf16 v[108:111], v[36:39], v[212:215], v[108:111]
    v_mfma_f32_16x16x32_bf16 v[116:119], v[36:39], v[228:231], v[116:119]
    ds_read_b128 v[36:39], v2 offset:18432
    v_mfma_f32_16x16x32_bf16 v[108:111], v[40:43], v[216:219], v[108:111]
    v_mfma_f32_16x16x32_bf16 v[116:119], v[40:43], v[232:235], v[116:119]
    ds_read_b128 v[40:43], v2 offset:19456
    buffer_load_dwordx4 v1, s[16:19], s57 offen offset:1024 sc1 lds
    v_mfma_f32_16x16x32_bf16 v[112:115], v[44:47], v[204:207], v[236:239]
    v_mfma_f32_16x16x32_bf16 v[120:123], v[44:47], v[220:223], v[240:243]
    ds_read_b128 v[44:47], v2 offset:20480
    s_add_u32 m0, s51, 49152
    s_add_u32 s60, s59, s53
    v_mfma_f32_16x16x32_bf16 v[112:115], v[48:51], v[208:211], v[112:115]
    v_mfma_f32_16x16x32_bf16 v[120:123], v[48:51], v[224:227], v[120:123]
    ds_read_b128 v[48:51], v2 offset:21504
    buffer_load_dwordx4 v1, s[20:23], s60 offen sc1 lds
    v_mfma_f32_16x16x32_bf16 v[112:115], v[52:55], v[212:215], v[112:115]
    v_mfma_f32_16x16x32_bf16 v[120:123], v[52:55], v[228:231], v[120:123]
    ds_read_b128 v[52:55], v2 offset:22528
    v_mfma_f32_16x16x32_bf16 v[112:115], v[56:59], v[216:219], v[112:115]
    v_mfma_f32_16x16x32_bf16 v[120:123], v[56:59], v[232:235], v[120:123]
    ds_read_b128 v[56:59], v2 offset:23552
    buffer_load_dwordx4 v1, s[20:23], s60 offen offset:1024 sc1 lds
    s_add_u32 s48, s48, 1
    s_waitcnt vmcnt(4) lgkmcnt(0)
    s_barrier
AT_S1:
    s_bitcmp1_b64 s[62:63], s48
    s_cbranch_scc1 AT_S1_EV
AT_S1_GO:
    v_mfma_f32_16x16x32_bf16 v[124:127], v[28:31], v[204:207], v[236:239]
    v_exp_f32 v16, v108
    v_exp_f32 v17, v109
    v_mfma_f32_16x16x32_bf16 v[132:135], v[28:31], v[220:223], v[240:243]
    ds_read_b128 v[28:31], v2 offset:32768
    v_exp_f32 v18, v110
    s_add_u32 m0, s52, 16384
    v_mfma_f32_16x16x32_bf16 v[124:127], v[32:35], v[208:211], v[124:127]
    v_exp_f32 v19, v111
    v_cvt_pk_bf16_f32 v92, v16, v17
    v_exp_f32 v20, v112
    v_mfma_f32_16x16x32_bf16 v[132:135], v[32:35], v[224:227], v[132:135]
    ds_read_b128 v[32:35], v2 offset:33792
    buffer_load_dwordx4 v1, s[16:19], s58 offen sc1 lds
    v_exp_f32 v21, v113
    v_cvt_pk_bf16_f32 v93, v18, v19
    v_mfma_f32_16x16x32_bf16 v[124:127], v[36:39], v[212:215], v[124:127]
    v_exp_f32 v22, v114
    v_exp_f32 v23, v115
    v_mfma_f32_16x16x32_bf16 v[132:135], v[36:39], v[228:231], v[132:135]
    ds_read_b128 v[36:39], v2 offset:34816
    v_cvt_pk_bf16_f32 v94, v20, v21
    v_exp_f32 v16, v116
    v_mfma_f32_16x16x32_bf16 v[124:127], v[40:43], v[216:219], v[124:127]
    v_exp_f32 v17, v117
    v_cvt_pk_bf16_f32 v95, v22, v23
    v_mfma_f32_16x16x32_bf16 v[132:135], v[40:43], v[232:235], v[132:135]
    ds_read_b128 v[40:43], v2 offset:35840
    buffer_load_dwordx4 v1, s[16:19], s58 offen offset:1024 sc1 lds
    v_or3_b32 v9, v92, v93, v94
    v_exp_f32 v18, v118
    v_mfma_f32_16x16x32_bf16 v[128:131], v[44:47], v[204:207], v[236:239]
    v_exp_f32 v19, v119
    v_cvt_pk_bf16_f32 v96, v16, v17
    v_exp_f32 v20, v120
    v_mfma_f32_16x16x32_bf16 v[136:139], v[44:47], v[220:223], v[240:243]
    ds_read_b128 v[44:47], v2 offset:36864
    v_exp_f32 v21, v121
    v_cvt_pk_bf16_f32 v97, v18, v19
    s_add_u32 m0, s51, 0
    s_add_u32 s57, s60, s53
    v_mfma_f32_16x16x32_bf16 v[128:131], v[48:51], v[208:211], v[128:131]
    v_or3_b32 v9, v9, v95, v96
    v_exp_f32 v22, v122
    v_mfma_f32_16x16x32_bf16 v[136:139], v[48:51], v[224:227], v[136:139]
    ds_read_b128 v[48:51], v2 offset:37888
    buffer_load_dwordx4 v1, s[20:23], s57 offen sc1 lds
    v_exp_f32 v23, v123
    v_cvt_pk_bf16_f32 v98, v20, v21
    v_cvt_pk_bf16_f32 v99, v22, v23
    v_mfma_f32_16x16x32_bf16 v[128:131], v[52:55], v[212:215], v[128:131]
    v_or3_b32 v9, v9, v97, v98
    v_bitop3_b32 v9, v9, v99, s50 bitop3:0xa8
    v_cmp_ne_u32 vcc, 0, v9
    v_mfma_f32_16x16x32_bf16 v[136:139], v[52:55], v[228:231], v[136:139]
    ds_read_b128 v[52:55], v2 offset:38912
    v_mfma_f32_16x16x32_bf16 v[128:131], v[56:59], v[216:219], v[128:131]
    v_mfma_f32_16x16x32_bf16 v[136:139], v[56:59], v[232:235], v[136:139]
    ds_read_b128 v[56:59], v2 offset:39936
    buffer_load_dwordx4 v1, s[20:23], s57 offen offset:1024 sc1 lds
    s_cbranch_vccnz AT_S1_SLOW
AT_S1_RET:
    s_add_u32 s48, s48, 1
    s_waitcnt vmcnt(4) lgkmcnt(0)
    s_barrier
    s_cmp_lg_u32 s32, 2
    s_cbranch_scc1 ONLY_13
    s_lshl_b32 s3, s33, 12
    s_add_u32 s3, s3, 66715648
    buffer_load_dword v24, v26, s[12:15], s3 offen sc1
ONLY_13:
AT_S2:
    s_bitcmp1_b64 s[62:63], s48
    s_cbranch_scc1 AT_S2_EV
AT_S2_GO:
    v_mfma_f32_16x16x32_bf16 v[108:111], v[28:31], v[204:207], v[236:239]
    v_exp_f32 v16, v124
    v_mfma_f32_16x16x32_bf16 v[116:119], v[28:31], v[220:223], v[240:243]
    ds_read_b128 v[60:63], v3 offset:0
    ds_read_b128 v[64:67], v3 offset:1024
    v_mfma_f32_16x16x32_bf16 v[108:111], v[32:35], v[208:211], v[108:111]
    v_exp_f32 v17, v125
    v_mfma_f32_16x16x32_bf16 v[116:119], v[32:35], v[224:227], v[116:119]
    ds_read_b128 v[68:71], v3 offset:2048
    ds_read_b128 v[72:75], v3 offset:3072
    v_exp_f32 v18, v126
    v_mfma_f32_16x16x32_bf16 v[108:111], v[36:39], v[212:215], v[108:111]
    v_exp_f32 v19, v127
    v_mfma_f32_16x16x32_bf16 v[116:119], v[36:39], v[228:231], v[116:119]
    ds_read_b128 v[76:79], v3 offset:4096
    ds_read_b128 v[80:83], v3 offset:5120
    v_cvt_pk_bf16_f32 v100, v16, v17
    v_mfma_f32_16x16x32_bf16 v[108:111], v[40:43], v[216:219], v[108:111]
    v_exp_f32 v20, v128
    v_mfma_f32_16x16x32_bf16 v[116:119], v[40:43], v[232:235], v[116:119]
    ds_read_b128 v[84:87], v3 offset:6144
    ds_read_b128 v[88:91], v3 offset:7168
    s_add_u32 m0, s52, 32768
    v_mfma_f32_16x16x32_bf16 v[112:115], v[44:47], v[204:207], v[236:239]
    v_exp_f32 v21, v129
    v_mfma_f32_16x16x32_bf16 v[120:123], v[44:47], v[220:223], v[240:243]
    ds_read_b128 v[28:31], v2 offset:49152
    buffer_load_dwordx4 v1, s[16:19], s59 offen sc1 lds
    v_cvt_pk_bf16_f32 v101, v18, v19
    v_mfma_f32_16x16x32_bf16 v[112:115], v[48:51], v[208:211], v[112:115]
    v_exp_f32 v22, v130
    v_mfma_f32_16x16x32_bf16 v[120:123], v[48:51], v[224:227], v[120:123]
    ds_read_b128 v[32:35], v2 offset:50176
    v_exp_f32 v23, v131
    v_mfma_f32_16x16x32_bf16 v[112:115], v[52:55], v[212:215], v[112:115]
    v_cvt_pk_bf16_f32 v102, v20, v21
    v_mfma_f32_16x16x32_bf16 v[120:123], v[52:55], v[228:231], v[120:123]
    ds_read_b128 v[36:39], v2 offset:51200
    buffer_load_dwordx4 v1, s[16:19], s59 offen offset:1024 sc1 lds
    v_exp_f32 v16, v132
    v_mfma_f32_16x16x32_bf16 v[112:115], v[56:59], v[216:219], v[112:115]
    v_mfma_f32_16x16x32_bf16 v[120:123], v[56:59], v[232:235], v[120:123]
    ds_read_b128 v[40:43], v2 offset:52224
    v_exp_f32 v17, v133
    s_waitcnt lgkmcnt(4)
    v_mfma_f32_16x16x32_bf16 v[140:143], v[60:63], v[92:95], 0
    v_cvt_pk_bf16_f32 v103, v22, v23
    v_or3_b32 v9, v100, v101, v102
    v_mfma_f32_16x16x32_bf16 v[172:175], v[60:63], v[96:99], 0
    ds_read_b128 v[44:47], v2 offset:53248
    v_exp_f32 v18, v134
    s_add_u32 m0, s51, 16384
    s_add_u32 s58, s57, s53
    v_mfma_f32_16x16x32_bf16 v[144:147], v[64:67], v[92:95], 0
    v_mfma_f32_16x16x32_bf16 v[176:179], v[64:67], v[96:99], 0
    ds_read_b128 v[48:51], v2 offset:54272
    buffer_load_dwordx4 v1, s[20:23], s58 offen sc1 lds
    v_exp_f32 v19, v135
    v_mfma_f32_16x16x32_bf16 v[148:151], v[68:71], v[92:95], 0
    v_cvt_pk_bf16_f32 v104, v16, v17
    v_mfma_f32_16x16x32_bf16 v[180:183], v[68:71], v[96:99], 0
    ds_read_b128 v[52:55], v2 offset:55296
    v_exp_f32 v20, v136
    v_mfma_f32_16x16x32_bf16 v[152:155], v[72:75], v[92:95], 0
    v_exp_f32 v21, v137
    v_mfma_f32_16x16x32_bf16 v[184:187], v[72:75], v[96:99], 0
    v_cvt_pk_bf16_f32 v105, v18, v19
    v_mfma_f32_16x16x32_bf16 v[248:251], v[244:247], v[92:95], 0
    v_or3_b32 v9, v9, v103, v104
    v_mfma_f32_16x16x32_bf16 v[252:255], v[244:247], v[96:99], 0
    ds_read_b128 v[56:59], v2 offset:56320
    buffer_load_dwordx4 v1, s[20:23], s58 offen offset:1024 sc1 lds
    v_exp_f32 v22, v138
    v_mfma_f32_16x16x32_bf16 v[156:159], v[76:79], v[92:95], 0
    v_exp_f32 v23, v139
    v_mfma_f32_16x16x32_bf16 v[188:191], v[76:79], v[96:99], 0
    v_cvt_pk_bf16_f32 v106, v20, v21
    v_mfma_f32_16x16x32_bf16 v[160:163], v[80:83], v[92:95], 0
    v_cvt_pk_bf16_f32 v107, v22, v23
    v_mfma_f32_16x16x32_bf16 v[192:195], v[80:83], v[96:99], 0
    v_or3_b32 v9, v9, v105, v106
    v_bitop3_b32 v9, v9, v107, s50 bitop3:0xa8
    v_mfma_f32_16x16x32_bf16 v[164:167], v[84:87], v[92:95], 0
    v_cmp_ne_u32 vcc, 0, v9
    v_mfma_f32_16x16x32_bf16 v[196:199], v[84:87], v[96:99], 0
    v_mfma_f32_16x16x32_bf16 v[168:171], v[88:91], v[92:95], 0
    v_mfma_f32_16x16x32_bf16 v[200:203], v[88:91], v[96:99], 0
    s_cbranch_vccnz AT_S2_SLOW
AT_S2_RET:
    s_add_u32 s48, s48, 1
    s_cmp_lg_u32 s32, 2
    s_cbranch_scc1 POLL_14D
    s_lshl_b32 s3, s33, 12
    s_add_u32 s3, s3, 66715648
    s_mov_b32 s38, 0
    s_waitcnt vmcnt(4)
    s_branch POLL_14C
POLL_14:
    s_sleep 8
    buffer_load_dword v24, v26, s[12:15], s3 offen sc1
    s_waitcnt vmcnt(0)
POLL_14C:
    v_cmp_eq_u32 vcc, 0, v24
    s_add_u32 s38, s38, 1
    s_and_b32 s76, vcc_lo, 65535
    s_cbranch_scc0 POLL_14D
    s_cmp_lt_u32 s38, 100000
    s_cbranch_scc1 POLL_14
POLL_14D:
    s_waitcnt vmcnt(4) lgkmcnt(0)
    s_barrier
    s_branch AT_L3
    .p2align 6
AT_TOP:
    s_waitcnt vmcnt(4) lgkmcnt(0)
    s_barrier
AT_L2_GO:
    v_mfma_f32_16x16x32_bf16 v[108:111], v[28:31], v[204:207], v[236:239]
    v_exp_f32 v16, v124
    v_mfma_f32_16x16x32_bf16 v[116:119], v[28:31], v[220:223], v[240:243]
    ds_read_b128 v[60:63], v3 offset:0
    ds_read_b128 v[64:67], v3 offset:1024
    v_mfma_f32_16x16x32_bf16 v[108:111], v[32:35], v[208:211], v[108:111]
    v_exp_f32 v17, v125
    v_mfma_f32_16x16x32_bf16 v[116:119], v[32:35], v[224:227], v[116:119]
    ds_read_b128 v[68:71], v3 offset:2048
    ds_read_b128 v[72:75], v3 offset:3072
    v_exp_f32 v18, v126
    v_mfma_f32_16x16x32_bf16 v[108:111], v[36:39], v[212:215], v[108:111]
    v_exp_f32 v19, v127
    v_mfma_f32_16x16x32_bf16 v[116:119], v[36:39], v[228:231], v[116:119]
    ds_read_b128 v[76:79], v3 offset:4096
    ds_read_b128 v[80:83], v3 offset:5120
    v_cvt_pk_bf16_f32 v100, v16, v17
    v_mfma_f32_16x16x32_bf16 v[108:111], v[40:43], v[216:219], v[108:111]
    v_exp_f32 v20, v128
    v_mfma_f32_16x16x32_bf16 v[116:119], v[40:43], v[232:235], v[116:119]
    ds_read_b128 v[84:87], v3 offset:6144
    ds_read_b128 v[88:91], v3 offset:7168
    s_add_u32 m0, s52, 32768
    v_mfma_f32_16x16x32_bf16 v[112:115], v[44:47], v[204:207], v[236:239]
    v_exp_f32 v21, v129
    v_mfma_f32_16x16x32_bf16 v[120:123], v[44:47], v[220:223], v[240:243]
    ds_read_b128 v[28:31], v2 offset:49152
    buffer_load_dwordx4 v1, s[16:19], s59 offen sc1 lds
    v_cvt_pk_bf16_f32 v101, v18, v19
    v_mfma_f32_16x16x32_bf16 v[112:115], v[48:51], v[208:211], v[112:115]
    v_exp_f32 v22, v130
    v_mfma_f32_16x16x32_bf16 v[120:123], v[48:51], v[224:227], v[120:123]
    ds_read_b128 v[32:35], v2 offset:50176
    v_exp_f32 v23, v131
    v_mfma_f32_16x16x32_bf16 v[112:115], v[52:55], v[212:215], v[112:115]
    v_cvt_pk_bf16_f32 v102, v20, v21
    v_mfma_f32_16x16x32_bf16 v[120:123], v[52:55], v[228:231], v[120:123]
    ds_read_b128 v[36:39], v2 offset:51200
    buffer_load_dwordx4 v1, s[16:19], s59 offen offset:1024 sc1 lds
    v_exp_f32 v16, v132
    v_mfma_f32_16x16x32_bf16 v[112:115], v[56:59], v[216:219], v[112:115]
    v_mfma_f32_16x16x32_bf16 v[120:123], v[56:59], v[232:235], v[120:123]
    ds_read_b128 v[40:43], v2 offset:52224
    v_exp_f32 v17, v133
    s_waitcnt lgkmcnt(4)
    v_mfma_f32_16x16x32_bf16 v[140:143], v[60:63], v[92:95], v[140:143]
    v_cvt_pk_bf16_f32 v103, v22, v23
    v_or3_b32 v9, v100, v101, v102
    v_mfma_f32_16x16x32_bf16 v[172:175], v[60:63], v[96:99], v[172:175]
    ds_read_b128 v[44:47], v2 offset:53248
    v_exp_f32 v18, v134
    s_add_u32 m0, s51, 16384
    s_add_u32 s58, s57, s53
    v_mfma_f32_16x16x32_bf16 v[144:147], v[64:67], v[92:95], v[144:147]
    v_mfma_f32_16x16x32_bf16 v[176:179], v[64:67], v[96:99], v[176:179]
    ds_read_b128 v[48:51], v2 offset:54272
    buffer_load_dwordx4 v1, s[20:23], s58 offen sc1 lds
    v_exp_f32 v19, v135
    v_mfma_f32_16x16x32_bf16 v[148:151], v[68:71], v[92:95], v[148:151]
    v_cvt_pk_bf16_f32 v104, v16, v17
    v_mfma_f32_16x16x32_bf16 v[180:183], v[68:71], v[96:99], v[180:183]
    ds_read_b128 v[52:55], v2 offset:55296
    v_exp_f32 v20, v136
    v_mfma_f32_16x16x32_bf16 v[152:155], v[72:75], v[92:95], v[152:155]
    v_exp_f32 v21, v137
    v_mfma_f32_16x16x32_bf16 v[184:187], v[72:75], v[96:99], v[184:187]
    v_cvt_pk_bf16_f32 v105, v18, v19
    v_mfma_f32_16x16x32_bf16 v[248:251], v[244:247], v[92:95], v[248:251]
    v_or3_b32 v9, v9, v103, v104
    v_mfma_f32_16x16x32_bf16 v[252:255], v[244:247], v[96:99], v[252:255]
    ds_read_b128 v[56:59], v2 offset:56320
    buffer_load_dwordx4 v1, s[20:23], s58 offen offset:1024 sc1 lds
    v_exp_f32 v22, v138
    v_mfma_f32_16x16x32_bf16 v[156:159], v[76:79], v[92:95], v[156:159]
    v_exp_f32 v23, v139
    v_mfma_f32_16x16x32_bf16 v[188:191], v[76:79], v[96:99], v[188:191]
    s_add_u32 s48, s48, 1
    s_bitcmp1_b64 s[62:63], s48
    s_cselect_b32 s44, 1, 0
    v_cvt_pk_bf16_f32 v106, v20, v21
    v_mfma_f32_16x16x32_bf16 v[160:163], v[80:83], v[92:95], v[160:163]
    v_cvt_pk_bf16_f32 v107, v22, v23
    v_mfma_f32_16x16x32_bf16 v[192:195], v[80:83], v[96:99], v[192:195]
    v_or3_b32 v9, v9, v105, v106
    v_bitop3_b32 v9, v9, v107, s50 bitop3:0xa8
    v_mfma_f32_16x16x32_bf16 v[164:167], v[84:87], v[92:95], v[164:167]
    v_cmp_ne_u32 vcc, s44, v9
    v_mfma_f32_16x16x32_bf16 v[196:199], v[84:87], v[96:99], v[196:199]
    v_mfma_f32_16x16x32_bf16 v[168:171], v[88:91], v[92:95], v[168:171]
    v_mfma_f32_16x16x32_bf16 v[200:203], v[88:91], v[96:99], v[200:203]
    s_cbranch_vccnz AT_L2_SP
    s_waitcnt vmcnt(4) lgkmcnt(0)
    s_barrier
AT_L3_GO:
    v_mfma_f32_16x16x32_bf16 v[124:127], v[28:31], v[204:207], v[236:239]
    v_exp_f32 v16, v108
    v_mfma_f32_16x16x32_bf16 v[132:135], v[28:31], v[220:223], v[240:243]
    ds_read_b128 v[60:63], v3 offset:16384
    ds_read_b128 v[64:67], v3 offset:17408
    v_mfma_f32_16x16x32_bf16 v[124:127], v[32:35], v[208:211], v[124:127]
    v_exp_f32 v17, v109
    v_mfma_f32_16x16x32_bf16 v[132:135], v[32:35], v[224:227], v[132:135]
    ds_read_b128 v[68:71], v3 offset:18432
    ds_read_b128 v[72:75], v3 offset:19456
    v_exp_f32 v18, v110
    v_mfma_f32_16x16x32_bf16 v[124:127], v[36:39], v[212:215], v[124:127]
    v_exp_f32 v19, v111
    v_mfma_f32_16x16x32_bf16 v[132:135], v[36:39], v[228:231], v[132:135]
    ds_read_b128 v[76:79], v3 offset:20480
    ds_read_b128 v[80:83], v3 offset:21504
    v_cvt_pk_bf16_f32 v92, v16, v17
    v_mfma_f32_16x16x32_bf16 v[124:127], v[40:43], v[216:219], v[124:127]
    v_exp_f32 v20, v112
    v_mfma_f32_16x16x32_bf16 v[132:135], v[40:43], v[232:235], v[132:135]
    ds_read_b128 v[84:87], v3 offset:22528
    ds_read_b128 v[88:91], v3 offset:23552
    s_add_u32 m0, s52, 49152
    v_mfma_f32_16x16x32_bf16 v[128:131], v[44:47], v[204:207], v[236:239]
    v_exp_f32 v21, v113
    v_mfma_f32_16x16x32_bf16 v[136:139], v[44:47], v[220:223], v[240:243]
    ds_read_b128 v[28:31], v2 offset:0
    buffer_load_dwordx4 v1, s[16:19], s60 offen sc1 lds
    v_cvt_pk_bf16_f32 v93, v18, v19
    v_mfma_f32_16x16x32_bf16 v[128:131], v[48:51], v[208:211], v[128:131]
    v_exp_f32 v22, v114
    v_mfma_f32_16x16x32_bf16 v[136:139], v[48:51], v[224:227], v[136:139]
    ds_read_b128 v[32:35], v2 offset:1024
    v_exp_f32 v23, v115
    v_mfma_f32_16x16x32_bf16 v[128:131], v[52:55], v[212:215], v[128:131]
    v_cvt_pk_bf16_f32 v94, v20, v21
    v_mfma_f32_16x16x32_bf16 v[136:139], v[52:55], v[228:231], v[136:139]
    ds_read_b128 v[36:39], v2 offset:2048
    buffer_load_dwordx4 v1, s[16:19], s60 offen offset:1024 sc1 lds
    v_exp_f32 v16, v116
    v_mfma_f32_16x16x32_bf16 v[128:131], v[56:59], v[216:219], v[128:131]
    v_mfma_f32_16x16x32_bf16 v[136:139], v[56:59], v[232:235], v[136:139]
    ds_read_b128 v[40:43], v2 offset:3072
    v_exp_f32 v17, v117
    s_waitcnt lgkmcnt(4)
    v_mfma_f32_16x16x32_bf16 v[140:143], v[60:63], v[100:103], v[140:143]
    v_cvt_pk_bf16_f32 v95, v22, v23
    v_or3_b32 v9, v92, v93, v94
    v_mfma_f32_16x16x32_bf16 v[172:175], v[60:63], v[104:107], v[172:175]
    ds_read_b128 v[44:47], v2 offset:4096
    v_exp_f32 v18, v118
    s_add_u32 m0, s51, 32768
    s_add_u32 s59, s58, s53
    v_mfma_f32_16x16x32_bf16 v[144:147], v[64:67], v[100:103], v[144:147]
    v_mfma_f32_16x16x32_bf16 v[176:179], v[64:67], v[104:107], v[176:179]
    ds_read_b128 v[48:51], v2 offset:5120
    buffer_load_dwordx4 v1, s[20:23], s59 offen sc1 lds
    v_exp_f32 v19, v119
    v_mfma_f32_16x16x32_bf16 v[148:151], v[68:71], v[100:103], v[148:151]
    v_cvt_pk_bf16_f32 v96, v16, v17
    v_mfma_f32_16x16x32_bf16 v[180:183], v[68:71], v[104:107], v[180:183]
    ds_read_b128 v[52:55], v2 offset:6144
    v_exp_f32 v20, v120
    v_mfma_f32_16x16x32_bf16 v[152:155], v[72:75], v[100:103], v[152:155]
    v_exp_f32 v21, v121
    v_mfma_f32_16x16x32_bf16 v[184:187], v[72:75], v[104:107], v[184:187]
    v_cvt_pk_bf16_f32 v97, v18, v19
    v_mfma_f32_16x16x32_bf16 v[248:251], v[244:247], v[100:103], v[248:251]
    v_or3_b32 v9, v9, v95, v96
    v_mfma_f32_16x16x32_bf16 v[252:255], v[244:247], v[104:107], v[252:255]
    ds_read_b128 v[56:59], v2 offset:7168
    buffer_load_dwordx4 v1, s[20:23], s59 offen offset:1024 sc1 lds
    v_exp_f32 v22, v122
    v_mfma_f32_16x16x32_bf16 v[156:159], v[76:79], v[100:103], v[156:159]
    v_exp_f32 v23, v123
    v_mfma_f32_16x16x32_bf16 v[188:191], v[76:79], v[104:107], v[188:191]
    s_add_u32 s48, s48, 1
    s_bitcmp1_b64 s[62:63], s48
    s_cselect_b32 s44, 1, 0
    v_cvt_pk_bf16_f32 v98, v20, v21
    v_mfma_f32_16x16x32_bf16 v[160:163], v[80:83], v[100:103], v[160:163]
    v_cvt_pk_bf16_f32 v99, v22, v23
    v_mfma_f32_16x16x32_bf16 v[192:195], v[80:83], v[104:107], v[192:195]
    v_or3_b32 v9, v9, v97, v98
    v_bitop3_b32 v9, v9, v99, s50 bitop3:0xa8
    v_mfma_f32_16x16x32_bf16 v[164:167], v[84:87], v[100:103], v[164:167]
    v_cmp_ne_u32 vcc, s44, v9
    v_mfma_f32_16x16x32_bf16 v[196:199], v[84:87], v[104:107], v[196:199]
    v_mfma_f32_16x16x32_bf16 v[168:171], v[88:91], v[100:103], v[168:171]
    v_mfma_f32_16x16x32_bf16 v[200:203], v[88:91], v[104:107], v[200:203]
    s_cbranch_vccnz AT_L3_SP
    s_waitcnt vmcnt(4) lgkmcnt(0)
    s_barrier
AT_L0_GO:
    v_mfma_f32_16x16x32_bf16 v[108:111], v[28:31], v[204:207], v[236:239]
    v_exp_f32 v16, v124
    v_mfma_f32_16x16x32_bf16 v[116:119], v[28:31], v[220:223], v[240:243]
    ds_read_b128 v[60:63], v3 offset:32768
    ds_read_b128 v[64:67], v3 offset:33792
    v_mfma_f32_16x16x32_bf16 v[108:111], v[32:35], v[208:211], v[108:111]
    v_exp_f32 v17, v125
    v_mfma_f32_16x16x32_bf16 v[116:119], v[32:35], v[224:227], v[116:119]
    ds_read_b128 v[68:71], v3 offset:34816
    ds_read_b128 v[72:75], v3 offset:35840
    v_exp_f32 v18, v126
    v_mfma_f32_16x16x32_bf16 v[108:111], v[36:39], v[212:215], v[108:111]
    v_exp_f32 v19, v127
    v_mfma_f32_16x16x32_bf16 v[116:119], v[36:39], v[228:231], v[116:119]
    ds_read_b128 v[76:79], v3 offset:36864
    ds_read_b128 v[80:83], v3 offset:37888
    v_cvt_pk_bf16_f32 v100, v16, v17
    v_mfma_f32_16x16x32_bf16 v[108:111], v[40:43], v[216:219], v[108:111]
    v_exp_f32 v20, v128
    v_mfma_f32_16x16x32_bf16 v[116:119], v[40:43], v[232:235], v[116:119]
    ds_read_b128 v[84:87], v3 offset:38912
    ds_read_b128 v[88:91], v3 offset:39936
    s_add_u32 m0, s52, 0
    v_mfma_f32_16x16x32_bf16 v[112:115], v[44:47], v[204:207], v[236:239]
    v_exp_f32 v21, v129
    v_mfma_f32_16x16x32_bf16 v[120:123], v[44:47], v[220:223], v[240:243]
    ds_read_b128 v[28:31], v2 offset:16384
    buffer_load_dwordx4 v1, s[16:19], s57 offen sc1 lds
    v_cvt_pk_bf16_f32 v101, v18, v19
    v_mfma_f32_16x16x32_bf16 v[112:115], v[48:51], v[208:211], v[112:115]
    v_exp_f32 v22, v130
    v_mfma_f32_16x16x32_bf16 v[120:123], v[48:51], v[224:227], v[120:123]
    ds_read_b128 v[32:35], v2 offset:17408
    v_exp_f32 v23, v131
    v_mfma_f32_16x16x32_bf16 v[112:115], v[52:55], v[212:215], v[112:115]
    v_cvt_pk_bf16_f32 v102, v20, v21
    v_mfma_f32_16x16x32_bf16 v[120:123], v[52:55], v[228:231], v[120:123]
    ds_read_b128 v[36:39], v2 offset:18432
    buffer_load_dwordx4 v1, s[16:19], s57 offen offset:1024 sc1 lds
    v_exp_f32 v16, v132
    v_mfma_f32_16x16x32_bf16 v[112:115], v[56:59], v[216:219], v[112:115]
    v_mfma_f32_16x16x32_bf16 v[120:123], v[56:59], v[232:235], v[120:123]
    ds_read_b128 v[40:43], v2 offset:19456
    v_exp_f32 v17, v133
    s_waitcnt lgkmcnt(4)
    v_mfma_f32_16x16x32_bf16 v[140:143], v[60:63], v[92:95], v[140:143]
    v_cvt_pk_bf16_f32 v103, v22, v23
    v_or3_b32 v9, v100, v101, v102
    v_mfma_f32_16x16x32_bf16 v[172:175], v[60:63], v[96:99], v[172:175]
    ds_read_b128 v[44:47], v2 offset:20480
    v_exp_f32 v18, v134
    s_add_u32 m0, s51, 49152
    s_add_u32 s60, s59, s53
    v_mfma_f32_16x16x32_bf16 v[144:147], v[64:67], v[92:95], v[144:147]
    v_mfma_f32_16x16x32_bf16 v[176:179], v[64:67], v[96:99], v[176:179]
    ds_read_b128 v[48:51], v2 offset:21504
    buffer_load_dwordx4 v1, s[20:23], s60 offen sc1 lds
    v_exp_f32 v19, v135
    v_mfma_f32_16x16x32_bf16 v[148:151], v[68:71], v[92:95], v[148:151]
    v_cvt_pk_bf16_f32 v104, v16, v17
    v_mfma_f32_16x16x32_bf16 v[180:183], v[68:71], v[96:99], v[180:183]
    ds_read_b128 v[52:55], v2 offset:22528
    v_exp_f32 v20, v136
    v_mfma_f32_16x16x32_bf16 v[152:155], v[72:75], v[92:95], v[152:155]
    v_exp_f32 v21, v137
    v_mfma_f32_16x16x32_bf16 v[184:187], v[72:75], v[96:99], v[184:187]
    v_cvt_pk_bf16_f32 v105, v18, v19
    v_mfma_f32_16x16x32_bf16 v[248:251], v[244:247], v[92:95], v[248:251]
    v_or3_b32 v9, v9, v103, v104
    v_mfma_f32_16x16x32_bf16 v[252:255], v[244:247], v[96:99], v[252:255]
    ds_read_b128 v[56:59], v2 offset:23552
    buffer_load_dwordx4 v1, s[20:23], s60 offen offset:1024 sc1 lds
    v_exp_f32 v22, v138
    v_mfma_f32_16x16x32_bf16 v[156:159], v[76:79], v[92:95], v[156:159]
    v_exp_f32 v23, v139
    v_mfma_f32_16x16x32_bf16 v[188:191], v[76:79], v[96:99], v[188:191]
    s_add_u32 s48, s48, 1
    s_bitcmp1_b64 s[62:63], s48
    s_cselect_b32 s44, 1, 0
    v_cvt_pk_bf16_f32 v106, v20, v21
    v_mfma_f32_16x16x32_bf16 v[160:163], v[80:83], v[92:95], v[160:163]
    v_cvt_pk_bf16_f32 v107, v22, v23
    v_mfma_f32_16x16x32_bf16 v[192:195], v[80:83], v[96:99], v[192:195]
    v_or3_b32 v9, v9, v105, v106
    v_bitop3_b32 v9, v9, v107, s50 bitop3:0xa8
    v_mfma_f32_16x16x32_bf16 v[164:167], v[84:87], v[92:95], v[164:167]
    v_cmp_ne_u32 vcc, s44, v9
    v_mfma_f32_16x16x32_bf16 v[196:199], v[84:87], v[96:99], v[196:199]
    v_mfma_f32_16x16x32_bf16 v[168:171], v[88:91], v[92:95], v[168:171]
    v_mfma_f32_16x16x32_bf16 v[200:203], v[88:91], v[96:99], v[200:203]
    s_cbranch_vccnz AT_L0_SP
    s_waitcnt vmcnt(4) lgkmcnt(0)
    s_barrier
AT_L1_GO:
    v_mfma_f32_16x16x32_bf16 v[124:127], v[28:31], v[204:207], v[236:239]
    v_exp_f32 v16, v108
    v_mfma_f32_16x16x32_bf16 v[132:135], v[28:31], v[220:223], v[240:243]
    ds_read_b128 v[60:63], v3 offset:49152
    ds_read_b128 v[64:67], v3 offset:50176
    v_mfma_f32_16x16x32_bf16 v[124:127], v[32:35], v[208:211], v[124:127]
    v_exp_f32 v17, v109
    v_mfma_f32_16x16x32_bf16 v[132:135], v[32:35], v[224:227], v[132:135]
    ds_read_b128 v[68:71], v3 offset:51200
    ds_read_b128 v[72:75], v3 offset:52224
    v_exp_f32 v18, v110
    v_mfma_f32_16x16x32_bf16 v[124:127], v[36:39], v[212:215], v[124:127]
    v_exp_f32 v19, v111
    v_mfma_f32_16x16x32_bf16 v[132:135], v[36:39], v[228:231], v[132:135]
    ds_read_b128 v[76:79], v3 offset:53248
    ds_read_b128 v[80:83], v3 offset:54272
    v_cvt_pk_bf16_f32 v92, v16, v17
    v_mfma_f32_16x16x32_bf16 v[124:127], v[40:43], v[216:219], v[124:127]
    v_exp_f32 v20, v112
    v_mfma_f32_16x16x32_bf16 v[132:135], v[40:43], v[232:235], v[132:135]
    ds_read_b128 v[84:87], v3 offset:55296
    ds_read_b128 v[88:91], v3 offset:56320
    s_add_u32 m0, s52, 16384
    v_mfma_f32_16x16x32_bf16 v[128:131], v[44:47], v[204:207], v[236:239]
    v_exp_f32 v21, v113
    v_mfma_f32_16x16x32_bf16 v[136:139], v[44:47], v[220:223], v[240:243]
    ds_read_b128 v[28:31], v2 offset:32768
    buffer_load_dwordx4 v1, s[16:19], s58 offen sc1 lds
    v_cvt_pk_bf16_f32 v93, v18, v19
    v_mfma_f32_16x16x32_bf16 v[128:131], v[48:51], v[208:211], v[128:131]
    v_exp_f32 v22, v114
    v_mfma_f32_16x16x32_bf16 v[136:139], v[48:51], v[224:227], v[136:139]
    ds_read_b128 v[32:35], v2 offset:33792
    v_exp_f32 v23, v115
    v_mfma_f32_16x16x32_bf16 v[128:131], v[52:55], v[212:215], v[128:131]
    v_cvt_pk_bf16_f32 v94, v20, v21
    v_mfma_f32_16x16x32_bf16 v[136:139], v[52:55], v[228:231], v[136:139]
    ds_read_b128 v[36:39], v2 offset:34816
    buffer_load_dwordx4 v1, s[16:19], s58 offen offset:1024 sc1 lds
    v_exp_f32 v16, v116
    v_mfma_f32_16x16x32_bf16 v[128:131], v[56:59], v[216:219], v[128:131]
    v_mfma_f32_16x16x32_bf16 v[136:139], v[56:59], v[232:235], v[136:139]
    ds_read_b128 v[40:43], v2 offset:35840
    v_exp_f32 v17, v117
    s_waitcnt lgkmcnt(4)
    v_mfma_f32_16x16x32_bf16 v[140:143], v[60:63], v[100:103], v[140:143]
    v_cvt_pk_bf16_f32 v95, v22, v23
    v_or3_b32 v9, v92, v93, v94
    v_mfma_f32_16x16x32_bf16 v[172:175], v[60:63], v[104:107], v[172:175]
    ds_read_b128 v[44:47], v2 offset:36864
    v_exp_f32 v18, v118
    s_add_u32 m0, s51, 0
    s_add_u32 s57, s60, s53
    v_mfma_f32_16x16x32_bf16 v[144:147], v[64:67], v[100:103], v[144:147]
    v_mfma_f32_16x16x32_bf16 v[176:179], v[64:67], v[104:107], v[176:179]
    ds_read_b128 v[48:51], v2 offset:37888
    buffer_load_dwordx4 v1, s[20:23], s57 offen sc1 lds
    v_exp_f32 v19, v119
    v_mfma_f32_16x16x32_bf16 v[148:151], v[68:71], v[100:103], v[148:151]
    v_cvt_pk_bf16_f32 v96, v16, v17
    v_mfma_f32_16x16x32_bf16 v[180:183], v[68:71], v[104:107], v[180:183]
    ds_read_b128 v[52:55], v2 offset:38912
    v_exp_f32 v20, v120
    v_mfma_f32_16x16x32_bf16 v[152:155], v[72:75], v[100:103], v[152:155]
    v_exp_f32 v21, v121
    v_mfma_f32_16x16x32_bf16 v[184:187], v[72:75], v[104:107], v[184:187]
    v_cvt_pk_bf16_f32 v97, v18, v19
    v_mfma_f32_16x16x32_bf16 v[248:251], v[244:247], v[100:103], v[248:251]
    v_or3_b32 v9, v9, v95, v96
    v_mfma_f32_16x16x32_bf16 v[252:255], v[244:247], v[104:107], v[252:255]
    ds_read_b128 v[56:59], v2 offset:39936
    buffer_load_dwordx4 v1, s[20:23], s57 offen offset:1024 sc1 lds
    v_exp_f32 v22, v122
    v_mfma_f32_16x16x32_bf16 v[156:159], v[76:79], v[100:103], v[156:159]
    v_exp_f32 v23, v123
    v_mfma_f32_16x16x32_bf16 v[188:191], v[76:79], v[104:107], v[188:191]
    s_add_u32 s48, s48, 1
    s_bitcmp1_b64 s[62:63], s48
    s_cselect_b32 s44, 1, 0
    v_cvt_pk_bf16_f32 v98, v20, v21
    v_mfma_f32_16x16x32_bf16 v[160:163], v[80:83], v[100:103], v[160:163]
    v_cvt_pk_bf16_f32 v99, v22, v23
    v_mfma_f32_16x16x32_bf16 v[192:195], v[80:83], v[104:107], v[192:195]
    v_or3_b32 v9, v9, v97, v98
    v_bitop3_b32 v9, v9, v99, s50 bitop3:0xa8
    v_mfma_f32_16x16x32_bf16 v[164:167], v[84:87], v[100:103], v[164:167]
    v_cmp_ne_u32 vcc, s44, v9
    v_mfma_f32_16x16x32_bf16 v[196:199], v[84:87], v[104:107], v[196:199]
    v_mfma_f32_16x16x32_bf16 v[168:171], v[88:91], v[100:103], v[168:171]
    v_mfma_f32_16x16x32_bf16 v[200:203], v[88:91], v[104:107], v[200:203]
    s_cbranch_vccz AT_TOP
    s_branch AT_L1_SP
AT_P33:
    s_cmp_lg_u32 s32, 6
    s_cbranch_scc1 ONLY_15
    s_mov_b32 s3, 66846720
    buffer_load_dword v24, v26, s[12:15], s3 offen sc1
ONLY_15:
AT_S33:
    s_bitcmp1_b64 s[62:63], s48
    s_cbranch_scc1 AT_S33_EV
AT_S33_GO:
    v_mfma_f32_16x16x32_bf16 v[132:135], v[28:31], v[220:223], v[240:243]
    ds_read_b128 v[60:63], v3 offset:49152
    ds_read_b128 v[64:67], v3 offset:50176
    v_exp_f32 v16, v108
    v_mfma_f32_16x16x32_bf16 v[132:135], v[32:35], v[224:227], v[132:135]
    ds_read_b128 v[68:71], v3 offset:51200
    ds_read_b128 v[72:75], v3 offset:52224
    v_exp_f32 v17, v109
    v_mfma_f32_16x16x32_bf16 v[132:135], v[36:39], v[228:231], v[132:135]
    ds_read_b128 v[76:79], v3 offset:53248
    ds_read_b128 v[80:83], v3 offset:54272
    v_exp_f32 v18, v110
    v_mfma_f32_16x16x32_bf16 v[132:135], v[40:43], v[232:235], v[132:135]
    ds_read_b128 v[84:87], v3 offset:55296
    ds_read_b128 v[88:91], v3 offset:56320
    v_exp_f32 v19, v111
    s_add_u32 m0, s52, 16384
    v_mfma_f32_16x16x32_bf16 v[136:139], v[44:47], v[220:223], v[240:243]
    buffer_load_dwordx4 v1, s[16:19], s58 offen sc1 lds
    v_cvt_pk_bf16_f32 v92, v16, v17
    v_mfma_f32_16x16x32_bf16 v[136:139], v[48:51], v[224:227], v[136:139]
    v_exp_f32 v20, v112
    v_mfma_f32_16x16x32_bf16 v[136:139], v[52:55], v[228:231], v[136:139]
    buffer_load_dwordx4 v1, s[16:19], s58 offen offset:1024 sc1 lds
    v_exp_f32 v21, v113
    v_cvt_pk_bf16_f32 v93, v18, v19
    v_mfma_f32_16x16x32_bf16 v[136:139], v[56:59], v[232:235], v[136:139]
    v_exp_f32 v22, v114
    s_waitcnt lgkmcnt(0)
    v_mfma_f32_16x16x32_bf16 v[140:143], v[60:63], v[100:103], v[140:143]
    v_exp_f32 v23, v115
    v_mfma_f32_16x16x32_bf16 v[172:175], v[60:63], v[104:107], v[172:175]
    v_cvt_pk_bf16_f32 v94, v20, v21
    s_add_u32 m0, s51, 0
    s_add_u32 s57, s60, s53
    v_mfma_f32_16x16x32_bf16 v[144:147], v[64:67], v[100:103], v[144:147]
    v_exp_f32 v16, v116
    v_mfma_f32_16x16x32_bf16 v[176:179], v[64:67], v[104:107], v[176:179]
    buffer_load_dwordx4 v1, s[20:23], s57 offen sc1 lds
    v_exp_f32 v17, v117
    v_mfma_f32_16x16x32_bf16 v[148:151], v[68:71], v[100:103], v[148:151]
    v_cvt_pk_bf16_f32 v95, v22, v23
    v_or3_b32 v9, v92, v93, v94
    v_mfma_f32_16x16x32_bf16 v[180:183], v[68:71], v[104:107], v[180:183]
    v_exp_f32 v18, v118
    v_mfma_f32_16x16x32_bf16 v[152:155], v[72:75], v[100:103], v[152:155]
    v_exp_f32 v19, v119
    v_mfma_f32_16x16x32_bf16 v[184:187], v[72:75], v[104:107], v[184:187]
    v_cvt_pk_bf16_f32 v96, v16, v17
    v_exp_f32 v20, v120
    v_mfma_f32_16x16x32_bf16 v[248:251], v[244:247], v[100:103], v[248:251]
    v_exp_f32 v21, v121
    v_mfma_f32_16x16x32_bf16 v[252:255], v[244:247], v[104:107], v[252:255]
    buffer_load_dwordx4 v1, s[20:23], s57 offen offset:1024 sc1 lds
    v_cvt_pk_bf16_f32 v97, v18, v19
    v_mfma_f32_16x16x32_bf16 v[156:159], v[76:79], v[100:103], v[156:159]
    v_or3_b32 v9, v9, v95, v96
    v_exp_f32 v22, v122
    v_mfma_f32_16x16x32_bf16 v[188:191], v[76:79], v[104:107], v[188:191]
    v_exp_f32 v23, v123
    v_mfma_f32_16x16x32_bf16 v[160:163], v[80:83], v[100:103], v[160:163]
    v_cvt_pk_bf16_f32 v98, v20, v21
    v_mfma_f32_16x16x32_bf16 v[192:195], v[80:83], v[104:107], v[192:195]
    v_cvt_pk_bf16_f32 v99, v22, v23
    v_or3_b32 v9, v9, v97, v98
    v_mfma_f32_16x16x32_bf16 v[164:167], v[84:87], v[100:103], v[164:167]
    v_bitop3_b32 v9, v9, v99, s50 bitop3:0xa8
    v_cmp_ne_u32 vcc, 0, v9
    v_mfma_f32_16x16x32_bf16 v[196:199], v[84:87], v[104:107], v[196:199]
    v_mfma_f32_16x16x32_bf16 v[168:171], v[88:91], v[100:103], v[168:171]
    v_mfma_f32_16x16x32_bf16 v[200:203], v[88:91], v[104:107], v[200:203]
    s_cbranch_vccnz AT_S33_SLOW
AT_S33_RET:
    s_add_u32 s48, s48, 1
    s_cmp_lg_u32 s32, 6
    s_cbranch_scc1 POLL_16D
    s_mov_b32 s3, 66846720
    s_mov_b32 s38, 0
    s_waitcnt vmcnt(4)
    s_branch POLL_16C
POLL_16:
    s_sleep 8
    buffer_load_dword v24, v26, s[12:15], s3 offen sc1
    s_waitcnt vmcnt(0)
POLL_16C:
    v_cmp_eq_u32 vcc, 0, v24
    s_add_u32 s38, s38, 1
    s_and_b32 s76, vcc_lo, -1
    s_cbranch_scc0 POLL_16D
    s_cmp_lt_u32 s38, 100000
    s_cbranch_scc1 POLL_16
POLL_16D:
    s_waitcnt vmcnt(4) lgkmcnt(0)
    s_barrier
AT_S34:
    s_bitcmp1_b64 s[62:63], s48
    s_cbranch_scc1 AT_S34_EV
AT_S34_GO:
    ds_read_b128 v[60:63], v3 offset:0
    ds_read_b128 v[64:67], v3 offset:1024
    ds_read_b128 v[68:71], v3 offset:2048
    ds_read_b128 v[72:75], v3 offset:3072
    ds_read_b128 v[76:79], v3 offset:4096
    ds_read_b128 v[80:83], v3 offset:5120
    ds_read_b128 v[84:87], v3 offset:6144
    ds_read_b128 v[88:91], v3 offset:7168
    s_waitcnt lgkmcnt(6)
    v_mfma_f32_16x16x32_bf16 v[140:143], v[60:63], v[92:95], v[140:143]
    v_exp_f32 v16, v132
    v_mfma_f32_16x16x32_bf16 v[172:175], v[60:63], v[96:99], v[172:175]
    v_exp_f32 v17, v133
    v_mfma_f32_16x16x32_bf16 v[144:147], v[64:67], v[92:95], v[144:147]
    v_mfma_f32_16x16x32_bf16 v[176:179], v[64:67], v[96:99], v[176:179]
    v_exp_f32 v18, v134
    s_waitcnt lgkmcnt(4)
    v_mfma_f32_16x16x32_bf16 v[148:151], v[68:71], v[92:95], v[148:151]
    v_exp_f32 v19, v135
    v_mfma_f32_16x16x32_bf16 v[180:183], v[68:71], v[96:99], v[180:183]
    v_cvt_pk_bf16_f32 v104, v16, v17
    v_mfma_f32_16x16x32_bf16 v[152:155], v[72:75], v[92:95], v[152:155]
    v_exp_f32 v20, v136
    v_mfma_f32_16x16x32_bf16 v[184:187], v[72:75], v[96:99], v[184:187]
    v_exp_f32 v21, v137
    v_mfma_f32_16x16x32_bf16 v[248:251], v[244:247], v[92:95], v[248:251]
    v_cvt_pk_bf16_f32 v105, v18, v19
    v_mfma_f32_16x16x32_bf16 v[252:255], v[244:247], v[96:99], v[252:255]
    v_exp_f32 v22, v138
    s_waitcnt lgkmcnt(2)
    v_mfma_f32_16x16x32_bf16 v[156:159], v[76:79], v[92:95], v[156:159]
    v_mfma_f32_16x16x32_bf16 v[188:191], v[76:79], v[96:99], v[188:191]
    v_exp_f32 v23, v139
    v_mfma_f32_16x16x32_bf16 v[160:163], v[80:83], v[92:95], v[160:163]
    v_cvt_pk_bf16_f32 v106, v20, v21
    v_cvt_pk_bf16_f32 v107, v22, v23
    v_mfma_f32_16x16x32_bf16 v[192:195], v[80:83], v[96:99], v[192:195]
    v_or3_b32 v9, v104, v105, v106
    s_waitcnt lgkmcnt(0)
    v_mfma_f32_16x16x32_bf16 v[164:167], v[84:87], v[92:95], v[164:167]
    v_bitop3_b32 v9, v9, v107, s50 bitop3:0xa8
    v_cmp_ne_u32 vcc, 0, v9
    v_mfma_f32_16x16x32_bf16 v[196:199], v[84:87], v[96:99], v[196:199]
    v_mfma_f32_16x16x32_bf16 v[168:171], v[88:91], v[92:95], v[168:171]
    v_mfma_f32_16x16x32_bf16 v[200:203], v[88:91], v[96:99], v[200:203]
    s_cbranch_vccnz AT_S34_SLOW
AT_S34_RET:
    s_add_u32 s48, s48, 1
    s_waitcnt vmcnt(0) lgkmcnt(0)
    s_barrier
    s_mov_b32 s76, s70
    s_mov_b32 s77, s71
    s_mov_b32 s78, 2621440
    s_sub_u32 s37, s32, 4
    s_and_b32 s38, s2, 1
    s_sub_u32 s3, 3, s38
    s_cmp_ge_u32 s37, s3
    s_cbranch_scc1 AT_S35
    s_lshr_b32 s3, s2, 1
    s_mul_i32 s3, s3, 5
    s_mul_i32 s38, s38, 3
    s_add_u32 s3, s3, s38
    s_add_u32 s3, s3, s37
    s_mul_i32 s39, s37, 21248
    s_add_u32 s39, s39, 98304
    s_lshl_b32 s37, s3, 12
    s_mul_i32 s38, s3, 4224
    s_add_u32 s38, s38, 58720256
    s_add_u32 m0, s39, 17152
    v_add_u32 v6, s37, v1
    buffer_load_dwordx4 v1, s[12:15], s38 offen offset:0 sc1 lds
    buffer_load_dwordx4 v1, s[12:15], s38 offen offset:1024 sc1 lds
    buffer_load_dwordx4 v1, s[12:15], s38 offen offset:2048 sc1 lds
    buffer_load_dwordx4 v1, s[12:15], s38 offen offset:3072 sc1 lds
    v_add_u32 v7, 1024, v6
    s_add_u32 m0, s39, 64
    s_nop 0
    buffer_load_dwordx4 v6, s[76:79], 0 offen lds
    s_add_u32 m0, s39, 1088
    s_nop 0
    buffer_load_dwordx4 v7, s[76:79], 0 offen offset:0 lds
    buffer_load_dwordx4 v7, s[76:79], 0 offen offset:1024 lds
    buffer_load_dwordx4 v7, s[76:79], 0 offen offset:2048 lds
    v_subrev_u32 v6, 2, v6
    v_add_u32 v7, 1024, v6
    s_add_u32 m0, s39, 4224
    s_nop 0
    buffer_load_dwordx4 v6, s[76:79], 0 offen lds
    s_add_u32 m0, s39, 5248
    s_nop 0
    buffer_load_dwordx4 v7, s[76:79], 0 offen offset:0 lds
    buffer_load_dwordx4 v7, s[76:79], 0 offen offset:1024 lds
    buffer_load_dwordx4 v7, s[76:79], 0 offen offset:2048 lds
    v_subrev_u32 v6, 2, v6
    v_add_u32 v7, 1024, v6
    s_add_u32 m0, s39, 8384
    s_nop 0
    buffer_load_dwordx4 v6, s[76:79], 0 offen lds
    s_add_u32 m0, s39, 9408
    s_nop 0
    buffer_load_dwordx4 v7, s[76:79], 0 offen offset:0 lds
    buffer_load_dwordx4 v7, s[76:79], 0 offen offset:1024 lds
    buffer_load_dwordx4 v7, s[76:79], 0 offen offset:2048 lds
    v_subrev_u32 v6, 2, v6
    v_add_u32 v7, 1024, v6
    s_add_u32 m0, s39, 12544
    s_nop 0
    buffer_load_dwordx4 v6, s[76:79], 0 offen lds
    s_add_u32 m0, s39, 13568
    s_nop 0
    buffer_load_dwordx4 v7, s[76:79], 0 offen offset:0 lds
    buffer_load_dwordx4 v7, s[76:79], 0 offen offset:1024 lds
    buffer_load_dwordx4 v7, s[76:79], 0 offen offset:2048 lds
AT_S35:
    s_bitcmp1_b64 s[62:63], s48
    s_cbranch_scc1 AT_S35_EV
AT_S35_GO:
    ds_read_b128 v[60:63], v3 offset:16384
    ds_read_b128 v[64:67], v3 offset:17408
    ds_read_b128 v[68:71], v3 offset:18432
    ds_read_b128 v[72:75], v3 offset:19456
    ds_read_b128 v[76:79], v3 offset:20480
    ds_read_b128 v[80:83], v3 offset:21504
    ds_read_b128 v[84:87], v3 offset:22528
    ds_read_b128 v[88:91], v3 offset:23552
    s_waitcnt lgkmcnt(6)
    v_mfma_f32_16x16x32_bf16 v[172:175], v[60:63], v[104:107], v[172:175]
    v_mfma_f32_16x16x32_bf16 v[176:179], v[64:67], v[104:107], v[176:179]
    s_waitcnt lgkmcnt(4)
    v_mfma_f32_16x16x32_bf16 v[180:183], v[68:71], v[104:107], v[180:183]
    v_mfma_f32_16x16x32_bf16 v[184:187], v[72:75], v[104:107], v[184:187]
    v_mfma_f32_16x16x32_bf16 v[252:255], v[244:247], v[104:107], v[252:255]
    s_waitcnt lgkmcnt(2)
    v_mfma_f32_16x16x32_bf16 v[188:191], v[76:79], v[104:107], v[188:191]
    v_mfma_f32_16x16x32_bf16 v[192:195], v[80:83], v[104:107], v[192:195]
    s_waitcnt lgkmcnt(0)
    v_mfma_f32_16x16x32_bf16 v[196:199], v[84:87], v[104:107], v[196:199]
    v_mfma_f32_16x16x32_bf16 v[200:203], v[88:91], v[104:107], v[200:203]
    s_mul_i32 s37, s32, 8704
    s_xor_b32 s38, s32, 4
    s_mul_i32 s38, s38, 8704
    v_add_u32 v28, s37, v1
    v_add_u32 v29, s38, v1
    v_lshlrev_b32 v30, 3, v0
    v_add_u32 v31, s38, v30
    v_add_u32 v30, s37, v30
    s_cmp_eq_u32 s35, 0
    s_cbranch_scc1 AT_MA
    v_mov_b32 v14, v236
    v_mov_b32 v15, v248
    ds_write_b64 v30, v[14:15] offset:8192
    ds_write_b128 v28, v[140:143] offset:0
    ds_write_b128 v28, v[144:147] offset:1024
    ds_write_b128 v28, v[148:151] offset:2048
    ds_write_b128 v28, v[152:155] offset:3072
    ds_write_b128 v28, v[156:159] offset:4096
    ds_write_b128 v28, v[160:163] offset:5120
    ds_write_b128 v28, v[164:167] offset:6144
    ds_write_b128 v28, v[168:171] offset:7168
    s_add_u32 s55, s55, 528384
    s_waitcnt lgkmcnt(0)
    s_barrier
    ds_read_b64 v[12:13], v31 offset:8192
    ds_read_b128 v[140:143], v29 offset:0
    ds_read_b128 v[144:147], v29 offset:1024
    ds_read_b128 v[148:151], v29 offset:2048
    ds_read_b128 v[152:155], v29 offset:3072
    ds_read_b128 v[156:159], v29 offset:4096
    ds_read_b128 v[160:163], v29 offset:5120
    ds_read_b128 v[164:167], v29 offset:6144
    ds_read_b128 v[168:171], v29 offset:7168
    s_waitcnt lgkmcnt(8)
    v_min_f32 v9, v240, v12
    v_sub_f32 v10, v9, v240
    v_sub_f32 v12, v9, v12
    v_exp_f32 v10, v10
    v_exp_f32 v12, v12
    v_mul_f32 v9, v252, v10
    v_fmac_f32 v9, v13, v12
    v_rcp_f32 v9, v9
    s_nop 0
    v_mul_f32 v10, v10, v9
    v_mul_f32 v12, v12, v9
    v_mul_f32 v172, v172, v10
    v_mul_f32 v173, v173, v10
    v_mul_f32 v174, v174, v10
    v_mul_f32 v175, v175, v10
    v_mul_f32 v176, v176, v10
    v_mul_f32 v177, v177, v10
    v_mul_f32 v178, v178, v10
    v_mul_f32 v179, v179, v10
    s_waitcnt lgkmcnt(6)
    v_fmac_f32 v172, v140, v12
    v_fmac_f32 v173, v141, v12
    v_fmac_f32 v174, v142, v12
    v_fmac_f32 v175, v143, v12
    v_fmac_f32 v176, v144, v12
    v_fmac_f32 v177, v145, v12
    v_fmac_f32 v178, v146, v12
    v_fmac_f32 v179, v147, v12
    v_cvt_pk_bf16_f32 v32, v172, v173
    v_cvt_pk_bf16_f32 v33, v174, v175
    v_cvt_pk_bf16_f32 v34, v176, v177
    v_cvt_pk_bf16_f32 v35, v178, v179
    buffer_store_dwordx4 v[32:35], v1, s[12:15], s55 offen offset:0 sc1
    v_mul_f32 v180, v180, v10
    v_mul_f32 v181, v181, v10
    v_mul_f32 v182, v182, v10
    v_mul_f32 v183, v183, v10
    v_mul_f32 v184, v184, v10
    v_mul_f32 v185, v185, v10
    v_mul_f32 v186, v186, v10
    v_mul_f32 v187, v187, v10
    s_waitcnt lgkmcnt(4)
    v_fmac_f32 v180, v148, v12
    v_fmac_f32 v181, v149, v12
    v_fmac_f32 v182, v150, v12
    v_fmac_f32 v183, v151, v12
    v_fmac_f32 v184, v152, v12
    v_fmac_f32 v185, v153, v12
    v_fmac_f32 v186, v154, v12
    v_fmac_f32 v187, v155, v12
    v_cvt_pk_bf16_f32 v36, v180, v181
    v_cvt_pk_bf16_f32 v37, v182, v183
    v_cvt_pk_bf16_f32 v38, v184, v185
    v_cvt_pk_bf16_f32 v39, v186, v187
    buffer_store_dwordx4 v[36:39], v1, s[12:15], s55 offen offset:1024 sc1
    v_mul_f32 v188, v188, v10
    v_mul_f32 v189, v189, v10
    v_mul_f32 v190, v190, v10
    v_mul_f32 v191, v191, v10
    v_mul_f32 v192, v192, v10
    v_mul_f32 v193, v193, v10
    v_mul_f32 v194, v194, v10
    v_mul_f32 v195, v195, v10
    s_waitcnt lgkmcnt(2)
    v_fmac_f32 v188, v156, v12
    v_fmac_f32 v189, v157, v12
    v_fmac_f32 v190, v158, v12
    v_fmac_f32 v191, v159, v12
    v_fmac_f32 v192, v160, v12
    v_fmac_f32 v193, v161, v12
    v_fmac_f32 v194, v162, v12
    v_fmac_f32 v195, v163, v12
    v_cvt_pk_bf16_f32 v40, v188, v189
    v_cvt_pk_bf16_f32 v41, v190, v191
    v_cvt_pk_bf16_f32 v42, v192, v193
    v_cvt_pk_bf16_f32 v43, v194, v195
    buffer_store_dwordx4 v[40:43], v1, s[12:15], s55 offen offset:2048 sc1
    v_mul_f32 v196, v196, v10
    v_mul_f32 v197, v197, v10
    v_mul_f32 v198, v198, v10
    v_mul_f32 v199, v199, v10
    v_mul_f32 v200, v200, v10
    v_mul_f32 v201, v201, v10
    v_mul_f32 v202, v202, v10
    v_mul_f32 v203, v203, v10
    s_waitcnt lgkmcnt(0)
    v_fmac_f32 v196, v164, v12
    v_fmac_f32 v197, v165, v12
    v_fmac_f32 v198, v166, v12
    v_fmac_f32 v199, v167, v12
    v_fmac_f32 v200, v168, v12
    v_fmac_f32 v201, v169, v12
    v_fmac_f32 v202, v170, v12
    v_fmac_f32 v203, v171, v12
    v_cvt_pk_bf16_f32 v44, v196, v197
    v_cvt_pk_bf16_f32 v45, v198, v199
    v_cvt_pk_bf16_f32 v46, v200, v201
    v_cvt_pk_bf16_f32 v47, v202, v203
    buffer_store_dwordx4 v[44:47], v1, s[12:15], s55 offen offset:3072 sc1
    s_branch AT_MB
AT_MA:
    v_mov_b32 v14, v240
    v_mov_b32 v15, v252
    ds_write_b64 v30, v[14:15] offset:8192
    ds_write_b128 v28, v[172:175] offset:0
    ds_write_b128 v28, v[176:179] offset:1024
    ds_write_b128 v28, v[180:183] offset:2048
    ds_write_b128 v28, v[184:187] offset:3072
    ds_write_b128 v28, v[188:191] offset:4096
    ds_write_b128 v28, v[192:195] offset:5120
    ds_write_b128 v28, v[196:199] offset:6144
    ds_write_b128 v28, v[200:203] offset:7168
    s_waitcnt lgkmcnt(0)
    s_barrier
    ds_read_b64 v[12:13], v31 offset:8192
    ds_read_b128 v[172:175], v29 offset:0
    ds_read_b128 v[176:179], v29 offset:1024
    ds_read_b128 v[180:183], v29 offset:2048
    ds_read_b128 v[184:187], v29 offset:3072
    ds_read_b128 v[188:191], v29 offset:4096
    ds_read_b128 v[192:195], v29 offset:5120
    ds_read_b128 v[196:199], v29 offset:6144
    ds_read_b128 v[200:203], v29 offset:7168
    s_waitcnt lgkmcnt(8)
    v_min_f32 v9, v236, v12
    v_sub_f32 v10, v9, v236
    v_sub_f32 v12, v9, v12
    v_exp_f32 v10, v10
    v_exp_f32 v12, v12
    v_mul_f32 v9, v248, v10
    v_fmac_f32 v9, v13, v12
    v_rcp_f32 v9, v9
    s_nop 0
    v_mul_f32 v10, v10, v9
    v_mul_f32 v12, v12, v9
    v_mul_f32 v140, v140, v10
    v_mul_f32 v141, v141, v10
    v_mul_f32 v142, v142, v10
    v_mul_f32 v143, v143, v10
    v_mul_f32 v144, v144, v10
    v_mul_f32 v145, v145, v10
    v_mul_f32 v146, v146, v10
    v_mul_f32 v147, v147, v10
    s_waitcnt lgkmcnt(6)
    v_fmac_f32 v140, v172, v12
    v_fmac_f32 v141, v173, v12
    v_fmac_f32 v142, v174, v12
    v_fmac_f32 v143, v175, v12
    v_fmac_f32 v144, v176, v12
    v_fmac_f32 v145, v177, v12
    v_fmac_f32 v146, v178, v12
    v_fmac_f32 v147, v179, v12
    v_cvt_pk_bf16_f32 v32, v140, v141
    v_cvt_pk_bf16_f32 v33, v142, v143
    v_cvt_pk_bf16_f32 v34, v144, v145
    v_cvt_pk_bf16_f32 v35, v146, v147
    buffer_store_dwordx4 v[32:35], v1, s[12:15], s55 offen offset:0 sc1
    v_mul_f32 v148, v148, v10
    v_mul_f32 v149, v149, v10
    v_mul_f32 v150, v150, v10
    v_mul_f32 v151, v151, v10
    v_mul_f32 v152, v152, v10
    v_mul_f32 v153, v153, v10
    v_mul_f32 v154, v154, v10
    v_mul_f32 v155, v155, v10
    s_waitcnt lgkmcnt(4)
    v_fmac_f32 v148, v180, v12
    v_fmac_f32 v149, v181, v12
    v_fmac_f32 v150, v182, v12
    v_fmac_f32 v151, v183, v12
    v_fmac_f32 v152, v184, v12
    v_fmac_f32 v153, v185, v12
    v_fmac_f32 v154, v186, v12
    v_fmac_f32 v155, v187, v12
    v_cvt_pk_bf16_f32 v36, v148, v149
    v_cvt_pk_bf16_f32 v37, v150, v151
    v_cvt_pk_bf16_f32 v38, v152, v153
    v_cvt_pk_bf16_f32 v39, v154, v155
    buffer_store_dwordx4 v[36:39], v1, s[12:15], s55 offen offset:1024 sc1
    v_mul_f32 v156, v156, v10
    v_mul_f32 v157, v157, v10
    v_mul_f32 v158, v158, v10
    v_mul_f32 v159, v159, v10
    v_mul_f32 v160, v160, v10
    v_mul_f32 v161, v161, v10
    v_mul_f32 v162, v162, v10
    v_mul_f32 v163, v163, v10
    s_waitcnt lgkmcnt(2)
    v_fmac_f32 v156, v188, v12
    v_fmac_f32 v157, v189, v12
    v_fmac_f32 v158, v190, v12
    v_fmac_f32 v159, v191, v12
    v_fmac_f32 v160, v192, v12
    v_fmac_f32 v161, v193, v12
    v_fmac_f32 v162, v194, v12
    v_fmac_f32 v163, v195, v12
    v_cvt_pk_bf16_f32 v40, v156, v157
    v_cvt_pk_bf16_f32 v41, v158, v159
    v_cvt_pk_bf16_f32 v42, v160, v161
    v_cvt_pk_bf16_f32 v43, v162, v163
    buffer_store_dwordx4 v[40:43], v1, s[12:15], s55 offen offset:2048 sc1
    v_mul_f32 v164, v164, v10
    v_mul_f32 v165, v165, v10
    v_mul_f32 v166, v166, v10
    v_mul_f32 v167, v167, v10
    v_mul_f32 v168, v168, v10
    v_mul_f32 v169, v169, v10
    v_mul_f32 v170, v170, v10
    v_mul_f32 v171, v171, v10
    s_waitcnt lgkmcnt(0)
    v_fmac_f32 v164, v196, v12
    v_fmac_f32 v165, v197, v12
    v_fmac_f32 v166, v198, v12
    v_fmac_f32 v167, v199, v12
    v_fmac_f32 v168, v200, v12
    v_fmac_f32 v169, v201, v12
    v_fmac_f32 v170, v202, v12
    v_fmac_f32 v171, v203, v12
    v_cvt_pk_bf16_f32 v44, v164, v165
    v_cvt_pk_bf16_f32 v45, v166, v167
    v_cvt_pk_bf16_f32 v46, v168, v169
    v_cvt_pk_bf16_f32 v47, v170, v171
    buffer_store_dwordx4 v[44:47], v1, s[12:15], s55 offen offset:3072 sc1
AT_MB:
    s_sub_u32 s38, 15, s34
    s_lshl_b32 s38, s38, 12
    s_lshl_b32 s37, s33, 2
    s_add_u32 s37, s37, s38
    s_add_u32 s37, s37, 66846720
    s_mov_b32 s28, s32
    s_load_dwordx2 s[4:5], s[0:1], 120
    s_load_dwordx2 s[8:9], s[0:1], 0
    s_load_dwordx2 s[12:13], s[0:1], 104
    s_load_dwordx2 s[16:17], s[0:1], 32
    s_load_dwordx2 s[20:21], s[0:1], 40
    s_load_dwordx2 s[24:25], s[0:1], 112
    s_and_b32 s31, s2, 3
    s_lshl_b32 s31, s31, 3
    s_bfe_u32 s29, s2, 0x30003
    s_add_u32 s31, s31, s29
    s_and_b32 s32, s2, 4
    s_lshr_b32 s29, s2, 6
    s_add_u32 s32, s32, s29
    v_lshlrev_b32 v1, 4, v0
    s_mov_b32 s6, 67108864
    s_mov_b32 s7, 0x00020000
    s_mov_b32 s10, 2621440
    s_mov_b32 s11, 0x00020000
    s_mov_b32 s14, 2621440
    s_mov_b32 s15, 0x00020000
    s_mov_b32 s18, 2621440
    s_mov_b32 s19, 0x00020000
    s_mov_b32 s22, 1280
    s_mov_b32 s23, 0x00020000
    s_mov_b32 s26, 256
    s_mov_b32 s27, 0x00020000
    s_cmp_ge_u32 s28, 4
    s_cbranch_scc1 T_SIDE
    s_mul_i32 s29, s31, 528384
    s_add_u32 s29, s29, 33554432
    v_add_u32 v4, s29, v1
    v_add_u32 v5, 132096, v4
    v_add_u32 v6, 264192, v4
    v_add_u32 v7, 396288, v4
    s_mul_i32 s29, s32, 660480
    s_add_u32 s29, s29, 51380224
    v_add_u32 v8, s29, v1
    v_add_u32 v9, 132096, v8
    v_add_u32 v10, 264192, v8
    v_add_u32 v11, 396288, v8
    v_add_u32 v12, 528384, v8
    s_lshl_b32 s33, s28, 15
    s_waitcnt lgkmcnt(0)
    s_add_u32 s38, s33, 4096
    s_waitcnt vmcnt(0)
    s_barrier
    v_mov_b32 v2, 71744
    ds_read_b32 v3, v2
    buffer_load_dwordx4 v[48:51], v8, s[4:7], s33 offen offset:0 sc1
    buffer_load_dwordx4 v[52:55], v9, s[4:7], s33 offen offset:0 sc1
    buffer_load_dwordx4 v[56:59], v10, s[4:7], s33 offen offset:0 sc1
    buffer_load_dwordx4 v[60:63], v11, s[4:7], s33 offen offset:0 sc1
    buffer_load_dwordx4 v[64:67], v12, s[4:7], s33 offen offset:0 sc1
    buffer_load_dwordx4 v[84:87], v8, s[4:7], s33 offen offset:1024 sc1
    buffer_load_dwordx4 v[88:91], v9, s[4:7], s33 offen offset:1024 sc1
    buffer_load_dwordx4 v[92:95], v10, s[4:7], s33 offen offset:1024 sc1
    buffer_load_dwordx4 v[96:99], v11, s[4:7], s33 offen offset:1024 sc1
    buffer_load_dwordx4 v[100:103], v12, s[4:7], s33 offen offset:1024 sc1
    buffer_load_dwordx4 v[120:123], v8, s[4:7], s33 offen offset:2048 sc1
    buffer_load_dwordx4 v[124:127], v9, s[4:7], s33 offen offset:2048 sc1
    buffer_load_dwordx4 v[128:131], v10, s[4:7], s33 offen offset:2048 sc1
    buffer_load_dwordx4 v[132:135], v11, s[4:7], s33 offen offset:2048 sc1
    buffer_load_dwordx4 v[136:139], v12, s[4:7], s33 offen offset:2048 sc1
    buffer_load_dwordx4 v[156:159], v8, s[4:7], s33 offen offset:3072 sc1
    buffer_load_dwordx4 v[160:163], v9, s[4:7], s33 offen offset:3072 sc1
    buffer_load_dwordx4 v[164:167], v10, s[4:7], s33 offen offset:3072 sc1
    buffer_load_dwordx4 v[168:171], v11, s[4:7], s33 offen offset:3072 sc1
    buffer_load_dwordx4 v[172:175], v12, s[4:7], s33 offen offset:3072 sc1
    s_mov_b32 s30, 0
    s_branch T_RDY1
T_RDY:
    s_sleep 2
    ds_read_b32 v3, v2
T_RDY1:
    s_waitcnt lgkmcnt(0)
    v_readfirstlane_b32 s29, v3
    s_add_u32 s30, s30, 1
    s_cmp_lg_u32 s29, 0
    s_cbranch_scc1 T_RDY2
    s_cmp_lt_u32 s30, 4000000
    s_cbranch_scc1 T_RDY
T_RDY2:
    buffer_load_dwordx4 v[32:35], v4, s[4:7], s33 offen offset:0 sc1
    buffer_load_dwordx4 v[36:39], v5, s[4:7], s33 offen offset:0 sc1
    buffer_load_dwordx4 v[40:43], v6, s[4:7], s33 offen offset:0 sc1
    buffer_load_dwordx4 v[44:47], v7, s[4:7], s33 offen offset:0 sc1
    buffer_load_dwordx4 v[68:71], v4, s[4:7], s33 offen offset:1024 sc1
    buffer_load_dwordx4 v[72:75], v5, s[4:7], s33 offen offset:1024 sc1
    buffer_load_dwordx4 v[76:79], v6, s[4:7], s33 offen offset:1024 sc1
    buffer_load_dwordx4 v[80:83], v7, s[4:7], s33 offen offset:1024 sc1
    buffer_load_dwordx4 v[104:107], v4, s[4:7], s33 offen offset:2048 sc1
    buffer_load_dwordx4 v[108:111], v5, s[4:7], s33 offen offset:2048 sc1
    buffer_load_dwordx4 v[112:115], v6, s[4:7], s33 offen offset:2048 sc1
    buffer_load_dwordx4 v[116:119], v7, s[4:7], s33 offen offset:2048 sc1
    buffer_load_dwordx4 v[140:143], v4, s[4:7], s33 offen offset:3072 sc1
    buffer_load_dwordx4 v[144:147], v5, s[4:7], s33 offen offset:3072 sc1
    buffer_load_dwordx4 v[148:151], v6, s[4:7], s33 offen offset:3072 sc1
    buffer_load_dwordx4 v[152:155], v7, s[4:7], s33 offen offset:3072 sc1
    v_and_b32 v2, 15, v0
    v_lshrrev_b32 v3, 4, v0
    s_lshl_b32 s29, s31, 6
    s_lshl_b32 s30, s28, 4
    s_add_u32 s29, s29, s30
    v_add_u32 v2, s29, v2
    v_mul_u32_u24 v13, 1280, v2
    v_lshl_add_u32 v13, v3, 3, v13
    s_mul_i32 s29, s32, 160
    v_add_u32 v13, s29, v13
    v_lshlrev_b32 v2, 2, v2
    s_waitcnt vmcnt(12)
    v_mfma_f32_16x16x32_bf16 v[176:179], v[48:51], v[32:35], 0
    v_mfma_f32_16x16x32_bf16 v[196:199], v[48:51], v[36:39], 0
    v_mfma_f32_16x16x32_bf16 v[216:219], v[48:51], v[40:43], 0
    v_mfma_f32_16x16x32_bf16 v[236:239], v[48:51], v[44:47], 0
    buffer_load_dwordx4 v[48:51], v8, s[4:7], s38 offen offset:0 sc1
    v_mfma_f32_16x16x32_bf16 v[180:183], v[52:55], v[32:35], 0
    v_mfma_f32_16x16x32_bf16 v[200:203], v[52:55], v[36:39], 0
    v_mfma_f32_16x16x32_bf16 v[220:223], v[52:55], v[40:43], 0
    v_mfma_f32_16x16x32_bf16 v[240:243], v[52:55], v[44:47], 0
    buffer_load_dwordx4 v[52:55], v9, s[4:7], s38 offen offset:0 sc1
    v_mfma_f32_16x16x32_bf16 v[184:187], v[56:59], v[32:35], 0
    v_mfma_f32_16x16x32_bf16 v[204:207], v[56:59], v[36:39], 0
    v_mfma_f32_16x16x32_bf16 v[224:227], v[56:59], v[40:43], 0
    v_mfma_f32_16x16x32_bf16 v[244:247], v[56:59], v[44:47], 0
    buffer_load_dwordx4 v[56:59], v10, s[4:7], s38 offen offset:0 sc1
    v_mfma_f32_16x16x32_bf16 v[188:191], v[60:63], v[32:35], 0
    v_mfma_f32_16x16x32_bf16 v[208:211], v[60:63], v[36:39], 0
    v_mfma_f32_16x16x32_bf16 v[228:231], v[60:63], v[40:43], 0
    v_mfma_f32_16x16x32_bf16 v[248:251], v[60:63], v[44:47], 0
    buffer_load_dwordx4 v[60:63], v11, s[4:7], s38 offen offset:0 sc1
    v_mfma_f32_16x16x32_bf16 v[192:195], v[64:67], v[32:35], 0
    buffer_load_dwordx4 v[32:35], v4, s[4:7], s38 offen offset:0 sc1
    v_mfma_f32_16x16x32_bf16 v[212:215], v[64:67], v[36:39], 0
    buffer_load_dwordx4 v[36:39], v5, s[4:7], s38 offen offset:0 sc1
    v_mfma_f32_16x16x32_bf16 v[232:235], v[64:67], v[40:43], 0
    buffer_load_dwordx4 v[40:43], v6, s[4:7], s38 offen offset:0 sc1
    v_mfma_f32_16x16x32_bf16 v[252:255], v[64:67], v[44:47], 0
    buffer_load_dwordx4 v[64:67], v12, s[4:7], s38 offen offset:0 sc1
    buffer_load_dwordx4 v[44:47], v7, s[4:7], s38 offen offset:0 sc1
    s_waitcnt vmcnt(17)
    v_mfma_f32_16x16x32_bf16 v[176:179], v[84:87], v[68:71], v[176:179]
    v_mfma_f32_16x16x32_bf16 v[196:199], v[84:87], v[72:75], v[196:199]
    v_mfma_f32_16x16x32_bf16 v[216:219], v[84:87], v[76:79], v[216:219]
    v_mfma_f32_16x16x32_bf16 v[236:239], v[84:87], v[80:83], v[236:239]
    buffer_load_dwordx4 v[84:87], v8, s[4:7], s38 offen offset:1024 sc1
    v_mfma_f32_16x16x32_bf16 v[180:183], v[88:91], v[68:71], v[180:183]
    v_mfma_f32_16x16x32_bf16 v[200:203], v[88:91], v[72:75], v[200:203]
    v_mfma_f32_16x16x32_bf16 v[220:223], v[88:91], v[76:79], v[220:223]
    v_mfma_f32_16x16x32_bf16 v[240:243], v[88:91], v[80:83], v[240:243]
    buffer_load_dwordx4 v[88:91], v9, s[4:7], s38 offen offset:1024 sc1
    v_mfma_f32_16x16x32_bf16 v[184:187], v[92:95], v[68:71], v[184:187]
    v_mfma_f32_16x16x32_bf16 v[204:207], v[92:95], v[72:75], v[204:207]
    v_mfma_f32_16x16x32_bf16 v[224:227], v[92:95], v[76:79], v[224:227]
    v_mfma_f32_16x16x32_bf16 v[244:247], v[92:95], v[80:83], v[244:247]
    buffer_load_dwordx4 v[92:95], v10, s[4:7], s38 offen offset:1024 sc1
    v_mfma_f32_16x16x32_bf16 v[188:191], v[96:99], v[68:71], v[188:191]
    v_mfma_f32_16x16x32_bf16 v[208:211], v[96:99], v[72:75], v[208:211]
    v_mfma_f32_16x16x32_bf16 v[228:231], v[96:99], v[76:79], v[228:231]
    v_mfma_f32_16x16x32_bf16 v[248:251], v[96:99], v[80:83], v[248:251]
    buffer_load_dwordx4 v[96:99], v11, s[4:7], s38 offen offset:1024 sc1
    v_mfma_f32_16x16x32_bf16 v[192:195], v[100:103], v[68:71], v[192:195]
    buffer_load_dwordx4 v[68:71], v4, s[4:7], s38 offen offset:1024 sc1
    v_mfma_f32_16x16x32_bf16 v[212:215], v[100:103], v[72:75], v[212:215]
    buffer_load_dwordx4 v[72:75], v5, s[4:7], s38 offen offset:1024 sc1
    v_mfma_f32_16x16x32_bf16 v[232:235], v[100:103], v[76:79], v[232:235]
    buffer_load_dwordx4 v[76:79], v6, s[4:7], s38 offen offset:1024 sc1
    v_mfma_f32_16x16x32_bf16 v[252:255], v[100:103], v[80:83], v[252:255]
    buffer_load_dwordx4 v[100:103], v12, s[4:7], s38 offen offset:1024 sc1
    buffer_load_dwordx4 v[80:83], v7, s[4:7], s38 offen offset:1024 sc1
    s_waitcnt vmcnt(22)
    v_mfma_f32_16x16x32_bf16 v[176:179], v[120:123], v[104:107], v[176:179]
    v_mfma_f32_16x16x32_bf16 v[196:199], v[120:123], v[108:111], v[196:199]
    v_mfma_f32_16x16x32_bf16 v[216:219], v[120:123], v[112:115], v[216:219]
    v_mfma_f32_16x16x32_bf16 v[236:239], v[120:123], v[116:119], v[236:239]
    buffer_load_dwordx4 v[120:123], v8, s[4:7], s38 offen offset:2048 sc1
    v_mfma_f32_16x16x32_bf16 v[180:183], v[124:127], v[104:107], v[180:183]
    v_mfma_f32_16x16x32_bf16 v[200:203], v[124:127], v[108:111], v[200:203]
    v_mfma_f32_16x16x32_bf16 v[220:223], v[124:127], v[112:115], v[220:223]
    v_mfma_f32_16x16x32_bf16 v[240:243], v[124:127], v[116:119], v[240:243]
    buffer_load_dwordx4 v[124:127], v9, s[4:7], s38 offen offset:2048 sc1
    v_mfma_f32_16x16x32_bf16 v[184:187], v[128:131], v[104:107], v[184:187]
    v_mfma_f32_16x16x32_bf16 v[204:207], v[128:131], v[108:111], v[204:207]
    v_mfma_f32_16x16x32_bf16 v[224:227], v[128:131], v[112:115], v[224:227]
    v_mfma_f32_16x16x32_bf16 v[244:247], v[128:131], v[116:119], v[244:247]
    buffer_load_dwordx4 v[128:131], v10, s[4:7], s38 offen offset:2048 sc1
    v_mfma_f32_16x16x32_bf16 v[188:191], v[132:135], v[104:107], v[188:191]
    v_mfma_f32_16x16x32_bf16 v[208:211], v[132:135], v[108:111], v[208:211]
    v_mfma_f32_16x16x32_bf16 v[228:231], v[132:135], v[112:115], v[228:231]
    v_mfma_f32_16x16x32_bf16 v[248:251], v[132:135], v[116:119], v[248:251]
    buffer_load_dwordx4 v[132:135], v11, s[4:7], s38 offen offset:2048 sc1
    v_mfma_f32_16x16x32_bf16 v[192:195], v[136:139], v[104:107], v[192:195]
    buffer_load_dwordx4 v[104:107], v4, s[4:7], s38 offen offset:2048 sc1
    v_mfma_f32_16x16x32_bf16 v[212:215], v[136:139], v[108:111], v[212:215]
    buffer_load_dwordx4 v[108:111], v5, s[4:7], s38 offen offset:2048 sc1
    v_mfma_f32_16x16x32_bf16 v[232:235], v[136:139], v[112:115], v[232:235]
    buffer_load_dwordx4 v[112:115], v6, s[4:7], s38 offen offset:2048 sc1
    v_mfma_f32_16x16x32_bf16 v[252:255], v[136:139], v[116:119], v[252:255]
    buffer_load_dwordx4 v[136:139], v12, s[4:7], s38 offen offset:2048 sc1
    buffer_load_dwordx4 v[116:119], v7, s[4:7], s38 offen offset:2048 sc1
    s_waitcnt vmcnt(27)
    v_mfma_f32_16x16x32_bf16 v[176:179], v[156:159], v[140:143], v[176:179]
    v_mfma_f32_16x16x32_bf16 v[196:199], v[156:159], v[144:147], v[196:199]
    v_mfma_f32_16x16x32_bf16 v[216:219], v[156:159], v[148:151], v[216:219]
    v_mfma_f32_16x16x32_bf16 v[236:239], v[156:159], v[152:155], v[236:239]
    buffer_load_dwordx4 v[156:159], v8, s[4:7], s38 offen offset:3072 sc1
    v_mfma_f32_16x16x32_bf16 v[180:183], v[160:163], v[140:143], v[180:183]
    v_mfma_f32_16x16x32_bf16 v[200:203], v[160:163], v[144:147], v[200:203]
    v_mfma_f32_16x16x32_bf16 v[220:223], v[160:163], v[148:151], v[220:223]
    v_mfma_f32_16x16x32_bf16 v[240:243], v[160:163], v[152:155], v[240:243]
    buffer_load_dwordx4 v[160:163], v9, s[4:7], s38 offen offset:3072 sc1
    v_mfma_f32_16x16x32_bf16 v[184:187], v[164:167], v[140:143], v[184:187]
    v_mfma_f32_16x16x32_bf16 v[204:207], v[164:167], v[144:147], v[204:207]
    v_mfma_f32_16x16x32_bf16 v[224:227], v[164:167], v[148:151], v[224:227]
    v_mfma_f32_16x16x32_bf16 v[244:247], v[164:167], v[152:155], v[244:247]
    buffer_load_dwordx4 v[164:167], v10, s[4:7], s38 offen offset:3072 sc1
    v_mfma_f32_16x16x32_bf16 v[188:191], v[168:171], v[140:143], v[188:191]
    v_mfma_f32_16x16x32_bf16 v[208:211], v[168:171], v[144:147], v[208:211]
    v_mfma_f32_16x16x32_bf16 v[228:231], v[168:171], v[148:151], v[228:231]
    v_mfma_f32_16x16x32_bf16 v[248:251], v[168:171], v[152:155], v[248:251]
    buffer_load_dwordx4 v[168:171], v11, s[4:7], s38 offen offset:3072 sc1
    v_mfma_f32_16x16x32_bf16 v[192:195], v[172:175], v[140:143], v[192:195]
    buffer_load_dwordx4 v[140:143], v4, s[4:7], s38 offen offset:3072 sc1
    v_mfma_f32_16x16x32_bf16 v[212:215], v[172:175], v[144:147], v[212:215]
    buffer_load_dwordx4 v[144:147], v5, s[4:7], s38 offen offset:3072 sc1
    v_mfma_f32_16x16x32_bf16 v[232:235], v[172:175], v[148:151], v[232:235]
    buffer_load_dwordx4 v[148:151], v6, s[4:7], s38 offen offset:3072 sc1
    v_mfma_f32_16x16x32_bf16 v[252:255], v[172:175], v[152:155], v[252:255]
    buffer_load_dwordx4 v[172:175], v12, s[4:7], s38 offen offset:3072 sc1
    buffer_load_dwordx4 v[152:155], v7, s[4:7], s38 offen offset:3072 sc1
    s_waitcnt vmcnt(27)
    s_add_u32 s33, s33, 8192
    v_mfma_f32_16x16x32_bf16 v[176:179], v[48:51], v[32:35], v[176:179]
    v_mfma_f32_16x16x32_bf16 v[196:199], v[48:51], v[36:39], v[196:199]
    v_mfma_f32_16x16x32_bf16 v[216:219], v[48:51], v[40:43], v[216:219]
    v_mfma_f32_16x16x32_bf16 v[236:239], v[48:51], v[44:47], v[236:239]
    buffer_load_dwordx4 v[48:51], v8, s[4:7], s33 offen offset:0 sc1
    v_mfma_f32_16x16x32_bf16 v[180:183], v[52:55], v[32:35], v[180:183]
    v_mfma_f32_16x16x32_bf16 v[200:203], v[52:55], v[36:39], v[200:203]
    v_mfma_f32_16x16x32_bf16 v[220:223], v[52:55], v[40:43], v[220:223]
    v_mfma_f32_16x16x32_bf16 v[240:243], v[52:55], v[44:47], v[240:243]
    buffer_load_dwordx4 v[52:55], v9, s[4:7], s33 offen offset:0 sc1
    v_mfma_f32_16x16x32_bf16 v[184:187], v[56:59], v[32:35], v[184:187]
    v_mfma_f32_16x16x32_bf16 v[204:207], v[56:59], v[36:39], v[204:207]
    v_mfma_f32_16x16x32_bf16 v[224:227], v[56:59], v[40:43], v[224:227]
    v_mfma_f32_16x16x32_bf16 v[244:247], v[56:59], v[44:47], v[244:247]
    buffer_load_dwordx4 v[56:59], v10, s[4:7], s33 offen offset:0 sc1
    v_mfma_f32_16x16x32_bf16 v[188:191], v[60:63], v[32:35], v[188:191]
    v_mfma_f32_16x16x32_bf16 v[208:211], v[60:63], v[36:39], v[208:211]
    v_mfma_f32_16x16x32_bf16 v[228:231], v[60:63], v[40:43], v[228:231]
    v_mfma_f32_16x16x32_bf16 v[248:251], v[60:63], v[44:47], v[248:251]
    buffer_load_dwordx4 v[60:63], v11, s[4:7], s33 offen offset:0 sc1
    v_mfma_f32_16x16x32_bf16 v[192:195], v[64:67], v[32:35], v[192:195]
    buffer_load_dwordx4 v[32:35], v4, s[4:7], s33 offen offset:0 sc1
    v_mfma_f32_16x16x32_bf16 v[212:215], v[64:67], v[36:39], v[212:215]
    buffer_load_dwordx4 v[36:39], v5, s[4:7], s33 offen offset:0 sc1
    v_mfma_f32_16x16x32_bf16 v[232:235], v[64:67], v[40:43], v[232:235]
    buffer_load_dwordx4 v[40:43], v6, s[4:7], s33 offen offset:0 sc1
    v_mfma_f32_16x16x32_bf16 v[252:255], v[64:67], v[44:47], v[252:255]
    buffer_load_dwordx4 v[64:67], v12, s[4:7], s33 offen offset:0 sc1
    buffer_load_dwordx4 v[44:47], v7, s[4:7], s33 offen offset:0 sc1
    s_waitcnt vmcnt(27)
    v_mfma_f32_16x16x32_bf16 v[176:179], v[84:87], v[68:71], v[176:179]
    v_mfma_f32_16x16x32_bf16 v[196:199], v[84:87], v[72:75], v[196:199]
    v_mfma_f32_16x16x32_bf16 v[216:219], v[84:87], v[76:79], v[216:219]
    v_mfma_f32_16x16x32_bf16 v[236:239], v[84:87], v[80:83], v[236:239]
    buffer_load_dwordx4 v[84:87], v8, s[4:7], s33 offen offset:1024 sc1
    v_mfma_f32_16x16x32_bf16 v[180:183], v[88:91], v[68:71], v[180:183]
    v_mfma_f32_16x16x32_bf16 v[200:203], v[88:91], v[72:75], v[200:203]
    v_mfma_f32_16x16x32_bf16 v[220:223], v[88:91], v[76:79], v[220:223]
    v_mfma_f32_16x16x32_bf16 v[240:243], v[88:91], v[80:83], v[240:243]
    buffer_load_dwordx4 v[88:91], v9, s[4:7], s33 offen offset:1024 sc1
    v_mfma_f32_16x16x32_bf16 v[184:187], v[92:95], v[68:71], v[184:187]
    v_mfma_f32_16x16x32_bf16 v[204:207], v[92:95], v[72:75], v[204:207]
    v_mfma_f32_16x16x32_bf16 v[224:227], v[92:95], v[76:79], v[224:227]
    v_mfma_f32_16x16x32_bf16 v[244:247], v[92:95], v[80:83], v[244:247]
    buffer_load_dwordx4 v[92:95], v10, s[4:7], s33 offen offset:1024 sc1
    v_mfma_f32_16x16x32_bf16 v[188:191], v[96:99], v[68:71], v[188:191]
    v_mfma_f32_16x16x32_bf16 v[208:211], v[96:99], v[72:75], v[208:211]
    v_mfma_f32_16x16x32_bf16 v[228:231], v[96:99], v[76:79], v[228:231]
    v_mfma_f32_16x16x32_bf16 v[248:251], v[96:99], v[80:83], v[248:251]
    buffer_load_dwordx4 v[96:99], v11, s[4:7], s33 offen offset:1024 sc1
    v_mfma_f32_16x16x32_bf16 v[192:195], v[100:103], v[68:71], v[192:195]
    buffer_load_dwordx4 v[68:71], v4, s[4:7], s33 offen offset:1024 sc1
    v_mfma_f32_16x16x32_bf16 v[212:215], v[100:103], v[72:75], v[212:215]
    buffer_load_dwordx4 v[72:75], v5, s[4:7], s33 offen offset:1024 sc1
    v_mfma_f32_16x16x32_bf16 v[232:235], v[100:103], v[76:79], v[232:235]
    buffer_load_dwordx4 v[76:79], v6, s[4:7], s33 offen offset:1024 sc1
    v_mfma_f32_16x16x32_bf16 v[252:255], v[100:103], v[80:83], v[252:255]
    buffer_load_dwordx4 v[100:103], v12, s[4:7], s33 offen offset:1024 sc1
    buffer_load_dwordx4 v[80:83], v7, s[4:7], s33 offen offset:1024 sc1
    s_waitcnt vmcnt(27)
    v_mfma_f32_16x16x32_bf16 v[176:179], v[120:123], v[104:107], v[176:179]
    v_mfma_f32_16x16x32_bf16 v[196:199], v[120:123], v[108:111], v[196:199]
    v_mfma_f32_16x16x32_bf16 v[216:219], v[120:123], v[112:115], v[216:219]
    v_mfma_f32_16x16x32_bf16 v[236:239], v[120:123], v[116:119], v[236:239]
    buffer_load_dwordx4 v[120:123], v8, s[4:7], s33 offen offset:2048 sc1
    v_mfma_f32_16x16x32_bf16 v[180:183], v[124:127], v[104:107], v[180:183]
    v_mfma_f32_16x16x32_bf16 v[200:203], v[124:127], v[108:111], v[200:203]
    v_mfma_f32_16x16x32_bf16 v[220:223], v[124:127], v[112:115], v[220:223]
    v_mfma_f32_16x16x32_bf16 v[240:243], v[124:127], v[116:119], v[240:243]
    buffer_load_dwordx4 v[124:127], v9, s[4:7], s33 offen offset:2048 sc1
    v_mfma_f32_16x16x32_bf16 v[184:187], v[128:131], v[104:107], v[184:187]
    v_mfma_f32_16x16x32_bf16 v[204:207], v[128:131], v[108:111], v[204:207]
    v_mfma_f32_16x16x32_bf16 v[224:227], v[128:131], v[112:115], v[224:227]
    v_mfma_f32_16x16x32_bf16 v[244:247], v[128:131], v[116:119], v[244:247]
    buffer_load_dwordx4 v[128:131], v10, s[4:7], s33 offen offset:2048 sc1
    v_mfma_f32_16x16x32_bf16 v[188:191], v[132:135], v[104:107], v[188:191]
    v_mfma_f32_16x16x32_bf16 v[208:211], v[132:135], v[108:111], v[208:211]
    v_mfma_f32_16x16x32_bf16 v[228:231], v[132:135], v[112:115], v[228:231]
    v_mfma_f32_16x16x32_bf16 v[248:251], v[132:135], v[116:119], v[248:251]
    buffer_load_dwordx4 v[132:135], v11, s[4:7], s33 offen offset:2048 sc1
    v_mfma_f32_16x16x32_bf16 v[192:195], v[136:139], v[104:107], v[192:195]
    buffer_load_dwordx4 v[104:107], v4, s[4:7], s33 offen offset:2048 sc1
    v_mfma_f32_16x16x32_bf16 v[212:215], v[136:139], v[108:111], v[212:215]
    buffer_load_dwordx4 v[108:111], v5, s[4:7], s33 offen offset:2048 sc1
    v_mfma_f32_16x16x32_bf16 v[232:235], v[136:139], v[112:115], v[232:235]
    buffer_load_dwordx4 v[112:115], v6, s[4:7], s33 offen offset:2048 sc1
    v_mfma_f32_16x16x32_bf16 v[252:255], v[136:139], v[116:119], v[252:255]
    buffer_load_dwordx4 v[136:139], v12, s[4:7], s33 offen offset:2048 sc1
    buffer_load_dwordx4 v[116:119], v7, s[4:7], s33 offen offset:2048 sc1
    s_waitcnt vmcnt(27)
    v_mfma_f32_16x16x32_bf16 v[176:179], v[156:159], v[140:143], v[176:179]
    v_mfma_f32_16x16x32_bf16 v[196:199], v[156:159], v[144:147], v[196:199]
    v_mfma_f32_16x16x32_bf16 v[216:219], v[156:159], v[148:151], v[216:219]
    v_mfma_f32_16x16x32_bf16 v[236:239], v[156:159], v[152:155], v[236:239]
    buffer_load_dwordx4 v[156:159], v8, s[4:7], s33 offen offset:3072 sc1
    v_mfma_f32_16x16x32_bf16 v[180:183], v[160:163], v[140:143], v[180:183]
    v_mfma_f32_16x16x32_bf16 v[200:203], v[160:163], v[144:147], v[200:203]
    v_mfma_f32_16x16x32_bf16 v[220:223], v[160:163], v[148:151], v[220:223]
    v_mfma_f32_16x16x32_bf16 v[240:243], v[160:163], v[152:155], v[240:243]
    buffer_load_dwordx4 v[160:163], v9, s[4:7], s33 offen offset:3072 sc1
    v_mfma_f32_16x16x32_bf16 v[184:187], v[164:167], v[140:143], v[184:187]
    v_mfma_f32_16x16x32_bf16 v[204:207], v[164:167], v[144:147], v[204:207]
    v_mfma_f32_16x16x32_bf16 v[224:227], v[164:167], v[148:151], v[224:227]
    v_mfma_f32_16x16x32_bf16 v[244:247], v[164:167], v[152:155], v[244:247]
    buffer_load_dwordx4 v[164:167], v10, s[4:7], s33 offen offset:3072 sc1
    v_mfma_f32_16x16x32_bf16 v[188:191], v[168:171], v[140:143], v[188:191]
    v_mfma_f32_16x16x32_bf16 v[208:211], v[168:171], v[144:147], v[208:211]
    v_mfma_f32_16x16x32_bf16 v[228:231], v[168:171], v[148:151], v[228:231]
    v_mfma_f32_16x16x32_bf16 v[248:251], v[168:171], v[152:155], v[248:251]
    buffer_load_dwordx4 v[168:171], v11, s[4:7], s33 offen offset:3072 sc1
    v_mfma_f32_16x16x32_bf16 v[192:195], v[172:175], v[140:143], v[192:195]
    buffer_load_dwordx4 v[140:143], v4, s[4:7], s33 offen offset:3072 sc1
    v_mfma_f32_16x16x32_bf16 v[212:215], v[172:175], v[144:147], v[212:215]
    buffer_load_dwordx4 v[144:147], v5, s[4:7], s33 offen offset:3072 sc1
    v_mfma_f32_16x16x32_bf16 v[232:235], v[172:175], v[148:151], v[232:235]
    buffer_load_dwordx4 v[148:151], v6, s[4:7], s33 offen offset:3072 sc1
    v_mfma_f32_16x16x32_bf16 v[252:255], v[172:175], v[152:155], v[252:255]
    buffer_load_dwordx4 v[172:175], v12, s[4:7], s33 offen offset:3072 sc1
    buffer_load_dwordx4 v[152:155], v7, s[4:7], s33 offen offset:3072 sc1
    s_waitcnt vmcnt(27)
    s_add_u32 s38, s38, 8192
    v_mfma_f32_16x16x32_bf16 v[176:179], v[48:51], v[32:35], v[176:179]
    v_mfma_f32_16x16x32_bf16 v[196:199], v[48:51], v[36:39], v[196:199]
    v_mfma_f32_16x16x32_bf16 v[216:219], v[48:51], v[40:43], v[216:219]
    v_mfma_f32_16x16x32_bf16 v[236:239], v[48:51], v[44:47], v[236:239]
    buffer_load_dwordx4 v[48:51], v8, s[4:7], s38 offen offset:0 sc1
    v_mfma_f32_16x16x32_bf16 v[180:183], v[52:55], v[32:35], v[180:183]
    v_mfma_f32_16x16x32_bf16 v[200:203], v[52:55], v[36:39], v[200:203]
    v_mfma_f32_16x16x32_bf16 v[220:223], v[52:55], v[40:43], v[220:223]
    v_mfma_f32_16x16x32_bf16 v[240:243], v[52:55], v[44:47], v[240:243]
    buffer_load_dwordx4 v[52:55], v9, s[4:7], s38 offen offset:0 sc1
    v_mfma_f32_16x16x32_bf16 v[184:187], v[56:59], v[32:35], v[184:187]
    v_mfma_f32_16x16x32_bf16 v[204:207], v[56:59], v[36:39], v[204:207]
    v_mfma_f32_16x16x32_bf16 v[224:227], v[56:59], v[40:43], v[224:227]
    v_mfma_f32_16x16x32_bf16 v[244:247], v[56:59], v[44:47], v[244:247]
    buffer_load_dwordx4 v[56:59], v10, s[4:7], s38 offen offset:0 sc1
    v_mfma_f32_16x16x32_bf16 v[188:191], v[60:63], v[32:35], v[188:191]
    v_mfma_f32_16x16x32_bf16 v[208:211], v[60:63], v[36:39], v[208:211]
    v_mfma_f32_16x16x32_bf16 v[228:231], v[60:63], v[40:43], v[228:231]
    v_mfma_f32_16x16x32_bf16 v[248:251], v[60:63], v[44:47], v[248:251]
    buffer_load_dwordx4 v[60:63], v11, s[4:7], s38 offen offset:0 sc1
    v_mfma_f32_16x16x32_bf16 v[192:195], v[64:67], v[32:35], v[192:195]
    buffer_load_dwordx4 v[32:35], v4, s[4:7], s38 offen offset:0 sc1
    v_mfma_f32_16x16x32_bf16 v[212:215], v[64:67], v[36:39], v[212:215]
    buffer_load_dwordx4 v[36:39], v5, s[4:7], s38 offen offset:0 sc1
    v_mfma_f32_16x16x32_bf16 v[232:235], v[64:67], v[40:43], v[232:235]
    buffer_load_dwordx4 v[40:43], v6, s[4:7], s38 offen offset:0 sc1
    v_mfma_f32_16x16x32_bf16 v[252:255], v[64:67], v[44:47], v[252:255]
    buffer_load_dwordx4 v[64:67], v12, s[4:7], s38 offen offset:0 sc1
    buffer_load_dwordx4 v[44:47], v7, s[4:7], s38 offen offset:0 sc1
    s_waitcnt vmcnt(27)
    v_mfma_f32_16x16x32_bf16 v[176:179], v[84:87], v[68:71], v[176:179]
    v_mfma_f32_16x16x32_bf16 v[196:199], v[84:87], v[72:75], v[196:199]
    v_mfma_f32_16x16x32_bf16 v[216:219], v[84:87], v[76:79], v[216:219]
    v_mfma_f32_16x16x32_bf16 v[236:239], v[84:87], v[80:83], v[236:239]
    buffer_load_dwordx4 v[84:87], v8, s[4:7], s38 offen offset:1024 sc1
    v_mfma_f32_16x16x32_bf16 v[180:183], v[88:91], v[68:71], v[180:183]
    v_mfma_f32_16x16x32_bf16 v[200:203], v[88:91], v[72:75], v[200:203]
    v_mfma_f32_16x16x32_bf16 v[220:223], v[88:91], v[76:79], v[220:223]
    v_mfma_f32_16x16x32_bf16 v[240:243], v[88:91], v[80:83], v[240:243]
    buffer_load_dwordx4 v[88:91], v9, s[4:7], s38 offen offset:1024 sc1
    v_mfma_f32_16x16x32_bf16 v[184:187], v[92:95], v[68:71], v[184:187]
    v_mfma_f32_16x16x32_bf16 v[204:207], v[92:95], v[72:75], v[204:207]
    v_mfma_f32_16x16x32_bf16 v[224:227], v[92:95], v[76:79], v[224:227]
    v_mfma_f32_16x16x32_bf16 v[244:247], v[92:95], v[80:83], v[244:247]
    buffer_load_dwordx4 v[92:95], v10, s[4:7], s38 offen offset:1024 sc1
    v_mfma_f32_16x16x32_bf16 v[188:191], v[96:99], v[68:71], v[188:191]
    v_mfma_f32_16x16x32_bf16 v[208:211], v[96:99], v[72:75], v[208:211]
    v_mfma_f32_16x16x32_bf16 v[228:231], v[96:99], v[76:79], v[228:231]
    v_mfma_f32_16x16x32_bf16 v[248:251], v[96:99], v[80:83], v[248:251]
    buffer_load_dwordx4 v[96:99], v11, s[4:7], s38 offen offset:1024 sc1
    v_mfma_f32_16x16x32_bf16 v[192:195], v[100:103], v[68:71], v[192:195]
    buffer_load_dwordx4 v[68:71], v4, s[4:7], s38 offen offset:1024 sc1
    v_mfma_f32_16x16x32_bf16 v[212:215], v[100:103], v[72:75], v[212:215]
    buffer_load_dwordx4 v[72:75], v5, s[4:7], s38 offen offset:1024 sc1
    v_mfma_f32_16x16x32_bf16 v[232:235], v[100:103], v[76:79], v[232:235]
    buffer_load_dwordx4 v[76:79], v6, s[4:7], s38 offen offset:1024 sc1
    v_mfma_f32_16x16x32_bf16 v[252:255], v[100:103], v[80:83], v[252:255]
    buffer_load_dwordx4 v[100:103], v12, s[4:7], s38 offen offset:1024 sc1
    buffer_load_dwordx4 v[80:83], v7, s[4:7], s38 offen offset:1024 sc1
    s_waitcnt vmcnt(27)
    v_mfma_f32_16x16x32_bf16 v[176:179], v[120:123], v[104:107], v[176:179]
    v_mfma_f32_16x16x32_bf16 v[196:199], v[120:123], v[108:111], v[196:199]
    v_mfma_f32_16x16x32_bf16 v[216:219], v[120:123], v[112:115], v[216:219]
    v_mfma_f32_16x16x32_bf16 v[236:239], v[120:123], v[116:119], v[236:239]
    buffer_load_dwordx4 v[120:123], v8, s[4:7], s38 offen offset:2048 sc1
    v_mfma_f32_16x16x32_bf16 v[180:183], v[124:127], v[104:107], v[180:183]
    v_mfma_f32_16x16x32_bf16 v[200:203], v[124:127], v[108:111], v[200:203]
    v_mfma_f32_16x16x32_bf16 v[220:223], v[124:127], v[112:115], v[220:223]
    v_mfma_f32_16x16x32_bf16 v[240:243], v[124:127], v[116:119], v[240:243]
    buffer_load_dwordx4 v[124:127], v9, s[4:7], s38 offen offset:2048 sc1
    v_mfma_f32_16x16x32_bf16 v[184:187], v[128:131], v[104:107], v[184:187]
    v_mfma_f32_16x16x32_bf16 v[204:207], v[128:131], v[108:111], v[204:207]
    v_mfma_f32_16x16x32_bf16 v[224:227], v[128:131], v[112:115], v[224:227]
    v_mfma_f32_16x16x32_bf16 v[244:247], v[128:131], v[116:119], v[244:247]
    buffer_load_dwordx4 v[128:131], v10, s[4:7], s38 offen offset:2048 sc1
    v_mfma_f32_16x16x32_bf16 v[188:191], v[132:135], v[104:107], v[188:191]
    v_mfma_f32_16x16x32_bf16 v[208:211], v[132:135], v[108:111], v[208:211]
    v_mfma_f32_16x16x32_bf16 v[228:231], v[132:135], v[112:115], v[228:231]
    v_mfma_f32_16x16x32_bf16 v[248:251], v[132:135], v[116:119], v[248:251]
    buffer_load_dwordx4 v[132:135], v11, s[4:7], s38 offen offset:2048 sc1
    v_mfma_f32_16x16x32_bf16 v[192:195], v[136:139], v[104:107], v[192:195]
    buffer_load_dwordx4 v[104:107], v4, s[4:7], s38 offen offset:2048 sc1
    v_mfma_f32_16x16x32_bf16 v[212:215], v[136:139], v[108:111], v[212:215]
    buffer_load_dwordx4 v[108:111], v5, s[4:7], s38 offen offset:2048 sc1
    v_mfma_f32_16x16x32_bf16 v[232:235], v[136:139], v[112:115], v[232:235]
    buffer_load_dwordx4 v[112:115], v6, s[4:7], s38 offen offset:2048 sc1
    v_mfma_f32_16x16x32_bf16 v[252:255], v[136:139], v[116:119], v[252:255]
    buffer_load_dwordx4 v[136:139], v12, s[4:7], s38 offen offset:2048 sc1
    buffer_load_dwordx4 v[116:119], v7, s[4:7], s38 offen offset:2048 sc1
    s_waitcnt vmcnt(27)
    v_mfma_f32_16x16x32_bf16 v[176:179], v[156:159], v[140:143], v[176:179]
    v_mfma_f32_16x16x32_bf16 v[196:199], v[156:159], v[144:147], v[196:199]
    v_mfma_f32_16x16x32_bf16 v[216:219], v[156:159], v[148:151], v[216:219]
    v_mfma_f32_16x16x32_bf16 v[236:239], v[156:159], v[152:155], v[236:239]
    buffer_load_dwordx4 v[156:159], v8, s[4:7], s38 offen offset:3072 sc1
    v_mfma_f32_16x16x32_bf16 v[180:183], v[160:163], v[140:143], v[180:183]
    v_mfma_f32_16x16x32_bf16 v[200:203], v[160:163], v[144:147], v[200:203]
    v_mfma_f32_16x16x32_bf16 v[220:223], v[160:163], v[148:151], v[220:223]
    v_mfma_f32_16x16x32_bf16 v[240:243], v[160:163], v[152:155], v[240:243]
    buffer_load_dwordx4 v[160:163], v9, s[4:7], s38 offen offset:3072 sc1
    v_mfma_f32_16x16x32_bf16 v[184:187], v[164:167], v[140:143], v[184:187]
    v_mfma_f32_16x16x32_bf16 v[204:207], v[164:167], v[144:147], v[204:207]
    v_mfma_f32_16x16x32_bf16 v[224:227], v[164:167], v[148:151], v[224:227]
    v_mfma_f32_16x16x32_bf16 v[244:247], v[164:167], v[152:155], v[244:247]
    buffer_load_dwordx4 v[164:167], v10, s[4:7], s38 offen offset:3072 sc1
    v_mfma_f32_16x16x32_bf16 v[188:191], v[168:171], v[140:143], v[188:191]
    v_mfma_f32_16x16x32_bf16 v[208:211], v[168:171], v[144:147], v[208:211]
    v_mfma_f32_16x16x32_bf16 v[228:231], v[168:171], v[148:151], v[228:231]
    v_mfma_f32_16x16x32_bf16 v[248:251], v[168:171], v[152:155], v[248:251]
    buffer_load_dwordx4 v[168:171], v11, s[4:7], s38 offen offset:3072 sc1
    v_mfma_f32_16x16x32_bf16 v[192:195], v[172:175], v[140:143], v[192:195]
    buffer_load_dwordx4 v[140:143], v4, s[4:7], s38 offen offset:3072 sc1
    v_mfma_f32_16x16x32_bf16 v[212:215], v[172:175], v[144:147], v[212:215]
    buffer_load_dwordx4 v[144:147], v5, s[4:7], s38 offen offset:3072 sc1
    v_mfma_f32_16x16x32_bf16 v[232:235], v[172:175], v[148:151], v[232:235]
    buffer_load_dwordx4 v[148:151], v6, s[4:7], s38 offen offset:3072 sc1
    v_mfma_f32_16x16x32_bf16 v[252:255], v[172:175], v[152:155], v[252:255]
    buffer_load_dwordx4 v[172:175], v12, s[4:7], s38 offen offset:3072 sc1
    buffer_load_dwordx4 v[152:155], v7, s[4:7], s38 offen offset:3072 sc1
    s_waitcnt vmcnt(27)
    s_add_u32 s33, s33, 8192
    v_mfma_f32_16x16x32_bf16 v[176:179], v[48:51], v[32:35], v[176:179]
    v_mfma_f32_16x16x32_bf16 v[196:199], v[48:51], v[36:39], v[196:199]
    v_mfma_f32_16x16x32_bf16 v[216:219], v[48:51], v[40:43], v[216:219]
    v_mfma_f32_16x16x32_bf16 v[236:239], v[48:51], v[44:47], v[236:239]
    buffer_load_dwordx4 v[48:51], v8, s[4:7], s33 offen offset:0 sc1
    v_mfma_f32_16x16x32_bf16 v[180:183], v[52:55], v[32:35], v[180:183]
    v_mfma_f32_16x16x32_bf16 v[200:203], v[52:55], v[36:39], v[200:203]
    v_mfma_f32_16x16x32_bf16 v[220:223], v[52:55], v[40:43], v[220:223]
    v_mfma_f32_16x16x32_bf16 v[240:243], v[52:55], v[44:47], v[240:243]
    buffer_load_dwordx4 v[52:55], v9, s[4:7], s33 offen offset:0 sc1
    v_mfma_f32_16x16x32_bf16 v[184:187], v[56:59], v[32:35], v[184:187]
    v_mfma_f32_16x16x32_bf16 v[204:207], v[56:59], v[36:39], v[204:207]
    v_mfma_f32_16x16x32_bf16 v[224:227], v[56:59], v[40:43], v[224:227]
    v_mfma_f32_16x16x32_bf16 v[244:247], v[56:59], v[44:47], v[244:247]
    buffer_load_dwordx4 v[56:59], v10, s[4:7], s33 offen offset:0 sc1
    v_mfma_f32_16x16x32_bf16 v[188:191], v[60:63], v[32:35], v[188:191]
    v_mfma_f32_16x16x32_bf16 v[208:211], v[60:63], v[36:39], v[208:211]
    v_mfma_f32_16x16x32_bf16 v[228:231], v[60:63], v[40:43], v[228:231]
    v_mfma_f32_16x16x32_bf16 v[248:251], v[60:63], v[44:47], v[248:251]
    buffer_load_dwordx4 v[60:63], v11, s[4:7], s33 offen offset:0 sc1
    v_mfma_f32_16x16x32_bf16 v[192:195], v[64:67], v[32:35], v[192:195]
    buffer_load_dwordx4 v[32:35], v4, s[4:7], s33 offen offset:0 sc1
    v_mfma_f32_16x16x32_bf16 v[212:215], v[64:67], v[36:39], v[212:215]
    buffer_load_dwordx4 v[36:39], v5, s[4:7], s33 offen offset:0 sc1
    v_mfma_f32_16x16x32_bf16 v[232:235], v[64:67], v[40:43], v[232:235]
    buffer_load_dwordx4 v[40:43], v6, s[4:7], s33 offen offset:0 sc1
    v_mfma_f32_16x16x32_bf16 v[252:255], v[64:67], v[44:47], v[252:255]
    buffer_load_dwordx4 v[64:67], v12, s[4:7], s33 offen offset:0 sc1
    buffer_load_dwordx4 v[44:47], v7, s[4:7], s33 offen offset:0 sc1
    s_waitcnt vmcnt(27)
    v_mfma_f32_16x16x32_bf16 v[176:179], v[84:87], v[68:71], v[176:179]
    v_mfma_f32_16x16x32_bf16 v[196:199], v[84:87], v[72:75], v[196:199]
    v_mfma_f32_16x16x32_bf16 v[216:219], v[84:87], v[76:79], v[216:219]
    v_mfma_f32_16x16x32_bf16 v[236:239], v[84:87], v[80:83], v[236:239]
    buffer_load_dwordx4 v[84:87], v8, s[4:7], s33 offen offset:1024 sc1
    v_mfma_f32_16x16x32_bf16 v[180:183], v[88:91], v[68:71], v[180:183]
    v_mfma_f32_16x16x32_bf16 v[200:203], v[88:91], v[72:75], v[200:203]
    v_mfma_f32_16x16x32_bf16 v[220:223], v[88:91], v[76:79], v[220:223]
    v_mfma_f32_16x16x32_bf16 v[240:243], v[88:91], v[80:83], v[240:243]
    buffer_load_dwordx4 v[88:91], v9, s[4:7], s33 offen offset:1024 sc1
    v_mfma_f32_16x16x32_bf16 v[184:187], v[92:95], v[68:71], v[184:187]
    v_mfma_f32_16x16x32_bf16 v[204:207], v[92:95], v[72:75], v[204:207]
    v_mfma_f32_16x16x32_bf16 v[224:227], v[92:95], v[76:79], v[224:227]
    v_mfma_f32_16x16x32_bf16 v[244:247], v[92:95], v[80:83], v[244:247]
    buffer_load_dwordx4 v[92:95], v10, s[4:7], s33 offen offset:1024 sc1
    v_mfma_f32_16x16x32_bf16 v[188:191], v[96:99], v[68:71], v[188:191]
    v_mfma_f32_16x16x32_bf16 v[208:211], v[96:99], v[72:75], v[208:211]
    v_mfma_f32_16x16x32_bf16 v[228:231], v[96:99], v[76:79], v[228:231]
    v_mfma_f32_16x16x32_bf16 v[248:251], v[96:99], v[80:83], v[248:251]
    buffer_load_dwordx4 v[96:99], v11, s[4:7], s33 offen offset:1024 sc1
    v_mfma_f32_16x16x32_bf16 v[192:195], v[100:103], v[68:71], v[192:195]
    buffer_load_dwordx4 v[68:71], v4, s[4:7], s33 offen offset:1024 sc1
    v_mfma_f32_16x16x32_bf16 v[212:215], v[100:103], v[72:75], v[212:215]
    buffer_load_dwordx4 v[72:75], v5, s[4:7], s33 offen offset:1024 sc1
    v_mfma_f32_16x16x32_bf16 v[232:235], v[100:103], v[76:79], v[232:235]
    buffer_load_dwordx4 v[76:79], v6, s[4:7], s33 offen offset:1024 sc1
    v_mfma_f32_16x16x32_bf16 v[252:255], v[100:103], v[80:83], v[252:255]
    buffer_load_dwordx4 v[100:103], v12, s[4:7], s33 offen offset:1024 sc1
    buffer_load_dwordx4 v[80:83], v7, s[4:7], s33 offen offset:1024 sc1
    s_waitcnt vmcnt(27)
    v_mfma_f32_16x16x32_bf16 v[176:179], v[120:123], v[104:107], v[176:179]
    v_mfma_f32_16x16x32_bf16 v[196:199], v[120:123], v[108:111], v[196:199]
    v_mfma_f32_16x16x32_bf16 v[216:219], v[120:123], v[112:115], v[216:219]
    v_mfma_f32_16x16x32_bf16 v[236:239], v[120:123], v[116:119], v[236:239]
    buffer_load_dwordx4 v[120:123], v8, s[4:7], s33 offen offset:2048 sc1
    v_mfma_f32_16x16x32_bf16 v[180:183], v[124:127], v[104:107], v[180:183]
    v_mfma_f32_16x16x32_bf16 v[200:203], v[124:127], v[108:111], v[200:203]
    v_mfma_f32_16x16x32_bf16 v[220:223], v[124:127], v[112:115], v[220:223]
    v_mfma_f32_16x16x32_bf16 v[240:243], v[124:127], v[116:119], v[240:243]
    buffer_load_dwordx4 v[124:127], v9, s[4:7], s33 offen offset:2048 sc1
    v_mfma_f32_16x16x32_bf16 v[184:187], v[128:131], v[104:107], v[184:187]
    v_mfma_f32_16x16x32_bf16 v[204:207], v[128:131], v[108:111], v[204:207]
    v_mfma_f32_16x16x32_bf16 v[224:227], v[128:131], v[112:115], v[224:227]
    v_mfma_f32_16x16x32_bf16 v[244:247], v[128:131], v[116:119], v[244:247]
    buffer_load_dwordx4 v[128:131], v10, s[4:7], s33 offen offset:2048 sc1
    v_mfma_f32_16x16x32_bf16 v[188:191], v[132:135], v[104:107], v[188:191]
    v_mfma_f32_16x16x32_bf16 v[208:211], v[132:135], v[108:111], v[208:211]
    v_mfma_f32_16x16x32_bf16 v[228:231], v[132:135], v[112:115], v[228:231]
    v_mfma_f32_16x16x32_bf16 v[248:251], v[132:135], v[116:119], v[248:251]
    buffer_load_dwordx4 v[132:135], v11, s[4:7], s33 offen offset:2048 sc1
    v_mfma_f32_16x16x32_bf16 v[192:195], v[136:139], v[104:107], v[192:195]
    buffer_load_dwordx4 v[104:107], v4, s[4:7], s33 offen offset:2048 sc1
    v_mfma_f32_16x16x32_bf16 v[212:215], v[136:139], v[108:111], v[212:215]
    buffer_load_dwordx4 v[108:111], v5, s[4:7], s33 offen offset:2048 sc1
    v_mfma_f32_16x16x32_bf16 v[232:235], v[136:139], v[112:115], v[232:235]
    buffer_load_dwordx4 v[112:115], v6, s[4:7], s33 offen offset:2048 sc1
    v_mfma_f32_16x16x32_bf16 v[252:255], v[136:139], v[116:119], v[252:255]
    buffer_load_dwordx4 v[136:139], v12, s[4:7], s33 offen offset:2048 sc1
    buffer_load_dwordx4 v[116:119], v7, s[4:7], s33 offen offset:2048 sc1
    s_waitcnt vmcnt(27)
    v_mfma_f32_16x16x32_bf16 v[176:179], v[156:159], v[140:143], v[176:179]
    v_mfma_f32_16x16x32_bf16 v[196:199], v[156:159], v[144:147], v[196:199]
    v_mfma_f32_16x16x32_bf16 v[216:219], v[156:159], v[148:151], v[216:219]
    v_mfma_f32_16x16x32_bf16 v[236:239], v[156:159], v[152:155], v[236:239]
    buffer_load_dwordx4 v[156:159], v8, s[4:7], s33 offen offset:3072 sc1
    v_mfma_f32_16x16x32_bf16 v[180:183], v[160:163], v[140:143], v[180:183]
    v_mfma_f32_16x16x32_bf16 v[200:203], v[160:163], v[144:147], v[200:203]
    v_mfma_f32_16x16x32_bf16 v[220:223], v[160:163], v[148:151], v[220:223]
    v_mfma_f32_16x16x32_bf16 v[240:243], v[160:163], v[152:155], v[240:243]
    buffer_load_dwordx4 v[160:163], v9, s[4:7], s33 offen offset:3072 sc1
    v_mfma_f32_16x16x32_bf16 v[184:187], v[164:167], v[140:143], v[184:187]
    v_mfma_f32_16x16x32_bf16 v[204:207], v[164:167], v[144:147], v[204:207]
    v_mfma_f32_16x16x32_bf16 v[224:227], v[164:167], v[148:151], v[224:227]
    v_mfma_f32_16x16x32_bf16 v[244:247], v[164:167], v[152:155], v[244:247]
    buffer_load_dwordx4 v[164:167], v10, s[4:7], s33 offen offset:3072 sc1
    v_mfma_f32_16x16x32_bf16 v[188:191], v[168:171], v[140:143], v[188:191]
    v_mfma_f32_16x16x32_bf16 v[208:211], v[168:171], v[144:147], v[208:211]
    v_mfma_f32_16x16x32_bf16 v[228:231], v[168:171], v[148:151], v[228:231]
    v_mfma_f32_16x16x32_bf16 v[248:251], v[168:171], v[152:155], v[248:251]
    buffer_load_dwordx4 v[168:171], v11, s[4:7], s33 offen offset:3072 sc1
    v_mfma_f32_16x16x32_bf16 v[192:195], v[172:175], v[140:143], v[192:195]
    buffer_load_dwordx4 v[140:143], v4, s[4:7], s33 offen offset:3072 sc1
    v_mfma_f32_16x16x32_bf16 v[212:215], v[172:175], v[144:147], v[212:215]
    buffer_load_dwordx4 v[144:147], v5, s[4:7], s33 offen offset:3072 sc1
    v_mfma_f32_16x16x32_bf16 v[232:235], v[172:175], v[148:151], v[232:235]
    buffer_load_dwordx4 v[148:151], v6, s[4:7], s33 offen offset:3072 sc1
    v_mfma_f32_16x16x32_bf16 v[252:255], v[172:175], v[152:155], v[252:255]
    buffer_load_dwordx4 v[172:175], v12, s[4:7], s33 offen offset:3072 sc1
    buffer_load_dwordx4 v[152:155], v7, s[4:7], s33 offen offset:3072 sc1
    s_waitcnt vmcnt(27)
    s_add_u32 s38, s38, 8192
    v_mfma_f32_16x16x32_bf16 v[176:179], v[48:51], v[32:35], v[176:179]
    v_mfma_f32_16x16x32_bf16 v[196:199], v[48:51], v[36:39], v[196:199]
    v_mfma_f32_16x16x32_bf16 v[216:219], v[48:51], v[40:43], v[216:219]
    v_mfma_f32_16x16x32_bf16 v[236:239], v[48:51], v[44:47], v[236:239]
    buffer_load_dwordx4 v[48:51], v8, s[4:7], s38 offen offset:0 sc1
    v_mfma_f32_16x16x32_bf16 v[180:183], v[52:55], v[32:35], v[180:183]
    v_mfma_f32_16x16x32_bf16 v[200:203], v[52:55], v[36:39], v[200:203]
    v_mfma_f32_16x16x32_bf16 v[220:223], v[52:55], v[40:43], v[220:223]
    v_mfma_f32_16x16x32_bf16 v[240:243], v[52:55], v[44:47], v[240:243]
    buffer_load_dwordx4 v[52:55], v9, s[4:7], s38 offen offset:0 sc1
    v_mfma_f32_16x16x32_bf16 v[184:187], v[56:59], v[32:35], v[184:187]
    v_mfma_f32_16x16x32_bf16 v[204:207], v[56:59], v[36:39], v[204:207]
    v_mfma_f32_16x16x32_bf16 v[224:227], v[56:59], v[40:43], v[224:227]
    v_mfma_f32_16x16x32_bf16 v[244:247], v[56:59], v[44:47], v[244:247]
    buffer_load_dwordx4 v[56:59], v10, s[4:7], s38 offen offset:0 sc1
    v_mfma_f32_16x16x32_bf16 v[188:191], v[60:63], v[32:35], v[188:191]
    v_mfma_f32_16x16x32_bf16 v[208:211], v[60:63], v[36:39], v[208:211]
    v_mfma_f32_16x16x32_bf16 v[228:231], v[60:63], v[40:43], v[228:231]
    v_mfma_f32_16x16x32_bf16 v[248:251], v[60:63], v[44:47], v[248:251]
    buffer_load_dwordx4 v[60:63], v11, s[4:7], s38 offen offset:0 sc1
    v_mfma_f32_16x16x32_bf16 v[192:195], v[64:67], v[32:35], v[192:195]
    buffer_load_dwordx4 v[32:35], v4, s[4:7], s38 offen offset:0 sc1
    v_mfma_f32_16x16x32_bf16 v[212:215], v[64:67], v[36:39], v[212:215]
    buffer_load_dwordx4 v[36:39], v5, s[4:7], s38 offen offset:0 sc1
    v_mfma_f32_16x16x32_bf16 v[232:235], v[64:67], v[40:43], v[232:235]
    buffer_load_dwordx4 v[40:43], v6, s[4:7], s38 offen offset:0 sc1
    v_mfma_f32_16x16x32_bf16 v[252:255], v[64:67], v[44:47], v[252:255]
    buffer_load_dwordx4 v[64:67], v12, s[4:7], s38 offen offset:0 sc1
    buffer_load_dwordx4 v[44:47], v7, s[4:7], s38 offen offset:0 sc1
    s_waitcnt vmcnt(27)
    v_mfma_f32_16x16x32_bf16 v[176:179], v[84:87], v[68:71], v[176:179]
    v_mfma_f32_16x16x32_bf16 v[196:199], v[84:87], v[72:75], v[196:199]
    v_mfma_f32_16x16x32_bf16 v[216:219], v[84:87], v[76:79], v[216:219]
    v_mfma_f32_16x16x32_bf16 v[236:239], v[84:87], v[80:83], v[236:239]
    buffer_load_dwordx4 v[84:87], v8, s[4:7], s38 offen offset:1024 sc1
    v_mfma_f32_16x16x32_bf16 v[180:183], v[88:91], v[68:71], v[180:183]
    v_mfma_f32_16x16x32_bf16 v[200:203], v[88:91], v[72:75], v[200:203]
    v_mfma_f32_16x16x32_bf16 v[220:223], v[88:91], v[76:79], v[220:223]
    v_mfma_f32_16x16x32_bf16 v[240:243], v[88:91], v[80:83], v[240:243]
    buffer_load_dwordx4 v[88:91], v9, s[4:7], s38 offen offset:1024 sc1
    v_mfma_f32_16x16x32_bf16 v[184:187], v[92:95], v[68:71], v[184:187]
    v_mfma_f32_16x16x32_bf16 v[204:207], v[92:95], v[72:75], v[204:207]
    v_mfma_f32_16x16x32_bf16 v[224:227], v[92:95], v[76:79], v[224:227]
    v_mfma_f32_16x16x32_bf16 v[244:247], v[92:95], v[80:83], v[244:247]
    buffer_load_dwordx4 v[92:95], v10, s[4:7], s38 offen offset:1024 sc1
    v_mfma_f32_16x16x32_bf16 v[188:191], v[96:99], v[68:71], v[188:191]
    v_mfma_f32_16x16x32_bf16 v[208:211], v[96:99], v[72:75], v[208:211]
    v_mfma_f32_16x16x32_bf16 v[228:231], v[96:99], v[76:79], v[228:231]
    v_mfma_f32_16x16x32_bf16 v[248:251], v[96:99], v[80:83], v[248:251]
    buffer_load_dwordx4 v[96:99], v11, s[4:7], s38 offen offset:1024 sc1
    v_mfma_f32_16x16x32_bf16 v[192:195], v[100:103], v[68:71], v[192:195]
    buffer_load_dwordx4 v[68:71], v4, s[4:7], s38 offen offset:1024 sc1
    v_mfma_f32_16x16x32_bf16 v[212:215], v[100:103], v[72:75], v[212:215]
    buffer_load_dwordx4 v[72:75], v5, s[4:7], s38 offen offset:1024 sc1
    v_mfma_f32_16x16x32_bf16 v[232:235], v[100:103], v[76:79], v[232:235]
    buffer_load_dwordx4 v[76:79], v6, s[4:7], s38 offen offset:1024 sc1
    v_mfma_f32_16x16x32_bf16 v[252:255], v[100:103], v[80:83], v[252:255]
    buffer_load_dwordx4 v[100:103], v12, s[4:7], s38 offen offset:1024 sc1
    buffer_load_dwordx4 v[80:83], v7, s[4:7], s38 offen offset:1024 sc1
    s_waitcnt vmcnt(27)
    v_mfma_f32_16x16x32_bf16 v[176:179], v[120:123], v[104:107], v[176:179]
    v_mfma_f32_16x16x32_bf16 v[196:199], v[120:123], v[108:111], v[196:199]
    v_mfma_f32_16x16x32_bf16 v[216:219], v[120:123], v[112:115], v[216:219]
    v_mfma_f32_16x16x32_bf16 v[236:239], v[120:123], v[116:119], v[236:239]
    buffer_load_dwordx4 v[120:123], v8, s[4:7], s38 offen offset:2048 sc1
    v_mfma_f32_16x16x32_bf16 v[180:183], v[124:127], v[104:107], v[180:183]
    v_mfma_f32_16x16x32_bf16 v[200:203], v[124:127], v[108:111], v[200:203]
    v_mfma_f32_16x16x32_bf16 v[220:223], v[124:127], v[112:115], v[220:223]
    v_mfma_f32_16x16x32_bf16 v[240:243], v[124:127], v[116:119], v[240:243]
    buffer_load_dwordx4 v[124:127], v9, s[4:7], s38 offen offset:2048 sc1
    v_mfma_f32_16x16x32_bf16 v[184:187], v[128:131], v[104:107], v[184:187]
    v_mfma_f32_16x16x32_bf16 v[204:207], v[128:131], v[108:111], v[204:207]
    v_mfma_f32_16x16x32_bf16 v[224:227], v[128:131], v[112:115], v[224:227]
    v_mfma_f32_16x16x32_bf16 v[244:247], v[128:131], v[116:119], v[244:247]
    buffer_load_dwordx4 v[128:131], v10, s[4:7], s38 offen offset:2048 sc1
    v_mfma_f32_16x16x32_bf16 v[188:191], v[132:135], v[104:107], v[188:191]
    v_mfma_f32_16x16x32_bf16 v[208:211], v[132:135], v[108:111], v[208:211]
    v_mfma_f32_16x16x32_bf16 v[228:231], v[132:135], v[112:115], v[228:231]
    v_mfma_f32_16x16x32_bf16 v[248:251], v[132:135], v[116:119], v[248:251]
    buffer_load_dwordx4 v[132:135], v11, s[4:7], s38 offen offset:2048 sc1
    v_mfma_f32_16x16x32_bf16 v[192:195], v[136:139], v[104:107], v[192:195]
    buffer_load_dwordx4 v[104:107], v4, s[4:7], s38 offen offset:2048 sc1
    v_mfma_f32_16x16x32_bf16 v[212:215], v[136:139], v[108:111], v[212:215]
    buffer_load_dwordx4 v[108:111], v5, s[4:7], s38 offen offset:2048 sc1
    v_mfma_f32_16x16x32_bf16 v[232:235], v[136:139], v[112:115], v[232:235]
    buffer_load_dwordx4 v[112:115], v6, s[4:7], s38 offen offset:2048 sc1
    v_mfma_f32_16x16x32_bf16 v[252:255], v[136:139], v[116:119], v[252:255]
    buffer_load_dwordx4 v[136:139], v12, s[4:7], s38 offen offset:2048 sc1
    buffer_load_dwordx4 v[116:119], v7, s[4:7], s38 offen offset:2048 sc1
    s_waitcnt vmcnt(27)
    v_mfma_f32_16x16x32_bf16 v[176:179], v[156:159], v[140:143], v[176:179]
    v_mfma_f32_16x16x32_bf16 v[196:199], v[156:159], v[144:147], v[196:199]
    v_mfma_f32_16x16x32_bf16 v[216:219], v[156:159], v[148:151], v[216:219]
    v_mfma_f32_16x16x32_bf16 v[236:239], v[156:159], v[152:155], v[236:239]
    buffer_load_dwordx4 v[156:159], v8, s[4:7], s38 offen offset:3072 sc1
    v_mfma_f32_16x16x32_bf16 v[180:183], v[160:163], v[140:143], v[180:183]
    v_mfma_f32_16x16x32_bf16 v[200:203], v[160:163], v[144:147], v[200:203]
    v_mfma_f32_16x16x32_bf16 v[220:223], v[160:163], v[148:151], v[220:223]
    v_mfma_f32_16x16x32_bf16 v[240:243], v[160:163], v[152:155], v[240:243]
    buffer_load_dwordx4 v[160:163], v9, s[4:7], s38 offen offset:3072 sc1
    v_mfma_f32_16x16x32_bf16 v[184:187], v[164:167], v[140:143], v[184:187]
    v_mfma_f32_16x16x32_bf16 v[204:207], v[164:167], v[144:147], v[204:207]
    v_mfma_f32_16x16x32_bf16 v[224:227], v[164:167], v[148:151], v[224:227]
    v_mfma_f32_16x16x32_bf16 v[244:247], v[164:167], v[152:155], v[244:247]
    buffer_load_dwordx4 v[164:167], v10, s[4:7], s38 offen offset:3072 sc1
    v_mfma_f32_16x16x32_bf16 v[188:191], v[168:171], v[140:143], v[188:191]
    v_mfma_f32_16x16x32_bf16 v[208:211], v[168:171], v[144:147], v[208:211]
    v_mfma_f32_16x16x32_bf16 v[228:231], v[168:171], v[148:151], v[228:231]
    v_mfma_f32_16x16x32_bf16 v[248:251], v[168:171], v[152:155], v[248:251]
    buffer_load_dwordx4 v[168:171], v11, s[4:7], s38 offen offset:3072 sc1
    v_mfma_f32_16x16x32_bf16 v[192:195], v[172:175], v[140:143], v[192:195]
    buffer_load_dwordx4 v[140:143], v4, s[4:7], s38 offen offset:3072 sc1
    v_mfma_f32_16x16x32_bf16 v[212:215], v[172:175], v[144:147], v[212:215]
    buffer_load_dwordx4 v[144:147], v5, s[4:7], s38 offen offset:3072 sc1
    v_mfma_f32_16x16x32_bf16 v[232:235], v[172:175], v[148:151], v[232:235]
    buffer_load_dwordx4 v[148:151], v6, s[4:7], s38 offen offset:3072 sc1
    v_mfma_f32_16x16x32_bf16 v[252:255], v[172:175], v[152:155], v[252:255]
    buffer_load_dwordx4 v[172:175], v12, s[4:7], s38 offen offset:3072 sc1
    buffer_load_dwordx4 v[152:155], v7, s[4:7], s38 offen offset:3072 sc1
    s_waitcnt vmcnt(27)
    s_add_u32 s33, s33, 8192
    v_mfma_f32_16x16x32_bf16 v[176:179], v[48:51], v[32:35], v[176:179]
    v_mfma_f32_16x16x32_bf16 v[196:199], v[48:51], v[36:39], v[196:199]
    v_mfma_f32_16x16x32_bf16 v[216:219], v[48:51], v[40:43], v[216:219]
    v_mfma_f32_16x16x32_bf16 v[236:239], v[48:51], v[44:47], v[236:239]
    buffer_load_dwordx4 v[48:51], v8, s[4:7], s33 offen offset:0 sc1
    v_mfma_f32_16x16x32_bf16 v[180:183], v[52:55], v[32:35], v[180:183]
    v_mfma_f32_16x16x32_bf16 v[200:203], v[52:55], v[36:39], v[200:203]
    v_mfma_f32_16x16x32_bf16 v[220:223], v[52:55], v[40:43], v[220:223]
    v_mfma_f32_16x16x32_bf16 v[240:243], v[52:55], v[44:47], v[240:243]
    buffer_load_dwordx4 v[52:55], v9, s[4:7], s33 offen offset:0 sc1
    v_mfma_f32_16x16x32_bf16 v[184:187], v[56:59], v[32:35], v[184:187]
    v_mfma_f32_16x16x32_bf16 v[204:207], v[56:59], v[36:39], v[204:207]
    v_mfma_f32_16x16x32_bf16 v[224:227], v[56:59], v[40:43], v[224:227]
    v_mfma_f32_16x16x32_bf16 v[244:247], v[56:59], v[44:47], v[244:247]
    buffer_load_dwordx4 v[56:59], v10, s[4:7], s33 offen offset:0 sc1
    v_mfma_f32_16x16x32_bf16 v[188:191], v[60:63], v[32:35], v[188:191]
    v_mfma_f32_16x16x32_bf16 v[208:211], v[60:63], v[36:39], v[208:211]
    v_mfma_f32_16x16x32_bf16 v[228:231], v[60:63], v[40:43], v[228:231]
    v_mfma_f32_16x16x32_bf16 v[248:251], v[60:63], v[44:47], v[248:251]
    buffer_load_dwordx4 v[60:63], v11, s[4:7], s33 offen offset:0 sc1
    v_mfma_f32_16x16x32_bf16 v[192:195], v[64:67], v[32:35], v[192:195]
    buffer_load_dwordx4 v[32:35], v4, s[4:7], s33 offen offset:0 sc1
    v_mfma_f32_16x16x32_bf16 v[212:215], v[64:67], v[36:39], v[212:215]
    buffer_load_dwordx4 v[36:39], v5, s[4:7], s33 offen offset:0 sc1
    v_mfma_f32_16x16x32_bf16 v[232:235], v[64:67], v[40:43], v[232:235]
    buffer_load_dwordx4 v[40:43], v6, s[4:7], s33 offen offset:0 sc1
    v_mfma_f32_16x16x32_bf16 v[252:255], v[64:67], v[44:47], v[252:255]
    buffer_load_dwordx4 v[64:67], v12, s[4:7], s33 offen offset:0 sc1
    buffer_load_dwordx4 v[44:47], v7, s[4:7], s33 offen offset:0 sc1
    s_waitcnt vmcnt(27)
    v_mfma_f32_16x16x32_bf16 v[176:179], v[84:87], v[68:71], v[176:179]
    v_mfma_f32_16x16x32_bf16 v[196:199], v[84:87], v[72:75], v[196:199]
    v_mfma_f32_16x16x32_bf16 v[216:219], v[84:87], v[76:79], v[216:219]
    v_mfma_f32_16x16x32_bf16 v[236:239], v[84:87], v[80:83], v[236:239]
    buffer_load_dwordx4 v[84:87], v8, s[4:7], s33 offen offset:1024 sc1
    v_mfma_f32_16x16x32_bf16 v[180:183], v[88:91], v[68:71], v[180:183]
    v_mfma_f32_16x16x32_bf16 v[200:203], v[88:91], v[72:75], v[200:203]
    v_mfma_f32_16x16x32_bf16 v[220:223], v[88:91], v[76:79], v[220:223]
    v_mfma_f32_16x16x32_bf16 v[240:243], v[88:91], v[80:83], v[240:243]
    buffer_load_dwordx4 v[88:91], v9, s[4:7], s33 offen offset:1024 sc1
    v_mfma_f32_16x16x32_bf16 v[184:187], v[92:95], v[68:71], v[184:187]
    v_mfma_f32_16x16x32_bf16 v[204:207], v[92:95], v[72:75], v[204:207]
    v_mfma_f32_16x16x32_bf16 v[224:227], v[92:95], v[76:79], v[224:227]
    v_mfma_f32_16x16x32_bf16 v[244:247], v[92:95], v[80:83], v[244:247]
    buffer_load_dwordx4 v[92:95], v10, s[4:7], s33 offen offset:1024 sc1
    v_mfma_f32_16x16x32_bf16 v[188:191], v[96:99], v[68:71], v[188:191]
    v_mfma_f32_16x16x32_bf16 v[208:211], v[96:99], v[72:75], v[208:211]
    v_mfma_f32_16x16x32_bf16 v[228:231], v[96:99], v[76:79], v[228:231]
    v_mfma_f32_16x16x32_bf16 v[248:251], v[96:99], v[80:83], v[248:251]
    buffer_load_dwordx4 v[96:99], v11, s[4:7], s33 offen offset:1024 sc1
    v_mfma_f32_16x16x32_bf16 v[192:195], v[100:103], v[68:71], v[192:195]
    buffer_load_dwordx4 v[68:71], v4, s[4:7], s33 offen offset:1024 sc1
    v_mfma_f32_16x16x32_bf16 v[212:215], v[100:103], v[72:75], v[212:215]
    buffer_load_dwordx4 v[72:75], v5, s[4:7], s33 offen offset:1024 sc1
    v_mfma_f32_16x16x32_bf16 v[232:235], v[100:103], v[76:79], v[232:235]
    buffer_load_dwordx4 v[76:79], v6, s[4:7], s33 offen offset:1024 sc1
    v_mfma_f32_16x16x32_bf16 v[252:255], v[100:103], v[80:83], v[252:255]
    buffer_load_dwordx4 v[100:103], v12, s[4:7], s33 offen offset:1024 sc1
    buffer_load_dwordx4 v[80:83], v7, s[4:7], s33 offen offset:1024 sc1
    s_waitcnt vmcnt(27)
    v_mfma_f32_16x16x32_bf16 v[176:179], v[120:123], v[104:107], v[176:179]
    v_mfma_f32_16x16x32_bf16 v[196:199], v[120:123], v[108:111], v[196:199]
    v_mfma_f32_16x16x32_bf16 v[216:219], v[120:123], v[112:115], v[216:219]
    v_mfma_f32_16x16x32_bf16 v[236:239], v[120:123], v[116:119], v[236:239]
    buffer_load_dwordx4 v[120:123], v8, s[4:7], s33 offen offset:2048 sc1
    v_mfma_f32_16x16x32_bf16 v[180:183], v[124:127], v[104:107], v[180:183]
    v_mfma_f32_16x16x32_bf16 v[200:203], v[124:127], v[108:111], v[200:203]
    v_mfma_f32_16x16x32_bf16 v[220:223], v[124:127], v[112:115], v[220:223]
    v_mfma_f32_16x16x32_bf16 v[240:243], v[124:127], v[116:119], v[240:243]
    buffer_load_dwordx4 v[124:127], v9, s[4:7], s33 offen offset:2048 sc1
    v_mfma_f32_16x16x32_bf16 v[184:187], v[128:131], v[104:107], v[184:187]
    v_mfma_f32_16x16x32_bf16 v[204:207], v[128:131], v[108:111], v[204:207]
    v_mfma_f32_16x16x32_bf16 v[224:227], v[128:131], v[112:115], v[224:227]
    v_mfma_f32_16x16x32_bf16 v[244:247], v[128:131], v[116:119], v[244:247]
    buffer_load_dwordx4 v[128:131], v10, s[4:7], s33 offen offset:2048 sc1
    v_mfma_f32_16x16x32_bf16 v[188:191], v[132:135], v[104:107], v[188:191]
    v_mfma_f32_16x16x32_bf16 v[208:211], v[132:135], v[108:111], v[208:211]
    v_mfma_f32_16x16x32_bf16 v[228:231], v[132:135], v[112:115], v[228:231]
    v_mfma_f32_16x16x32_bf16 v[248:251], v[132:135], v[116:119], v[248:251]
    buffer_load_dwordx4 v[132:135], v11, s[4:7], s33 offen offset:2048 sc1
    v_mfma_f32_16x16x32_bf16 v[192:195], v[136:139], v[104:107], v[192:195]
    buffer_load_dwordx4 v[104:107], v4, s[4:7], s33 offen offset:2048 sc1
    v_mfma_f32_16x16x32_bf16 v[212:215], v[136:139], v[108:111], v[212:215]
    buffer_load_dwordx4 v[108:111], v5, s[4:7], s33 offen offset:2048 sc1
    v_mfma_f32_16x16x32_bf16 v[232:235], v[136:139], v[112:115], v[232:235]
    buffer_load_dwordx4 v[112:115], v6, s[4:7], s33 offen offset:2048 sc1
    v_mfma_f32_16x16x32_bf16 v[252:255], v[136:139], v[116:119], v[252:255]
    buffer_load_dwordx4 v[136:139], v12, s[4:7], s33 offen offset:2048 sc1
    buffer_load_dwordx4 v[116:119], v7, s[4:7], s33 offen offset:2048 sc1
    s_waitcnt vmcnt(27)
    v_mfma_f32_16x16x32_bf16 v[176:179], v[156:159], v[140:143], v[176:179]
    v_mfma_f32_16x16x32_bf16 v[196:199], v[156:159], v[144:147], v[196:199]
    v_mfma_f32_16x16x32_bf16 v[216:219], v[156:159], v[148:151], v[216:219]
    v_mfma_f32_16x16x32_bf16 v[236:239], v[156:159], v[152:155], v[236:239]
    buffer_load_dwordx4 v[156:159], v8, s[4:7], s33 offen offset:3072 sc1
    v_mfma_f32_16x16x32_bf16 v[180:183], v[160:163], v[140:143], v[180:183]
    v_mfma_f32_16x16x32_bf16 v[200:203], v[160:163], v[144:147], v[200:203]
    v_mfma_f32_16x16x32_bf16 v[220:223], v[160:163], v[148:151], v[220:223]
    v_mfma_f32_16x16x32_bf16 v[240:243], v[160:163], v[152:155], v[240:243]
    buffer_load_dwordx4 v[160:163], v9, s[4:7], s33 offen offset:3072 sc1
    v_mfma_f32_16x16x32_bf16 v[184:187], v[164:167], v[140:143], v[184:187]
    v_mfma_f32_16x16x32_bf16 v[204:207], v[164:167], v[144:147], v[204:207]
    v_mfma_f32_16x16x32_bf16 v[224:227], v[164:167], v[148:151], v[224:227]
    v_mfma_f32_16x16x32_bf16 v[244:247], v[164:167], v[152:155], v[244:247]
    buffer_load_dwordx4 v[164:167], v10, s[4:7], s33 offen offset:3072 sc1
    v_mfma_f32_16x16x32_bf16 v[188:191], v[168:171], v[140:143], v[188:191]
    v_mfma_f32_16x16x32_bf16 v[208:211], v[168:171], v[144:147], v[208:211]
    v_mfma_f32_16x16x32_bf16 v[228:231], v[168:171], v[148:151], v[228:231]
    v_mfma_f32_16x16x32_bf16 v[248:251], v[168:171], v[152:155], v[248:251]
    buffer_load_dwordx4 v[168:171], v11, s[4:7], s33 offen offset:3072 sc1
    v_mfma_f32_16x16x32_bf16 v[192:195], v[172:175], v[140:143], v[192:195]
    buffer_load_dwordx4 v[140:143], v4, s[4:7], s33 offen offset:3072 sc1
    v_mfma_f32_16x16x32_bf16 v[212:215], v[172:175], v[144:147], v[212:215]
    buffer_load_dwordx4 v[144:147], v5, s[4:7], s33 offen offset:3072 sc1
    v_mfma_f32_16x16x32_bf16 v[232:235], v[172:175], v[148:151], v[232:235]
    buffer_load_dwordx4 v[148:151], v6, s[4:7], s33 offen offset:3072 sc1
    v_mfma_f32_16x16x32_bf16 v[252:255], v[172:175], v[152:155], v[252:255]
    buffer_load_dwordx4 v[172:175], v12, s[4:7], s33 offen offset:3072 sc1
    buffer_load_dwordx4 v[152:155], v7, s[4:7], s33 offen offset:3072 sc1
    s_waitcnt vmcnt(27)
    s_add_u32 s38, s38, 8192
    v_mfma_f32_16x16x32_bf16 v[176:179], v[48:51], v[32:35], v[176:179]
    v_mfma_f32_16x16x32_bf16 v[196:199], v[48:51], v[36:39], v[196:199]
    v_mfma_f32_16x16x32_bf16 v[216:219], v[48:51], v[40:43], v[216:219]
    v_mfma_f32_16x16x32_bf16 v[236:239], v[48:51], v[44:47], v[236:239]
    buffer_load_dwordx4 v[48:51], v8, s[4:7], s38 offen offset:0 sc1
    v_mfma_f32_16x16x32_bf16 v[180:183], v[52:55], v[32:35], v[180:183]
    v_mfma_f32_16x16x32_bf16 v[200:203], v[52:55], v[36:39], v[200:203]
    v_mfma_f32_16x16x32_bf16 v[220:223], v[52:55], v[40:43], v[220:223]
    v_mfma_f32_16x16x32_bf16 v[240:243], v[52:55], v[44:47], v[240:243]
    buffer_load_dwordx4 v[52:55], v9, s[4:7], s38 offen offset:0 sc1
    v_mfma_f32_16x16x32_bf16 v[184:187], v[56:59], v[32:35], v[184:187]
    v_mfma_f32_16x16x32_bf16 v[204:207], v[56:59], v[36:39], v[204:207]
    v_mfma_f32_16x16x32_bf16 v[224:227], v[56:59], v[40:43], v[224:227]
    v_mfma_f32_16x16x32_bf16 v[244:247], v[56:59], v[44:47], v[244:247]
    buffer_load_dwordx4 v[56:59], v10, s[4:7], s38 offen offset:0 sc1
    v_mfma_f32_16x16x32_bf16 v[188:191], v[60:63], v[32:35], v[188:191]
    v_mfma_f32_16x16x32_bf16 v[208:211], v[60:63], v[36:39], v[208:211]
    v_mfma_f32_16x16x32_bf16 v[228:231], v[60:63], v[40:43], v[228:231]
    v_mfma_f32_16x16x32_bf16 v[248:251], v[60:63], v[44:47], v[248:251]
    buffer_load_dwordx4 v[60:63], v11, s[4:7], s38 offen offset:0 sc1
    v_mfma_f32_16x16x32_bf16 v[192:195], v[64:67], v[32:35], v[192:195]
    buffer_load_dwordx4 v[32:35], v4, s[4:7], s38 offen offset:0 sc1
    v_mfma_f32_16x16x32_bf16 v[212:215], v[64:67], v[36:39], v[212:215]
    buffer_load_dwordx4 v[36:39], v5, s[4:7], s38 offen offset:0 sc1
    v_mfma_f32_16x16x32_bf16 v[232:235], v[64:67], v[40:43], v[232:235]
    buffer_load_dwordx4 v[40:43], v6, s[4:7], s38 offen offset:0 sc1
    v_mfma_f32_16x16x32_bf16 v[252:255], v[64:67], v[44:47], v[252:255]
    buffer_load_dwordx4 v[64:67], v12, s[4:7], s38 offen offset:0 sc1
    buffer_load_dwordx4 v[44:47], v7, s[4:7], s38 offen offset:0 sc1
    s_waitcnt vmcnt(27)
    v_mfma_f32_16x16x32_bf16 v[176:179], v[84:87], v[68:71], v[176:179]
    v_mfma_f32_16x16x32_bf16 v[196:199], v[84:87], v[72:75], v[196:199]
    v_mfma_f32_16x16x32_bf16 v[216:219], v[84:87], v[76:79], v[216:219]
    v_mfma_f32_16x16x32_bf16 v[236:239], v[84:87], v[80:83], v[236:239]
    buffer_load_dwordx4 v[84:87], v8, s[4:7], s38 offen offset:1024 sc1
    v_mfma_f32_16x16x32_bf16 v[180:183], v[88:91], v[68:71], v[180:183]
    v_mfma_f32_16x16x32_bf16 v[200:203], v[88:91], v[72:75], v[200:203]
    v_mfma_f32_16x16x32_bf16 v[220:223], v[88:91], v[76:79], v[220:223]
    v_mfma_f32_16x16x32_bf16 v[240:243], v[88:91], v[80:83], v[240:243]
    buffer_load_dwordx4 v[88:91], v9, s[4:7], s38 offen offset:1024 sc1
    v_mfma_f32_16x16x32_bf16 v[184:187], v[92:95], v[68:71], v[184:187]
    v_mfma_f32_16x16x32_bf16 v[204:207], v[92:95], v[72:75], v[204:207]
    v_mfma_f32_16x16x32_bf16 v[224:227], v[92:95], v[76:79], v[224:227]
    v_mfma_f32_16x16x32_bf16 v[244:247], v[92:95], v[80:83], v[244:247]
    buffer_load_dwordx4 v[92:95], v10, s[4:7], s38 offen offset:1024 sc1
    v_mfma_f32_16x16x32_bf16 v[188:191], v[96:99], v[68:71], v[188:191]
    v_mfma_f32_16x16x32_bf16 v[208:211], v[96:99], v[72:75], v[208:211]
    v_mfma_f32_16x16x32_bf16 v[228:231], v[96:99], v[76:79], v[228:231]
    v_mfma_f32_16x16x32_bf16 v[248:251], v[96:99], v[80:83], v[248:251]
    buffer_load_dwordx4 v[96:99], v11, s[4:7], s38 offen offset:1024 sc1
    v_mfma_f32_16x16x32_bf16 v[192:195], v[100:103], v[68:71], v[192:195]
    buffer_load_dwordx4 v[68:71], v4, s[4:7], s38 offen offset:1024 sc1
    v_mfma_f32_16x16x32_bf16 v[212:215], v[100:103], v[72:75], v[212:215]
    buffer_load_dwordx4 v[72:75], v5, s[4:7], s38 offen offset:1024 sc1
    v_mfma_f32_16x16x32_bf16 v[232:235], v[100:103], v[76:79], v[232:235]
    buffer_load_dwordx4 v[76:79], v6, s[4:7], s38 offen offset:1024 sc1
    v_mfma_f32_16x16x32_bf16 v[252:255], v[100:103], v[80:83], v[252:255]
    buffer_load_dwordx4 v[100:103], v12, s[4:7], s38 offen offset:1024 sc1
    buffer_load_dwordx4 v[80:83], v7, s[4:7], s38 offen offset:1024 sc1
    s_waitcnt vmcnt(27)
    v_mfma_f32_16x16x32_bf16 v[176:179], v[120:123], v[104:107], v[176:179]
    v_mfma_f32_16x16x32_bf16 v[196:199], v[120:123], v[108:111], v[196:199]
    v_mfma_f32_16x16x32_bf16 v[216:219], v[120:123], v[112:115], v[216:219]
    v_mfma_f32_16x16x32_bf16 v[236:239], v[120:123], v[116:119], v[236:239]
    buffer_load_dwordx4 v[120:123], v8, s[4:7], s38 offen offset:2048 sc1
    v_mfma_f32_16x16x32_bf16 v[180:183], v[124:127], v[104:107], v[180:183]
    v_mfma_f32_16x16x32_bf16 v[200:203], v[124:127], v[108:111], v[200:203]
    v_mfma_f32_16x16x32_bf16 v[220:223], v[124:127], v[112:115], v[220:223]
    v_mfma_f32_16x16x32_bf16 v[240:243], v[124:127], v[116:119], v[240:243]
    buffer_load_dwordx4 v[124:127], v9, s[4:7], s38 offen offset:2048 sc1
    v_mfma_f32_16x16x32_bf16 v[184:187], v[128:131], v[104:107], v[184:187]
    v_mfma_f32_16x16x32_bf16 v[204:207], v[128:131], v[108:111], v[204:207]
    v_mfma_f32_16x16x32_bf16 v[224:227], v[128:131], v[112:115], v[224:227]
    v_mfma_f32_16x16x32_bf16 v[244:247], v[128:131], v[116:119], v[244:247]
    buffer_load_dwordx4 v[128:131], v10, s[4:7], s38 offen offset:2048 sc1
    v_mfma_f32_16x16x32_bf16 v[188:191], v[132:135], v[104:107], v[188:191]
    v_mfma_f32_16x16x32_bf16 v[208:211], v[132:135], v[108:111], v[208:211]
    v_mfma_f32_16x16x32_bf16 v[228:231], v[132:135], v[112:115], v[228:231]
    v_mfma_f32_16x16x32_bf16 v[248:251], v[132:135], v[116:119], v[248:251]
    buffer_load_dwordx4 v[132:135], v11, s[4:7], s38 offen offset:2048 sc1
    v_mfma_f32_16x16x32_bf16 v[192:195], v[136:139], v[104:107], v[192:195]
    buffer_load_dwordx4 v[104:107], v4, s[4:7], s38 offen offset:2048 sc1
    v_mfma_f32_16x16x32_bf16 v[212:215], v[136:139], v[108:111], v[212:215]
    buffer_load_dwordx4 v[108:111], v5, s[4:7], s38 offen offset:2048 sc1
    v_mfma_f32_16x16x32_bf16 v[232:235], v[136:139], v[112:115], v[232:235]
    buffer_load_dwordx4 v[112:115], v6, s[4:7], s38 offen offset:2048 sc1
    v_mfma_f32_16x16x32_bf16 v[252:255], v[136:139], v[116:119], v[252:255]
    buffer_load_dwordx4 v[136:139], v12, s[4:7], s38 offen offset:2048 sc1
    buffer_load_dwordx4 v[116:119], v7, s[4:7], s38 offen offset:2048 sc1
    s_waitcnt vmcnt(27)
    v_mov_b32 v26, 71680
    v_mov_b32 v27, 4
    s_mov_b64 exec, 1
    ds_add_u32 v26, v27
    s_mov_b64 exec, -1
    v_mfma_f32_16x16x32_bf16 v[176:179], v[156:159], v[140:143], v[176:179]
    v_mfma_f32_16x16x32_bf16 v[196:199], v[156:159], v[144:147], v[196:199]
    v_mfma_f32_16x16x32_bf16 v[216:219], v[156:159], v[148:151], v[216:219]
    v_mfma_f32_16x16x32_bf16 v[236:239], v[156:159], v[152:155], v[236:239]
    buffer_load_dwordx4 v[156:159], v8, s[4:7], s38 offen offset:3072 sc1
    v_mfma_f32_16x16x32_bf16 v[180:183], v[160:163], v[140:143], v[180:183]
    v_mfma_f32_16x16x32_bf16 v[200:203], v[160:163], v[144:147], v[200:203]
    v_mfma_f32_16x16x32_bf16 v[220:223], v[160:163], v[148:151], v[220:223]
    v_mfma_f32_16x16x32_bf16 v[240:243], v[160:163], v[152:155], v[240:243]
    buffer_load_dwordx4 v[160:163], v9, s[4:7], s38 offen offset:3072 sc1
    v_mfma_f32_16x16x32_bf16 v[184:187], v[164:167], v[140:143], v[184:187]
    v_mfma_f32_16x16x32_bf16 v[204:207], v[164:167], v[144:147], v[204:207]
    v_mfma_f32_16x16x32_bf16 v[224:227], v[164:167], v[148:151], v[224:227]
    v_mfma_f32_16x16x32_bf16 v[244:247], v[164:167], v[152:155], v[244:247]
    buffer_load_dwordx4 v[164:167], v10, s[4:7], s38 offen offset:3072 sc1
    v_mfma_f32_16x16x32_bf16 v[188:191], v[168:171], v[140:143], v[188:191]
    v_mfma_f32_16x16x32_bf16 v[208:211], v[168:171], v[144:147], v[208:211]
    v_mfma_f32_16x16x32_bf16 v[228:231], v[168:171], v[148:151], v[228:231]
    v_mfma_f32_16x16x32_bf16 v[248:251], v[168:171], v[152:155], v[248:251]
    buffer_load_dwordx4 v[168:171], v11, s[4:7], s38 offen offset:3072 sc1
    v_mfma_f32_16x16x32_bf16 v[192:195], v[172:175], v[140:143], v[192:195]
    buffer_load_dwordx4 v[140:143], v4, s[4:7], s38 offen offset:3072 sc1
    v_mfma_f32_16x16x32_bf16 v[212:215], v[172:175], v[144:147], v[212:215]
    buffer_load_dwordx4 v[144:147], v5, s[4:7], s38 offen offset:3072 sc1
    v_mfma_f32_16x16x32_bf16 v[232:235], v[172:175], v[148:151], v[232:235]
    buffer_load_dwordx4 v[148:151], v6, s[4:7], s38 offen offset:3072 sc1
    v_mfma_f32_16x16x32_bf16 v[252:255], v[172:175], v[152:155], v[252:255]
    buffer_load_dwordx4 v[172:175], v12, s[4:7], s38 offen offset:3072 sc1
    buffer_load_dwordx4 v[152:155], v7, s[4:7], s38 offen offset:3072 sc1
    s_waitcnt vmcnt(27)
    s_add_u32 s33, s33, 8192
    v_mfma_f32_16x16x32_bf16 v[176:179], v[48:51], v[32:35], v[176:179]
    v_mfma_f32_16x16x32_bf16 v[196:199], v[48:51], v[36:39], v[196:199]
    v_mfma_f32_16x16x32_bf16 v[216:219], v[48:51], v[40:43], v[216:219]
    v_mfma_f32_16x16x32_bf16 v[236:239], v[48:51], v[44:47], v[236:239]
    buffer_load_dwordx2 v[16:17], v13, s[8:11], 0 offen offset:0
    s_mov_b32 s29, 66060288
    buffer_load_dword v14, v2, s[4:7], s29 offen sc1
    v_mfma_f32_16x16x32_bf16 v[180:183], v[52:55], v[32:35], v[180:183]
    v_mfma_f32_16x16x32_bf16 v[200:203], v[52:55], v[36:39], v[200:203]
    v_mfma_f32_16x16x32_bf16 v[220:223], v[52:55], v[40:43], v[220:223]
    v_mfma_f32_16x16x32_bf16 v[240:243], v[52:55], v[44:47], v[240:243]
    buffer_load_dwordx2 v[18:19], v13, s[8:11], 0 offen offset:32
    v_mfma_f32_16x16x32_bf16 v[184:187], v[56:59], v[32:35], v[184:187]
    v_mfma_f32_16x16x32_bf16 v[204:207], v[56:59], v[36:39], v[204:207]
    v_mfma_f32_16x16x32_bf16 v[224:227], v[56:59], v[40:43], v[224:227]
    v_mfma_f32_16x16x32_bf16 v[244:247], v[56:59], v[44:47], v[244:247]
    buffer_load_dwordx2 v[20:21], v13, s[8:11], 0 offen offset:64
    v_mfma_f32_16x16x32_bf16 v[188:191], v[60:63], v[32:35], v[188:191]
    v_mfma_f32_16x16x32_bf16 v[208:211], v[60:63], v[36:39], v[208:211]
    v_mfma_f32_16x16x32_bf16 v[228:231], v[60:63], v[40:43], v[228:231]
    v_mfma_f32_16x16x32_bf16 v[248:251], v[60:63], v[44:47], v[248:251]
    buffer_load_dwordx2 v[22:23], v13, s[8:11], 0 offen offset:96
    v_mfma_f32_16x16x32_bf16 v[192:195], v[64:67], v[32:35], v[192:195]
    v_mfma_f32_16x16x32_bf16 v[212:215], v[64:67], v[36:39], v[212:215]
    v_mfma_f32_16x16x32_bf16 v[232:235], v[64:67], v[40:43], v[232:235]
    v_mfma_f32_16x16x32_bf16 v[252:255], v[64:67], v[44:47], v[252:255]
    buffer_load_dwordx2 v[24:25], v13, s[8:11], 0 offen offset:128
    s_waitcnt vmcnt(24)
    v_mfma_f32_16x16x32_bf16 v[176:179], v[84:87], v[68:71], v[176:179]
    v_mfma_f32_16x16x32_bf16 v[196:199], v[84:87], v[72:75], v[196:199]
    v_mfma_f32_16x16x32_bf16 v[216:219], v[84:87], v[76:79], v[216:219]
    v_mfma_f32_16x16x32_bf16 v[236:239], v[84:87], v[80:83], v[236:239]
    v_mfma_f32_16x16x32_bf16 v[180:183], v[88:91], v[68:71], v[180:183]
    v_mfma_f32_16x16x32_bf16 v[200:203], v[88:91], v[72:75], v[200:203]
    v_mfma_f32_16x16x32_bf16 v[220:223], v[88:91], v[76:79], v[220:223]
    v_mfma_f32_16x16x32_bf16 v[240:243], v[88:91], v[80:83], v[240:243]
    v_mfma_f32_16x16x32_bf16 v[184:187], v[92:95], v[68:71], v[184:187]
    v_mfma_f32_16x16x32_bf16 v[204:207], v[92:95], v[72:75], v[204:207]
    v_mfma_f32_16x16x32_bf16 v[224:227], v[92:95], v[76:79], v[224:227]
    v_mfma_f32_16x16x32_bf16 v[244:247], v[92:95], v[80:83], v[244:247]
    v_mfma_f32_16x16x32_bf16 v[188:191], v[96:99], v[68:71], v[188:191]
    v_mfma_f32_16x16x32_bf16 v[208:211], v[96:99], v[72:75], v[208:211]
    v_mfma_f32_16x16x32_bf16 v[228:231], v[96:99], v[76:79], v[228:231]
    v_mfma_f32_16x16x32_bf16 v[248:251], v[96:99], v[80:83], v[248:251]
    v_mfma_f32_16x16x32_bf16 v[192:195], v[100:103], v[68:71], v[192:195]
    v_mfma_f32_16x16x32_bf16 v[212:215], v[100:103], v[72:75], v[212:215]
    v_mfma_f32_16x16x32_bf16 v[232:235], v[100:103], v[76:79], v[232:235]
    v_mfma_f32_16x16x32_bf16 v[252:255], v[100:103], v[80:83], v[252:255]
    s_waitcnt vmcnt(15)
    v_mfma_f32_16x16x32_bf16 v[176:179], v[120:123], v[104:107], v[176:179]
    v_mfma_f32_16x16x32_bf16 v[196:199], v[120:123], v[108:111], v[196:199]
    v_mfma_f32_16x16x32_bf16 v[216:219], v[120:123], v[112:115], v[216:219]
    v_mfma_f32_16x16x32_bf16 v[236:239], v[120:123], v[116:119], v[236:239]
    v_mfma_f32_16x16x32_bf16 v[180:183], v[124:127], v[104:107], v[180:183]
    v_mfma_f32_16x16x32_bf16 v[200:203], v[124:127], v[108:111], v[200:203]
    v_mfma_f32_16x16x32_bf16 v[220:223], v[124:127], v[112:115], v[220:223]
    v_mfma_f32_16x16x32_bf16 v[240:243], v[124:127], v[116:119], v[240:243]
    v_mfma_f32_16x16x32_bf16 v[184:187], v[128:131], v[104:107], v[184:187]
    v_mfma_f32_16x16x32_bf16 v[204:207], v[128:131], v[108:111], v[204:207]
    v_mfma_f32_16x16x32_bf16 v[224:227], v[128:131], v[112:115], v[224:227]
    v_mfma_f32_16x16x32_bf16 v[244:247], v[128:131], v[116:119], v[244:247]
    v_mfma_f32_16x16x32_bf16 v[188:191], v[132:135], v[104:107], v[188:191]
    v_mfma_f32_16x16x32_bf16 v[208:211], v[132:135], v[108:111], v[208:211]
    v_mfma_f32_16x16x32_bf16 v[228:231], v[132:135], v[112:115], v[228:231]
    v_mfma_f32_16x16x32_bf16 v[248:251], v[132:135], v[116:119], v[248:251]
    v_mfma_f32_16x16x32_bf16 v[192:195], v[136:139], v[104:107], v[192:195]
    v_mfma_f32_16x16x32_bf16 v[212:215], v[136:139], v[108:111], v[212:215]
    v_mfma_f32_16x16x32_bf16 v[232:235], v[136:139], v[112:115], v[232:235]
    v_mfma_f32_16x16x32_bf16 v[252:255], v[136:139], v[116:119], v[252:255]
    s_waitcnt vmcnt(6)
    v_mfma_f32_16x16x32_bf16 v[176:179], v[156:159], v[140:143], v[176:179]
    v_mfma_f32_16x16x32_bf16 v[196:199], v[156:159], v[144:147], v[196:199]
    v_mfma_f32_16x16x32_bf16 v[216:219], v[156:159], v[148:151], v[216:219]
    v_mfma_f32_16x16x32_bf16 v[236:239], v[156:159], v[152:155], v[236:239]
    v_mfma_f32_16x16x32_bf16 v[180:183], v[160:163], v[140:143], v[180:183]
    v_mfma_f32_16x16x32_bf16 v[200:203], v[160:163], v[144:147], v[200:203]
    v_mfma_f32_16x16x32_bf16 v[220:223], v[160:163], v[148:151], v[220:223]
    v_mfma_f32_16x16x32_bf16 v[240:243], v[160:163], v[152:155], v[240:243]
    v_mfma_f32_16x16x32_bf16 v[184:187], v[164:167], v[140:143], v[184:187]
    v_mfma_f32_16x16x32_bf16 v[204:207], v[164:167], v[144:147], v[204:207]
    v_mfma_f32_16x16x32_bf16 v[224:227], v[164:167], v[148:151], v[224:227]
    v_mfma_f32_16x16x32_bf16 v[244:247], v[164:167], v[152:155], v[244:247]
    v_mfma_f32_16x16x32_bf16 v[188:191], v[168:171], v[140:143], v[188:191]
    v_mfma_f32_16x16x32_bf16 v[208:211], v[168:171], v[144:147], v[208:211]
    v_mfma_f32_16x16x32_bf16 v[228:231], v[168:171], v[148:151], v[228:231]
    v_mfma_f32_16x16x32_bf16 v[248:251], v[168:171], v[152:155], v[248:251]
    v_mfma_f32_16x16x32_bf16 v[192:195], v[172:175], v[140:143], v[192:195]
    v_mfma_f32_16x16x32_bf16 v[212:215], v[172:175], v[144:147], v[212:215]
    v_mfma_f32_16x16x32_bf16 v[232:235], v[172:175], v[148:151], v[232:235]
    v_mfma_f32_16x16x32_bf16 v[252:255], v[172:175], v[152:155], v[252:255]
    s_cmp_eq_u32 s28, 0
    s_cbranch_scc1 TSK_17
    s_sub_u32 s29, s28, 1
    s_and_b32 s29, s29, 3
    s_mul_i32 s29, s29, 5120
    v_add_u32 v4, s29, v1
    ds_write_b128 v4, v[176:179] offset:0
    ds_write_b128 v4, v[180:183] offset:1024
    ds_write_b128 v4, v[184:187] offset:2048
    ds_write_b128 v4, v[188:191] offset:3072
    ds_write_b128 v4, v[192:195] offset:4096
    s_branch TSK_17N
TSK_17:
    v_mov_b32 v44, v176
    v_mov_b32 v45, v177
    v_mov_b32 v46, v178
    v_mov_b32 v47, v179
    v_mov_b32 v60, v180
    v_mov_b32 v61, v181
    v_mov_b32 v62, v182
    v_mov_b32 v63, v183
    v_mov_b32 v76, v184
    v_mov_b32 v77, v185
    v_mov_b32 v78, v186
    v_mov_b32 v79, v187
    v_mov_b32 v92, v188
    v_mov_b32 v93, v189
    v_mov_b32 v94, v190
    v_mov_b32 v95, v191
    v_mov_b32 v108, v192
    v_mov_b32 v109, v193
    v_mov_b32 v110, v194
    v_mov_b32 v111, v195
TSK_17N:
    s_cmp_eq_u32 s28, 1
    s_cbranch_scc1 TSK_18
    s_sub_u32 s29, s28, 2
    s_and_b32 s29, s29, 3
    s_mul_i32 s29, s29, 5120
    v_add_u32 v4, s29, v1
    ds_write_b128 v4, v[196:199] offset:15360
    ds_write_b128 v4, v[200:203] offset:16384
    ds_write_b128 v4, v[204:207] offset:17408
    ds_write_b128 v4, v[208:211] offset:18432
    ds_write_b128 v4, v[212:215] offset:19456
    s_branch TSK_18N
TSK_18:
    v_mov_b32 v44, v196
    v_mov_b32 v45, v197
    v_mov_b32 v46, v198
    v_mov_b32 v47, v199
    v_mov_b32 v60, v200
    v_mov_b32 v61, v201
    v_mov_b32 v62, v202
    v_mov_b32 v63, v203
    v_mov_b32 v76, v204
    v_mov_b32 v77, v205
    v_mov_b32 v78, v206
    v_mov_b32 v79, v207
    v_mov_b32 v92, v208
    v_mov_b32 v93, v209
    v_mov_b32 v94, v210
    v_mov_b32 v95, v211
    v_mov_b32 v108, v212
    v_mov_b32 v109, v213
    v_mov_b32 v110, v214
    v_mov_b32 v111, v215
TSK_18N:
    s_cmp_eq_u32 s28, 2
    s_cbranch_scc1 TSK_19
    s_sub_u32 s29, s28, 3
    s_and_b32 s29, s29, 3
    s_mul_i32 s29, s29, 5120
    v_add_u32 v4, s29, v1
    ds_write_b128 v4, v[216:219] offset:30720
    ds_write_b128 v4, v[220:223] offset:31744
    ds_write_b128 v4, v[224:227] offset:32768
    ds_write_b128 v4, v[228:231] offset:33792
    ds_write_b128 v4, v[232:235] offset:34816
    s_branch TSK_19N
TSK_19:
    v_mov_b32 v44, v216
    v_mov_b32 v45, v217
    v_mov_b32 v46, v218
    v_mov_b32 v47, v219
    v_mov_b32 v60, v220
    v_mov_b32 v61, v221
    v_mov_b32 v62, v222
    v_mov_b32 v63, v223
    v_mov_b32 v76, v224
    v_mov_b32 v77, v225
    v_mov_b32 v78, v226
    v_mov_b32 v79, v227
    v_mov_b32 v92, v228
    v_mov_b32 v93, v229
    v_mov_b32 v94, v230
    v_mov_b32 v95, v231
    v_mov_b32 v108, v232
    v_mov_b32 v109, v233
    v_mov_b32 v110, v234
    v_mov_b32 v111, v235
TSK_19N:
    s_cmp_eq_u32 s28, 3
    s_cbranch_scc1 TSK_20
    s_sub_u32 s29, s28, 4
    s_and_b32 s29, s29, 3
    s_mul_i32 s29, s29, 5120
    v_add_u32 v4, s29, v1
    ds_write_b128 v4, v[236:239] offset:46080
    ds_write_b128 v4, v[240:243] offset:47104
    ds_write_b128 v4, v[244:247] offset:48128
    ds_write_b128 v4, v[248:251] offset:49152
    ds_write_b128 v4, v[252:255] offset:50176
    s_branch TSK_20N
TSK_20:
    v_mov_b32 v44, v236
    v_mov_b32 v45, v237
    v_mov_b32 v46, v238
    v_mov_b32 v47, v239
    v_mov_b32 v60, v240
    v_mov_b32 v61, v241
    v_mov_b32 v62, v242
    v_mov_b32 v63, v243
    v_mov_b32 v76, v244
    v_mov_b32 v77, v245
    v_mov_b32 v78, v246
    v_mov_b32 v79, v247
    v_mov_b32 v92, v248
    v_mov_b32 v93, v249
    v_mov_b32 v94, v250
    v_mov_b32 v95, v251
    v_mov_b32 v108, v252
    v_mov_b32 v109, v253
    v_mov_b32 v110, v254
    v_mov_b32 v111, v255
TSK_20N:
    s_mul_i32 s29, s28, 15360
    v_add_u32 v5, s29, v1
    v_lshrrev_b32 v7, 2, v0
    v_lshlrev_b32 v7, 7, v7
    v_and_b32 v8, 3, v0
    v_lshl_add_u32 v7, v8, 3, v7
    s_lshl_b32 s29, s28, 5
    s_add_u32 s29, s29, 61440
    v_add_u32 v7, s29, v7
    s_waitcnt vmcnt(0) lgkmcnt(0)
    s_barrier
    ds_read_b128 v[32:35], v5 offset:0
    ds_read_b128 v[36:39], v5 offset:5120
    ds_read_b128 v[40:43], v5 offset:10240
    ds_read_b64_tr_b16 v[112:113], v7 offset:0
    ds_read_b128 v[48:51], v5 offset:1024
    ds_read_b128 v[52:55], v5 offset:6144
    ds_read_b128 v[56:59], v5 offset:11264
    ds_read_b64_tr_b16 v[114:115], v7 offset:2048
    ds_read_b128 v[64:67], v5 offset:2048
    ds_read_b128 v[68:71], v5 offset:7168
    ds_read_b128 v[72:75], v5 offset:12288
    ds_read_b64_tr_b16 v[116:117], v7 offset:4096
    ds_read_b128 v[80:83], v5 offset:3072
    ds_read_b128 v[84:87], v5 offset:8192
    ds_read_b128 v[88:91], v5 offset:13312
    ds_read_b64_tr_b16 v[118:119], v7 offset:6144
    ds_read_b128 v[96:99], v5 offset:4096
    ds_read_b128 v[100:103], v5 offset:9216
    ds_read_b128 v[104:107], v5 offset:14336
    ds_read_b64_tr_b16 v[120:121], v7 offset:8192
    v_sub_f32 v15, 1.0, v14
    v_cvt_pk_bf16_f32 v26, v15, v15
    v_lshlrev_b32 v15, 16, v26
    v_and_b32 v27, 0xffff0000, v26
    s_waitcnt lgkmcnt(15)
    v_add_f32 v32, v32, v36
    v_add_f32 v40, v40, v44
    v_add_f32 v33, v33, v37
    v_add_f32 v41, v41, v45
    v_add_f32 v34, v34, v38
    v_add_f32 v42, v42, v46
    v_add_f32 v35, v35, v39
    v_add_f32 v43, v43, v47
    v_add_f32 v32, v32, v40
    v_add_f32 v33, v33, v41
    v_add_f32 v34, v34, v42
    v_add_f32 v35, v35, v43
    v_cvt_pk_bf16_f32 v26, v32, v33
    v_lshlrev_b32 v36, 16, v26
    v_and_b32 v37, 0xffff0000, v26
    v_mul_f32 v36, v15, v36
    v_mul_f32 v37, v15, v37
    v_cvt_pk_bf16_f32 v26, v36, v37
    v_lshlrev_b32 v36, 16, v26
    v_and_b32 v37, 0xffff0000, v26
    v_lshlrev_b32 v38, 16, v16
    v_and_b32 v39, 0xffff0000, v16
    v_lshlrev_b32 v40, 16, v112
    v_and_b32 v41, 0xffff0000, v112
    v_mul_f32 v38, v38, v40
    v_mul_f32 v39, v39, v41
    v_cvt_pk_bf16_f32 v26, v38, v39
    v_lshlrev_b32 v38, 16, v26
    v_and_b32 v39, 0xffff0000, v26
    v_mul_f32 v38, v14, v38
    v_mul_f32 v39, v14, v39
    v_cvt_pk_bf16_f32 v26, v38, v39
    v_lshlrev_b32 v38, 16, v26
    v_and_b32 v39, 0xffff0000, v26
    v_add_f32 v38, v38, v36
    v_add_f32 v39, v39, v37
    v_cvt_pk_bf16_f32 v44, v38, v39
    v_cvt_pk_bf16_f32 v26, v34, v35
    v_lshlrev_b32 v36, 16, v26
    v_and_b32 v37, 0xffff0000, v26
    v_mul_f32 v36, v15, v36
    v_mul_f32 v37, v15, v37
    v_cvt_pk_bf16_f32 v26, v36, v37
    v_lshlrev_b32 v36, 16, v26
    v_and_b32 v37, 0xffff0000, v26
    v_lshlrev_b32 v38, 16, v17
    v_and_b32 v39, 0xffff0000, v17
    v_lshlrev_b32 v40, 16, v113
    v_and_b32 v41, 0xffff0000, v113
    v_mul_f32 v38, v38, v40
    v_mul_f32 v39, v39, v41
    v_cvt_pk_bf16_f32 v26, v38, v39
    v_lshlrev_b32 v38, 16, v26
    v_and_b32 v39, 0xffff0000, v26
    v_mul_f32 v38, v14, v38
    v_mul_f32 v39, v14, v39
    v_cvt_pk_bf16_f32 v26, v38, v39
    v_lshlrev_b32 v38, 16, v26
    v_and_b32 v39, 0xffff0000, v26
    v_add_f32 v38, v38, v36
    v_add_f32 v39, v39, v37
    v_cvt_pk_bf16_f32 v45, v38, v39
    buffer_store_dwordx2 v[44:45], v13, s[12:15], 0 offen offset:0
    s_waitcnt lgkmcnt(12)
    v_add_f32 v48, v48, v52
    v_add_f32 v56, v56, v60
    v_add_f32 v49, v49, v53
    v_add_f32 v57, v57, v61
    v_add_f32 v50, v50, v54
    v_add_f32 v58, v58, v62
    v_add_f32 v51, v51, v55
    v_add_f32 v59, v59, v63
    v_add_f32 v48, v48, v56
    v_add_f32 v49, v49, v57
    v_add_f32 v50, v50, v58
    v_add_f32 v51, v51, v59
    v_cvt_pk_bf16_f32 v26, v48, v49
    v_lshlrev_b32 v52, 16, v26
    v_and_b32 v53, 0xffff0000, v26
    v_mul_f32 v52, v15, v52
    v_mul_f32 v53, v15, v53
    v_cvt_pk_bf16_f32 v26, v52, v53
    v_lshlrev_b32 v52, 16, v26
    v_and_b32 v53, 0xffff0000, v26
    v_lshlrev_b32 v54, 16, v18
    v_and_b32 v55, 0xffff0000, v18
    v_lshlrev_b32 v56, 16, v114
    v_and_b32 v57, 0xffff0000, v114
    v_mul_f32 v54, v54, v56
    v_mul_f32 v55, v55, v57
    v_cvt_pk_bf16_f32 v26, v54, v55
    v_lshlrev_b32 v54, 16, v26
    v_and_b32 v55, 0xffff0000, v26
    v_mul_f32 v54, v14, v54
    v_mul_f32 v55, v14, v55
    v_cvt_pk_bf16_f32 v26, v54, v55
    v_lshlrev_b32 v54, 16, v26
    v_and_b32 v55, 0xffff0000, v26
    v_add_f32 v54, v54, v52
    v_add_f32 v55, v55, v53
    v_cvt_pk_bf16_f32 v60, v54, v55
    v_cvt_pk_bf16_f32 v26, v50, v51
    v_lshlrev_b32 v52, 16, v26
    v_and_b32 v53, 0xffff0000, v26
    v_mul_f32 v52, v15, v52
    v_mul_f32 v53, v15, v53
    v_cvt_pk_bf16_f32 v26, v52, v53
    v_lshlrev_b32 v52, 16, v26
    v_and_b32 v53, 0xffff0000, v26
    v_lshlrev_b32 v54, 16, v19
    v_and_b32 v55, 0xffff0000, v19
    v_lshlrev_b32 v56, 16, v115
    v_and_b32 v57, 0xffff0000, v115
    v_mul_f32 v54, v54, v56
    v_mul_f32 v55, v55, v57
    v_cvt_pk_bf16_f32 v26, v54, v55
    v_lshlrev_b32 v54, 16, v26
    v_and_b32 v55, 0xffff0000, v26
    v_mul_f32 v54, v14, v54
    v_mul_f32 v55, v14, v55
    v_cvt_pk_bf16_f32 v26, v54, v55
    v_lshlrev_b32 v54, 16, v26
    v_and_b32 v55, 0xffff0000, v26
    v_add_f32 v54, v54, v52
    v_add_f32 v55, v55, v53
    v_cvt_pk_bf16_f32 v61, v54, v55
    buffer_store_dwordx2 v[60:61], v13, s[12:15], 0 offen offset:32
    s_waitcnt lgkmcnt(8)
    v_add_f32 v64, v64, v68
    v_add_f32 v72, v72, v76
    v_add_f32 v65, v65, v69
    v_add_f32 v73, v73, v77
    v_add_f32 v66, v66, v70
    v_add_f32 v74, v74, v78
    v_add_f32 v67, v67, v71
    v_add_f32 v75, v75, v79
    v_add_f32 v64, v64, v72
    v_add_f32 v65, v65, v73
    v_add_f32 v66, v66, v74
    v_add_f32 v67, v67, v75
    v_cvt_pk_bf16_f32 v26, v64, v65
    v_lshlrev_b32 v68, 16, v26
    v_and_b32 v69, 0xffff0000, v26
    v_mul_f32 v68, v15, v68
    v_mul_f32 v69, v15, v69
    v_cvt_pk_bf16_f32 v26, v68, v69
    v_lshlrev_b32 v68, 16, v26
    v_and_b32 v69, 0xffff0000, v26
    v_lshlrev_b32 v70, 16, v20
    v_and_b32 v71, 0xffff0000, v20
    v_lshlrev_b32 v72, 16, v116
    v_and_b32 v73, 0xffff0000, v116
    v_mul_f32 v70, v70, v72
    v_mul_f32 v71, v71, v73
    v_cvt_pk_bf16_f32 v26, v70, v71
    v_lshlrev_b32 v70, 16, v26
    v_and_b32 v71, 0xffff0000, v26
    v_mul_f32 v70, v14, v70
    v_mul_f32 v71, v14, v71
    v_cvt_pk_bf16_f32 v26, v70, v71
    v_lshlrev_b32 v70, 16, v26
    v_and_b32 v71, 0xffff0000, v26
    v_add_f32 v70, v70, v68
    v_add_f32 v71, v71, v69
    v_cvt_pk_bf16_f32 v76, v70, v71
    v_cvt_pk_bf16_f32 v26, v66, v67
    v_lshlrev_b32 v68, 16, v26
    v_and_b32 v69, 0xffff0000, v26
    v_mul_f32 v68, v15, v68
    v_mul_f32 v69, v15, v69
    v_cvt_pk_bf16_f32 v26, v68, v69
    v_lshlrev_b32 v68, 16, v26
    v_and_b32 v69, 0xffff0000, v26
    v_lshlrev_b32 v70, 16, v21
    v_and_b32 v71, 0xffff0000, v21
    v_lshlrev_b32 v72, 16, v117
    v_and_b32 v73, 0xffff0000, v117
    v_mul_f32 v70, v70, v72
    v_mul_f32 v71, v71, v73
    v_cvt_pk_bf16_f32 v26, v70, v71
    v_lshlrev_b32 v70, 16, v26
    v_and_b32 v71, 0xffff0000, v26
    v_mul_f32 v70, v14, v70
    v_mul_f32 v71, v14, v71
    v_cvt_pk_bf16_f32 v26, v70, v71
    v_lshlrev_b32 v70, 16, v26
    v_and_b32 v71, 0xffff0000, v26
    v_add_f32 v70, v70, v68
    v_add_f32 v71, v71, v69
    v_cvt_pk_bf16_f32 v77, v70, v71
    buffer_store_dwordx2 v[76:77], v13, s[12:15], 0 offen offset:64
    s_waitcnt lgkmcnt(4)
    v_add_f32 v80, v80, v84
    v_add_f32 v88, v88, v92
    v_add_f32 v81, v81, v85
    v_add_f32 v89, v89, v93
    v_add_f32 v82, v82, v86
    v_add_f32 v90, v90, v94
    v_add_f32 v83, v83, v87
    v_add_f32 v91, v91, v95
    v_add_f32 v80, v80, v88
    v_add_f32 v81, v81, v89
    v_add_f32 v82, v82, v90
    v_add_f32 v83, v83, v91
    v_cvt_pk_bf16_f32 v26, v80, v81
    v_lshlrev_b32 v84, 16, v26
    v_and_b32 v85, 0xffff0000, v26
    v_mul_f32 v84, v15, v84
    v_mul_f32 v85, v15, v85
    v_cvt_pk_bf16_f32 v26, v84, v85
    v_lshlrev_b32 v84, 16, v26
    v_and_b32 v85, 0xffff0000, v26
    v_lshlrev_b32 v86, 16, v22
    v_and_b32 v87, 0xffff0000, v22
    v_lshlrev_b32 v88, 16, v118
    v_and_b32 v89, 0xffff0000, v118
    v_mul_f32 v86, v86, v88
    v_mul_f32 v87, v87, v89
    v_cvt_pk_bf16_f32 v26, v86, v87
    v_lshlrev_b32 v86, 16, v26
    v_and_b32 v87, 0xffff0000, v26
    v_mul_f32 v86, v14, v86
    v_mul_f32 v87, v14, v87
    v_cvt_pk_bf16_f32 v26, v86, v87
    v_lshlrev_b32 v86, 16, v26
    v_and_b32 v87, 0xffff0000, v26
    v_add_f32 v86, v86, v84
    v_add_f32 v87, v87, v85
    v_cvt_pk_bf16_f32 v92, v86, v87
    v_cvt_pk_bf16_f32 v26, v82, v83
    v_lshlrev_b32 v84, 16, v26
    v_and_b32 v85, 0xffff0000, v26
    v_mul_f32 v84, v15, v84
    v_mul_f32 v85, v15, v85
    v_cvt_pk_bf16_f32 v26, v84, v85
    v_lshlrev_b32 v84, 16, v26
    v_and_b32 v85, 0xffff0000, v26
    v_lshlrev_b32 v86, 16, v23
    v_and_b32 v87, 0xffff0000, v23
    v_lshlrev_b32 v88, 16, v119
    v_and_b32 v89, 0xffff0000, v119
    v_mul_f32 v86, v86, v88
    v_mul_f32 v87, v87, v89
    v_cvt_pk_bf16_f32 v26, v86, v87
    v_lshlrev_b32 v86, 16, v26
    v_and_b32 v87, 0xffff0000, v26
    v_mul_f32 v86, v14, v86
    v_mul_f32 v87, v14, v87
    v_cvt_pk_bf16_f32 v26, v86, v87
    v_lshlrev_b32 v86, 16, v26
    v_and_b32 v87, 0xffff0000, v26
    v_add_f32 v86, v86, v84
    v_add_f32 v87, v87, v85
    v_cvt_pk_bf16_f32 v93, v86, v87
    buffer_store_dwordx2 v[92:93], v13, s[12:15], 0 offen offset:96
    s_waitcnt lgkmcnt(0)
    v_add_f32 v96, v96, v100
    v_add_f32 v104, v104, v108
    v_add_f32 v97, v97, v101
    v_add_f32 v105, v105, v109
    v_add_f32 v98, v98, v102
    v_add_f32 v106, v106, v110
    v_add_f32 v99, v99, v103
    v_add_f32 v107, v107, v111
    v_add_f32 v96, v96, v104
    v_add_f32 v97, v97, v105
    v_add_f32 v98, v98, v106
    v_add_f32 v99, v99, v107
    v_cvt_pk_bf16_f32 v26, v96, v97
    v_lshlrev_b32 v100, 16, v26
    v_and_b32 v101, 0xffff0000, v26
    v_mul_f32 v100, v15, v100
    v_mul_f32 v101, v15, v101
    v_cvt_pk_bf16_f32 v26, v100, v101
    v_lshlrev_b32 v100, 16, v26
    v_and_b32 v101, 0xffff0000, v26
    v_lshlrev_b32 v102, 16, v24
    v_and_b32 v103, 0xffff0000, v24
    v_lshlrev_b32 v104, 16, v120
    v_and_b32 v105, 0xffff0000, v120
    v_mul_f32 v102, v102, v104
    v_mul_f32 v103, v103, v105
    v_cvt_pk_bf16_f32 v26, v102, v103
    v_lshlrev_b32 v102, 16, v26
    v_and_b32 v103, 0xffff0000, v26
    v_mul_f32 v102, v14, v102
    v_mul_f32 v103, v14, v103
    v_cvt_pk_bf16_f32 v26, v102, v103
    v_lshlrev_b32 v102, 16, v26
    v_and_b32 v103, 0xffff0000, v26
    v_add_f32 v102, v102, v100
    v_add_f32 v103, v103, v101
    v_cvt_pk_bf16_f32 v108, v102, v103
    v_cvt_pk_bf16_f32 v26, v98, v99
    v_lshlrev_b32 v100, 16, v26
    v_and_b32 v101, 0xffff0000, v26
    v_mul_f32 v100, v15, v100
    v_mul_f32 v101, v15, v101
    v_cvt_pk_bf16_f32 v26, v100, v101
    v_lshlrev_b32 v100, 16, v26
    v_and_b32 v101, 0xffff0000, v26
    v_lshlrev_b32 v102, 16, v25
    v_and_b32 v103, 0xffff0000, v25
    v_lshlrev_b32 v104, 16, v121
    v_and_b32 v105, 0xffff0000, v121
    v_mul_f32 v102, v102, v104
    v_mul_f32 v103, v103, v105
    v_cvt_pk_bf16_f32 v26, v102, v103
    v_lshlrev_b32 v102, 16, v26
    v_and_b32 v103, 0xffff0000, v26
    v_mul_f32 v102, v14, v102
    v_mul_f32 v103, v14, v103
    v_cvt_pk_bf16_f32 v26, v102, v103
    v_lshlrev_b32 v102, 16, v26
    v_and_b32 v103, 0xffff0000, v26
    v_add_f32 v102, v102, v100
    v_add_f32 v103, v103, v101
    v_cvt_pk_bf16_f32 v109, v102, v103
    buffer_store_dwordx2 v[108:109], v13, s[12:15], 0 offen offset:128
    s_endpgm
T_SIDE:
    s_setprio 3
    s_waitcnt lgkmcnt(0)
    s_and_b32 s36, s2, 1
    s_sub_u32 s36, 3, s36
    s_cmp_lg_u32 s28, 7
    s_cbranch_scc1 T_CONV
    v_mov_b32 v2, 71680
    v_mov_b32 v3, 0
    ds_write_b32 v2, v3
    v_and_b32 v6, 31, v0
    v_lshlrev_b32 v6, 2, v6
    s_lshr_b32 s3, s31, 1
    s_lshl_b32 s3, s3, 12
    s_add_u32 s3, s3, 66846720
    v_mov_b32 v4, 1
    s_mov_b32 s30, 0
    v_mov_b32 v7, s30
    ds_write_b32 v2, v7 offset:64
    s_waitcnt vmcnt(0) lgkmcnt(0)
    s_barrier
    s_mov_b64 exec, 1
    buffer_store_dword v4, v3, s[4:7], s37 offen sc1
    s_mov_b64 exec, -1
    v_mov_b32 v3, v6
    s_cmp_eq_u32 s30, 1
    s_cbranch_scc1 T_CP3
    s_branch T_CP1
T_CP:
    s_sleep 8
T_CP1:
    buffer_load_dword v5, v3, s[4:7], s3 offen sc1
    s_waitcnt vmcnt(0)
    v_cmp_eq_u32 vcc, 0, v5
    s_add_u32 s30, s30, 1
    s_cbranch_vccz T_CP2
    s_cmp_lt_u32 s30, 100000
    s_cbranch_scc1 T_CP
T_CP2:
    ds_write_b32 v2, v4 offset:64
T_CP3:
    v_lshrrev_b32 v2, 3, v0
    v_and_b32 v4, 7, v0
    v_lshlrev_b32 v4, 4, v4
    v_mul_u32_u24 v2, 4224, v2
    v_add_u32 v2, v2, v4
    s_lshl_b32 s3, s32, 12
    s_add_u32 s3, s3, 66584576
    v_and_b32 v3, 31, v0
    v_lshlrev_b32 v3, 2, v3
    s_mov_b32 s30, 0
    v_mov_b32 v6, 71680
T_LPOLL:
    s_sleep 8
    ds_read_b32 v5, v6
    s_waitcnt lgkmcnt(0)
    v_readfirstlane_b32 s29, v5
    s_add_u32 s30, s30, 1
    s_cmp_ge_u32 s29, 16
    s_cbranch_scc1 T_POLL1
    s_cmp_lt_u32 s30, 100000
    s_cbranch_scc1 T_LPOLL
T_POLL:
    s_sleep 24
T_POLL1:
    buffer_load_dword v5, v3, s[4:7], s3 offen sc1
    s_waitcnt vmcnt(0)
    v_cmp_eq_u32 vcc, 0, v5
    s_add_u32 s30, s30, 1
    s_cbranch_vccz T_POK
    s_cmp_lt_u32 s30, 100000
    s_cbranch_scc1 T_POLL
T_POK:
    s_mul_i32 s29, s32, 337920
    s_lshl_b32 s30, s31, 7
    s_add_u32 s29, s29, s30
    s_add_u32 s29, s29, 62914560
    s_mov_b32 m0, 61440
    s_nop 0
    buffer_load_dwordx4 v2, s[4:7], s29 offen sc1 lds
    s_mov_b32 m0, 62464
    s_add_u32 s29, s29, 33792
    buffer_load_dwordx4 v2, s[4:7], s29 offen sc1 lds
    s_mov_b32 m0, 63488
    s_add_u32 s29, s29, 33792
    buffer_load_dwordx4 v2, s[4:7], s29 offen sc1 lds
    s_mov_b32 m0, 64512
    s_add_u32 s29, s29, 33792
    buffer_load_dwordx4 v2, s[4:7], s29 offen sc1 lds
    s_mov_b32 m0, 65536
    s_add_u32 s29, s29, 33792
    buffer_load_dwordx4 v2, s[4:7], s29 offen sc1 lds
    s_mov_b32 m0, 66560
    s_add_u32 s29, s29, 33792
    buffer_load_dwordx4 v2, s[4:7], s29 offen sc1 lds
    s_mov_b32 m0, 67584
    s_add_u32 s29, s29, 33792
    buffer_load_dwordx4 v2, s[4:7], s29 offen sc1 lds
    s_mov_b32 m0, 68608
    s_add_u32 s29, s29, 33792
    buffer_load_dwordx4 v2, s[4:7], s29 offen sc1 lds
    s_mov_b32 m0, 69632
    s_add_u32 s29, s29, 33792
    buffer_load_dwordx4 v2, s[4:7], s29 offen sc1 lds
    s_mov_b32 m0, 70656
    s_add_u32 s29, s29, 33792
    buffer_load_dwordx4 v2, s[4:7], s29 offen sc1 lds
    s_waitcnt vmcnt(0)
    s_barrier
    s_endpgm
T_CONV:
    s_sub_u32 s29, s28, 4
    s_cmp_ge_u32 s29, s36
    s_cbranch_scc1 T_WEND
    s_lshr_b32 s34, s2, 1
    s_mul_i32 s34, s34, 5
    s_and_b32 s30, s2, 1
    s_mul_i32 s30, s30, 3
    s_add_u32 s34, s34, s30
    s_add_u32 s34, s34, s29
    s_mul_i32 s35, s29, 21248
    s_add_u32 s35, s35, 98304
    s_lshl_b32 s29, s34, 12
    v_mov_b32 v8, 0
    v_mov_b32 v9, 0
    v_lshlrev_b32 v5, 3, v0
    v_add_u32 v6, s35, v5
    ds_write_b64 v6, v[8:9] offset:16640
    v_and_b32 v6, 7, v0
    v_bfe_u32 v7, v0, 3, 2
    v_lshlrev_b32 v12, 1, v6
    buffer_load_ushort v13, v12, s[16:19], s29 offen
    s_lshl_b32 s29, s34, 1
    buffer_load_ushort v14, v8, s[20:23], s29 offen
    v_add_u32 v6, v6, v7
    v_mul_u32_u24 v12, 4160, v7
    v_lshl_add_u32 v12, v6, 1, v12
    v_add_u32 v12, s35, v12
    v_bfe_u32 v18, v0, 2, 2
    v_mul_u32_u24 v18, 4160, v18
    v_and_b32 v19, 3, v0
    v_lshl_add_u32 v18, v19, 3, v18
    v_lshrrev_b32 v19, 4, v0
    v_lshlrev_b32 v20, 4, v19
    v_sub_u32 v18, v18, v20
    s_add_u32 s29, s35, 88
    v_add_u32 v16, s29, v18
    v_and_b32 v21, 15, v0
    v_lshl_add_u32 v18, v21, 5, v20
    s_add_u32 s29, s35, 16672
    v_add_u32 v17, s29, v18
    v_lshlrev_b32 v15, 5, v21
    v_lshl_add_u32 v15, v19, 3, v15
    v_lshlrev_b32 v20, 3, v19
    v_sub_u32 v20, v21, v20
    v_mov_b32 v22, 0xffff
    v_cmp_le_i32 vcc, -16, v20
    v_cmp_le_i32 s[40:41], -15, v20
    s_nop 0
    v_cndmask_b32 v24, 0, v22, vcc
    v_cndmask_b32 v24, v24, -1, s[40:41]
    v_cmp_le_i32 vcc, -14, v20
    v_cmp_le_i32 s[40:41], -13, v20
    s_nop 0
    v_cndmask_b32 v25, 0, v22, vcc
    v_cndmask_b32 v25, v25, -1, s[40:41]
    v_cmp_le_i32 vcc, -12, v20
    v_cmp_le_i32 s[40:41], -11, v20
    s_nop 0
    v_cndmask_b32 v26, 0, v22, vcc
    v_cndmask_b32 v26, v26, -1, s[40:41]
    v_cmp_le_i32 vcc, -10, v20
    v_cmp_le_i32 s[40:41], -9, v20
    s_nop 0
    v_cndmask_b32 v27, 0, v22, vcc
    v_cndmask_b32 v27, v27, -1, s[40:41]
    s_waitcnt vmcnt(2)
    s_barrier
    s_waitcnt vmcnt(0)
    v_cmp_gt_u32 vcc, 8, v6
    s_nop 0
    s_and_b32 exec_lo, vcc_lo, exec_lo
    s_mov_b32 exec_hi, 0
    ds_write_b16 v12, v13 offset:64
    s_mov_b64 exec, -1
    s_setprio 0
    ds_read_b128 v[64:67], v17 offset:448
    ds_read_b128 v[68:71], v17 offset:960
    ds_read_b128 v[72:75], v17 offset:1472
    ds_read_b128 v[76:79], v17 offset:1984
    ds_read_b64_tr_b16 v[32:33], v16 offset:8
    ds_read_b64_tr_b16 v[34:35], v16 offset:0
    s_waitcnt lgkmcnt(0)
    v_and_b32 v32, v32, v24
    v_and_b32 v33, v33, v25
    v_and_b32 v34, v34, v26
    v_and_b32 v35, v35, v27
    s_nop 1
    v_mfma_f32_16x16x32_bf16 v[160:163], v[32:35], v[64:67], 0
    ds_read_b128 v[80:83], v17 offset:2496
    ds_read_b128 v[84:87], v17 offset:3008
    v_mfma_f32_16x16x32_bf16 v[164:167], v[32:35], v[68:71], 0
    ds_read_b128 v[88:91], v17 offset:3520
    ds_read_b128 v[92:95], v17 offset:4032
    v_mfma_f32_16x16x32_bf16 v[168:171], v[32:35], v[72:75], 0
    ds_read_b64_tr_b16 v[36:37], v16 offset:520
    ds_read_b64_tr_b16 v[38:39], v16 offset:512
    v_mfma_f32_16x16x32_bf16 v[172:175], v[32:35], v[76:79], 0
    ds_read_b64_tr_b16 v[40:41], v16 offset:1032
    ds_read_b64_tr_b16 v[42:43], v16 offset:1024
    s_waitcnt lgkmcnt(6)
    v_mfma_f32_16x16x32_bf16 v[176:179], v[32:35], v[80:83], 0
    v_mfma_f32_16x16x32_bf16 v[180:183], v[32:35], v[84:87], 0
    s_waitcnt lgkmcnt(4)
    v_mfma_f32_16x16x32_bf16 v[184:187], v[32:35], v[88:91], 0
    v_mfma_f32_16x16x32_bf16 v[188:191], v[32:35], v[92:95], 0
    ds_read_b64_tr_b16 v[44:45], v16 offset:1544
    ds_read_b64_tr_b16 v[46:47], v16 offset:1536
    s_waitcnt lgkmcnt(4)
    v_mfma_f32_16x16x32_bf16 v[164:167], v[36:39], v[64:67], v[164:167]
    v_mfma_f32_16x16x32_bf16 v[168:171], v[36:39], v[68:71], v[168:171]
    v_mfma_f32_16x16x32_bf16 v[172:175], v[36:39], v[72:75], v[172:175]
    v_mfma_f32_16x16x32_bf16 v[176:179], v[36:39], v[76:79], v[176:179]
    v_mfma_f32_16x16x32_bf16 v[180:183], v[36:39], v[80:83], v[180:183]
    ds_read_b64_tr_b16 v[48:49], v16 offset:2056
    ds_read_b64_tr_b16 v[50:51], v16 offset:2048
    v_mfma_f32_16x16x32_bf16 v[184:187], v[36:39], v[84:87], v[184:187]
    v_mfma_f32_16x16x32_bf16 v[188:191], v[36:39], v[88:91], v[188:191]
    s_waitcnt lgkmcnt(4)
    v_mfma_f32_16x16x32_bf16 v[168:171], v[40:43], v[64:67], v[168:171]
    v_mfma_f32_16x16x32_bf16 v[172:175], v[40:43], v[68:71], v[172:175]
    ds_read_b64_tr_b16 v[52:53], v16 offset:2568
    ds_read_b64_tr_b16 v[54:55], v16 offset:2560
    v_mfma_f32_16x16x32_bf16 v[176:179], v[40:43], v[72:75], v[176:179]
    v_mfma_f32_16x16x32_bf16 v[180:183], v[40:43], v[76:79], v[180:183]
    ds_read_b128 v[128:131], v17 offset:384
    v_mfma_f32_16x16x32_bf16 v[184:187], v[40:43], v[80:83], v[184:187]
    ds_read_b64_tr_b16 v[56:57], v16 offset:3080
    ds_read_b64_tr_b16 v[58:59], v16 offset:3072
    v_mfma_f32_16x16x32_bf16 v[188:191], v[40:43], v[84:87], v[188:191]
    ds_read_b128 v[132:135], v17 offset:896
    ds_read_b128 v[136:139], v17 offset:1408
    s_waitcnt lgkmcnt(9)
    v_mfma_f32_16x16x32_bf16 v[172:175], v[44:47], v[64:67], v[172:175]
    ds_read_b64_tr_b16 v[60:61], v16 offset:3592
    ds_read_b64_tr_b16 v[62:63], v16 offset:3584
    v_mfma_f32_16x16x32_bf16 v[176:179], v[44:47], v[68:71], v[176:179]
    ds_read_b128 v[140:143], v17 offset:1920
    ds_read_b64_tr_b16 v[96:97], v16 offset:72
    v_mfma_f32_16x16x32_bf16 v[180:183], v[44:47], v[72:75], v[180:183]
    ds_read_b64_tr_b16 v[98:99], v16 offset:64
    ds_read_b128 v[144:147], v17 offset:2432
    v_mfma_f32_16x16x32_bf16 v[184:187], v[44:47], v[76:79], v[184:187]
    ds_read_b128 v[148:151], v17 offset:2944
    ds_read_b128 v[152:155], v17 offset:3456
    v_mfma_f32_16x16x32_bf16 v[188:191], v[44:47], v[80:83], v[188:191]
    ds_read_b128 v[156:159], v17 offset:3968
    s_waitcnt lgkmcnt(15)
    v_mfma_f32_16x16x32_bf16 v[176:179], v[48:51], v[64:67], v[176:179]
    v_mfma_f32_16x16x32_bf16 v[180:183], v[48:51], v[68:71], v[180:183]
    v_mfma_f32_16x16x32_bf16 v[184:187], v[48:51], v[72:75], v[184:187]
    v_mfma_f32_16x16x32_bf16 v[188:191], v[48:51], v[76:79], v[188:191]
    s_waitcnt lgkmcnt(14)
    v_mfma_f32_16x16x32_bf16 v[180:183], v[52:55], v[64:67], v[180:183]
    ds_read_b64_tr_b16 v[100:101], v16 offset:584
    ds_read_b64_tr_b16 v[102:103], v16 offset:576
    v_mfma_f32_16x16x32_bf16 v[184:187], v[52:55], v[68:71], v[184:187]
    v_mfma_f32_16x16x32_bf16 v[188:191], v[52:55], v[72:75], v[188:191]
    s_waitcnt lgkmcnt(13)
    v_mfma_f32_16x16x32_bf16 v[184:187], v[56:59], v[64:67], v[184:187]
    v_mfma_f32_16x16x32_bf16 v[188:191], v[56:59], v[68:71], v[188:191]
    s_waitcnt lgkmcnt(6)
    v_mfma_f32_16x16x32_bf16 v[188:191], v[60:63], v[64:67], v[188:191]
    v_mfma_f32_16x16x32_bf16 v[160:163], v[96:99], v[128:131], v[160:163]
    v_mfma_f32_16x16x32_bf16 v[164:167], v[96:99], v[132:135], v[164:167]
    ds_read_b64_tr_b16 v[104:105], v16 offset:1096
    ds_read_b64_tr_b16 v[106:107], v16 offset:1088
    v_mfma_f32_16x16x32_bf16 v[168:171], v[96:99], v[136:139], v[168:171]
    v_mfma_f32_16x16x32_bf16 v[172:175], v[96:99], v[140:143], v[172:175]
    s_waitcnt lgkmcnt(6)
    v_mfma_f32_16x16x32_bf16 v[176:179], v[96:99], v[144:147], v[176:179]
    v_mfma_f32_16x16x32_bf16 v[180:183], v[96:99], v[148:151], v[180:183]
    s_waitcnt lgkmcnt(4)
    v_mfma_f32_16x16x32_bf16 v[184:187], v[96:99], v[152:155], v[184:187]
    v_mfma_f32_16x16x32_bf16 v[188:191], v[96:99], v[156:159], v[188:191]
    ds_read_b64_tr_b16 v[108:109], v16 offset:1608
    ds_read_b64_tr_b16 v[110:111], v16 offset:1600
    s_waitcnt lgkmcnt(4)
    v_mfma_f32_16x16x32_bf16 v[164:167], v[100:103], v[128:131], v[164:167]
    v_mfma_f32_16x16x32_bf16 v[168:171], v[100:103], v[132:135], v[168:171]
    v_mfma_f32_16x16x32_bf16 v[172:175], v[100:103], v[136:139], v[172:175]
    v_mfma_f32_16x16x32_bf16 v[176:179], v[100:103], v[140:143], v[176:179]
    v_mfma_f32_16x16x32_bf16 v[180:183], v[100:103], v[144:147], v[180:183]
    ds_read_b64_tr_b16 v[112:113], v16 offset:2120
    ds_read_b64_tr_b16 v[114:115], v16 offset:2112
    v_mfma_f32_16x16x32_bf16 v[184:187], v[100:103], v[148:151], v[184:187]
    v_mfma_f32_16x16x32_bf16 v[188:191], v[100:103], v[152:155], v[188:191]
    s_waitcnt lgkmcnt(4)
    v_mfma_f32_16x16x32_bf16 v[168:171], v[104:107], v[128:131], v[168:171]
    v_mfma_f32_16x16x32_bf16 v[172:175], v[104:107], v[132:135], v[172:175]
    ds_read_b64_tr_b16 v[116:117], v16 offset:2632
    ds_read_b64_tr_b16 v[118:119], v16 offset:2624
    v_mfma_f32_16x16x32_bf16 v[176:179], v[104:107], v[136:139], v[176:179]
    v_mfma_f32_16x16x32_bf16 v[180:183], v[104:107], v[140:143], v[180:183]
    ds_read_b128 v[64:67], v17 offset:320
    v_mfma_f32_16x16x32_bf16 v[184:187], v[104:107], v[144:147], v[184:187]
    ds_read_b64_tr_b16 v[120:121], v16 offset:3144
    ds_read_b64_tr_b16 v[122:123], v16 offset:3136
    v_mfma_f32_16x16x32_bf16 v[188:191], v[104:107], v[148:151], v[188:191]
    ds_read_b128 v[68:71], v17 offset:832
    ds_read_b128 v[72:75], v17 offset:1344
    s_waitcnt lgkmcnt(9)
    v_mfma_f32_16x16x32_bf16 v[172:175], v[108:111], v[128:131], v[172:175]
    ds_read_b64_tr_b16 v[124:125], v16 offset:3656
    ds_read_b64_tr_b16 v[126:127], v16 offset:3648
    v_mfma_f32_16x16x32_bf16 v[176:179], v[108:111], v[132:135], v[176:179]
    ds_read_b128 v[76:79], v17 offset:1856
    ds_read_b64_tr_b16 v[32:33], v16 offset:136
    v_mfma_f32_16x16x32_bf16 v[180:183], v[108:111], v[136:139], v[180:183]
    ds_read_b64_tr_b16 v[34:35], v16 offset:128
    ds_read_b128 v[80:83], v17 offset:2368
    v_mfma_f32_16x16x32_bf16 v[184:187], v[108:111], v[140:143], v[184:187]
    ds_read_b128 v[84:87], v17 offset:2880
    ds_read_b128 v[88:91], v17 offset:3392
    v_mfma_f32_16x16x32_bf16 v[188:191], v[108:111], v[144:147], v[188:191]
    ds_read_b128 v[92:95], v17 offset:3904
    s_waitcnt lgkmcnt(15)
    v_mfma_f32_16x16x32_bf16 v[176:179], v[112:115], v[128:131], v[176:179]
    v_mfma_f32_16x16x32_bf16 v[180:183], v[112:115], v[132:135], v[180:183]
    v_mfma_f32_16x16x32_bf16 v[184:187], v[112:115], v[136:139], v[184:187]
    v_mfma_f32_16x16x32_bf16 v[188:191], v[112:115], v[140:143], v[188:191]
    s_waitcnt lgkmcnt(14)
    v_mfma_f32_16x16x32_bf16 v[180:183], v[116:119], v[128:131], v[180:183]
    ds_read_b64_tr_b16 v[36:37], v16 offset:648
    ds_read_b64_tr_b16 v[38:39], v16 offset:640
    v_mfma_f32_16x16x32_bf16 v[184:187], v[116:119], v[132:135], v[184:187]
    v_mfma_f32_16x16x32_bf16 v[188:191], v[116:119], v[136:139], v[188:191]
    s_waitcnt lgkmcnt(13)
    v_mfma_f32_16x16x32_bf16 v[184:187], v[120:123], v[128:131], v[184:187]
    v_mfma_f32_16x16x32_bf16 v[188:191], v[120:123], v[132:135], v[188:191]
    s_waitcnt lgkmcnt(6)
    v_mfma_f32_16x16x32_bf16 v[188:191], v[124:127], v[128:131], v[188:191]
    v_mfma_f32_16x16x32_bf16 v[160:163], v[32:35], v[64:67], v[160:163]
    v_mfma_f32_16x16x32_bf16 v[164:167], v[32:35], v[68:71], v[164:167]
    ds_read_b64_tr_b16 v[40:41], v16 offset:1160
    ds_read_b64_tr_b16 v[42:43], v16 offset:1152
    v_mfma_f32_16x16x32_bf16 v[168:171], v[32:35], v[72:75], v[168:171]
    v_mfma_f32_16x16x32_bf16 v[172:175], v[32:35], v[76:79], v[172:175]
    s_waitcnt lgkmcnt(6)
    v_mfma_f32_16x16x32_bf16 v[176:179], v[32:35], v[80:83], v[176:179]
    v_mfma_f32_16x16x32_bf16 v[180:183], v[32:35], v[84:87], v[180:183]
    s_waitcnt lgkmcnt(4)
    v_mfma_f32_16x16x32_bf16 v[184:187], v[32:35], v[88:91], v[184:187]
    v_mfma_f32_16x16x32_bf16 v[188:191], v[32:35], v[92:95], v[188:191]
    ds_read_b64_tr_b16 v[44:45], v16 offset:1672
    ds_read_b64_tr_b16 v[46:47], v16 offset:1664
    s_waitcnt lgkmcnt(4)
    v_mfma_f32_16x16x32_bf16 v[164:167], v[36:39], v[64:67], v[164:167]
    v_mfma_f32_16x16x32_bf16 v[168:171], v[36:39], v[68:71], v[168:171]
    v_mfma_f32_16x16x32_bf16 v[172:175], v[36:39], v[72:75], v[172:175]
    v_mfma_f32_16x16x32_bf16 v[176:179], v[36:39], v[76:79], v[176:179]
    v_mfma_f32_16x16x32_bf16 v[180:183], v[36:39], v[80:83], v[180:183]
    ds_read_b64_tr_b16 v[48:49], v16 offset:2184
    ds_read_b64_tr_b16 v[50:51], v16 offset:2176
    v_mfma_f32_16x16x32_bf16 v[184:187], v[36:39], v[84:87], v[184:187]
    v_mfma_f32_16x16x32_bf16 v[188:191], v[36:39], v[88:91], v[188:191]
    s_waitcnt lgkmcnt(4)
    v_mfma_f32_16x16x32_bf16 v[168:171], v[40:43], v[64:67], v[168:171]
    v_mfma_f32_16x16x32_bf16 v[172:175], v[40:43], v[68:71], v[172:175]
    ds_read_b64_tr_b16 v[52:53], v16 offset:2696
    ds_read_b64_tr_b16 v[54:55], v16 offset:2688
    v_mfma_f32_16x16x32_bf16 v[176:179], v[40:43], v[72:75], v[176:179]
    v_mfma_f32_16x16x32_bf16 v[180:183], v[40:43], v[76:79], v[180:183]
    ds_read_b128 v[128:131], v17 offset:256
    v_mfma_f32_16x16x32_bf16 v[184:187], v[40:43], v[80:83], v[184:187]
    ds_read_b64_tr_b16 v[56:57], v16 offset:3208
    ds_read_b64_tr_b16 v[58:59], v16 offset:3200
    v_mfma_f32_16x16x32_bf16 v[188:191], v[40:43], v[84:87], v[188:191]
    ds_read_b128 v[132:135], v17 offset:768
    ds_read_b128 v[136:139], v17 offset:1280
    s_waitcnt lgkmcnt(9)
    v_mfma_f32_16x16x32_bf16 v[172:175], v[44:47], v[64:67], v[172:175]
    ds_read_b64_tr_b16 v[60:61], v16 offset:3720
    ds_read_b64_tr_b16 v[62:63], v16 offset:3712
    v_mfma_f32_16x16x32_bf16 v[176:179], v[44:47], v[68:71], v[176:179]
    ds_read_b128 v[140:143], v17 offset:1792
    ds_read_b64_tr_b16 v[96:97], v16 offset:200
    v_mfma_f32_16x16x32_bf16 v[180:183], v[44:47], v[72:75], v[180:183]
    ds_read_b64_tr_b16 v[98:99], v16 offset:192
    ds_read_b128 v[144:147], v17 offset:2304
    v_mfma_f32_16x16x32_bf16 v[184:187], v[44:47], v[76:79], v[184:187]
    ds_read_b128 v[148:151], v17 offset:2816
    ds_read_b128 v[152:155], v17 offset:3328
    v_mfma_f32_16x16x32_bf16 v[188:191], v[44:47], v[80:83], v[188:191]
    ds_read_b128 v[156:159], v17 offset:3840
    s_waitcnt lgkmcnt(15)
    v_mfma_f32_16x16x32_bf16 v[176:179], v[48:51], v[64:67], v[176:179]
    v_mfma_f32_16x16x32_bf16 v[180:183], v[48:51], v[68:71], v[180:183]
    v_mfma_f32_16x16x32_bf16 v[184:187], v[48:51], v[72:75], v[184:187]
    v_mfma_f32_16x16x32_bf16 v[188:191], v[48:51], v[76:79], v[188:191]
    s_waitcnt lgkmcnt(14)
    v_mfma_f32_16x16x32_bf16 v[180:183], v[52:55], v[64:67], v[180:183]
    ds_read_b64_tr_b16 v[100:101], v16 offset:712
    ds_read_b64_tr_b16 v[102:103], v16 offset:704
    v_mfma_f32_16x16x32_bf16 v[184:187], v[52:55], v[68:71], v[184:187]
    v_mfma_f32_16x16x32_bf16 v[188:191], v[52:55], v[72:75], v[188:191]
    s_waitcnt lgkmcnt(13)
    v_mfma_f32_16x16x32_bf16 v[184:187], v[56:59], v[64:67], v[184:187]
    v_mfma_f32_16x16x32_bf16 v[188:191], v[56:59], v[68:71], v[188:191]
    s_waitcnt lgkmcnt(6)
    v_mfma_f32_16x16x32_bf16 v[188:191], v[60:63], v[64:67], v[188:191]
    v_mfma_f32_16x16x32_bf16 v[160:163], v[96:99], v[128:131], v[160:163]
    v_mfma_f32_16x16x32_bf16 v[164:167], v[96:99], v[132:135], v[164:167]
    ds_read_b64_tr_b16 v[104:105], v16 offset:1224
    ds_read_b64_tr_b16 v[106:107], v16 offset:1216
    v_mfma_f32_16x16x32_bf16 v[168:171], v[96:99], v[136:139], v[168:171]
    v_mfma_f32_16x16x32_bf16 v[172:175], v[96:99], v[140:143], v[172:175]
    s_waitcnt lgkmcnt(6)
    v_mfma_f32_16x16x32_bf16 v[176:179], v[96:99], v[144:147], v[176:179]
    v_mfma_f32_16x16x32_bf16 v[180:183], v[96:99], v[148:151], v[180:183]
    s_waitcnt lgkmcnt(4)
    v_mfma_f32_16x16x32_bf16 v[184:187], v[96:99], v[152:155], v[184:187]
    v_mfma_f32_16x16x32_bf16 v[188:191], v[96:99], v[156:159], v[188:191]
    ds_read_b64_tr_b16 v[108:109], v16 offset:1736
    ds_read_b64_tr_b16 v[110:111], v16 offset:1728
    s_waitcnt lgkmcnt(4)
    v_mfma_f32_16x16x32_bf16 v[164:167], v[100:103], v[128:131], v[164:167]
    v_mfma_f32_16x16x32_bf16 v[168:171], v[100:103], v[132:135], v[168:171]
    v_mfma_f32_16x16x32_bf16 v[172:175], v[100:103], v[136:139], v[172:175]
    v_mfma_f32_16x16x32_bf16 v[176:179], v[100:103], v[140:143], v[176:179]
    v_mfma_f32_16x16x32_bf16 v[180:183], v[100:103], v[144:147], v[180:183]
    ds_read_b64_tr_b16 v[112:113], v16 offset:2248
    ds_read_b64_tr_b16 v[114:115], v16 offset:2240
    v_mfma_f32_16x16x32_bf16 v[184:187], v[100:103], v[148:151], v[184:187]
    v_mfma_f32_16x16x32_bf16 v[188:191], v[100:103], v[152:155], v[188:191]
    s_waitcnt lgkmcnt(4)
    v_mfma_f32_16x16x32_bf16 v[168:171], v[104:107], v[128:131], v[168:171]
    v_mfma_f32_16x16x32_bf16 v[172:175], v[104:107], v[132:135], v[172:175]
    ds_read_b64_tr_b16 v[116:117], v16 offset:2760
    ds_read_b64_tr_b16 v[118:119], v16 offset:2752
    v_mfma_f32_16x16x32_bf16 v[176:179], v[104:107], v[136:139], v[176:179]
    v_mfma_f32_16x16x32_bf16 v[180:183], v[104:107], v[140:143], v[180:183]
    ds_read_b128 v[64:67], v17 offset:192
    v_mfma_f32_16x16x32_bf16 v[184:187], v[104:107], v[144:147], v[184:187]
    ds_read_b64_tr_b16 v[120:121], v16 offset:3272
    ds_read_b64_tr_b16 v[122:123], v16 offset:3264
    v_mfma_f32_16x16x32_bf16 v[188:191], v[104:107], v[148:151], v[188:191]
    ds_read_b128 v[68:71], v17 offset:704
    ds_read_b128 v[72:75], v17 offset:1216
    s_waitcnt lgkmcnt(9)
    v_mfma_f32_16x16x32_bf16 v[172:175], v[108:111], v[128:131], v[172:175]
    ds_read_b64_tr_b16 v[124:125], v16 offset:3784
    ds_read_b64_tr_b16 v[126:127], v16 offset:3776
    v_mfma_f32_16x16x32_bf16 v[176:179], v[108:111], v[132:135], v[176:179]
    ds_read_b128 v[76:79], v17 offset:1728
    ds_read_b64_tr_b16 v[32:33], v16 offset:264
    v_mfma_f32_16x16x32_bf16 v[180:183], v[108:111], v[136:139], v[180:183]
    ds_read_b64_tr_b16 v[34:35], v16 offset:256
    ds_read_b128 v[80:83], v17 offset:2240
    v_mfma_f32_16x16x32_bf16 v[184:187], v[108:111], v[140:143], v[184:187]
    ds_read_b128 v[84:87], v17 offset:2752
    ds_read_b128 v[88:91], v17 offset:3264
    v_mfma_f32_16x16x32_bf16 v[188:191], v[108:111], v[144:147], v[188:191]
    ds_read_b128 v[92:95], v17 offset:3776
    s_waitcnt lgkmcnt(15)
    v_mfma_f32_16x16x32_bf16 v[176:179], v[112:115], v[128:131], v[176:179]
    v_mfma_f32_16x16x32_bf16 v[180:183], v[112:115], v[132:135], v[180:183]
    v_mfma_f32_16x16x32_bf16 v[184:187], v[112:115], v[136:139], v[184:187]
    v_mfma_f32_16x16x32_bf16 v[188:191], v[112:115], v[140:143], v[188:191]
    s_waitcnt lgkmcnt(14)
    v_mfma_f32_16x16x32_bf16 v[180:183], v[116:119], v[128:131], v[180:183]
    ds_read_b64_tr_b16 v[36:37], v16 offset:776
    ds_read_b64_tr_b16 v[38:39], v16 offset:768
    v_mfma_f32_16x16x32_bf16 v[184:187], v[116:119], v[132:135], v[184:187]
    v_mfma_f32_16x16x32_bf16 v[188:191], v[116:119], v[136:139], v[188:191]
    s_waitcnt lgkmcnt(13)
    v_mfma_f32_16x16x32_bf16 v[184:187], v[120:123], v[128:131], v[184:187]
    v_mfma_f32_16x16x32_bf16 v[188:191], v[120:123], v[132:135], v[188:191]
    s_waitcnt lgkmcnt(6)
    v_mfma_f32_16x16x32_bf16 v[188:191], v[124:127], v[128:131], v[188:191]
    v_mfma_f32_16x16x32_bf16 v[160:163], v[32:35], v[64:67], v[160:163]
    v_mfma_f32_16x16x32_bf16 v[164:167], v[32:35], v[68:71], v[164:167]
    ds_read_b64_tr_b16 v[40:41], v16 offset:1288
    ds_read_b64_tr_b16 v[42:43], v16 offset:1280
    v_mfma_f32_16x16x32_bf16 v[168:171], v[32:35], v[72:75], v[168:171]
    v_mfma_f32_16x16x32_bf16 v[172:175], v[32:35], v[76:79], v[172:175]
    s_waitcnt lgkmcnt(6)
    v_mfma_f32_16x16x32_bf16 v[176:179], v[32:35], v[80:83], v[176:179]
    v_mfma_f32_16x16x32_bf16 v[180:183], v[32:35], v[84:87], v[180:183]
    s_waitcnt lgkmcnt(4)
    v_mfma_f32_16x16x32_bf16 v[184:187], v[32:35], v[88:91], v[184:187]
    v_mfma_f32_16x16x32_bf16 v[188:191], v[32:35], v[92:95], v[188:191]
    ds_read_b64_tr_b16 v[44:45], v16 offset:1800
    ds_read_b64_tr_b16 v[46:47], v16 offset:1792
    s_waitcnt lgkmcnt(4)
    v_mfma_f32_16x16x32_bf16 v[164:167], v[36:39], v[64:67], v[164:167]
    v_mfma_f32_16x16x32_bf16 v[168:171], v[36:39], v[68:71], v[168:171]
    v_mfma_f32_16x16x32_bf16 v[172:175], v[36:39], v[72:75], v[172:175]
    v_mfma_f32_16x16x32_bf16 v[176:179], v[36:39], v[76:79], v[176:179]
    v_mfma_f32_16x16x32_bf16 v[180:183], v[36:39], v[80:83], v[180:183]
    ds_read_b64_tr_b16 v[48:49], v16 offset:2312
    ds_read_b64_tr_b16 v[50:51], v16 offset:2304
    v_mfma_f32_16x16x32_bf16 v[184:187], v[36:39], v[84:87], v[184:187]
    v_mfma_f32_16x16x32_bf16 v[188:191], v[36:39], v[88:91], v[188:191]
    s_waitcnt lgkmcnt(4)
    v_mfma_f32_16x16x32_bf16 v[168:171], v[40:43], v[64:67], v[168:171]
    v_mfma_f32_16x16x32_bf16 v[172:175], v[40:43], v[68:71], v[172:175]
    ds_read_b64_tr_b16 v[52:53], v16 offset:2824
    ds_read_b64_tr_b16 v[54:55], v16 offset:2816
    v_mfma_f32_16x16x32_bf16 v[176:179], v[40:43], v[72:75], v[176:179]
    v_mfma_f32_16x16x32_bf16 v[180:183], v[40:43], v[76:79], v[180:183]
    ds_read_b128 v[128:131], v17 offset:128
    v_mfma_f32_16x16x32_bf16 v[184:187], v[40:43], v[80:83], v[184:187]
    ds_read_b64_tr_b16 v[56:57], v16 offset:3336
    ds_read_b64_tr_b16 v[58:59], v16 offset:3328
    v_mfma_f32_16x16x32_bf16 v[188:191], v[40:43], v[84:87], v[188:191]
    ds_read_b128 v[132:135], v17 offset:640
    ds_read_b128 v[136:139], v17 offset:1152
    s_waitcnt lgkmcnt(9)
    v_mfma_f32_16x16x32_bf16 v[172:175], v[44:47], v[64:67], v[172:175]
    ds_read_b64_tr_b16 v[60:61], v16 offset:3848
    ds_read_b64_tr_b16 v[62:63], v16 offset:3840
    v_mfma_f32_16x16x32_bf16 v[176:179], v[44:47], v[68:71], v[176:179]
    ds_read_b128 v[140:143], v17 offset:1664
    ds_read_b64_tr_b16 v[96:97], v16 offset:328
    v_mfma_f32_16x16x32_bf16 v[180:183], v[44:47], v[72:75], v[180:183]
    ds_read_b64_tr_b16 v[98:99], v16 offset:320
    ds_read_b128 v[144:147], v17 offset:2176
    v_mfma_f32_16x16x32_bf16 v[184:187], v[44:47], v[76:79], v[184:187]
    ds_read_b128 v[148:151], v17 offset:2688
    ds_read_b128 v[152:155], v17 offset:3200
    v_mfma_f32_16x16x32_bf16 v[188:191], v[44:47], v[80:83], v[188:191]
    ds_read_b128 v[156:159], v17 offset:3712
    s_waitcnt lgkmcnt(15)
    v_mfma_f32_16x16x32_bf16 v[176:179], v[48:51], v[64:67], v[176:179]
    v_mfma_f32_16x16x32_bf16 v[180:183], v[48:51], v[68:71], v[180:183]
    v_mfma_f32_16x16x32_bf16 v[184:187], v[48:51], v[72:75], v[184:187]
    v_mfma_f32_16x16x32_bf16 v[188:191], v[48:51], v[76:79], v[188:191]
    s_waitcnt lgkmcnt(14)
    v_mfma_f32_16x16x32_bf16 v[180:183], v[52:55], v[64:67], v[180:183]
    ds_read_b64_tr_b16 v[100:101], v16 offset:840
    ds_read_b64_tr_b16 v[102:103], v16 offset:832
    v_mfma_f32_16x16x32_bf16 v[184:187], v[52:55], v[68:71], v[184:187]
    v_mfma_f32_16x16x32_bf16 v[188:191], v[52:55], v[72:75], v[188:191]
    s_waitcnt lgkmcnt(13)
    v_mfma_f32_16x16x32_bf16 v[184:187], v[56:59], v[64:67], v[184:187]
    v_mfma_f32_16x16x32_bf16 v[188:191], v[56:59], v[68:71], v[188:191]
    s_waitcnt lgkmcnt(6)
    v_mfma_f32_16x16x32_bf16 v[188:191], v[60:63], v[64:67], v[188:191]
    v_mfma_f32_16x16x32_bf16 v[160:163], v[96:99], v[128:131], v[160:163]
    v_mfma_f32_16x16x32_bf16 v[164:167], v[96:99], v[132:135], v[164:167]
    ds_read_b64_tr_b16 v[104:105], v16 offset:1352
    ds_read_b64_tr_b16 v[106:107], v16 offset:1344
    v_mfma_f32_16x16x32_bf16 v[168:171], v[96:99], v[136:139], v[168:171]
    v_mfma_f32_16x16x32_bf16 v[172:175], v[96:99], v[140:143], v[172:175]
    s_waitcnt lgkmcnt(6)
    v_mfma_f32_16x16x32_bf16 v[176:179], v[96:99], v[144:147], v[176:179]
    v_mfma_f32_16x16x32_bf16 v[180:183], v[96:99], v[148:151], v[180:183]
    s_waitcnt lgkmcnt(4)
    v_mfma_f32_16x16x32_bf16 v[184:187], v[96:99], v[152:155], v[184:187]
    v_mfma_f32_16x16x32_bf16 v[188:191], v[96:99], v[156:159], v[188:191]
    ds_read_b64_tr_b16 v[108:109], v16 offset:1864
    ds_read_b64_tr_b16 v[110:111], v16 offset:1856
    s_waitcnt lgkmcnt(4)
    v_mfma_f32_16x16x32_bf16 v[164:167], v[100:103], v[128:131], v[164:167]
    v_mfma_f32_16x16x32_bf16 v[168:171], v[100:103], v[132:135], v[168:171]
    v_mfma_f32_16x16x32_bf16 v[172:175], v[100:103], v[136:139], v[172:175]
    v_mfma_f32_16x16x32_bf16 v[176:179], v[100:103], v[140:143], v[176:179]
    v_mfma_f32_16x16x32_bf16 v[180:183], v[100:103], v[144:147], v[180:183]
    ds_read_b64_tr_b16 v[112:113], v16 offset:2376
    ds_read_b64_tr_b16 v[114:115], v16 offset:2368
    v_mfma_f32_16x16x32_bf16 v[184:187], v[100:103], v[148:151], v[184:187]
    v_mfma_f32_16x16x32_bf16 v[188:191], v[100:103], v[152:155], v[188:191]
    s_waitcnt lgkmcnt(4)
    v_mfma_f32_16x16x32_bf16 v[168:171], v[104:107], v[128:131], v[168:171]
    v_mfma_f32_16x16x32_bf16 v[172:175], v[104:107], v[132:135], v[172:175]
    ds_read_b64_tr_b16 v[116:117], v16 offset:2888
    ds_read_b64_tr_b16 v[118:119], v16 offset:2880
    v_mfma_f32_16x16x32_bf16 v[176:179], v[104:107], v[136:139], v[176:179]
    v_mfma_f32_16x16x32_bf16 v[180:183], v[104:107], v[140:143], v[180:183]
    ds_read_b128 v[64:67], v17 offset:64
    v_mfma_f32_16x16x32_bf16 v[184:187], v[104:107], v[144:147], v[184:187]
    ds_read_b64_tr_b16 v[120:121], v16 offset:3400
    ds_read_b64_tr_b16 v[122:123], v16 offset:3392
    v_mfma_f32_16x16x32_bf16 v[188:191], v[104:107], v[148:151], v[188:191]
    ds_read_b128 v[68:71], v17 offset:576
    ds_read_b128 v[72:75], v17 offset:1088
    s_waitcnt lgkmcnt(9)
    v_mfma_f32_16x16x32_bf16 v[172:175], v[108:111], v[128:131], v[172:175]
    ds_read_b64_tr_b16 v[124:125], v16 offset:3912
    ds_read_b64_tr_b16 v[126:127], v16 offset:3904
    v_mfma_f32_16x16x32_bf16 v[176:179], v[108:111], v[132:135], v[176:179]
    ds_read_b128 v[76:79], v17 offset:1600
    ds_read_b64_tr_b16 v[32:33], v16 offset:392
    v_mfma_f32_16x16x32_bf16 v[180:183], v[108:111], v[136:139], v[180:183]
    ds_read_b64_tr_b16 v[34:35], v16 offset:384
    ds_read_b128 v[80:83], v17 offset:2112
    v_mfma_f32_16x16x32_bf16 v[184:187], v[108:111], v[140:143], v[184:187]
    ds_read_b128 v[84:87], v17 offset:2624
    ds_read_b128 v[88:91], v17 offset:3136
    v_mfma_f32_16x16x32_bf16 v[188:191], v[108:111], v[144:147], v[188:191]
    ds_read_b128 v[92:95], v17 offset:3648
    s_waitcnt lgkmcnt(15)
    v_mfma_f32_16x16x32_bf16 v[176:179], v[112:115], v[128:131], v[176:179]
    v_mfma_f32_16x16x32_bf16 v[180:183], v[112:115], v[132:135], v[180:183]
    v_mfma_f32_16x16x32_bf16 v[184:187], v[112:115], v[136:139], v[184:187]
    v_mfma_f32_16x16x32_bf16 v[188:191], v[112:115], v[140:143], v[188:191]
    s_waitcnt lgkmcnt(14)
    v_mfma_f32_16x16x32_bf16 v[180:183], v[116:119], v[128:131], v[180:183]
    ds_read_b64_tr_b16 v[36:37], v16 offset:904
    ds_read_b64_tr_b16 v[38:39], v16 offset:896
    v_mfma_f32_16x16x32_bf16 v[184:187], v[116:119], v[132:135], v[184:187]
    v_mfma_f32_16x16x32_bf16 v[188:191], v[116:119], v[136:139], v[188:191]
    s_waitcnt lgkmcnt(13)
    v_mfma_f32_16x16x32_bf16 v[184:187], v[120:123], v[128:131], v[184:187]
    v_mfma_f32_16x16x32_bf16 v[188:191], v[120:123], v[132:135], v[188:191]
    s_waitcnt lgkmcnt(6)
    v_mfma_f32_16x16x32_bf16 v[188:191], v[124:127], v[128:131], v[188:191]
    v_mfma_f32_16x16x32_bf16 v[160:163], v[32:35], v[64:67], v[160:163]
    v_mfma_f32_16x16x32_bf16 v[164:167], v[32:35], v[68:71], v[164:167]
    ds_read_b64_tr_b16 v[40:41], v16 offset:1416
    ds_read_b64_tr_b16 v[42:43], v16 offset:1408
    v_mfma_f32_16x16x32_bf16 v[168:171], v[32:35], v[72:75], v[168:171]
    v_mfma_f32_16x16x32_bf16 v[172:175], v[32:35], v[76:79], v[172:175]
    s_waitcnt lgkmcnt(6)
    v_mfma_f32_16x16x32_bf16 v[176:179], v[32:35], v[80:83], v[176:179]
    v_mfma_f32_16x16x32_bf16 v[180:183], v[32:35], v[84:87], v[180:183]
    s_waitcnt lgkmcnt(4)
    v_mfma_f32_16x16x32_bf16 v[184:187], v[32:35], v[88:91], v[184:187]
    v_mfma_f32_16x16x32_bf16 v[188:191], v[32:35], v[92:95], v[188:191]
    ds_read_b64_tr_b16 v[44:45], v16 offset:1928
    ds_read_b64_tr_b16 v[46:47], v16 offset:1920
    s_waitcnt lgkmcnt(4)
    v_mfma_f32_16x16x32_bf16 v[164:167], v[36:39], v[64:67], v[164:167]
    v_mfma_f32_16x16x32_bf16 v[168:171], v[36:39], v[68:71], v[168:171]
    v_mfma_f32_16x16x32_bf16 v[172:175], v[36:39], v[72:75], v[172:175]
    v_mfma_f32_16x16x32_bf16 v[176:179], v[36:39], v[76:79], v[176:179]
    v_mfma_f32_16x16x32_bf16 v[180:183], v[36:39], v[80:83], v[180:183]
    ds_read_b64_tr_b16 v[48:49], v16 offset:2440
    ds_read_b64_tr_b16 v[50:51], v16 offset:2432
    v_mfma_f32_16x16x32_bf16 v[184:187], v[36:39], v[84:87], v[184:187]
    v_mfma_f32_16x16x32_bf16 v[188:191], v[36:39], v[88:91], v[188:191]
    s_waitcnt lgkmcnt(4)
    v_mfma_f32_16x16x32_bf16 v[168:171], v[40:43], v[64:67], v[168:171]
    v_mfma_f32_16x16x32_bf16 v[172:175], v[40:43], v[68:71], v[172:175]
    ds_read_b64_tr_b16 v[52:53], v16 offset:2952
    ds_read_b64_tr_b16 v[54:55], v16 offset:2944
    v_mfma_f32_16x16x32_bf16 v[176:179], v[40:43], v[72:75], v[176:179]
    v_mfma_f32_16x16x32_bf16 v[180:183], v[40:43], v[76:79], v[180:183]
    ds_read_b128 v[128:131], v17 offset:0
    v_mfma_f32_16x16x32_bf16 v[184:187], v[40:43], v[80:83], v[184:187]
    ds_read_b64_tr_b16 v[56:57], v16 offset:3464
    ds_read_b64_tr_b16 v[58:59], v16 offset:3456
    v_mfma_f32_16x16x32_bf16 v[188:191], v[40:43], v[84:87], v[188:191]
    ds_read_b128 v[132:135], v17 offset:512
    ds_read_b128 v[136:139], v17 offset:1024
    s_waitcnt lgkmcnt(9)
    v_mfma_f32_16x16x32_bf16 v[172:175], v[44:47], v[64:67], v[172:175]
    ds_read_b64_tr_b16 v[60:61], v16 offset:3976
    ds_read_b64_tr_b16 v[62:63], v16 offset:3968
    v_mfma_f32_16x16x32_bf16 v[176:179], v[44:47], v[68:71], v[176:179]
    ds_read_b128 v[140:143], v17 offset:1536
    ds_read_b64_tr_b16 v[96:97], v16 offset:456
    v_mfma_f32_16x16x32_bf16 v[180:183], v[44:47], v[72:75], v[180:183]
    ds_read_b64_tr_b16 v[98:99], v16 offset:448
    ds_read_b128 v[144:147], v17 offset:2048
    v_mfma_f32_16x16x32_bf16 v[184:187], v[44:47], v[76:79], v[184:187]
    ds_read_b128 v[148:151], v17 offset:2560
    ds_read_b128 v[152:155], v17 offset:3072
    v_mfma_f32_16x16x32_bf16 v[188:191], v[44:47], v[80:83], v[188:191]
    ds_read_b128 v[156:159], v17 offset:3584
    s_waitcnt lgkmcnt(15)
    v_mfma_f32_16x16x32_bf16 v[176:179], v[48:51], v[64:67], v[176:179]
    v_mfma_f32_16x16x32_bf16 v[180:183], v[48:51], v[68:71], v[180:183]
    v_mfma_f32_16x16x32_bf16 v[184:187], v[48:51], v[72:75], v[184:187]
    v_mfma_f32_16x16x32_bf16 v[188:191], v[48:51], v[76:79], v[188:191]
    s_waitcnt lgkmcnt(14)
    v_mfma_f32_16x16x32_bf16 v[180:183], v[52:55], v[64:67], v[180:183]
    ds_read_b64_tr_b16 v[100:101], v16 offset:968
    ds_read_b64_tr_b16 v[102:103], v16 offset:960
    v_mfma_f32_16x16x32_bf16 v[184:187], v[52:55], v[68:71], v[184:187]
    v_mfma_f32_16x16x32_bf16 v[188:191], v[52:55], v[72:75], v[188:191]
    s_waitcnt lgkmcnt(13)
    v_mfma_f32_16x16x32_bf16 v[184:187], v[56:59], v[64:67], v[184:187]
    v_mfma_f32_16x16x32_bf16 v[188:191], v[56:59], v[68:71], v[188:191]
    s_waitcnt lgkmcnt(6)
    v_mfma_f32_16x16x32_bf16 v[188:191], v[60:63], v[64:67], v[188:191]
    v_mfma_f32_16x16x32_bf16 v[160:163], v[96:99], v[128:131], v[160:163]
    v_mfma_f32_16x16x32_bf16 v[164:167], v[96:99], v[132:135], v[164:167]
    ds_read_b64_tr_b16 v[104:105], v16 offset:1480
    ds_read_b64_tr_b16 v[106:107], v16 offset:1472
    v_mfma_f32_16x16x32_bf16 v[168:171], v[96:99], v[136:139], v[168:171]
    v_mfma_f32_16x16x32_bf16 v[172:175], v[96:99], v[140:143], v[172:175]
    s_waitcnt lgkmcnt(6)
    v_mfma_f32_16x16x32_bf16 v[176:179], v[96:99], v[144:147], v[176:179]
    v_mfma_f32_16x16x32_bf16 v[180:183], v[96:99], v[148:151], v[180:183]
    s_waitcnt lgkmcnt(4)
    v_mfma_f32_16x16x32_bf16 v[184:187], v[96:99], v[152:155], v[184:187]
    v_mfma_f32_16x16x32_bf16 v[188:191], v[96:99], v[156:159], v[188:191]
    ds_read_b64_tr_b16 v[108:109], v16 offset:1992
    ds_read_b64_tr_b16 v[110:111], v16 offset:1984
    s_waitcnt lgkmcnt(4)
    v_mfma_f32_16x16x32_bf16 v[164:167], v[100:103], v[128:131], v[164:167]
    v_mfma_f32_16x16x32_bf16 v[168:171], v[100:103], v[132:135], v[168:171]
    v_mfma_f32_16x16x32_bf16 v[172:175], v[100:103], v[136:139], v[172:175]
    v_mfma_f32_16x16x32_bf16 v[176:179], v[100:103], v[140:143], v[176:179]
    v_mfma_f32_16x16x32_bf16 v[180:183], v[100:103], v[144:147], v[180:183]
    ds_read_b64_tr_b16 v[112:113], v16 offset:2504
    ds_read_b64_tr_b16 v[114:115], v16 offset:2496
    v_mfma_f32_16x16x32_bf16 v[184:187], v[100:103], v[148:151], v[184:187]
    v_mfma_f32_16x16x32_bf16 v[188:191], v[100:103], v[152:155], v[188:191]
    s_waitcnt lgkmcnt(4)
    v_mfma_f32_16x16x32_bf16 v[168:171], v[104:107], v[128:131], v[168:171]
    v_mfma_f32_16x16x32_bf16 v[172:175], v[104:107], v[132:135], v[172:175]
    ds_read_b64_tr_b16 v[116:117], v16 offset:3016
    ds_read_b64_tr_b16 v[118:119], v16 offset:3008
    v_mfma_f32_16x16x32_bf16 v[176:179], v[104:107], v[136:139], v[176:179]
    v_mfma_f32_16x16x32_bf16 v[180:183], v[104:107], v[140:143], v[180:183]
    v_mfma_f32_16x16x32_bf16 v[184:187], v[104:107], v[144:147], v[184:187]
    ds_read_b64_tr_b16 v[120:121], v16 offset:3528
    ds_read_b64_tr_b16 v[122:123], v16 offset:3520
    v_mfma_f32_16x16x32_bf16 v[188:191], v[104:107], v[148:151], v[188:191]
    s_waitcnt lgkmcnt(6)
    v_mfma_f32_16x16x32_bf16 v[172:175], v[108:111], v[128:131], v[172:175]
    ds_read_b64_tr_b16 v[124:125], v16 offset:4040
    ds_read_b64_tr_b16 v[126:127], v16 offset:4032
    v_mfma_f32_16x16x32_bf16 v[176:179], v[108:111], v[132:135], v[176:179]
    v_mfma_f32_16x16x32_bf16 v[180:183], v[108:111], v[136:139], v[180:183]
    v_mfma_f32_16x16x32_bf16 v[184:187], v[108:111], v[140:143], v[184:187]
    v_mfma_f32_16x16x32_bf16 v[188:191], v[108:111], v[144:147], v[188:191]
    s_waitcnt lgkmcnt(6)
    v_mfma_f32_16x16x32_bf16 v[176:179], v[112:115], v[128:131], v[176:179]
    v_mfma_f32_16x16x32_bf16 v[180:183], v[112:115], v[132:135], v[180:183]
    v_mfma_f32_16x16x32_bf16 v[184:187], v[112:115], v[136:139], v[184:187]
    v_mfma_f32_16x16x32_bf16 v[188:191], v[112:115], v[140:143], v[188:191]
    s_waitcnt lgkmcnt(4)
    v_mfma_f32_16x16x32_bf16 v[180:183], v[116:119], v[128:131], v[180:183]
    v_mfma_f32_16x16x32_bf16 v[184:187], v[116:119], v[132:135], v[184:187]
    v_mfma_f32_16x16x32_bf16 v[188:191], v[116:119], v[136:139], v[188:191]
    s_waitcnt lgkmcnt(2)
    v_mfma_f32_16x16x32_bf16 v[184:187], v[120:123], v[128:131], v[184:187]
    v_mfma_f32_16x16x32_bf16 v[188:191], v[120:123], v[132:135], v[188:191]
    s_waitcnt lgkmcnt(0)
    v_mfma_f32_16x16x32_bf16 v[188:191], v[124:127], v[128:131], v[188:191]
    s_setprio 3
    s_add_u32 s29, s35, 17152
    v_add_u32 v5, s29, v15
    ds_read_b64 v[32:33], v5 offset:0
    ds_read_b64 v[34:35], v5 offset:512
    ds_read_b64 v[36:37], v5 offset:1024
    ds_read_b64 v[38:39], v5 offset:1536
    ds_read_b64 v[40:41], v5 offset:2048
    ds_read_b64 v[42:43], v5 offset:2560
    ds_read_b64 v[44:45], v5 offset:3072
    ds_read_b64 v[46:47], v5 offset:3584
    v_lshlrev_b32 v14, 16, v14
    s_mul_i32 s29, s34, 4224
    s_add_u32 s29, s29, 62914560
    s_waitcnt lgkmcnt(0)
    v_cvt_pk_bf16_f32 v52, v160, v161
    v_lshlrev_b32 v50, 16, v52
    v_and_b32 v51, 0xffff0000, v52
    v_lshlrev_b32 v53, 16, v32
    v_and_b32 v54, 0xffff0000, v32
    v_mul_f32 v53, v53, v14
    v_mul_f32 v54, v54, v14
    v_cvt_pk_bf16_f32 v52, v53, v54
    v_lshlrev_b32 v53, 16, v52
    v_and_b32 v54, 0xffff0000, v52
    v_add_f32 v50, v50, v53
    v_add_f32 v51, v51, v54
    v_cvt_pk_bf16_f32 v64, v50, v51
    v_cvt_pk_bf16_f32 v52, v162, v163
    v_lshlrev_b32 v50, 16, v52
    v_and_b32 v51, 0xffff0000, v52
    v_lshlrev_b32 v53, 16, v33
    v_and_b32 v54, 0xffff0000, v33
    v_mul_f32 v53, v53, v14
    v_mul_f32 v54, v54, v14
    v_cvt_pk_bf16_f32 v52, v53, v54
    v_lshlrev_b32 v53, 16, v52
    v_and_b32 v54, 0xffff0000, v52
    v_add_f32 v50, v50, v53
    v_add_f32 v51, v51, v54
    v_cvt_pk_bf16_f32 v65, v50, v51
    buffer_store_dwordx2 v[64:65], v15, s[4:7], s29 offen offset:0 sc1
    v_cvt_pk_bf16_f32 v52, v164, v165
    v_lshlrev_b32 v50, 16, v52
    v_and_b32 v51, 0xffff0000, v52
    v_lshlrev_b32 v53, 16, v34
    v_and_b32 v54, 0xffff0000, v34
    v_mul_f32 v53, v53, v14
    v_mul_f32 v54, v54, v14
    v_cvt_pk_bf16_f32 v52, v53, v54
    v_lshlrev_b32 v53, 16, v52
    v_and_b32 v54, 0xffff0000, v52
    v_add_f32 v50, v50, v53
    v_add_f32 v51, v51, v54
    v_cvt_pk_bf16_f32 v66, v50, v51
    v_cvt_pk_bf16_f32 v52, v166, v167
    v_lshlrev_b32 v50, 16, v52
    v_and_b32 v51, 0xffff0000, v52
    v_lshlrev_b32 v53, 16, v35
    v_and_b32 v54, 0xffff0000, v35
    v_mul_f32 v53, v53, v14
    v_mul_f32 v54, v54, v14
    v_cvt_pk_bf16_f32 v52, v53, v54
    v_lshlrev_b32 v53, 16, v52
    v_and_b32 v54, 0xffff0000, v52
    v_add_f32 v50, v50, v53
    v_add_f32 v51, v51, v54
    v_cvt_pk_bf16_f32 v67, v50, v51
    buffer_store_dwordx2 v[66:67], v15, s[4:7], s29 offen offset:512 sc1
    v_cvt_pk_bf16_f32 v52, v168, v169
    v_lshlrev_b32 v50, 16, v52
    v_and_b32 v51, 0xffff0000, v52
    v_lshlrev_b32 v53, 16, v36
    v_and_b32 v54, 0xffff0000, v36
    v_mul_f32 v53, v53, v14
    v_mul_f32 v54, v54, v14
    v_cvt_pk_bf16_f32 v52, v53, v54
    v_lshlrev_b32 v53, 16, v52
    v_and_b32 v54, 0xffff0000, v52
    v_add_f32 v50, v50, v53
    v_add_f32 v51, v51, v54
    v_cvt_pk_bf16_f32 v68, v50, v51
    v_cvt_pk_bf16_f32 v52, v170, v171
    v_lshlrev_b32 v50, 16, v52
    v_and_b32 v51, 0xffff0000, v52
    v_lshlrev_b32 v53, 16, v37
    v_and_b32 v54, 0xffff0000, v37
    v_mul_f32 v53, v53, v14
    v_mul_f32 v54, v54, v14
    v_cvt_pk_bf16_f32 v52, v53, v54
    v_lshlrev_b32 v53, 16, v52
    v_and_b32 v54, 0xffff0000, v52
    v_add_f32 v50, v50, v53
    v_add_f32 v51, v51, v54
    v_cvt_pk_bf16_f32 v69, v50, v51
    buffer_store_dwordx2 v[68:69], v15, s[4:7], s29 offen offset:1024 sc1
    v_cvt_pk_bf16_f32 v52, v172, v173
    v_lshlrev_b32 v50, 16, v52
    v_and_b32 v51, 0xffff0000, v52
    v_lshlrev_b32 v53, 16, v38
    v_and_b32 v54, 0xffff0000, v38
    v_mul_f32 v53, v53, v14
    v_mul_f32 v54, v54, v14
    v_cvt_pk_bf16_f32 v52, v53, v54
    v_lshlrev_b32 v53, 16, v52
    v_and_b32 v54, 0xffff0000, v52
    v_add_f32 v50, v50, v53
    v_add_f32 v51, v51, v54
    v_cvt_pk_bf16_f32 v70, v50, v51
    v_cvt_pk_bf16_f32 v52, v174, v175
    v_lshlrev_b32 v50, 16, v52
    v_and_b32 v51, 0xffff0000, v52
    v_lshlrev_b32 v53, 16, v39
    v_and_b32 v54, 0xffff0000, v39
    v_mul_f32 v53, v53, v14
    v_mul_f32 v54, v54, v14
    v_cvt_pk_bf16_f32 v52, v53, v54
    v_lshlrev_b32 v53, 16, v52
    v_and_b32 v54, 0xffff0000, v52
    v_add_f32 v50, v50, v53
    v_add_f32 v51, v51, v54
    v_cvt_pk_bf16_f32 v71, v50, v51
    buffer_store_dwordx2 v[70:71], v15, s[4:7], s29 offen offset:1536 sc1
    v_cvt_pk_bf16_f32 v52, v176, v177
    v_lshlrev_b32 v50, 16, v52
    v_and_b32 v51, 0xffff0000, v52
    v_lshlrev_b32 v53, 16, v40
    v_and_b32 v54, 0xffff0000, v40
    v_mul_f32 v53, v53, v14
    v_mul_f32 v54, v54, v14
    v_cvt_pk_bf16_f32 v52, v53, v54
    v_lshlrev_b32 v53, 16, v52
    v_and_b32 v54, 0xffff0000, v52
    v_add_f32 v50, v50, v53
    v_add_f32 v51, v51, v54
    v_cvt_pk_bf16_f32 v72, v50, v51
    v_cvt_pk_bf16_f32 v52, v178, v179
    v_lshlrev_b32 v50, 16, v52
    v_and_b32 v51, 0xffff0000, v52
    v_lshlrev_b32 v53, 16, v41
    v_and_b32 v54, 0xffff0000, v41
    v_mul_f32 v53, v53, v14
    v_mul_f32 v54, v54, v14
    v_cvt_pk_bf16_f32 v52, v53, v54
    v_lshlrev_b32 v53, 16, v52
    v_and_b32 v54, 0xffff0000, v52
    v_add_f32 v50, v50, v53
    v_add_f32 v51, v51, v54
    v_cvt_pk_bf16_f32 v73, v50, v51
    buffer_store_dwordx2 v[72:73], v15, s[4:7], s29 offen offset:2048 sc1
    v_cvt_pk_bf16_f32 v52, v180, v181
    v_lshlrev_b32 v50, 16, v52
    v_and_b32 v51, 0xffff0000, v52
    v_lshlrev_b32 v53, 16, v42
    v_and_b32 v54, 0xffff0000, v42
    v_mul_f32 v53, v53, v14
    v_mul_f32 v54, v54, v14
    v_cvt_pk_bf16_f32 v52, v53, v54
    v_lshlrev_b32 v53, 16, v52
    v_and_b32 v54, 0xffff0000, v52
    v_add_f32 v50, v50, v53
    v_add_f32 v51, v51, v54
    v_cvt_pk_bf16_f32 v74, v50, v51
    v_cvt_pk_bf16_f32 v52, v182, v183
    v_lshlrev_b32 v50, 16, v52
    v_and_b32 v51, 0xffff0000, v52
    v_lshlrev_b32 v53, 16, v43
    v_and_b32 v54, 0xffff0000, v43
    v_mul_f32 v53, v53, v14
    v_mul_f32 v54, v54, v14
    v_cvt_pk_bf16_f32 v52, v53, v54
    v_lshlrev_b32 v53, 16, v52
    v_and_b32 v54, 0xffff0000, v52
    v_add_f32 v50, v50, v53
    v_add_f32 v51, v51, v54
    v_cvt_pk_bf16_f32 v75, v50, v51
    buffer_store_dwordx2 v[74:75], v15, s[4:7], s29 offen offset:2560 sc1
    v_cvt_pk_bf16_f32 v52, v184, v185
    v_lshlrev_b32 v50, 16, v52
    v_and_b32 v51, 0xffff0000, v52
    v_lshlrev_b32 v53, 16, v44
    v_and_b32 v54, 0xffff0000, v44
    v_mul_f32 v53, v53, v14
    v_mul_f32 v54, v54, v14
    v_cvt_pk_bf16_f32 v52, v53, v54
    v_lshlrev_b32 v53, 16, v52
    v_and_b32 v54, 0xffff0000, v52
    v_add_f32 v50, v50, v53
    v_add_f32 v51, v51, v54
    v_cvt_pk_bf16_f32 v76, v50, v51
    v_cvt_pk_bf16_f32 v52, v186, v187
    v_lshlrev_b32 v50, 16, v52
    v_and_b32 v51, 0xffff0000, v52
    v_lshlrev_b32 v53, 16, v45
    v_and_b32 v54, 0xffff0000, v45
    v_mul_f32 v53, v53, v14
    v_mul_f32 v54, v54, v14
    v_cvt_pk_bf16_f32 v52, v53, v54
    v_lshlrev_b32 v53, 16, v52
    v_and_b32 v54, 0xffff0000, v52
    v_add_f32 v50, v50, v53
    v_add_f32 v51, v51, v54
    v_cvt_pk_bf16_f32 v77, v50, v51
    buffer_store_dwordx2 v[76:77], v15, s[4:7], s29 offen offset:3072 sc1
    v_cvt_pk_bf16_f32 v52, v188, v189
    v_lshlrev_b32 v50, 16, v52
    v_and_b32 v51, 0xffff0000, v52
    v_lshlrev_b32 v53, 16, v46
    v_and_b32 v54, 0xffff0000, v46
    v_mul_f32 v53, v53, v14
    v_mul_f32 v54, v54, v14
    v_cvt_pk_bf16_f32 v52, v53, v54
    v_lshlrev_b32 v53, 16, v52
    v_and_b32 v54, 0xffff0000, v52
    v_add_f32 v50, v50, v53
    v_add_f32 v51, v51, v54
    v_cvt_pk_bf16_f32 v78, v50, v51
    v_cvt_pk_bf16_f32 v52, v190, v191
    v_lshlrev_b32 v50, 16, v52
    v_and_b32 v51, 0xffff0000, v52
    v_lshlrev_b32 v53, 16, v47
    v_and_b32 v54, 0xffff0000, v47
    v_mul_f32 v53, v53, v14
    v_mul_f32 v54, v54, v14
    v_cvt_pk_bf16_f32 v52, v53, v54
    v_lshlrev_b32 v53, 16, v52
    v_and_b32 v54, 0xffff0000, v52
    v_add_f32 v50, v50, v53
    v_add_f32 v51, v51, v54
    v_cvt_pk_bf16_f32 v79, v50, v51
    buffer_store_dwordx2 v[78:79], v15, s[4:7], s29 offen offset:3584 sc1
    s_waitcnt vmcnt(0)
    s_mov_b64 exec, 1
    v_mov_b32 v2, 71680
    v_mov_b32 v3, 1
    ds_add_rtn_u32 v4, v2, v3
    s_waitcnt lgkmcnt(0)
    v_readfirstlane_b32 s29, v4
    s_nop 0
    s_add_u32 s29, s29, 1
    s_and_b32 s29, s29, 3
    s_cmp_lg_u32 s29, s36
    s_cbranch_scc1 T_END
    s_lshr_b32 s3, s2, 5
    s_lshl_b32 s3, s3, 12
    s_and_b32 s29, s2, 31
    s_lshl_b32 s29, s29, 2
    s_add_u32 s3, s3, s29
    s_add_u32 s3, s3, 66584576
    buffer_store_dword v3, v8, s[4:7], s3 offen sc1
T_WEND:
    s_waitcnt vmcnt(0)
T_END:
    s_endpgm
M_END:
    s_endpgm
AT_S1_EV:
    s_cmp_eq_u32 s48, s56
    s_cselect_b32 s53, 16384, s53
    s_cselect_b32 s22, 16777216, s22
    s_sub_u32 s37, s48, s56
    s_cmp_eq_u32 s37, 3
    s_cselect_b32 s18, 16777216, s18
    s_cmp_eq_u32 s37, 2
    s_cselect_b32 s38, s40, 0
    v_add_u32 v2, s38, v2
    s_cmp_eq_u32 s37, 5
    s_cselect_b32 s38, s40, 0
    v_add_u32 v3, s38, v3
    s_cmp_eq_u32 s48, 31
    s_cselect_b32 s22, 0, s22
    s_sub_u32 s37, s48, s47
    s_cmp_lg_u32 s37, 2
    s_cbranch_scc1 AT_S1_E1
    v_rcp_f32 v10, v248
    v_rcp_f32 v11, v252
    v_mov_b32 v248, 0
    v_mov_b32 v249, 0
    v_mov_b32 v250, 0
    v_mov_b32 v251, 0
    v_mov_b32 v252, 0
    v_mov_b32 v253, 0
    v_mov_b32 v254, 0
    v_mov_b32 v255, 0
    v_mul_f32 v140, v140, v10
    v_mul_f32 v141, v141, v10
    v_mul_f32 v142, v142, v10
    v_mul_f32 v143, v143, v10
    v_mul_f32 v144, v144, v10
    v_mul_f32 v145, v145, v10
    v_mul_f32 v146, v146, v10
    v_mul_f32 v147, v147, v10
    v_mul_f32 v148, v148, v10
    v_mul_f32 v149, v149, v10
    v_mul_f32 v150, v150, v10
    v_mul_f32 v151, v151, v10
    v_mul_f32 v152, v152, v10
    v_mul_f32 v153, v153, v10
    v_mul_f32 v154, v154, v10
    v_mul_f32 v155, v155, v10
    v_mul_f32 v156, v156, v10
    v_mul_f32 v157, v157, v10
    v_mul_f32 v158, v158, v10
    v_mul_f32 v159, v159, v10
    v_mul_f32 v160, v160, v10
    v_mul_f32 v161, v161, v10
    v_mul_f32 v162, v162, v10
    v_mul_f32 v163, v163, v10
    v_mul_f32 v164, v164, v10
    v_mul_f32 v165, v165, v10
    v_mul_f32 v166, v166, v10
    v_mul_f32 v167, v167, v10
    v_mul_f32 v168, v168, v10
    v_mul_f32 v169, v169, v10
    v_mul_f32 v170, v170, v10
    v_mul_f32 v171, v171, v10
    v_mul_f32 v172, v172, v11
    v_mul_f32 v173, v173, v11
    v_mul_f32 v174, v174, v11
    v_mul_f32 v175, v175, v11
    v_mul_f32 v176, v176, v11
    v_mul_f32 v177, v177, v11
    v_mul_f32 v178, v178, v11
    v_mul_f32 v179, v179, v11
    v_mul_f32 v180, v180, v11
    v_mul_f32 v181, v181, v11
    v_mul_f32 v182, v182, v11
    v_mul_f32 v183, v183, v11
    v_mul_f32 v184, v184, v11
    v_mul_f32 v185, v185, v11
    v_mul_f32 v186, v186, v11
    v_mul_f32 v187, v187, v11
    v_mul_f32 v188, v188, v11
    v_mul_f32 v189, v189, v11
    v_mul_f32 v190, v190, v11
    v_mul_f32 v191, v191, v11
    v_mul_f32 v192, v192, v11
    v_mul_f32 v193, v193, v11
    v_mul_f32 v194, v194, v11
    v_mul_f32 v195, v195, v11
    v_mul_f32 v196, v196, v11
    v_mul_f32 v197, v197, v11
    v_mul_f32 v198, v198, v11
    v_mul_f32 v199, v199, v11
    v_mul_f32 v200, v200, v11
    v_mul_f32 v201, v201, v11
    v_mul_f32 v202, v202, v11
    v_mul_f32 v203, v203, v11
    v_cvt_pk_bf16_f32 v16, v140, v141
    v_cvt_pk_bf16_f32 v17, v142, v143
    v_cvt_pk_bf16_f32 v18, v144, v145
    v_cvt_pk_bf16_f32 v19, v146, v147
    buffer_store_dwordx4 v[16:19], v1, s[12:15], s54 offen offset:0 sc1
    v_cvt_pk_bf16_f32 v20, v148, v149
    v_cvt_pk_bf16_f32 v21, v150, v151
    v_cvt_pk_bf16_f32 v22, v152, v153
    v_cvt_pk_bf16_f32 v23, v154, v155
    buffer_store_dwordx4 v[20:23], v1, s[12:15], s54 offen offset:1024 sc1
    v_cvt_pk_bf16_f32 v16, v156, v157
    v_cvt_pk_bf16_f32 v17, v158, v159
    v_cvt_pk_bf16_f32 v18, v160, v161
    v_cvt_pk_bf16_f32 v19, v162, v163
    buffer_store_dwordx4 v[16:19], v1, s[12:15], s54 offen offset:2048 sc1
    v_cvt_pk_bf16_f32 v20, v164, v165
    v_cvt_pk_bf16_f32 v21, v166, v167
    v_cvt_pk_bf16_f32 v22, v168, v169
    v_cvt_pk_bf16_f32 v23, v170, v171
    buffer_store_dwordx4 v[20:23], v1, s[12:15], s54 offen offset:3072 sc1
    v_cvt_pk_bf16_f32 v16, v172, v173
    v_cvt_pk_bf16_f32 v17, v174, v175
    v_cvt_pk_bf16_f32 v18, v176, v177
    v_cvt_pk_bf16_f32 v19, v178, v179
    s_add_u32 s54, s54, 528384
    buffer_store_dwordx4 v[16:19], v1, s[12:15], s54 offen offset:0 sc1
    v_cvt_pk_bf16_f32 v20, v180, v181
    v_cvt_pk_bf16_f32 v21, v182, v183
    v_cvt_pk_bf16_f32 v22, v184, v185
    v_cvt_pk_bf16_f32 v23, v186, v187
    buffer_store_dwordx4 v[20:23], v1, s[12:15], s54 offen offset:1024 sc1
    v_cvt_pk_bf16_f32 v16, v188, v189
    v_cvt_pk_bf16_f32 v17, v190, v191
    v_cvt_pk_bf16_f32 v18, v192, v193
    v_cvt_pk_bf16_f32 v19, v194, v195
    buffer_store_dwordx4 v[16:19], v1, s[12:15], s54 offen offset:2048 sc1
    v_cvt_pk_bf16_f32 v20, v196, v197
    v_cvt_pk_bf16_f32 v21, v198, v199
    v_cvt_pk_bf16_f32 v22, v200, v201
    v_cvt_pk_bf16_f32 v23, v202, v203
    buffer_store_dwordx4 v[20:23], v1, s[12:15], s54 offen offset:3072 sc1
    v_mov_b32 v140, 0
    v_mov_b32 v141, 0
    v_mov_b32 v142, 0
    v_mov_b32 v143, 0
    v_mov_b32 v144, 0
    v_mov_b32 v145, 0
    v_mov_b32 v146, 0
    v_mov_b32 v147, 0
    v_mov_b32 v148, 0
    v_mov_b32 v149, 0
    v_mov_b32 v150, 0
    v_mov_b32 v151, 0
    v_mov_b32 v152, 0
    v_mov_b32 v153, 0
    v_mov_b32 v154, 0
    v_mov_b32 v155, 0
    v_mov_b32 v156, 0
    v_mov_b32 v157, 0
    v_mov_b32 v158, 0
    v_mov_b32 v159, 0
    v_mov_b32 v160, 0
    v_mov_b32 v161, 0
    v_mov_b32 v162, 0
    v_mov_b32 v163, 0
    v_mov_b32 v164, 0
    v_mov_b32 v165, 0
    v_mov_b32 v166, 0
    v_mov_b32 v167, 0
    v_mov_b32 v168, 0
    v_mov_b32 v169, 0
    v_mov_b32 v170, 0
    v_mov_b32 v171, 0
    v_mov_b32 v172, 0
    v_mov_b32 v173, 0
    v_mov_b32 v174, 0
    v_mov_b32 v175, 0
    v_mov_b32 v176, 0
    v_mov_b32 v177, 0
    v_mov_b32 v178, 0
    v_mov_b32 v179, 0
    v_mov_b32 v180, 0
    v_mov_b32 v181, 0
    v_mov_b32 v182, 0
    v_mov_b32 v183, 0
    v_mov_b32 v184, 0
    v_mov_b32 v185, 0
    v_mov_b32 v186, 0
    v_mov_b32 v187, 0
    v_mov_b32 v188, 0
    v_mov_b32 v189, 0
    v_mov_b32 v190, 0
    v_mov_b32 v191, 0
    v_mov_b32 v192, 0
    v_mov_b32 v193, 0
    v_mov_b32 v194, 0
    v_mov_b32 v195, 0
    v_mov_b32 v196, 0
    v_mov_b32 v197, 0
    v_mov_b32 v198, 0
    v_mov_b32 v199, 0
    v_mov_b32 v200, 0
    v_mov_b32 v201, 0
    v_mov_b32 v202, 0
    v_mov_b32 v203, 0
AT_S1_E1:
    s_cmp_lg_u32 s32, 0
    s_cbranch_scc1 ONLY_21
    s_cmp_lg_u32 s37, 3
    s_cbranch_scc1 ONLY_21
    s_mov_b64 exec, 1
    v_mov_b32 v10, 1
    s_lshl_b32 s3, s34, 10
    s_add_u32 s3, s3, s33
    s_lshl_b32 s3, s3, 2
    s_add_u32 s3, s3, 66846720
    buffer_store_dword v10, v25, s[12:15], s3 offen sc1
    s_mov_b64 exec, -1
ONLY_21:
    s_cmp_lg_u32 s37, 0
    s_cbranch_scc1 AT_S1_E2
    ds_read_b128 v[204:207], v5 offset:32768
    ds_read_b128 v[208:211], v5 offset:33792
    ds_read_b128 v[212:215], v5 offset:34816
    ds_read_b128 v[216:219], v5 offset:35840
    ds_read_b128 v[220:223], v5 offset:49152
    ds_read_b128 v[224:227], v5 offset:50176
    ds_read_b128 v[228:231], v5 offset:51200
    ds_read_b128 v[232:235], v5 offset:52224
    v_mov_b32 v236, 0
    v_mov_b32 v237, 0
    v_mov_b32 v238, 0
    v_mov_b32 v239, 0
    v_mov_b32 v240, 0
    v_mov_b32 v241, 0
    v_mov_b32 v242, 0
    v_mov_b32 v243, 0
    s_waitcnt lgkmcnt(0)
AT_S1_E2:
    s_sub_u32 s38, s48, s49
    s_sub_u32 s38, s38, 1
    s_cmp_lt_u32 s38, 4
    s_cbranch_scc1 AT_S1_EM
    s_cmp_lt_u32 s48, 33
    s_cbranch_scc1 AT_S1_E3
    s_sub_u32 s38, s48, 33
    s_lshl_b32 s38, s38, 1
    s_add_u32 s38, s38, s35
AT_S1_EM:
    s_lshl_b32 s38, s38, 5
    v_subrev_u32 v10, s38, v4
    v_add_u32 v11, 64, v10
    v_cmp_le_i32 s[4:5], 0, v10
    v_cmp_le_i32 s[6:7], 1, v10
    v_cmp_le_i32 s[8:9], 2, v10
    v_cmp_le_i32 s[10:11], 3, v10
    v_cndmask_b32 v108, v8, v108, s[4:5]
    v_cndmask_b32 v109, v8, v109, s[6:7]
    v_cndmask_b32 v110, v8, v110, s[8:9]
    v_cndmask_b32 v111, v8, v111, s[10:11]
    v_cmp_le_i32 s[4:5], 16, v10
    v_cmp_le_i32 s[6:7], 17, v10
    v_cmp_le_i32 s[8:9], 18, v10
    v_cmp_le_i32 s[10:11], 19, v10
    v_cndmask_b32 v112, v8, v112, s[4:5]
    v_cndmask_b32 v113, v8, v113, s[6:7]
    v_cndmask_b32 v114, v8, v114, s[8:9]
    v_cndmask_b32 v115, v8, v115, s[10:11]
    v_cmp_le_i32 s[4:5], 0, v11
    v_cmp_le_i32 s[6:7], 1, v11
    v_cmp_le_i32 s[8:9], 2, v11
    v_cmp_le_i32 s[10:11], 3, v11
    v_cndmask_b32 v116, v8, v116, s[4:5]
    v_cndmask_b32 v117, v8, v117, s[6:7]
    v_cndmask_b32 v118, v8, v118, s[8:9]
    v_cndmask_b32 v119, v8, v119, s[10:11]
    v_cmp_le_i32 s[4:5], 16, v11
    v_cmp_le_i32 s[6:7], 17, v11
    v_cmp_le_i32 s[8:9], 18, v11
    v_cmp_le_i32 s[10:11], 19, v11
    v_cndmask_b32 v120, v8, v120, s[4:5]
    v_cndmask_b32 v121, v8, v121, s[6:7]
    v_cndmask_b32 v122, v8, v122, s[8:9]
    v_cndmask_b32 v123, v8, v123, s[10:11]
AT_S1_E3:
    s_cmp_eq_u32 s37, 1
    s_cbranch_scc1 AT_S1_E4
    s_cmp_lg_u32 s48, 1
    s_cbranch_scc1 AT_S1_GO
AT_S1_E4:
    v_max3_f32 v10, v108, v109, v110
    v_max3_f32 v10, v10, v111, v112
    v_max3_f32 v10, v10, v113, v114
    v_max_f32 v10, v10, v115
    v_mov_b32 v12, v10
    s_nop 1
    v_permlane16_swap_b32 v10, v12
    v_max_f32 v10, v10, v12
    v_mov_b32 v12, v10
    s_nop 1
    v_permlane32_swap_b32 v10, v12
    v_max_f32 v10, v10, v12
    v_add_f32 v10, 0x41400000, v10
    v_max3_f32 v11, v116, v117, v118
    v_max3_f32 v11, v11, v119, v120
    v_max3_f32 v11, v11, v121, v122
    v_max_f32 v11, v11, v123
    v_mov_b32 v13, v11
    s_nop 1
    v_permlane16_swap_b32 v11, v13
    v_max_f32 v11, v11, v13
    v_mov_b32 v13, v11
    s_nop 1
    v_permlane32_swap_b32 v11, v13
    v_max_f32 v11, v11, v13
    v_add_f32 v11, 0x41400000, v11
    v_sub_f32 v236, v236, v10
    v_sub_f32 v237, v237, v10
    v_sub_f32 v238, v238, v10
    v_sub_f32 v239, v239, v10
    v_sub_f32 v240, v240, v11
    v_sub_f32 v241, v241, v11
    v_sub_f32 v242, v242, v11
    v_sub_f32 v243, v243, v11
    v_sub_f32 v108, v108, v10
    v_sub_f32 v109, v109, v10
    v_sub_f32 v110, v110, v10
    v_sub_f32 v111, v111, v10
    v_sub_f32 v112, v112, v10
    v_sub_f32 v113, v113, v10
    v_sub_f32 v114, v114, v10
    v_sub_f32 v115, v115, v10
    v_sub_f32 v116, v116, v11
    v_sub_f32 v117, v117, v11
    v_sub_f32 v118, v118, v11
    v_sub_f32 v119, v119, v11
    v_sub_f32 v120, v120, v11
    v_sub_f32 v121, v121, v11
    v_sub_f32 v122, v122, v11
    v_sub_f32 v123, v123, v11
    s_branch AT_S1_GO
AT_S1_SLOW:
    v_max3_f32 v10, v108, v109, v110
    v_max3_f32 v10, v10, v111, v112
    v_max3_f32 v10, v10, v113, v114
    v_max_f32 v10, v10, v115
    v_mov_b32 v12, v10
    s_nop 1
    v_permlane16_swap_b32 v10, v12
    v_max_f32 v10, v10, v12
    v_mov_b32 v12, v10
    s_nop 1
    v_permlane32_swap_b32 v10, v12
    v_max_f32 v10, v10, v12
    v_add_f32 v10, 0x41400000, v10
    v_max_f32 v10, 0, v10
    v_exp_f32 v12, -v10
    v_max3_f32 v11, v116, v117, v118
    v_max3_f32 v11, v11, v119, v120
    v_max3_f32 v11, v11, v121, v122
    v_max_f32 v11, v11, v123
    v_mov_b32 v13, v11
    s_nop 1
    v_permlane16_swap_b32 v11, v13
    v_max_f32 v11, v11, v13
    v_mov_b32 v13, v11
    s_nop 1
    v_permlane32_swap_b32 v11, v13
    v_max_f32 v11, v11, v13
    v_add_f32 v11, 0x41400000, v11
    v_max_f32 v11, 0, v11
    v_exp_f32 v13, -v11
    v_sub_f32 v236, v236, v10
    v_sub_f32 v237, v237, v10
    v_sub_f32 v238, v238, v10
    v_sub_f32 v239, v239, v10
    v_sub_f32 v240, v240, v11
    v_sub_f32 v241, v241, v11
    v_sub_f32 v242, v242, v11
    v_sub_f32 v243, v243, v11
    v_sub_f32 v124, v124, v10
    v_sub_f32 v125, v125, v10
    v_sub_f32 v126, v126, v10
    v_sub_f32 v127, v127, v10
    v_sub_f32 v128, v128, v10
    v_sub_f32 v129, v129, v10
    v_sub_f32 v130, v130, v10
    v_sub_f32 v131, v131, v10
    v_sub_f32 v132, v132, v11
    v_sub_f32 v133, v133, v11
    v_sub_f32 v134, v134, v11
    v_sub_f32 v135, v135, v11
    v_sub_f32 v136, v136, v11
    v_sub_f32 v137, v137, v11
    v_sub_f32 v138, v138, v11
    v_sub_f32 v139, v139, v11
    v_sub_f32 v108, v108, v10
    v_sub_f32 v109, v109, v10
    v_sub_f32 v110, v110, v10
    v_sub_f32 v111, v111, v10
    v_sub_f32 v112, v112, v10
    v_sub_f32 v113, v113, v10
    v_sub_f32 v114, v114, v10
    v_sub_f32 v115, v115, v10
    v_sub_f32 v116, v116, v11
    v_sub_f32 v117, v117, v11
    v_sub_f32 v118, v118, v11
    v_sub_f32 v119, v119, v11
    v_sub_f32 v120, v120, v11
    v_sub_f32 v121, v121, v11
    v_sub_f32 v122, v122, v11
    v_sub_f32 v123, v123, v11
    v_mul_f32 v140, v140, v12
    v_mul_f32 v141, v141, v12
    v_mul_f32 v142, v142, v12
    v_mul_f32 v143, v143, v12
    v_mul_f32 v144, v144, v12
    v_mul_f32 v145, v145, v12
    v_mul_f32 v146, v146, v12
    v_mul_f32 v147, v147, v12
    v_mul_f32 v148, v148, v12
    v_mul_f32 v149, v149, v12
    v_mul_f32 v150, v150, v12
    v_mul_f32 v151, v151, v12
    v_mul_f32 v152, v152, v12
    v_mul_f32 v153, v153, v12
    v_mul_f32 v154, v154, v12
    v_mul_f32 v155, v155, v12
    v_mul_f32 v156, v156, v12
    v_mul_f32 v157, v157, v12
    v_mul_f32 v158, v158, v12
    v_mul_f32 v159, v159, v12
    v_mul_f32 v160, v160, v12
    v_mul_f32 v161, v161, v12
    v_mul_f32 v162, v162, v12
    v_mul_f32 v163, v163, v12
    v_mul_f32 v164, v164, v12
    v_mul_f32 v165, v165, v12
    v_mul_f32 v166, v166, v12
    v_mul_f32 v167, v167, v12
    v_mul_f32 v168, v168, v12
    v_mul_f32 v169, v169, v12
    v_mul_f32 v170, v170, v12
    v_mul_f32 v171, v171, v12
    v_mul_f32 v172, v172, v13
    v_mul_f32 v173, v173, v13
    v_mul_f32 v174, v174, v13
    v_mul_f32 v175, v175, v13
    v_mul_f32 v176, v176, v13
    v_mul_f32 v177, v177, v13
    v_mul_f32 v178, v178, v13
    v_mul_f32 v179, v179, v13
    v_mul_f32 v180, v180, v13
    v_mul_f32 v181, v181, v13
    v_mul_f32 v182, v182, v13
    v_mul_f32 v183, v183, v13
    v_mul_f32 v184, v184, v13
    v_mul_f32 v185, v185, v13
    v_mul_f32 v186, v186, v13
    v_mul_f32 v187, v187, v13
    v_mul_f32 v188, v188, v13
    v_mul_f32 v189, v189, v13
    v_mul_f32 v190, v190, v13
    v_mul_f32 v191, v191, v13
    v_mul_f32 v192, v192, v13
    v_mul_f32 v193, v193, v13
    v_mul_f32 v194, v194, v13
    v_mul_f32 v195, v195, v13
    v_mul_f32 v196, v196, v13
    v_mul_f32 v197, v197, v13
    v_mul_f32 v198, v198, v13
    v_mul_f32 v199, v199, v13
    v_mul_f32 v200, v200, v13
    v_mul_f32 v201, v201, v13
    v_mul_f32 v202, v202, v13
    v_mul_f32 v203, v203, v13
    v_mul_f32 v248, v248, v12
    v_mul_f32 v249, v249, v12
    v_mul_f32 v250, v250, v12
    v_mul_f32 v251, v251, v12
    v_mul_f32 v252, v252, v13
    v_mul_f32 v253, v253, v13
    v_mul_f32 v254, v254, v13
    v_mul_f32 v255, v255, v13
    v_exp_f32 v16, v108
    v_exp_f32 v17, v109
    v_exp_f32 v18, v110
    v_exp_f32 v19, v111
    v_cvt_pk_bf16_f32 v92, v16, v17
    v_exp_f32 v20, v112
    v_exp_f32 v21, v113
    v_cvt_pk_bf16_f32 v93, v18, v19
    v_exp_f32 v22, v114
    v_exp_f32 v23, v115
    v_cvt_pk_bf16_f32 v94, v20, v21
    v_exp_f32 v16, v116
    v_exp_f32 v17, v117
    v_cvt_pk_bf16_f32 v95, v22, v23
    v_or3_b32 v9, v92, v93, v94
    v_exp_f32 v18, v118
    v_exp_f32 v19, v119
    v_cvt_pk_bf16_f32 v96, v16, v17
    v_exp_f32 v20, v120
    v_exp_f32 v21, v121
    v_cvt_pk_bf16_f32 v97, v18, v19
    v_or3_b32 v9, v9, v95, v96
    v_exp_f32 v22, v122
    v_exp_f32 v23, v123
    v_cvt_pk_bf16_f32 v98, v20, v21
    v_cvt_pk_bf16_f32 v99, v22, v23
    v_or3_b32 v9, v9, v97, v98
    v_bitop3_b32 v9, v9, v99, s50 bitop3:0xa8
    s_branch AT_S1_RET
AT_S2_EV:
    s_cmp_eq_u32 s48, s56
    s_cselect_b32 s53, 16384, s53
    s_cselect_b32 s22, 16777216, s22
    s_sub_u32 s37, s48, s56
    s_cmp_eq_u32 s37, 3
    s_cselect_b32 s18, 16777216, s18
    s_cmp_eq_u32 s37, 2
    s_cselect_b32 s38, s40, 0
    v_add_u32 v2, s38, v2
    s_cmp_eq_u32 s37, 5
    s_cselect_b32 s38, s40, 0
    v_add_u32 v3, s38, v3
    s_cmp_eq_u32 s48, 31
    s_cselect_b32 s22, 0, s22
    s_sub_u32 s37, s48, s47
    s_cmp_lg_u32 s37, 2
    s_cbranch_scc1 AT_S2_E1
    v_rcp_f32 v10, v248
    v_rcp_f32 v11, v252
    v_mov_b32 v248, 0
    v_mov_b32 v249, 0
    v_mov_b32 v250, 0
    v_mov_b32 v251, 0
    v_mov_b32 v252, 0
    v_mov_b32 v253, 0
    v_mov_b32 v254, 0
    v_mov_b32 v255, 0
    v_mul_f32 v140, v140, v10
    v_mul_f32 v141, v141, v10
    v_mul_f32 v142, v142, v10
    v_mul_f32 v143, v143, v10
    v_mul_f32 v144, v144, v10
    v_mul_f32 v145, v145, v10
    v_mul_f32 v146, v146, v10
    v_mul_f32 v147, v147, v10
    v_mul_f32 v148, v148, v10
    v_mul_f32 v149, v149, v10
    v_mul_f32 v150, v150, v10
    v_mul_f32 v151, v151, v10
    v_mul_f32 v152, v152, v10
    v_mul_f32 v153, v153, v10
    v_mul_f32 v154, v154, v10
    v_mul_f32 v155, v155, v10
    v_mul_f32 v156, v156, v10
    v_mul_f32 v157, v157, v10
    v_mul_f32 v158, v158, v10
    v_mul_f32 v159, v159, v10
    v_mul_f32 v160, v160, v10
    v_mul_f32 v161, v161, v10
    v_mul_f32 v162, v162, v10
    v_mul_f32 v163, v163, v10
    v_mul_f32 v164, v164, v10
    v_mul_f32 v165, v165, v10
    v_mul_f32 v166, v166, v10
    v_mul_f32 v167, v167, v10
    v_mul_f32 v168, v168, v10
    v_mul_f32 v169, v169, v10
    v_mul_f32 v170, v170, v10
    v_mul_f32 v171, v171, v10
    v_mul_f32 v172, v172, v11
    v_mul_f32 v173, v173, v11
    v_mul_f32 v174, v174, v11
    v_mul_f32 v175, v175, v11
    v_mul_f32 v176, v176, v11
    v_mul_f32 v177, v177, v11
    v_mul_f32 v178, v178, v11
    v_mul_f32 v179, v179, v11
    v_mul_f32 v180, v180, v11
    v_mul_f32 v181, v181, v11
    v_mul_f32 v182, v182, v11
    v_mul_f32 v183, v183, v11
    v_mul_f32 v184, v184, v11
    v_mul_f32 v185, v185, v11
    v_mul_f32 v186, v186, v11
    v_mul_f32 v187, v187, v11
    v_mul_f32 v188, v188, v11
    v_mul_f32 v189, v189, v11
    v_mul_f32 v190, v190, v11
    v_mul_f32 v191, v191, v11
    v_mul_f32 v192, v192, v11
    v_mul_f32 v193, v193, v11
    v_mul_f32 v194, v194, v11
    v_mul_f32 v195, v195, v11
    v_mul_f32 v196, v196, v11
    v_mul_f32 v197, v197, v11
    v_mul_f32 v198, v198, v11
    v_mul_f32 v199, v199, v11
    v_mul_f32 v200, v200, v11
    v_mul_f32 v201, v201, v11
    v_mul_f32 v202, v202, v11
    v_mul_f32 v203, v203, v11
    v_cvt_pk_bf16_f32 v16, v140, v141
    v_cvt_pk_bf16_f32 v17, v142, v143
    v_cvt_pk_bf16_f32 v18, v144, v145
    v_cvt_pk_bf16_f32 v19, v146, v147
    buffer_store_dwordx4 v[16:19], v1, s[12:15], s54 offen offset:0 sc1
    v_cvt_pk_bf16_f32 v20, v148, v149
    v_cvt_pk_bf16_f32 v21, v150, v151
    v_cvt_pk_bf16_f32 v22, v152, v153
    v_cvt_pk_bf16_f32 v23, v154, v155
    buffer_store_dwordx4 v[20:23], v1, s[12:15], s54 offen offset:1024 sc1
    v_cvt_pk_bf16_f32 v16, v156, v157
    v_cvt_pk_bf16_f32 v17, v158, v159
    v_cvt_pk_bf16_f32 v18, v160, v161
    v_cvt_pk_bf16_f32 v19, v162, v163
    buffer_store_dwordx4 v[16:19], v1, s[12:15], s54 offen offset:2048 sc1
    v_cvt_pk_bf16_f32 v20, v164, v165
    v_cvt_pk_bf16_f32 v21, v166, v167
    v_cvt_pk_bf16_f32 v22, v168, v169
    v_cvt_pk_bf16_f32 v23, v170, v171
    buffer_store_dwordx4 v[20:23], v1, s[12:15], s54 offen offset:3072 sc1
    v_cvt_pk_bf16_f32 v16, v172, v173
    v_cvt_pk_bf16_f32 v17, v174, v175
    v_cvt_pk_bf16_f32 v18, v176, v177
    v_cvt_pk_bf16_f32 v19, v178, v179
    s_add_u32 s54, s54, 528384
    buffer_store_dwordx4 v[16:19], v1, s[12:15], s54 offen offset:0 sc1
    v_cvt_pk_bf16_f32 v20, v180, v181
    v_cvt_pk_bf16_f32 v21, v182, v183
    v_cvt_pk_bf16_f32 v22, v184, v185
    v_cvt_pk_bf16_f32 v23, v186, v187
    buffer_store_dwordx4 v[20:23], v1, s[12:15], s54 offen offset:1024 sc1
    v_cvt_pk_bf16_f32 v16, v188, v189
    v_cvt_pk_bf16_f32 v17, v190, v191
    v_cvt_pk_bf16_f32 v18, v192, v193
    v_cvt_pk_bf16_f32 v19, v194, v195
    buffer_store_dwordx4 v[16:19], v1, s[12:15], s54 offen offset:2048 sc1
    v_cvt_pk_bf16_f32 v20, v196, v197
    v_cvt_pk_bf16_f32 v21, v198, v199
    v_cvt_pk_bf16_f32 v22, v200, v201
    v_cvt_pk_bf16_f32 v23, v202, v203
    buffer_store_dwordx4 v[20:23], v1, s[12:15], s54 offen offset:3072 sc1
    v_mov_b32 v140, 0
    v_mov_b32 v141, 0
    v_mov_b32 v142, 0
    v_mov_b32 v143, 0
    v_mov_b32 v144, 0
    v_mov_b32 v145, 0
    v_mov_b32 v146, 0
    v_mov_b32 v147, 0
    v_mov_b32 v148, 0
    v_mov_b32 v149, 0
    v_mov_b32 v150, 0
    v_mov_b32 v151, 0
    v_mov_b32 v152, 0
    v_mov_b32 v153, 0
    v_mov_b32 v154, 0
    v_mov_b32 v155, 0
    v_mov_b32 v156, 0
    v_mov_b32 v157, 0
    v_mov_b32 v158, 0
    v_mov_b32 v159, 0
    v_mov_b32 v160, 0
    v_mov_b32 v161, 0
    v_mov_b32 v162, 0
    v_mov_b32 v163, 0
    v_mov_b32 v164, 0
    v_mov_b32 v165, 0
    v_mov_b32 v166, 0
    v_mov_b32 v167, 0
    v_mov_b32 v168, 0
    v_mov_b32 v169, 0
    v_mov_b32 v170, 0
    v_mov_b32 v171, 0
    v_mov_b32 v172, 0
    v_mov_b32 v173, 0
    v_mov_b32 v174, 0
    v_mov_b32 v175, 0
    v_mov_b32 v176, 0
    v_mov_b32 v177, 0
    v_mov_b32 v178, 0
    v_mov_b32 v179, 0
    v_mov_b32 v180, 0
    v_mov_b32 v181, 0
    v_mov_b32 v182, 0
    v_mov_b32 v183, 0
    v_mov_b32 v184, 0
    v_mov_b32 v185, 0
    v_mov_b32 v186, 0
    v_mov_b32 v187, 0
    v_mov_b32 v188, 0
    v_mov_b32 v189, 0
    v_mov_b32 v190, 0
    v_mov_b32 v191, 0
    v_mov_b32 v192, 0
    v_mov_b32 v193, 0
    v_mov_b32 v194, 0
    v_mov_b32 v195, 0
    v_mov_b32 v196, 0
    v_mov_b32 v197, 0
    v_mov_b32 v198, 0
    v_mov_b32 v199, 0
    v_mov_b32 v200, 0
    v_mov_b32 v201, 0
    v_mov_b32 v202, 0
    v_mov_b32 v203, 0
AT_S2_E1:
    s_cmp_lg_u32 s32, 0
    s_cbranch_scc1 ONLY_22
    s_cmp_lg_u32 s37, 3
    s_cbranch_scc1 ONLY_22
    s_mov_b64 exec, 1
    v_mov_b32 v10, 1
    s_lshl_b32 s3, s34, 10
    s_add_u32 s3, s3, s33
    s_lshl_b32 s3, s3, 2
    s_add_u32 s3, s3, 66846720
    buffer_store_dword v10, v25, s[12:15], s3 offen sc1
    s_mov_b64 exec, -1
ONLY_22:
    s_cmp_lg_u32 s37, 0
    s_cbranch_scc1 AT_S2_E2
    ds_read_b128 v[204:207], v5 offset:32768
    ds_read_b128 v[208:211], v5 offset:33792
    ds_read_b128 v[212:215], v5 offset:34816
    ds_read_b128 v[216:219], v5 offset:35840
    ds_read_b128 v[220:223], v5 offset:49152
    ds_read_b128 v[224:227], v5 offset:50176
    ds_read_b128 v[228:231], v5 offset:51200
    ds_read_b128 v[232:235], v5 offset:52224
    v_mov_b32 v236, 0
    v_mov_b32 v237, 0
    v_mov_b32 v238, 0
    v_mov_b32 v239, 0
    v_mov_b32 v240, 0
    v_mov_b32 v241, 0
    v_mov_b32 v242, 0
    v_mov_b32 v243, 0
    s_waitcnt lgkmcnt(0)
AT_S2_E2:
    s_sub_u32 s38, s48, s49
    s_sub_u32 s38, s38, 1
    s_cmp_lt_u32 s38, 4
    s_cbranch_scc1 AT_S2_EM
    s_cmp_lt_u32 s48, 33
    s_cbranch_scc1 AT_S2_E3
    s_sub_u32 s38, s48, 33
    s_lshl_b32 s38, s38, 1
    s_add_u32 s38, s38, s35
AT_S2_EM:
    s_lshl_b32 s38, s38, 5
    v_subrev_u32 v10, s38, v4
    v_add_u32 v11, 64, v10
    v_cmp_le_i32 s[4:5], 0, v10
    v_cmp_le_i32 s[6:7], 1, v10
    v_cmp_le_i32 s[8:9], 2, v10
    v_cmp_le_i32 s[10:11], 3, v10
    v_cndmask_b32 v124, v8, v124, s[4:5]
    v_cndmask_b32 v125, v8, v125, s[6:7]
    v_cndmask_b32 v126, v8, v126, s[8:9]
    v_cndmask_b32 v127, v8, v127, s[10:11]
    v_cmp_le_i32 s[4:5], 16, v10
    v_cmp_le_i32 s[6:7], 17, v10
    v_cmp_le_i32 s[8:9], 18, v10
    v_cmp_le_i32 s[10:11], 19, v10
    v_cndmask_b32 v128, v8, v128, s[4:5]
    v_cndmask_b32 v129, v8, v129, s[6:7]
    v_cndmask_b32 v130, v8, v130, s[8:9]
    v_cndmask_b32 v131, v8, v131, s[10:11]
    v_cmp_le_i32 s[4:5], 0, v11
    v_cmp_le_i32 s[6:7], 1, v11
    v_cmp_le_i32 s[8:9], 2, v11
    v_cmp_le_i32 s[10:11], 3, v11
    v_cndmask_b32 v132, v8, v132, s[4:5]
    v_cndmask_b32 v133, v8, v133, s[6:7]
    v_cndmask_b32 v134, v8, v134, s[8:9]
    v_cndmask_b32 v135, v8, v135, s[10:11]
    v_cmp_le_i32 s[4:5], 16, v11
    v_cmp_le_i32 s[6:7], 17, v11
    v_cmp_le_i32 s[8:9], 18, v11
    v_cmp_le_i32 s[10:11], 19, v11
    v_cndmask_b32 v136, v8, v136, s[4:5]
    v_cndmask_b32 v137, v8, v137, s[6:7]
    v_cndmask_b32 v138, v8, v138, s[8:9]
    v_cndmask_b32 v139, v8, v139, s[10:11]
AT_S2_E3:
    s_cmp_eq_u32 s37, 1
    s_cbranch_scc1 AT_S2_E4
    s_cmp_lg_u32 s48, 1
    s_cbranch_scc1 AT_S2_GO
AT_S2_E4:
    v_max3_f32 v10, v124, v125, v126
    v_max3_f32 v10, v10, v127, v128
    v_max3_f32 v10, v10, v129, v130
    v_max_f32 v10, v10, v131
    v_mov_b32 v12, v10
    s_nop 1
    v_permlane16_swap_b32 v10, v12
    v_max_f32 v10, v10, v12
    v_mov_b32 v12, v10
    s_nop 1
    v_permlane32_swap_b32 v10, v12
    v_max_f32 v10, v10, v12
    v_add_f32 v10, 0x41400000, v10
    v_max3_f32 v11, v132, v133, v134
    v_max3_f32 v11, v11, v135, v136
    v_max3_f32 v11, v11, v137, v138
    v_max_f32 v11, v11, v139
    v_mov_b32 v13, v11
    s_nop 1
    v_permlane16_swap_b32 v11, v13
    v_max_f32 v11, v11, v13
    v_mov_b32 v13, v11
    s_nop 1
    v_permlane32_swap_b32 v11, v13
    v_max_f32 v11, v11, v13
    v_add_f32 v11, 0x41400000, v11
    v_sub_f32 v236, v236, v10
    v_sub_f32 v237, v237, v10
    v_sub_f32 v238, v238, v10
    v_sub_f32 v239, v239, v10
    v_sub_f32 v240, v240, v11
    v_sub_f32 v241, v241, v11
    v_sub_f32 v242, v242, v11
    v_sub_f32 v243, v243, v11
    v_sub_f32 v124, v124, v10
    v_sub_f32 v125, v125, v10
    v_sub_f32 v126, v126, v10
    v_sub_f32 v127, v127, v10
    v_sub_f32 v128, v128, v10
    v_sub_f32 v129, v129, v10
    v_sub_f32 v130, v130, v10
    v_sub_f32 v131, v131, v10
    v_sub_f32 v132, v132, v11
    v_sub_f32 v133, v133, v11
    v_sub_f32 v134, v134, v11
    v_sub_f32 v135, v135, v11
    v_sub_f32 v136, v136, v11
    v_sub_f32 v137, v137, v11
    v_sub_f32 v138, v138, v11
    v_sub_f32 v139, v139, v11
    s_branch AT_S2_GO
AT_S2_SLOW:
    v_max3_f32 v10, v124, v125, v126
    v_max3_f32 v10, v10, v127, v128
    v_max3_f32 v10, v10, v129, v130
    v_max_f32 v10, v10, v131
    v_mov_b32 v12, v10
    s_nop 1
    v_permlane16_swap_b32 v10, v12
    v_max_f32 v10, v10, v12
    v_mov_b32 v12, v10
    s_nop 1
    v_permlane32_swap_b32 v10, v12
    v_max_f32 v10, v10, v12
    v_add_f32 v10, 0x41400000, v10
    v_max_f32 v10, 0, v10
    v_exp_f32 v12, -v10
    v_max3_f32 v11, v132, v133, v134
    v_max3_f32 v11, v11, v135, v136
    v_max3_f32 v11, v11, v137, v138
    v_max_f32 v11, v11, v139
    v_mov_b32 v13, v11
    s_nop 1
    v_permlane16_swap_b32 v11, v13
    v_max_f32 v11, v11, v13
    v_mov_b32 v13, v11
    s_nop 1
    v_permlane32_swap_b32 v11, v13
    v_max_f32 v11, v11, v13
    v_add_f32 v11, 0x41400000, v11
    v_max_f32 v11, 0, v11
    v_exp_f32 v13, -v11
    v_sub_f32 v236, v236, v10
    v_sub_f32 v237, v237, v10
    v_sub_f32 v238, v238, v10
    v_sub_f32 v239, v239, v10
    v_sub_f32 v240, v240, v11
    v_sub_f32 v241, v241, v11
    v_sub_f32 v242, v242, v11
    v_sub_f32 v243, v243, v11
    v_sub_f32 v108, v108, v10
    v_sub_f32 v109, v109, v10
    v_sub_f32 v110, v110, v10
    v_sub_f32 v111, v111, v10
    v_sub_f32 v112, v112, v10
    v_sub_f32 v113, v113, v10
    v_sub_f32 v114, v114, v10
    v_sub_f32 v115, v115, v10
    v_sub_f32 v116, v116, v11
    v_sub_f32 v117, v117, v11
    v_sub_f32 v118, v118, v11
    v_sub_f32 v119, v119, v11
    v_sub_f32 v120, v120, v11
    v_sub_f32 v121, v121, v11
    v_sub_f32 v122, v122, v11
    v_sub_f32 v123, v123, v11
    v_sub_f32 v124, v124, v10
    v_sub_f32 v125, v125, v10
    v_sub_f32 v126, v126, v10
    v_sub_f32 v127, v127, v10
    v_sub_f32 v128, v128, v10
    v_sub_f32 v129, v129, v10
    v_sub_f32 v130, v130, v10
    v_sub_f32 v131, v131, v10
    v_sub_f32 v132, v132, v11
    v_sub_f32 v133, v133, v11
    v_sub_f32 v134, v134, v11
    v_sub_f32 v135, v135, v11
    v_sub_f32 v136, v136, v11
    v_sub_f32 v137, v137, v11
    v_sub_f32 v138, v138, v11
    v_sub_f32 v139, v139, v11
    v_mul_f32 v140, v140, v12
    v_mul_f32 v141, v141, v12
    v_mul_f32 v142, v142, v12
    v_mul_f32 v143, v143, v12
    v_mul_f32 v144, v144, v12
    v_mul_f32 v145, v145, v12
    v_mul_f32 v146, v146, v12
    v_mul_f32 v147, v147, v12
    v_mul_f32 v148, v148, v12
    v_mul_f32 v149, v149, v12
    v_mul_f32 v150, v150, v12
    v_mul_f32 v151, v151, v12
    v_mul_f32 v152, v152, v12
    v_mul_f32 v153, v153, v12
    v_mul_f32 v154, v154, v12
    v_mul_f32 v155, v155, v12
    v_mul_f32 v156, v156, v12
    v_mul_f32 v157, v157, v12
    v_mul_f32 v158, v158, v12
    v_mul_f32 v159, v159, v12
    v_mul_f32 v160, v160, v12
    v_mul_f32 v161, v161, v12
    v_mul_f32 v162, v162, v12
    v_mul_f32 v163, v163, v12
    v_mul_f32 v164, v164, v12
    v_mul_f32 v165, v165, v12
    v_mul_f32 v166, v166, v12
    v_mul_f32 v167, v167, v12
    v_mul_f32 v168, v168, v12
    v_mul_f32 v169, v169, v12
    v_mul_f32 v170, v170, v12
    v_mul_f32 v171, v171, v12
    v_mul_f32 v172, v172, v13
    v_mul_f32 v173, v173, v13
    v_mul_f32 v174, v174, v13
    v_mul_f32 v175, v175, v13
    v_mul_f32 v176, v176, v13
    v_mul_f32 v177, v177, v13
    v_mul_f32 v178, v178, v13
    v_mul_f32 v179, v179, v13
    v_mul_f32 v180, v180, v13
    v_mul_f32 v181, v181, v13
    v_mul_f32 v182, v182, v13
    v_mul_f32 v183, v183, v13
    v_mul_f32 v184, v184, v13
    v_mul_f32 v185, v185, v13
    v_mul_f32 v186, v186, v13
    v_mul_f32 v187, v187, v13
    v_mul_f32 v188, v188, v13
    v_mul_f32 v189, v189, v13
    v_mul_f32 v190, v190, v13
    v_mul_f32 v191, v191, v13
    v_mul_f32 v192, v192, v13
    v_mul_f32 v193, v193, v13
    v_mul_f32 v194, v194, v13
    v_mul_f32 v195, v195, v13
    v_mul_f32 v196, v196, v13
    v_mul_f32 v197, v197, v13
    v_mul_f32 v198, v198, v13
    v_mul_f32 v199, v199, v13
    v_mul_f32 v200, v200, v13
    v_mul_f32 v201, v201, v13
    v_mul_f32 v202, v202, v13
    v_mul_f32 v203, v203, v13
    v_mul_f32 v248, v248, v12
    v_mul_f32 v249, v249, v12
    v_mul_f32 v250, v250, v12
    v_mul_f32 v251, v251, v12
    v_mul_f32 v252, v252, v13
    v_mul_f32 v253, v253, v13
    v_mul_f32 v254, v254, v13
    v_mul_f32 v255, v255, v13
    v_exp_f32 v16, v124
    v_exp_f32 v17, v125
    v_exp_f32 v18, v126
    v_exp_f32 v19, v127
    v_cvt_pk_bf16_f32 v100, v16, v17
    v_exp_f32 v20, v128
    v_exp_f32 v21, v129
    v_cvt_pk_bf16_f32 v101, v18, v19
    v_exp_f32 v22, v130
    v_exp_f32 v23, v131
    v_cvt_pk_bf16_f32 v102, v20, v21
    v_exp_f32 v16, v132
    v_exp_f32 v17, v133
    v_cvt_pk_bf16_f32 v103, v22, v23
    v_or3_b32 v9, v100, v101, v102
    v_exp_f32 v18, v134
    v_exp_f32 v19, v135
    v_cvt_pk_bf16_f32 v104, v16, v17
    v_exp_f32 v20, v136
    v_exp_f32 v21, v137
    v_cvt_pk_bf16_f32 v105, v18, v19
    v_or3_b32 v9, v9, v103, v104
    v_exp_f32 v22, v138
    v_exp_f32 v23, v139
    v_cvt_pk_bf16_f32 v106, v20, v21
    v_cvt_pk_bf16_f32 v107, v22, v23
    v_or3_b32 v9, v9, v105, v106
    v_bitop3_b32 v9, v9, v107, s50 bitop3:0xa8
    s_branch AT_S2_RET
AT_L2:
    s_bitcmp1_b64 s[62:63], s48
    s_cbranch_scc0 AT_L2_GO
AT_L2_EV:
    s_cmp_eq_u32 s48, s56
    s_cselect_b32 s53, 16384, s53
    s_cselect_b32 s22, 16777216, s22
    s_sub_u32 s37, s48, s56
    s_cmp_eq_u32 s37, 3
    s_cselect_b32 s18, 16777216, s18
    s_cmp_eq_u32 s37, 2
    s_cselect_b32 s38, s40, 0
    v_add_u32 v2, s38, v2
    s_cmp_eq_u32 s37, 5
    s_cselect_b32 s38, s40, 0
    v_add_u32 v3, s38, v3
    s_cmp_eq_u32 s48, 31
    s_cselect_b32 s22, 0, s22
    s_sub_u32 s37, s48, s47
    s_cmp_lg_u32 s37, 2
    s_cbranch_scc1 AT_L2_E1
    v_rcp_f32 v10, v248
    v_rcp_f32 v11, v252
    v_mov_b32 v248, 0
    v_mov_b32 v249, 0
    v_mov_b32 v250, 0
    v_mov_b32 v251, 0
    v_mov_b32 v252, 0
    v_mov_b32 v253, 0
    v_mov_b32 v254, 0
    v_mov_b32 v255, 0
    v_mul_f32 v140, v140, v10
    v_mul_f32 v141, v141, v10
    v_mul_f32 v142, v142, v10
    v_mul_f32 v143, v143, v10
    v_mul_f32 v144, v144, v10
    v_mul_f32 v145, v145, v10
    v_mul_f32 v146, v146, v10
    v_mul_f32 v147, v147, v10
    v_mul_f32 v148, v148, v10
    v_mul_f32 v149, v149, v10
    v_mul_f32 v150, v150, v10
    v_mul_f32 v151, v151, v10
    v_mul_f32 v152, v152, v10
    v_mul_f32 v153, v153, v10
    v_mul_f32 v154, v154, v10
    v_mul_f32 v155, v155, v10
    v_mul_f32 v156, v156, v10
    v_mul_f32 v157, v157, v10
    v_mul_f32 v158, v158, v10
    v_mul_f32 v159, v159, v10
    v_mul_f32 v160, v160, v10
    v_mul_f32 v161, v161, v10
    v_mul_f32 v162, v162, v10
    v_mul_f32 v163, v163, v10
    v_mul_f32 v164, v164, v10
    v_mul_f32 v165, v165, v10
    v_mul_f32 v166, v166, v10
    v_mul_f32 v167, v167, v10
    v_mul_f32 v168, v168, v10
    v_mul_f32 v169, v169, v10
    v_mul_f32 v170, v170, v10
    v_mul_f32 v171, v171, v10
    v_mul_f32 v172, v172, v11
    v_mul_f32 v173, v173, v11
    v_mul_f32 v174, v174, v11
    v_mul_f32 v175, v175, v11
    v_mul_f32 v176, v176, v11
    v_mul_f32 v177, v177, v11
    v_mul_f32 v178, v178, v11
    v_mul_f32 v179, v179, v11
    v_mul_f32 v180, v180, v11
    v_mul_f32 v181, v181, v11
    v_mul_f32 v182, v182, v11
    v_mul_f32 v183, v183, v11
    v_mul_f32 v184, v184, v11
    v_mul_f32 v185, v185, v11
    v_mul_f32 v186, v186, v11
    v_mul_f32 v187, v187, v11
    v_mul_f32 v188, v188, v11
    v_mul_f32 v189, v189, v11
    v_mul_f32 v190, v190, v11
    v_mul_f32 v191, v191, v11
    v_mul_f32 v192, v192, v11
    v_mul_f32 v193, v193, v11
    v_mul_f32 v194, v194, v11
    v_mul_f32 v195, v195, v11
    v_mul_f32 v196, v196, v11
    v_mul_f32 v197, v197, v11
    v_mul_f32 v198, v198, v11
    v_mul_f32 v199, v199, v11
    v_mul_f32 v200, v200, v11
    v_mul_f32 v201, v201, v11
    v_mul_f32 v202, v202, v11
    v_mul_f32 v203, v203, v11
    v_cvt_pk_bf16_f32 v16, v140, v141
    v_cvt_pk_bf16_f32 v17, v142, v143
    v_cvt_pk_bf16_f32 v18, v144, v145
    v_cvt_pk_bf16_f32 v19, v146, v147
    buffer_store_dwordx4 v[16:19], v1, s[12:15], s54 offen offset:0 sc1
    v_cvt_pk_bf16_f32 v20, v148, v149
    v_cvt_pk_bf16_f32 v21, v150, v151
    v_cvt_pk_bf16_f32 v22, v152, v153
    v_cvt_pk_bf16_f32 v23, v154, v155
    buffer_store_dwordx4 v[20:23], v1, s[12:15], s54 offen offset:1024 sc1
    v_cvt_pk_bf16_f32 v16, v156, v157
    v_cvt_pk_bf16_f32 v17, v158, v159
    v_cvt_pk_bf16_f32 v18, v160, v161
    v_cvt_pk_bf16_f32 v19, v162, v163
    buffer_store_dwordx4 v[16:19], v1, s[12:15], s54 offen offset:2048 sc1
    v_cvt_pk_bf16_f32 v20, v164, v165
    v_cvt_pk_bf16_f32 v21, v166, v167
    v_cvt_pk_bf16_f32 v22, v168, v169
    v_cvt_pk_bf16_f32 v23, v170, v171
    buffer_store_dwordx4 v[20:23], v1, s[12:15], s54 offen offset:3072 sc1
    v_cvt_pk_bf16_f32 v16, v172, v173
    v_cvt_pk_bf16_f32 v17, v174, v175
    v_cvt_pk_bf16_f32 v18, v176, v177
    v_cvt_pk_bf16_f32 v19, v178, v179
    s_add_u32 s54, s54, 528384
    buffer_store_dwordx4 v[16:19], v1, s[12:15], s54 offen offset:0 sc1
    v_cvt_pk_bf16_f32 v20, v180, v181
    v_cvt_pk_bf16_f32 v21, v182, v183
    v_cvt_pk_bf16_f32 v22, v184, v185
    v_cvt_pk_bf16_f32 v23, v186, v187
    buffer_store_dwordx4 v[20:23], v1, s[12:15], s54 offen offset:1024 sc1
    v_cvt_pk_bf16_f32 v16, v188, v189
    v_cvt_pk_bf16_f32 v17, v190, v191
    v_cvt_pk_bf16_f32 v18, v192, v193
    v_cvt_pk_bf16_f32 v19, v194, v195
    buffer_store_dwordx4 v[16:19], v1, s[12:15], s54 offen offset:2048 sc1
    v_cvt_pk_bf16_f32 v20, v196, v197
    v_cvt_pk_bf16_f32 v21, v198, v199
    v_cvt_pk_bf16_f32 v22, v200, v201
    v_cvt_pk_bf16_f32 v23, v202, v203
    buffer_store_dwordx4 v[20:23], v1, s[12:15], s54 offen offset:3072 sc1
    v_mov_b32 v140, 0
    v_mov_b32 v141, 0
    v_mov_b32 v142, 0
    v_mov_b32 v143, 0
    v_mov_b32 v144, 0
    v_mov_b32 v145, 0
    v_mov_b32 v146, 0
    v_mov_b32 v147, 0
    v_mov_b32 v148, 0
    v_mov_b32 v149, 0
    v_mov_b32 v150, 0
    v_mov_b32 v151, 0
    v_mov_b32 v152, 0
    v_mov_b32 v153, 0
    v_mov_b32 v154, 0
    v_mov_b32 v155, 0
    v_mov_b32 v156, 0
    v_mov_b32 v157, 0
    v_mov_b32 v158, 0
    v_mov_b32 v159, 0
    v_mov_b32 v160, 0
    v_mov_b32 v161, 0
    v_mov_b32 v162, 0
    v_mov_b32 v163, 0
    v_mov_b32 v164, 0
    v_mov_b32 v165, 0
    v_mov_b32 v166, 0
    v_mov_b32 v167, 0
    v_mov_b32 v168, 0
    v_mov_b32 v169, 0
    v_mov_b32 v170, 0
    v_mov_b32 v171, 0
    v_mov_b32 v172, 0
    v_mov_b32 v173, 0
    v_mov_b32 v174, 0
    v_mov_b32 v175, 0
    v_mov_b32 v176, 0
    v_mov_b32 v177, 0
    v_mov_b32 v178, 0
    v_mov_b32 v179, 0
    v_mov_b32 v180, 0
    v_mov_b32 v181, 0
    v_mov_b32 v182, 0
    v_mov_b32 v183, 0
    v_mov_b32 v184, 0
    v_mov_b32 v185, 0
    v_mov_b32 v186, 0
    v_mov_b32 v187, 0
    v_mov_b32 v188, 0
    v_mov_b32 v189, 0
    v_mov_b32 v190, 0
    v_mov_b32 v191, 0
    v_mov_b32 v192, 0
    v_mov_b32 v193, 0
    v_mov_b32 v194, 0
    v_mov_b32 v195, 0
    v_mov_b32 v196, 0
    v_mov_b32 v197, 0
    v_mov_b32 v198, 0
    v_mov_b32 v199, 0
    v_mov_b32 v200, 0
    v_mov_b32 v201, 0
    v_mov_b32 v202, 0
    v_mov_b32 v203, 0
AT_L2_E1:
    s_cmp_lg_u32 s32, 0
    s_cbranch_scc1 ONLY_23
    s_cmp_lg_u32 s37, 3
    s_cbranch_scc1 ONLY_23
    s_mov_b64 exec, 1
    v_mov_b32 v10, 1
    s_lshl_b32 s3, s34, 10
    s_add_u32 s3, s3, s33
    s_lshl_b32 s3, s3, 2
    s_add_u32 s3, s3, 66846720
    buffer_store_dword v10, v25, s[12:15], s3 offen sc1
    s_mov_b64 exec, -1
ONLY_23:
    s_cmp_lg_u32 s37, 0
    s_cbranch_scc1 AT_L2_E2
    ds_read_b128 v[204:207], v5 offset:32768
    ds_read_b128 v[208:211], v5 offset:33792
    ds_read_b128 v[212:215], v5 offset:34816
    ds_read_b128 v[216:219], v5 offset:35840
    ds_read_b128 v[220:223], v5 offset:49152
    ds_read_b128 v[224:227], v5 offset:50176
    ds_read_b128 v[228:231], v5 offset:51200
    ds_read_b128 v[232:235], v5 offset:52224
    v_mov_b32 v236, 0
    v_mov_b32 v237, 0
    v_mov_b32 v238, 0
    v_mov_b32 v239, 0
    v_mov_b32 v240, 0
    v_mov_b32 v241, 0
    v_mov_b32 v242, 0
    v_mov_b32 v243, 0
    s_waitcnt lgkmcnt(0)
AT_L2_E2:
    s_sub_u32 s38, s48, s49
    s_sub_u32 s38, s38, 1
    s_cmp_lt_u32 s38, 4
    s_cbranch_scc1 AT_L2_EM
    s_cmp_lt_u32 s48, 33
    s_cbranch_scc1 AT_L2_E3
    s_sub_u32 s38, s48, 33
    s_lshl_b32 s38, s38, 1
    s_add_u32 s38, s38, s35
AT_L2_EM:
    s_lshl_b32 s38, s38, 5
    v_subrev_u32 v10, s38, v4
    v_add_u32 v11, 64, v10
    v_cmp_le_i32 s[4:5], 0, v10
    v_cmp_le_i32 s[6:7], 1, v10
    v_cmp_le_i32 s[8:9], 2, v10
    v_cmp_le_i32 s[10:11], 3, v10
    v_cndmask_b32 v124, v8, v124, s[4:5]
    v_cndmask_b32 v125, v8, v125, s[6:7]
    v_cndmask_b32 v126, v8, v126, s[8:9]
    v_cndmask_b32 v127, v8, v127, s[10:11]
    v_cmp_le_i32 s[4:5], 16, v10
    v_cmp_le_i32 s[6:7], 17, v10
    v_cmp_le_i32 s[8:9], 18, v10
    v_cmp_le_i32 s[10:11], 19, v10
    v_cndmask_b32 v128, v8, v128, s[4:5]
    v_cndmask_b32 v129, v8, v129, s[6:7]
    v_cndmask_b32 v130, v8, v130, s[8:9]
    v_cndmask_b32 v131, v8, v131, s[10:11]
    v_cmp_le_i32 s[4:5], 0, v11
    v_cmp_le_i32 s[6:7], 1, v11
    v_cmp_le_i32 s[8:9], 2, v11
    v_cmp_le_i32 s[10:11], 3, v11
    v_cndmask_b32 v132, v8, v132, s[4:5]
    v_cndmask_b32 v133, v8, v133, s[6:7]
    v_cndmask_b32 v134, v8, v134, s[8:9]
    v_cndmask_b32 v135, v8, v135, s[10:11]
    v_cmp_le_i32 s[4:5], 16, v11
    v_cmp_le_i32 s[6:7], 17, v11
    v_cmp_le_i32 s[8:9], 18, v11
    v_cmp_le_i32 s[10:11], 19, v11
    v_cndmask_b32 v136, v8, v136, s[4:5]
    v_cndmask_b32 v137, v8, v137, s[6:7]
    v_cndmask_b32 v138, v8, v138, s[8:9]
    v_cndmask_b32 v139, v8, v139, s[10:11]
AT_L2_E3:
    s_cmp_eq_u32 s37, 1
    s_cbranch_scc1 AT_L2_E4
    s_cmp_lg_u32 s48, 1
    s_cbranch_scc1 AT_L2_GO
AT_L2_E4:
    v_max3_f32 v10, v124, v125, v126
    v_max3_f32 v10, v10, v127, v128
    v_max3_f32 v10, v10, v129, v130
    v_max_f32 v10, v10, v131
    v_mov_b32 v12, v10
    s_nop 1
    v_permlane16_swap_b32 v10, v12
    v_max_f32 v10, v10, v12
    v_mov_b32 v12, v10
    s_nop 1
    v_permlane32_swap_b32 v10, v12
    v_max_f32 v10, v10, v12
    v_add_f32 v10, 0x41400000, v10
    v_max3_f32 v11, v132, v133, v134
    v_max3_f32 v11, v11, v135, v136
    v_max3_f32 v11, v11, v137, v138
    v_max_f32 v11, v11, v139
    v_mov_b32 v13, v11
    s_nop 1
    v_permlane16_swap_b32 v11, v13
    v_max_f32 v11, v11, v13
    v_mov_b32 v13, v11
    s_nop 1
    v_permlane32_swap_b32 v11, v13
    v_max_f32 v11, v11, v13
    v_add_f32 v11, 0x41400000, v11
    v_sub_f32 v236, v236, v10
    v_sub_f32 v237, v237, v10
    v_sub_f32 v238, v238, v10
    v_sub_f32 v239, v239, v10
    v_sub_f32 v240, v240, v11
    v_sub_f32 v241, v241, v11
    v_sub_f32 v242, v242, v11
    v_sub_f32 v243, v243, v11
    v_sub_f32 v124, v124, v10
    v_sub_f32 v125, v125, v10
    v_sub_f32 v126, v126, v10
    v_sub_f32 v127, v127, v10
    v_sub_f32 v128, v128, v10
    v_sub_f32 v129, v129, v10
    v_sub_f32 v130, v130, v10
    v_sub_f32 v131, v131, v10
    v_sub_f32 v132, v132, v11
    v_sub_f32 v133, v133, v11
    v_sub_f32 v134, v134, v11
    v_sub_f32 v135, v135, v11
    v_sub_f32 v136, v136, v11
    v_sub_f32 v137, v137, v11
    v_sub_f32 v138, v138, v11
    v_sub_f32 v139, v139, v11
    s_branch AT_L2_GO
AT_L2_SP:
    v_cmp_ne_u32 vcc, 0, v9
    s_cbranch_vccnz AT_L2_SLOW
AT_L2_RET:
    s_waitcnt vmcnt(4) lgkmcnt(0)
    s_barrier
    s_branch AT_L3
AT_L2_SLOW:
    v_max3_f32 v10, v124, v125, v126
    v_max3_f32 v10, v10, v127, v128
    v_max3_f32 v10, v10, v129, v130
    v_max_f32 v10, v10, v131
    v_mov_b32 v12, v10
    s_nop 1
    v_permlane16_swap_b32 v10, v12
    v_max_f32 v10, v10, v12
    v_mov_b32 v12, v10
    s_nop 1
    v_permlane32_swap_b32 v10, v12
    v_max_f32 v10, v10, v12
    v_add_f32 v10, 0x41400000, v10
    v_max_f32 v10, 0, v10
    v_exp_f32 v12, -v10
    v_max3_f32 v11, v132, v133, v134
    v_max3_f32 v11, v11, v135, v136
    v_max3_f32 v11, v11, v137, v138
    v_max_f32 v11, v11, v139
    v_mov_b32 v13, v11
    s_nop 1
    v_permlane16_swap_b32 v11, v13
    v_max_f32 v11, v11, v13
    v_mov_b32 v13, v11
    s_nop 1
    v_permlane32_swap_b32 v11, v13
    v_max_f32 v11, v11, v13
    v_add_f32 v11, 0x41400000, v11
    v_max_f32 v11, 0, v11
    v_exp_f32 v13, -v11
    v_sub_f32 v236, v236, v10
    v_sub_f32 v237, v237, v10
    v_sub_f32 v238, v238, v10
    v_sub_f32 v239, v239, v10
    v_sub_f32 v240, v240, v11
    v_sub_f32 v241, v241, v11
    v_sub_f32 v242, v242, v11
    v_sub_f32 v243, v243, v11
    v_sub_f32 v108, v108, v10
    v_sub_f32 v109, v109, v10
    v_sub_f32 v110, v110, v10
    v_sub_f32 v111, v111, v10
    v_sub_f32 v112, v112, v10
    v_sub_f32 v113, v113, v10
    v_sub_f32 v114, v114, v10
    v_sub_f32 v115, v115, v10
    v_sub_f32 v116, v116, v11
    v_sub_f32 v117, v117, v11
    v_sub_f32 v118, v118, v11
    v_sub_f32 v119, v119, v11
    v_sub_f32 v120, v120, v11
    v_sub_f32 v121, v121, v11
    v_sub_f32 v122, v122, v11
    v_sub_f32 v123, v123, v11
    v_sub_f32 v124, v124, v10
    v_sub_f32 v125, v125, v10
    v_sub_f32 v126, v126, v10
    v_sub_f32 v127, v127, v10
    v_sub_f32 v128, v128, v10
    v_sub_f32 v129, v129, v10
    v_sub_f32 v130, v130, v10
    v_sub_f32 v131, v131, v10
    v_sub_f32 v132, v132, v11
    v_sub_f32 v133, v133, v11
    v_sub_f32 v134, v134, v11
    v_sub_f32 v135, v135, v11
    v_sub_f32 v136, v136, v11
    v_sub_f32 v137, v137, v11
    v_sub_f32 v138, v138, v11
    v_sub_f32 v139, v139, v11
    v_mul_f32 v140, v140, v12
    v_mul_f32 v141, v141, v12
    v_mul_f32 v142, v142, v12
    v_mul_f32 v143, v143, v12
    v_mul_f32 v144, v144, v12
    v_mul_f32 v145, v145, v12
    v_mul_f32 v146, v146, v12
    v_mul_f32 v147, v147, v12
    v_mul_f32 v148, v148, v12
    v_mul_f32 v149, v149, v12
    v_mul_f32 v150, v150, v12
    v_mul_f32 v151, v151, v12
    v_mul_f32 v152, v152, v12
    v_mul_f32 v153, v153, v12
    v_mul_f32 v154, v154, v12
    v_mul_f32 v155, v155, v12
    v_mul_f32 v156, v156, v12
    v_mul_f32 v157, v157, v12
    v_mul_f32 v158, v158, v12
    v_mul_f32 v159, v159, v12
    v_mul_f32 v160, v160, v12
    v_mul_f32 v161, v161, v12
    v_mul_f32 v162, v162, v12
    v_mul_f32 v163, v163, v12
    v_mul_f32 v164, v164, v12
    v_mul_f32 v165, v165, v12
    v_mul_f32 v166, v166, v12
    v_mul_f32 v167, v167, v12
    v_mul_f32 v168, v168, v12
    v_mul_f32 v169, v169, v12
    v_mul_f32 v170, v170, v12
    v_mul_f32 v171, v171, v12
    v_mul_f32 v172, v172, v13
    v_mul_f32 v173, v173, v13
    v_mul_f32 v174, v174, v13
    v_mul_f32 v175, v175, v13
    v_mul_f32 v176, v176, v13
    v_mul_f32 v177, v177, v13
    v_mul_f32 v178, v178, v13
    v_mul_f32 v179, v179, v13
    v_mul_f32 v180, v180, v13
    v_mul_f32 v181, v181, v13
    v_mul_f32 v182, v182, v13
    v_mul_f32 v183, v183, v13
    v_mul_f32 v184, v184, v13
    v_mul_f32 v185, v185, v13
    v_mul_f32 v186, v186, v13
    v_mul_f32 v187, v187, v13
    v_mul_f32 v188, v188, v13
    v_mul_f32 v189, v189, v13
    v_mul_f32 v190, v190, v13
    v_mul_f32 v191, v191, v13
    v_mul_f32 v192, v192, v13
    v_mul_f32 v193, v193, v13
    v_mul_f32 v194, v194, v13
    v_mul_f32 v195, v195, v13
    v_mul_f32 v196, v196, v13
    v_mul_f32 v197, v197, v13
    v_mul_f32 v198, v198, v13
    v_mul_f32 v199, v199, v13
    v_mul_f32 v200, v200, v13
    v_mul_f32 v201, v201, v13
    v_mul_f32 v202, v202, v13
    v_mul_f32 v203, v203, v13
    v_mul_f32 v248, v248, v12
    v_mul_f32 v249, v249, v12
    v_mul_f32 v250, v250, v12
    v_mul_f32 v251, v251, v12
    v_mul_f32 v252, v252, v13
    v_mul_f32 v253, v253, v13
    v_mul_f32 v254, v254, v13
    v_mul_f32 v255, v255, v13
    v_exp_f32 v16, v124
    v_exp_f32 v17, v125
    v_exp_f32 v18, v126
    v_exp_f32 v19, v127
    v_cvt_pk_bf16_f32 v100, v16, v17
    v_exp_f32 v20, v128
    v_exp_f32 v21, v129
    v_cvt_pk_bf16_f32 v101, v18, v19
    v_exp_f32 v22, v130
    v_exp_f32 v23, v131
    v_cvt_pk_bf16_f32 v102, v20, v21
    v_exp_f32 v16, v132
    v_exp_f32 v17, v133
    v_cvt_pk_bf16_f32 v103, v22, v23
    v_or3_b32 v9, v100, v101, v102
    v_exp_f32 v18, v134
    v_exp_f32 v19, v135
    v_cvt_pk_bf16_f32 v104, v16, v17
    v_exp_f32 v20, v136
    v_exp_f32 v21, v137
    v_cvt_pk_bf16_f32 v105, v18, v19
    v_or3_b32 v9, v9, v103, v104
    v_exp_f32 v22, v138
    v_exp_f32 v23, v139
    v_cvt_pk_bf16_f32 v106, v20, v21
    v_cvt_pk_bf16_f32 v107, v22, v23
    v_or3_b32 v9, v9, v105, v106
    v_bitop3_b32 v9, v9, v107, s50 bitop3:0xa8
    s_branch AT_L2_RET
AT_L3:
    s_bitcmp1_b64 s[62:63], s48
    s_cbranch_scc0 AT_L3_GO
AT_L3_EV:
    s_cmp_eq_u32 s48, s56
    s_cselect_b32 s53, 16384, s53
    s_cselect_b32 s22, 16777216, s22
    s_sub_u32 s37, s48, s56
    s_cmp_eq_u32 s37, 3
    s_cselect_b32 s18, 16777216, s18
    s_cmp_eq_u32 s37, 2
    s_cselect_b32 s38, s40, 0
    v_add_u32 v2, s38, v2
    s_cmp_eq_u32 s37, 5
    s_cselect_b32 s38, s40, 0
    v_add_u32 v3, s38, v3
    s_cmp_eq_u32 s48, 31
    s_cselect_b32 s22, 0, s22
    s_sub_u32 s37, s48, s47
    s_cmp_lg_u32 s37, 2
    s_cbranch_scc1 AT_L3_E1
    v_rcp_f32 v10, v248
    v_rcp_f32 v11, v252
    v_mov_b32 v248, 0
    v_mov_b32 v249, 0
    v_mov_b32 v250, 0
    v_mov_b32 v251, 0
    v_mov_b32 v252, 0
    v_mov_b32 v253, 0
    v_mov_b32 v254, 0
    v_mov_b32 v255, 0
    v_mul_f32 v140, v140, v10
    v_mul_f32 v141, v141, v10
    v_mul_f32 v142, v142, v10
    v_mul_f32 v143, v143, v10
    v_mul_f32 v144, v144, v10
    v_mul_f32 v145, v145, v10
    v_mul_f32 v146, v146, v10
    v_mul_f32 v147, v147, v10
    v_mul_f32 v148, v148, v10
    v_mul_f32 v149, v149, v10
    v_mul_f32 v150, v150, v10
    v_mul_f32 v151, v151, v10
    v_mul_f32 v152, v152, v10
    v_mul_f32 v153, v153, v10
    v_mul_f32 v154, v154, v10
    v_mul_f32 v155, v155, v10
    v_mul_f32 v156, v156, v10
    v_mul_f32 v157, v157, v10
    v_mul_f32 v158, v158, v10
    v_mul_f32 v159, v159, v10
    v_mul_f32 v160, v160, v10
    v_mul_f32 v161, v161, v10
    v_mul_f32 v162, v162, v10
    v_mul_f32 v163, v163, v10
    v_mul_f32 v164, v164, v10
    v_mul_f32 v165, v165, v10
    v_mul_f32 v166, v166, v10
    v_mul_f32 v167, v167, v10
    v_mul_f32 v168, v168, v10
    v_mul_f32 v169, v169, v10
    v_mul_f32 v170, v170, v10
    v_mul_f32 v171, v171, v10
    v_mul_f32 v172, v172, v11
    v_mul_f32 v173, v173, v11
    v_mul_f32 v174, v174, v11
    v_mul_f32 v175, v175, v11
    v_mul_f32 v176, v176, v11
    v_mul_f32 v177, v177, v11
    v_mul_f32 v178, v178, v11
    v_mul_f32 v179, v179, v11
    v_mul_f32 v180, v180, v11
    v_mul_f32 v181, v181, v11
    v_mul_f32 v182, v182, v11
    v_mul_f32 v183, v183, v11
    v_mul_f32 v184, v184, v11
    v_mul_f32 v185, v185, v11
    v_mul_f32 v186, v186, v11
    v_mul_f32 v187, v187, v11
    v_mul_f32 v188, v188, v11
    v_mul_f32 v189, v189, v11
    v_mul_f32 v190, v190, v11
    v_mul_f32 v191, v191, v11
    v_mul_f32 v192, v192, v11
    v_mul_f32 v193, v193, v11
    v_mul_f32 v194, v194, v11
    v_mul_f32 v195, v195, v11
    v_mul_f32 v196, v196, v11
    v_mul_f32 v197, v197, v11
    v_mul_f32 v198, v198, v11
    v_mul_f32 v199, v199, v11
    v_mul_f32 v200, v200, v11
    v_mul_f32 v201, v201, v11
    v_mul_f32 v202, v202, v11
    v_mul_f32 v203, v203, v11
    v_cvt_pk_bf16_f32 v16, v140, v141
    v_cvt_pk_bf16_f32 v17, v142, v143
    v_cvt_pk_bf16_f32 v18, v144, v145
    v_cvt_pk_bf16_f32 v19, v146, v147
    buffer_store_dwordx4 v[16:19], v1, s[12:15], s54 offen offset:0 sc1
    v_cvt_pk_bf16_f32 v20, v148, v149
    v_cvt_pk_bf16_f32 v21, v150, v151
    v_cvt_pk_bf16_f32 v22, v152, v153
    v_cvt_pk_bf16_f32 v23, v154, v155
    buffer_store_dwordx4 v[20:23], v1, s[12:15], s54 offen offset:1024 sc1
    v_cvt_pk_bf16_f32 v16, v156, v157
    v_cvt_pk_bf16_f32 v17, v158, v159
    v_cvt_pk_bf16_f32 v18, v160, v161
    v_cvt_pk_bf16_f32 v19, v162, v163
    buffer_store_dwordx4 v[16:19], v1, s[12:15], s54 offen offset:2048 sc1
    v_cvt_pk_bf16_f32 v20, v164, v165
    v_cvt_pk_bf16_f32 v21, v166, v167
    v_cvt_pk_bf16_f32 v22, v168, v169
    v_cvt_pk_bf16_f32 v23, v170, v171
    buffer_store_dwordx4 v[20:23], v1, s[12:15], s54 offen offset:3072 sc1
    v_cvt_pk_bf16_f32 v16, v172, v173
    v_cvt_pk_bf16_f32 v17, v174, v175
    v_cvt_pk_bf16_f32 v18, v176, v177
    v_cvt_pk_bf16_f32 v19, v178, v179
    s_add_u32 s54, s54, 528384
    buffer_store_dwordx4 v[16:19], v1, s[12:15], s54 offen offset:0 sc1
    v_cvt_pk_bf16_f32 v20, v180, v181
    v_cvt_pk_bf16_f32 v21, v182, v183
    v_cvt_pk_bf16_f32 v22, v184, v185
    v_cvt_pk_bf16_f32 v23, v186, v187
    buffer_store_dwordx4 v[20:23], v1, s[12:15], s54 offen offset:1024 sc1
    v_cvt_pk_bf16_f32 v16, v188, v189
    v_cvt_pk_bf16_f32 v17, v190, v191
    v_cvt_pk_bf16_f32 v18, v192, v193
    v_cvt_pk_bf16_f32 v19, v194, v195
    buffer_store_dwordx4 v[16:19], v1, s[12:15], s54 offen offset:2048 sc1
    v_cvt_pk_bf16_f32 v20, v196, v197
    v_cvt_pk_bf16_f32 v21, v198, v199
    v_cvt_pk_bf16_f32 v22, v200, v201
    v_cvt_pk_bf16_f32 v23, v202, v203
    buffer_store_dwordx4 v[20:23], v1, s[12:15], s54 offen offset:3072 sc1
    v_mov_b32 v140, 0
    v_mov_b32 v141, 0
    v_mov_b32 v142, 0
    v_mov_b32 v143, 0
    v_mov_b32 v144, 0
    v_mov_b32 v145, 0
    v_mov_b32 v146, 0
    v_mov_b32 v147, 0
    v_mov_b32 v148, 0
    v_mov_b32 v149, 0
    v_mov_b32 v150, 0
    v_mov_b32 v151, 0
    v_mov_b32 v152, 0
    v_mov_b32 v153, 0
    v_mov_b32 v154, 0
    v_mov_b32 v155, 0
    v_mov_b32 v156, 0
    v_mov_b32 v157, 0
    v_mov_b32 v158, 0
    v_mov_b32 v159, 0
    v_mov_b32 v160, 0
    v_mov_b32 v161, 0
    v_mov_b32 v162, 0
    v_mov_b32 v163, 0
    v_mov_b32 v164, 0
    v_mov_b32 v165, 0
    v_mov_b32 v166, 0
    v_mov_b32 v167, 0
    v_mov_b32 v168, 0
    v_mov_b32 v169, 0
    v_mov_b32 v170, 0
    v_mov_b32 v171, 0
    v_mov_b32 v172, 0
    v_mov_b32 v173, 0
    v_mov_b32 v174, 0
    v_mov_b32 v175, 0
    v_mov_b32 v176, 0
    v_mov_b32 v177, 0
    v_mov_b32 v178, 0
    v_mov_b32 v179, 0
    v_mov_b32 v180, 0
    v_mov_b32 v181, 0
    v_mov_b32 v182, 0
    v_mov_b32 v183, 0
    v_mov_b32 v184, 0
    v_mov_b32 v185, 0
    v_mov_b32 v186, 0
    v_mov_b32 v187, 0
    v_mov_b32 v188, 0
    v_mov_b32 v189, 0
    v_mov_b32 v190, 0
    v_mov_b32 v191, 0
    v_mov_b32 v192, 0
    v_mov_b32 v193, 0
    v_mov_b32 v194, 0
    v_mov_b32 v195, 0
    v_mov_b32 v196, 0
    v_mov_b32 v197, 0
    v_mov_b32 v198, 0
    v_mov_b32 v199, 0
    v_mov_b32 v200, 0
    v_mov_b32 v201, 0
    v_mov_b32 v202, 0
    v_mov_b32 v203, 0
AT_L3_E1:
    s_cmp_lg_u32 s32, 0
    s_cbranch_scc1 ONLY_24
    s_cmp_lg_u32 s37, 3
    s_cbranch_scc1 ONLY_24
    s_mov_b64 exec, 1
    v_mov_b32 v10, 1
    s_lshl_b32 s3, s34, 10
    s_add_u32 s3, s3, s33
    s_lshl_b32 s3, s3, 2
    s_add_u32 s3, s3, 66846720
    buffer_store_dword v10, v25, s[12:15], s3 offen sc1
    s_mov_b64 exec, -1
ONLY_24:
    s_cmp_lg_u32 s37, 0
    s_cbranch_scc1 AT_L3_E2
    ds_read_b128 v[204:207], v5 offset:32768
    ds_read_b128 v[208:211], v5 offset:33792
    ds_read_b128 v[212:215], v5 offset:34816
    ds_read_b128 v[216:219], v5 offset:35840
    ds_read_b128 v[220:223], v5 offset:49152
    ds_read_b128 v[224:227], v5 offset:50176
    ds_read_b128 v[228:231], v5 offset:51200
    ds_read_b128 v[232:235], v5 offset:52224
    v_mov_b32 v236, 0
    v_mov_b32 v237, 0
    v_mov_b32 v238, 0
    v_mov_b32 v239, 0
    v_mov_b32 v240, 0
    v_mov_b32 v241, 0
    v_mov_b32 v242, 0
    v_mov_b32 v243, 0
    s_waitcnt lgkmcnt(0)
AT_L3_E2:
    s_sub_u32 s38, s48, s49
    s_sub_u32 s38, s38, 1
    s_cmp_lt_u32 s38, 4
    s_cbranch_scc1 AT_L3_EM
    s_cmp_lt_u32 s48, 33
    s_cbranch_scc1 AT_L3_E3
    s_sub_u32 s38, s48, 33
    s_lshl_b32 s38, s38, 1
    s_add_u32 s38, s38, s35
AT_L3_EM:
    s_lshl_b32 s38, s38, 5
    v_subrev_u32 v10, s38, v4
    v_add_u32 v11, 64, v10
    v_cmp_le_i32 s[4:5], 0, v10
    v_cmp_le_i32 s[6:7], 1, v10
    v_cmp_le_i32 s[8:9], 2, v10
    v_cmp_le_i32 s[10:11], 3, v10
    v_cndmask_b32 v108, v8, v108, s[4:5]
    v_cndmask_b32 v109, v8, v109, s[6:7]
    v_cndmask_b32 v110, v8, v110, s[8:9]
    v_cndmask_b32 v111, v8, v111, s[10:11]
    v_cmp_le_i32 s[4:5], 16, v10
    v_cmp_le_i32 s[6:7], 17, v10
    v_cmp_le_i32 s[8:9], 18, v10
    v_cmp_le_i32 s[10:11], 19, v10
    v_cndmask_b32 v112, v8, v112, s[4:5]
    v_cndmask_b32 v113, v8, v113, s[6:7]
    v_cndmask_b32 v114, v8, v114, s[8:9]
    v_cndmask_b32 v115, v8, v115, s[10:11]
    v_cmp_le_i32 s[4:5], 0, v11
    v_cmp_le_i32 s[6:7], 1, v11
    v_cmp_le_i32 s[8:9], 2, v11
    v_cmp_le_i32 s[10:11], 3, v11
    v_cndmask_b32 v116, v8, v116, s[4:5]
    v_cndmask_b32 v117, v8, v117, s[6:7]
    v_cndmask_b32 v118, v8, v118, s[8:9]
    v_cndmask_b32 v119, v8, v119, s[10:11]
    v_cmp_le_i32 s[4:5], 16, v11
    v_cmp_le_i32 s[6:7], 17, v11
    v_cmp_le_i32 s[8:9], 18, v11
    v_cmp_le_i32 s[10:11], 19, v11
    v_cndmask_b32 v120, v8, v120, s[4:5]
    v_cndmask_b32 v121, v8, v121, s[6:7]
    v_cndmask_b32 v122, v8, v122, s[8:9]
    v_cndmask_b32 v123, v8, v123, s[10:11]
AT_L3_E3:
    s_cmp_eq_u32 s37, 1
    s_cbranch_scc1 AT_L3_E4
    s_cmp_lg_u32 s48, 1
    s_cbranch_scc1 AT_L3_GO
AT_L3_E4:
    v_max3_f32 v10, v108, v109, v110
    v_max3_f32 v10, v10, v111, v112
    v_max3_f32 v10, v10, v113, v114
    v_max_f32 v10, v10, v115
    v_mov_b32 v12, v10
    s_nop 1
    v_permlane16_swap_b32 v10, v12
    v_max_f32 v10, v10, v12
    v_mov_b32 v12, v10
    s_nop 1
    v_permlane32_swap_b32 v10, v12
    v_max_f32 v10, v10, v12
    v_add_f32 v10, 0x41400000, v10
    v_max3_f32 v11, v116, v117, v118
    v_max3_f32 v11, v11, v119, v120
    v_max3_f32 v11, v11, v121, v122
    v_max_f32 v11, v11, v123
    v_mov_b32 v13, v11
    s_nop 1
    v_permlane16_swap_b32 v11, v13
    v_max_f32 v11, v11, v13
    v_mov_b32 v13, v11
    s_nop 1
    v_permlane32_swap_b32 v11, v13
    v_max_f32 v11, v11, v13
    v_add_f32 v11, 0x41400000, v11
    v_sub_f32 v236, v236, v10
    v_sub_f32 v237, v237, v10
    v_sub_f32 v238, v238, v10
    v_sub_f32 v239, v239, v10
    v_sub_f32 v240, v240, v11
    v_sub_f32 v241, v241, v11
    v_sub_f32 v242, v242, v11
    v_sub_f32 v243, v243, v11
    v_sub_f32 v108, v108, v10
    v_sub_f32 v109, v109, v10
    v_sub_f32 v110, v110, v10
    v_sub_f32 v111, v111, v10
    v_sub_f32 v112, v112, v10
    v_sub_f32 v113, v113, v10
    v_sub_f32 v114, v114, v10
    v_sub_f32 v115, v115, v10
    v_sub_f32 v116, v116, v11
    v_sub_f32 v117, v117, v11
    v_sub_f32 v118, v118, v11
    v_sub_f32 v119, v119, v11
    v_sub_f32 v120, v120, v11
    v_sub_f32 v121, v121, v11
    v_sub_f32 v122, v122, v11
    v_sub_f32 v123, v123, v11
    s_branch AT_L3_GO
AT_L3_SP:
    v_cmp_ne_u32 vcc, 0, v9
    s_cbranch_vccnz AT_L3_SLOW
AT_L3_RET:
    s_waitcnt vmcnt(4) lgkmcnt(0)
    s_barrier
    s_branch AT_L0
AT_L3_SLOW:
    v_max3_f32 v10, v108, v109, v110
    v_max3_f32 v10, v10, v111, v112
    v_max3_f32 v10, v10, v113, v114
    v_max_f32 v10, v10, v115
    v_mov_b32 v12, v10
    s_nop 1
    v_permlane16_swap_b32 v10, v12
    v_max_f32 v10, v10, v12
    v_mov_b32 v12, v10
    s_nop 1
    v_permlane32_swap_b32 v10, v12
    v_max_f32 v10, v10, v12
    v_add_f32 v10, 0x41400000, v10
    v_max_f32 v10, 0, v10
    v_exp_f32 v12, -v10
    v_max3_f32 v11, v116, v117, v118
    v_max3_f32 v11, v11, v119, v120
    v_max3_f32 v11, v11, v121, v122
    v_max_f32 v11, v11, v123
    v_mov_b32 v13, v11
    s_nop 1
    v_permlane16_swap_b32 v11, v13
    v_max_f32 v11, v11, v13
    v_mov_b32 v13, v11
    s_nop 1
    v_permlane32_swap_b32 v11, v13
    v_max_f32 v11, v11, v13
    v_add_f32 v11, 0x41400000, v11
    v_max_f32 v11, 0, v11
    v_exp_f32 v13, -v11
    v_sub_f32 v236, v236, v10
    v_sub_f32 v237, v237, v10
    v_sub_f32 v238, v238, v10
    v_sub_f32 v239, v239, v10
    v_sub_f32 v240, v240, v11
    v_sub_f32 v241, v241, v11
    v_sub_f32 v242, v242, v11
    v_sub_f32 v243, v243, v11
    v_sub_f32 v124, v124, v10
    v_sub_f32 v125, v125, v10
    v_sub_f32 v126, v126, v10
    v_sub_f32 v127, v127, v10
    v_sub_f32 v128, v128, v10
    v_sub_f32 v129, v129, v10
    v_sub_f32 v130, v130, v10
    v_sub_f32 v131, v131, v10
    v_sub_f32 v132, v132, v11
    v_sub_f32 v133, v133, v11
    v_sub_f32 v134, v134, v11
    v_sub_f32 v135, v135, v11
    v_sub_f32 v136, v136, v11
    v_sub_f32 v137, v137, v11
    v_sub_f32 v138, v138, v11
    v_sub_f32 v139, v139, v11
    v_sub_f32 v108, v108, v10
    v_sub_f32 v109, v109, v10
    v_sub_f32 v110, v110, v10
    v_sub_f32 v111, v111, v10
    v_sub_f32 v112, v112, v10
    v_sub_f32 v113, v113, v10
    v_sub_f32 v114, v114, v10
    v_sub_f32 v115, v115, v10
    v_sub_f32 v116, v116, v11
    v_sub_f32 v117, v117, v11
    v_sub_f32 v118, v118, v11
    v_sub_f32 v119, v119, v11
    v_sub_f32 v120, v120, v11
    v_sub_f32 v121, v121, v11
    v_sub_f32 v122, v122, v11
    v_sub_f32 v123, v123, v11
    v_mul_f32 v140, v140, v12
    v_mul_f32 v141, v141, v12
    v_mul_f32 v142, v142, v12
    v_mul_f32 v143, v143, v12
    v_mul_f32 v144, v144, v12
    v_mul_f32 v145, v145, v12
    v_mul_f32 v146, v146, v12
    v_mul_f32 v147, v147, v12
    v_mul_f32 v148, v148, v12
    v_mul_f32 v149, v149, v12
    v_mul_f32 v150, v150, v12
    v_mul_f32 v151, v151, v12
    v_mul_f32 v152, v152, v12
    v_mul_f32 v153, v153, v12
    v_mul_f32 v154, v154, v12
    v_mul_f32 v155, v155, v12
    v_mul_f32 v156, v156, v12
    v_mul_f32 v157, v157, v12
    v_mul_f32 v158, v158, v12
    v_mul_f32 v159, v159, v12
    v_mul_f32 v160, v160, v12
    v_mul_f32 v161, v161, v12
    v_mul_f32 v162, v162, v12
    v_mul_f32 v163, v163, v12
    v_mul_f32 v164, v164, v12
    v_mul_f32 v165, v165, v12
    v_mul_f32 v166, v166, v12
    v_mul_f32 v167, v167, v12
    v_mul_f32 v168, v168, v12
    v_mul_f32 v169, v169, v12
    v_mul_f32 v170, v170, v12
    v_mul_f32 v171, v171, v12
    v_mul_f32 v172, v172, v13
    v_mul_f32 v173, v173, v13
    v_mul_f32 v174, v174, v13
    v_mul_f32 v175, v175, v13
    v_mul_f32 v176, v176, v13
    v_mul_f32 v177, v177, v13
    v_mul_f32 v178, v178, v13
    v_mul_f32 v179, v179, v13
    v_mul_f32 v180, v180, v13
    v_mul_f32 v181, v181, v13
    v_mul_f32 v182, v182, v13
    v_mul_f32 v183, v183, v13
    v_mul_f32 v184, v184, v13
    v_mul_f32 v185, v185, v13
    v_mul_f32 v186, v186, v13
    v_mul_f32 v187, v187, v13
    v_mul_f32 v188, v188, v13
    v_mul_f32 v189, v189, v13
    v_mul_f32 v190, v190, v13
    v_mul_f32 v191, v191, v13
    v_mul_f32 v192, v192, v13
    v_mul_f32 v193, v193, v13
    v_mul_f32 v194, v194, v13
    v_mul_f32 v195, v195, v13
    v_mul_f32 v196, v196, v13
    v_mul_f32 v197, v197, v13
    v_mul_f32 v198, v198, v13
    v_mul_f32 v199, v199, v13
    v_mul_f32 v200, v200, v13
    v_mul_f32 v201, v201, v13
    v_mul_f32 v202, v202, v13
    v_mul_f32 v203, v203, v13
    v_mul_f32 v248, v248, v12
    v_mul_f32 v249, v249, v12
    v_mul_f32 v250, v250, v12
    v_mul_f32 v251, v251, v12
    v_mul_f32 v252, v252, v13
    v_mul_f32 v253, v253, v13
    v_mul_f32 v254, v254, v13
    v_mul_f32 v255, v255, v13
    v_exp_f32 v16, v108
    v_exp_f32 v17, v109
    v_exp_f32 v18, v110
    v_exp_f32 v19, v111
    v_cvt_pk_bf16_f32 v92, v16, v17
    v_exp_f32 v20, v112
    v_exp_f32 v21, v113
    v_cvt_pk_bf16_f32 v93, v18, v19
    v_exp_f32 v22, v114
    v_exp_f32 v23, v115
    v_cvt_pk_bf16_f32 v94, v20, v21
    v_exp_f32 v16, v116
    v_exp_f32 v17, v117
    v_cvt_pk_bf16_f32 v95, v22, v23
    v_or3_b32 v9, v92, v93, v94
    v_exp_f32 v18, v118
    v_exp_f32 v19, v119
    v_cvt_pk_bf16_f32 v96, v16, v17
    v_exp_f32 v20, v120
    v_exp_f32 v21, v121
    v_cvt_pk_bf16_f32 v97, v18, v19
    v_or3_b32 v9, v9, v95, v96
    v_exp_f32 v22, v122
    v_exp_f32 v23, v123
    v_cvt_pk_bf16_f32 v98, v20, v21
    v_cvt_pk_bf16_f32 v99, v22, v23
    v_or3_b32 v9, v9, v97, v98
    v_bitop3_b32 v9, v9, v99, s50 bitop3:0xa8
    s_branch AT_L3_RET
AT_L0:
    s_bitcmp1_b64 s[62:63], s48
    s_cbranch_scc0 AT_L0_GO
AT_L0_EV:
    s_cmp_eq_u32 s48, s56
    s_cselect_b32 s53, 16384, s53
    s_cselect_b32 s22, 16777216, s22
    s_sub_u32 s37, s48, s56
    s_cmp_eq_u32 s37, 3
    s_cselect_b32 s18, 16777216, s18
    s_cmp_eq_u32 s37, 2
    s_cselect_b32 s38, s40, 0
    v_add_u32 v2, s38, v2
    s_cmp_eq_u32 s37, 5
    s_cselect_b32 s38, s40, 0
    v_add_u32 v3, s38, v3
    s_cmp_eq_u32 s48, 31
    s_cselect_b32 s22, 0, s22
    s_sub_u32 s37, s48, s47
    s_cmp_lg_u32 s37, 2
    s_cbranch_scc1 AT_L0_E1
    v_rcp_f32 v10, v248
    v_rcp_f32 v11, v252
    v_mov_b32 v248, 0
    v_mov_b32 v249, 0
    v_mov_b32 v250, 0
    v_mov_b32 v251, 0
    v_mov_b32 v252, 0
    v_mov_b32 v253, 0
    v_mov_b32 v254, 0
    v_mov_b32 v255, 0
    v_mul_f32 v140, v140, v10
    v_mul_f32 v141, v141, v10
    v_mul_f32 v142, v142, v10
    v_mul_f32 v143, v143, v10
    v_mul_f32 v144, v144, v10
    v_mul_f32 v145, v145, v10
    v_mul_f32 v146, v146, v10
    v_mul_f32 v147, v147, v10
    v_mul_f32 v148, v148, v10
    v_mul_f32 v149, v149, v10
    v_mul_f32 v150, v150, v10
    v_mul_f32 v151, v151, v10
    v_mul_f32 v152, v152, v10
    v_mul_f32 v153, v153, v10
    v_mul_f32 v154, v154, v10
    v_mul_f32 v155, v155, v10
    v_mul_f32 v156, v156, v10
    v_mul_f32 v157, v157, v10
    v_mul_f32 v158, v158, v10
    v_mul_f32 v159, v159, v10
    v_mul_f32 v160, v160, v10
    v_mul_f32 v161, v161, v10
    v_mul_f32 v162, v162, v10
    v_mul_f32 v163, v163, v10
    v_mul_f32 v164, v164, v10
    v_mul_f32 v165, v165, v10
    v_mul_f32 v166, v166, v10
    v_mul_f32 v167, v167, v10
    v_mul_f32 v168, v168, v10
    v_mul_f32 v169, v169, v10
    v_mul_f32 v170, v170, v10
    v_mul_f32 v171, v171, v10
    v_mul_f32 v172, v172, v11
    v_mul_f32 v173, v173, v11
    v_mul_f32 v174, v174, v11
    v_mul_f32 v175, v175, v11
    v_mul_f32 v176, v176, v11
    v_mul_f32 v177, v177, v11
    v_mul_f32 v178, v178, v11
    v_mul_f32 v179, v179, v11
    v_mul_f32 v180, v180, v11
    v_mul_f32 v181, v181, v11
    v_mul_f32 v182, v182, v11
    v_mul_f32 v183, v183, v11
    v_mul_f32 v184, v184, v11
    v_mul_f32 v185, v185, v11
    v_mul_f32 v186, v186, v11
    v_mul_f32 v187, v187, v11
    v_mul_f32 v188, v188, v11
    v_mul_f32 v189, v189, v11
    v_mul_f32 v190, v190, v11
    v_mul_f32 v191, v191, v11
    v_mul_f32 v192, v192, v11
    v_mul_f32 v193, v193, v11
    v_mul_f32 v194, v194, v11
    v_mul_f32 v195, v195, v11
    v_mul_f32 v196, v196, v11
    v_mul_f32 v197, v197, v11
    v_mul_f32 v198, v198, v11
    v_mul_f32 v199, v199, v11
    v_mul_f32 v200, v200, v11
    v_mul_f32 v201, v201, v11
    v_mul_f32 v202, v202, v11
    v_mul_f32 v203, v203, v11
    v_cvt_pk_bf16_f32 v16, v140, v141
    v_cvt_pk_bf16_f32 v17, v142, v143
    v_cvt_pk_bf16_f32 v18, v144, v145
    v_cvt_pk_bf16_f32 v19, v146, v147
    buffer_store_dwordx4 v[16:19], v1, s[12:15], s54 offen offset:0 sc1
    v_cvt_pk_bf16_f32 v20, v148, v149
    v_cvt_pk_bf16_f32 v21, v150, v151
    v_cvt_pk_bf16_f32 v22, v152, v153
    v_cvt_pk_bf16_f32 v23, v154, v155
    buffer_store_dwordx4 v[20:23], v1, s[12:15], s54 offen offset:1024 sc1
    v_cvt_pk_bf16_f32 v16, v156, v157
    v_cvt_pk_bf16_f32 v17, v158, v159
    v_cvt_pk_bf16_f32 v18, v160, v161
    v_cvt_pk_bf16_f32 v19, v162, v163
    buffer_store_dwordx4 v[16:19], v1, s[12:15], s54 offen offset:2048 sc1
    v_cvt_pk_bf16_f32 v20, v164, v165
    v_cvt_pk_bf16_f32 v21, v166, v167
    v_cvt_pk_bf16_f32 v22, v168, v169
    v_cvt_pk_bf16_f32 v23, v170, v171
    buffer_store_dwordx4 v[20:23], v1, s[12:15], s54 offen offset:3072 sc1
    v_cvt_pk_bf16_f32 v16, v172, v173
    v_cvt_pk_bf16_f32 v17, v174, v175
    v_cvt_pk_bf16_f32 v18, v176, v177
    v_cvt_pk_bf16_f32 v19, v178, v179
    s_add_u32 s54, s54, 528384
    buffer_store_dwordx4 v[16:19], v1, s[12:15], s54 offen offset:0 sc1
    v_cvt_pk_bf16_f32 v20, v180, v181
    v_cvt_pk_bf16_f32 v21, v182, v183
    v_cvt_pk_bf16_f32 v22, v184, v185
    v_cvt_pk_bf16_f32 v23, v186, v187
    buffer_store_dwordx4 v[20:23], v1, s[12:15], s54 offen offset:1024 sc1
    v_cvt_pk_bf16_f32 v16, v188, v189
    v_cvt_pk_bf16_f32 v17, v190, v191
    v_cvt_pk_bf16_f32 v18, v192, v193
    v_cvt_pk_bf16_f32 v19, v194, v195
    buffer_store_dwordx4 v[16:19], v1, s[12:15], s54 offen offset:2048 sc1
    v_cvt_pk_bf16_f32 v20, v196, v197
    v_cvt_pk_bf16_f32 v21, v198, v199
    v_cvt_pk_bf16_f32 v22, v200, v201
    v_cvt_pk_bf16_f32 v23, v202, v203
    buffer_store_dwordx4 v[20:23], v1, s[12:15], s54 offen offset:3072 sc1
    v_mov_b32 v140, 0
    v_mov_b32 v141, 0
    v_mov_b32 v142, 0
    v_mov_b32 v143, 0
    v_mov_b32 v144, 0
    v_mov_b32 v145, 0
    v_mov_b32 v146, 0
    v_mov_b32 v147, 0
    v_mov_b32 v148, 0
    v_mov_b32 v149, 0
    v_mov_b32 v150, 0
    v_mov_b32 v151, 0
    v_mov_b32 v152, 0
    v_mov_b32 v153, 0
    v_mov_b32 v154, 0
    v_mov_b32 v155, 0
    v_mov_b32 v156, 0
    v_mov_b32 v157, 0
    v_mov_b32 v158, 0
    v_mov_b32 v159, 0
    v_mov_b32 v160, 0
    v_mov_b32 v161, 0
    v_mov_b32 v162, 0
    v_mov_b32 v163, 0
    v_mov_b32 v164, 0
    v_mov_b32 v165, 0
    v_mov_b32 v166, 0
    v_mov_b32 v167, 0
    v_mov_b32 v168, 0
    v_mov_b32 v169, 0
    v_mov_b32 v170, 0
    v_mov_b32 v171, 0
    v_mov_b32 v172, 0
    v_mov_b32 v173, 0
    v_mov_b32 v174, 0
    v_mov_b32 v175, 0
    v_mov_b32 v176, 0
    v_mov_b32 v177, 0
    v_mov_b32 v178, 0
    v_mov_b32 v179, 0
    v_mov_b32 v180, 0
    v_mov_b32 v181, 0
    v_mov_b32 v182, 0
    v_mov_b32 v183, 0
    v_mov_b32 v184, 0
    v_mov_b32 v185, 0
    v_mov_b32 v186, 0
    v_mov_b32 v187, 0
    v_mov_b32 v188, 0
    v_mov_b32 v189, 0
    v_mov_b32 v190, 0
    v_mov_b32 v191, 0
    v_mov_b32 v192, 0
    v_mov_b32 v193, 0
    v_mov_b32 v194, 0
    v_mov_b32 v195, 0
    v_mov_b32 v196, 0
    v_mov_b32 v197, 0
    v_mov_b32 v198, 0
    v_mov_b32 v199, 0
    v_mov_b32 v200, 0
    v_mov_b32 v201, 0
    v_mov_b32 v202, 0
    v_mov_b32 v203, 0
AT_L0_E1:
    s_cmp_lg_u32 s32, 0
    s_cbranch_scc1 ONLY_25
    s_cmp_lg_u32 s37, 3
    s_cbranch_scc1 ONLY_25
    s_mov_b64 exec, 1
    v_mov_b32 v10, 1
    s_lshl_b32 s3, s34, 10
    s_add_u32 s3, s3, s33
    s_lshl_b32 s3, s3, 2
    s_add_u32 s3, s3, 66846720
    buffer_store_dword v10, v25, s[12:15], s3 offen sc1
    s_mov_b64 exec, -1
ONLY_25:
    s_cmp_lg_u32 s37, 0
    s_cbranch_scc1 AT_L0_E2
    ds_read_b128 v[204:207], v5 offset:32768
    ds_read_b128 v[208:211], v5 offset:33792
    ds_read_b128 v[212:215], v5 offset:34816
    ds_read_b128 v[216:219], v5 offset:35840
    ds_read_b128 v[220:223], v5 offset:49152
    ds_read_b128 v[224:227], v5 offset:50176
    ds_read_b128 v[228:231], v5 offset:51200
    ds_read_b128 v[232:235], v5 offset:52224
    v_mov_b32 v236, 0
    v_mov_b32 v237, 0
    v_mov_b32 v238, 0
    v_mov_b32 v239, 0
    v_mov_b32 v240, 0
    v_mov_b32 v241, 0
    v_mov_b32 v242, 0
    v_mov_b32 v243, 0
    s_waitcnt lgkmcnt(0)
AT_L0_E2:
    s_sub_u32 s38, s48, s49
    s_sub_u32 s38, s38, 1
    s_cmp_lt_u32 s38, 4
    s_cbranch_scc1 AT_L0_EM
    s_cmp_lt_u32 s48, 33
    s_cbranch_scc1 AT_L0_E3
    s_sub_u32 s38, s48, 33
    s_lshl_b32 s38, s38, 1
    s_add_u32 s38, s38, s35
AT_L0_EM:
    s_lshl_b32 s38, s38, 5
    v_subrev_u32 v10, s38, v4
    v_add_u32 v11, 64, v10
    v_cmp_le_i32 s[4:5], 0, v10
    v_cmp_le_i32 s[6:7], 1, v10
    v_cmp_le_i32 s[8:9], 2, v10
    v_cmp_le_i32 s[10:11], 3, v10
    v_cndmask_b32 v124, v8, v124, s[4:5]
    v_cndmask_b32 v125, v8, v125, s[6:7]
    v_cndmask_b32 v126, v8, v126, s[8:9]
    v_cndmask_b32 v127, v8, v127, s[10:11]
    v_cmp_le_i32 s[4:5], 16, v10
    v_cmp_le_i32 s[6:7], 17, v10
    v_cmp_le_i32 s[8:9], 18, v10
    v_cmp_le_i32 s[10:11], 19, v10
    v_cndmask_b32 v128, v8, v128, s[4:5]
    v_cndmask_b32 v129, v8, v129, s[6:7]
    v_cndmask_b32 v130, v8, v130, s[8:9]
    v_cndmask_b32 v131, v8, v131, s[10:11]
    v_cmp_le_i32 s[4:5], 0, v11
    v_cmp_le_i32 s[6:7], 1, v11
    v_cmp_le_i32 s[8:9], 2, v11
    v_cmp_le_i32 s[10:11], 3, v11
    v_cndmask_b32 v132, v8, v132, s[4:5]
    v_cndmask_b32 v133, v8, v133, s[6:7]
    v_cndmask_b32 v134, v8, v134, s[8:9]
    v_cndmask_b32 v135, v8, v135, s[10:11]
    v_cmp_le_i32 s[4:5], 16, v11
    v_cmp_le_i32 s[6:7], 17, v11
    v_cmp_le_i32 s[8:9], 18, v11
    v_cmp_le_i32 s[10:11], 19, v11
    v_cndmask_b32 v136, v8, v136, s[4:5]
    v_cndmask_b32 v137, v8, v137, s[6:7]
    v_cndmask_b32 v138, v8, v138, s[8:9]
    v_cndmask_b32 v139, v8, v139, s[10:11]
AT_L0_E3:
    s_cmp_eq_u32 s37, 1
    s_cbranch_scc1 AT_L0_E4
    s_cmp_lg_u32 s48, 1
    s_cbranch_scc1 AT_L0_GO
AT_L0_E4:
    v_max3_f32 v10, v124, v125, v126
    v_max3_f32 v10, v10, v127, v128
    v_max3_f32 v10, v10, v129, v130
    v_max_f32 v10, v10, v131
    v_mov_b32 v12, v10
    s_nop 1
    v_permlane16_swap_b32 v10, v12
    v_max_f32 v10, v10, v12
    v_mov_b32 v12, v10
    s_nop 1
    v_permlane32_swap_b32 v10, v12
    v_max_f32 v10, v10, v12
    v_add_f32 v10, 0x41400000, v10
    v_max3_f32 v11, v132, v133, v134
    v_max3_f32 v11, v11, v135, v136
    v_max3_f32 v11, v11, v137, v138
    v_max_f32 v11, v11, v139
    v_mov_b32 v13, v11
    s_nop 1
    v_permlane16_swap_b32 v11, v13
    v_max_f32 v11, v11, v13
    v_mov_b32 v13, v11
    s_nop 1
    v_permlane32_swap_b32 v11, v13
    v_max_f32 v11, v11, v13
    v_add_f32 v11, 0x41400000, v11
    v_sub_f32 v236, v236, v10
    v_sub_f32 v237, v237, v10
    v_sub_f32 v238, v238, v10
    v_sub_f32 v239, v239, v10
    v_sub_f32 v240, v240, v11
    v_sub_f32 v241, v241, v11
    v_sub_f32 v242, v242, v11
    v_sub_f32 v243, v243, v11
    v_sub_f32 v124, v124, v10
    v_sub_f32 v125, v125, v10
    v_sub_f32 v126, v126, v10
    v_sub_f32 v127, v127, v10
    v_sub_f32 v128, v128, v10
    v_sub_f32 v129, v129, v10
    v_sub_f32 v130, v130, v10
    v_sub_f32 v131, v131, v10
    v_sub_f32 v132, v132, v11
    v_sub_f32 v133, v133, v11
    v_sub_f32 v134, v134, v11
    v_sub_f32 v135, v135, v11
    v_sub_f32 v136, v136, v11
    v_sub_f32 v137, v137, v11
    v_sub_f32 v138, v138, v11
    v_sub_f32 v139, v139, v11
    s_branch AT_L0_GO
AT_L0_SP:
    v_cmp_ne_u32 vcc, 0, v9
    s_cbranch_vccnz AT_L0_SLOW
AT_L0_RET:
    s_waitcnt vmcnt(4) lgkmcnt(0)
    s_barrier
    s_cmp_eq_u32 s48, 33
    s_cbranch_scc1 AT_P33
    s_branch AT_L1
AT_L0_SLOW:
    v_max3_f32 v10, v124, v125, v126
    v_max3_f32 v10, v10, v127, v128
    v_max3_f32 v10, v10, v129, v130
    v_max_f32 v10, v10, v131
    v_mov_b32 v12, v10
    s_nop 1
    v_permlane16_swap_b32 v10, v12
    v_max_f32 v10, v10, v12
    v_mov_b32 v12, v10
    s_nop 1
    v_permlane32_swap_b32 v10, v12
    v_max_f32 v10, v10, v12
    v_add_f32 v10, 0x41400000, v10
    v_max_f32 v10, 0, v10
    v_exp_f32 v12, -v10
    v_max3_f32 v11, v132, v133, v134
    v_max3_f32 v11, v11, v135, v136
    v_max3_f32 v11, v11, v137, v138
    v_max_f32 v11, v11, v139
    v_mov_b32 v13, v11
    s_nop 1
    v_permlane16_swap_b32 v11, v13
    v_max_f32 v11, v11, v13
    v_mov_b32 v13, v11
    s_nop 1
    v_permlane32_swap_b32 v11, v13
    v_max_f32 v11, v11, v13
    v_add_f32 v11, 0x41400000, v11
    v_max_f32 v11, 0, v11
    v_exp_f32 v13, -v11
    v_sub_f32 v236, v236, v10
    v_sub_f32 v237, v237, v10
    v_sub_f32 v238, v238, v10
    v_sub_f32 v239, v239, v10
    v_sub_f32 v240, v240, v11
    v_sub_f32 v241, v241, v11
    v_sub_f32 v242, v242, v11
    v_sub_f32 v243, v243, v11
    v_sub_f32 v108, v108, v10
    v_sub_f32 v109, v109, v10
    v_sub_f32 v110, v110, v10
    v_sub_f32 v111, v111, v10
    v_sub_f32 v112, v112, v10
    v_sub_f32 v113, v113, v10
    v_sub_f32 v114, v114, v10
    v_sub_f32 v115, v115, v10
    v_sub_f32 v116, v116, v11
    v_sub_f32 v117, v117, v11
    v_sub_f32 v118, v118, v11
    v_sub_f32 v119, v119, v11
    v_sub_f32 v120, v120, v11
    v_sub_f32 v121, v121, v11
    v_sub_f32 v122, v122, v11
    v_sub_f32 v123, v123, v11
    v_sub_f32 v124, v124, v10
    v_sub_f32 v125, v125, v10
    v_sub_f32 v126, v126, v10
    v_sub_f32 v127, v127, v10
    v_sub_f32 v128, v128, v10
    v_sub_f32 v129, v129, v10
    v_sub_f32 v130, v130, v10
    v_sub_f32 v131, v131, v10
    v_sub_f32 v132, v132, v11
    v_sub_f32 v133, v133, v11
    v_sub_f32 v134, v134, v11
    v_sub_f32 v135, v135, v11
    v_sub_f32 v136, v136, v11
    v_sub_f32 v137, v137, v11
    v_sub_f32 v138, v138, v11
    v_sub_f32 v139, v139, v11
    v_mul_f32 v140, v140, v12
    v_mul_f32 v141, v141, v12
    v_mul_f32 v142, v142, v12
    v_mul_f32 v143, v143, v12
    v_mul_f32 v144, v144, v12
    v_mul_f32 v145, v145, v12
    v_mul_f32 v146, v146, v12
    v_mul_f32 v147, v147, v12
    v_mul_f32 v148, v148, v12
    v_mul_f32 v149, v149, v12
    v_mul_f32 v150, v150, v12
    v_mul_f32 v151, v151, v12
    v_mul_f32 v152, v152, v12
    v_mul_f32 v153, v153, v12
    v_mul_f32 v154, v154, v12
    v_mul_f32 v155, v155, v12
    v_mul_f32 v156, v156, v12
    v_mul_f32 v157, v157, v12
    v_mul_f32 v158, v158, v12
    v_mul_f32 v159, v159, v12
    v_mul_f32 v160, v160, v12
    v_mul_f32 v161, v161, v12
    v_mul_f32 v162, v162, v12
    v_mul_f32 v163, v163, v12
    v_mul_f32 v164, v164, v12
    v_mul_f32 v165, v165, v12
    v_mul_f32 v166, v166, v12
    v_mul_f32 v167, v167, v12
    v_mul_f32 v168, v168, v12
    v_mul_f32 v169, v169, v12
    v_mul_f32 v170, v170, v12
    v_mul_f32 v171, v171, v12
    v_mul_f32 v172, v172, v13
    v_mul_f32 v173, v173, v13
    v_mul_f32 v174, v174, v13
    v_mul_f32 v175, v175, v13
    v_mul_f32 v176, v176, v13
    v_mul_f32 v177, v177, v13
    v_mul_f32 v178, v178, v13
    v_mul_f32 v179, v179, v13
    v_mul_f32 v180, v180, v13
    v_mul_f32 v181, v181, v13
    v_mul_f32 v182, v182, v13
    v_mul_f32 v183, v183, v13
    v_mul_f32 v184, v184, v13
    v_mul_f32 v185, v185, v13
    v_mul_f32 v186, v186, v13
    v_mul_f32 v187, v187, v13
    v_mul_f32 v188, v188, v13
    v_mul_f32 v189, v189, v13
    v_mul_f32 v190, v190, v13
    v_mul_f32 v191, v191, v13
    v_mul_f32 v192, v192, v13
    v_mul_f32 v193, v193, v13
    v_mul_f32 v194, v194, v13
    v_mul_f32 v195, v195, v13
    v_mul_f32 v196, v196, v13
    v_mul_f32 v197, v197, v13
    v_mul_f32 v198, v198, v13
    v_mul_f32 v199, v199, v13
    v_mul_f32 v200, v200, v13
    v_mul_f32 v201, v201, v13
    v_mul_f32 v202, v202, v13
    v_mul_f32 v203, v203, v13
    v_mul_f32 v248, v248, v12
    v_mul_f32 v249, v249, v12
    v_mul_f32 v250, v250, v12
    v_mul_f32 v251, v251, v12
    v_mul_f32 v252, v252, v13
    v_mul_f32 v253, v253, v13
    v_mul_f32 v254, v254, v13
    v_mul_f32 v255, v255, v13
    v_exp_f32 v16, v124
    v_exp_f32 v17, v125
    v_exp_f32 v18, v126
    v_exp_f32 v19, v127
    v_cvt_pk_bf16_f32 v100, v16, v17
    v_exp_f32 v20, v128
    v_exp_f32 v21, v129
    v_cvt_pk_bf16_f32 v101, v18, v19
    v_exp_f32 v22, v130
    v_exp_f32 v23, v131
    v_cvt_pk_bf16_f32 v102, v20, v21
    v_exp_f32 v16, v132
    v_exp_f32 v17, v133
    v_cvt_pk_bf16_f32 v103, v22, v23
    v_or3_b32 v9, v100, v101, v102
    v_exp_f32 v18, v134
    v_exp_f32 v19, v135
    v_cvt_pk_bf16_f32 v104, v16, v17
    v_exp_f32 v20, v136
    v_exp_f32 v21, v137
    v_cvt_pk_bf16_f32 v105, v18, v19
    v_or3_b32 v9, v9, v103, v104
    v_exp_f32 v22, v138
    v_exp_f32 v23, v139
    v_cvt_pk_bf16_f32 v106, v20, v21
    v_cvt_pk_bf16_f32 v107, v22, v23
    v_or3_b32 v9, v9, v105, v106
    v_bitop3_b32 v9, v9, v107, s50 bitop3:0xa8
    s_branch AT_L0_RET
AT_L1:
    s_bitcmp1_b64 s[62:63], s48
    s_cbranch_scc0 AT_L1_GO
AT_L1_EV:
    s_cmp_eq_u32 s48, s56
    s_cselect_b32 s53, 16384, s53
    s_cselect_b32 s22, 16777216, s22
    s_sub_u32 s37, s48, s56
    s_cmp_eq_u32 s37, 3
    s_cselect_b32 s18, 16777216, s18
    s_cmp_eq_u32 s37, 2
    s_cselect_b32 s38, s40, 0
    v_add_u32 v2, s38, v2
    s_cmp_eq_u32 s37, 5
    s_cselect_b32 s38, s40, 0
    v_add_u32 v3, s38, v3
    s_cmp_eq_u32 s48, 31
    s_cselect_b32 s22, 0, s22
    s_sub_u32 s37, s48, s47
    s_cmp_lg_u32 s37, 2
    s_cbranch_scc1 AT_L1_E1
    v_rcp_f32 v10, v248
    v_rcp_f32 v11, v252
    v_mov_b32 v248, 0
    v_mov_b32 v249, 0
    v_mov_b32 v250, 0
    v_mov_b32 v251, 0
    v_mov_b32 v252, 0
    v_mov_b32 v253, 0
    v_mov_b32 v254, 0
    v_mov_b32 v255, 0
    v_mul_f32 v140, v140, v10
    v_mul_f32 v141, v141, v10
    v_mul_f32 v142, v142, v10
    v_mul_f32 v143, v143, v10
    v_mul_f32 v144, v144, v10
    v_mul_f32 v145, v145, v10
    v_mul_f32 v146, v146, v10
    v_mul_f32 v147, v147, v10
    v_mul_f32 v148, v148, v10
    v_mul_f32 v149, v149, v10
    v_mul_f32 v150, v150, v10
    v_mul_f32 v151, v151, v10
    v_mul_f32 v152, v152, v10
    v_mul_f32 v153, v153, v10
    v_mul_f32 v154, v154, v10
    v_mul_f32 v155, v155, v10
    v_mul_f32 v156, v156, v10
    v_mul_f32 v157, v157, v10
    v_mul_f32 v158, v158, v10
    v_mul_f32 v159, v159, v10
    v_mul_f32 v160, v160, v10
    v_mul_f32 v161, v161, v10
    v_mul_f32 v162, v162, v10
    v_mul_f32 v163, v163, v10
    v_mul_f32 v164, v164, v10
    v_mul_f32 v165, v165, v10
    v_mul_f32 v166, v166, v10
    v_mul_f32 v167, v167, v10
    v_mul_f32 v168, v168, v10
    v_mul_f32 v169, v169, v10
    v_mul_f32 v170, v170, v10
    v_mul_f32 v171, v171, v10
    v_mul_f32 v172, v172, v11
    v_mul_f32 v173, v173, v11
    v_mul_f32 v174, v174, v11
    v_mul_f32 v175, v175, v11
    v_mul_f32 v176, v176, v11
    v_mul_f32 v177, v177, v11
    v_mul_f32 v178, v178, v11
    v_mul_f32 v179, v179, v11
    v_mul_f32 v180, v180, v11
    v_mul_f32 v181, v181, v11
    v_mul_f32 v182, v182, v11
    v_mul_f32 v183, v183, v11
    v_mul_f32 v184, v184, v11
    v_mul_f32 v185, v185, v11
    v_mul_f32 v186, v186, v11
    v_mul_f32 v187, v187, v11
    v_mul_f32 v188, v188, v11
    v_mul_f32 v189, v189, v11
    v_mul_f32 v190, v190, v11
    v_mul_f32 v191, v191, v11
    v_mul_f32 v192, v192, v11
    v_mul_f32 v193, v193, v11
    v_mul_f32 v194, v194, v11
    v_mul_f32 v195, v195, v11
    v_mul_f32 v196, v196, v11
    v_mul_f32 v197, v197, v11
    v_mul_f32 v198, v198, v11
    v_mul_f32 v199, v199, v11
    v_mul_f32 v200, v200, v11
    v_mul_f32 v201, v201, v11
    v_mul_f32 v202, v202, v11
    v_mul_f32 v203, v203, v11
    v_cvt_pk_bf16_f32 v16, v140, v141
    v_cvt_pk_bf16_f32 v17, v142, v143
    v_cvt_pk_bf16_f32 v18, v144, v145
    v_cvt_pk_bf16_f32 v19, v146, v147
    buffer_store_dwordx4 v[16:19], v1, s[12:15], s54 offen offset:0 sc1
    v_cvt_pk_bf16_f32 v20, v148, v149
    v_cvt_pk_bf16_f32 v21, v150, v151
    v_cvt_pk_bf16_f32 v22, v152, v153
    v_cvt_pk_bf16_f32 v23, v154, v155
    buffer_store_dwordx4 v[20:23], v1, s[12:15], s54 offen offset:1024 sc1
    v_cvt_pk_bf16_f32 v16, v156, v157
    v_cvt_pk_bf16_f32 v17, v158, v159
    v_cvt_pk_bf16_f32 v18, v160, v161
    v_cvt_pk_bf16_f32 v19, v162, v163
    buffer_store_dwordx4 v[16:19], v1, s[12:15], s54 offen offset:2048 sc1
    v_cvt_pk_bf16_f32 v20, v164, v165
    v_cvt_pk_bf16_f32 v21, v166, v167
    v_cvt_pk_bf16_f32 v22, v168, v169
    v_cvt_pk_bf16_f32 v23, v170, v171
    buffer_store_dwordx4 v[20:23], v1, s[12:15], s54 offen offset:3072 sc1
    v_cvt_pk_bf16_f32 v16, v172, v173
    v_cvt_pk_bf16_f32 v17, v174, v175
    v_cvt_pk_bf16_f32 v18, v176, v177
    v_cvt_pk_bf16_f32 v19, v178, v179
    s_add_u32 s54, s54, 528384
    buffer_store_dwordx4 v[16:19], v1, s[12:15], s54 offen offset:0 sc1
    v_cvt_pk_bf16_f32 v20, v180, v181
    v_cvt_pk_bf16_f32 v21, v182, v183
    v_cvt_pk_bf16_f32 v22, v184, v185
    v_cvt_pk_bf16_f32 v23, v186, v187
    buffer_store_dwordx4 v[20:23], v1, s[12:15], s54 offen offset:1024 sc1
    v_cvt_pk_bf16_f32 v16, v188, v189
    v_cvt_pk_bf16_f32 v17, v190, v191
    v_cvt_pk_bf16_f32 v18, v192, v193
    v_cvt_pk_bf16_f32 v19, v194, v195
    buffer_store_dwordx4 v[16:19], v1, s[12:15], s54 offen offset:2048 sc1
    v_cvt_pk_bf16_f32 v20, v196, v197
    v_cvt_pk_bf16_f32 v21, v198, v199
    v_cvt_pk_bf16_f32 v22, v200, v201
    v_cvt_pk_bf16_f32 v23, v202, v203
    buffer_store_dwordx4 v[20:23], v1, s[12:15], s54 offen offset:3072 sc1
    v_mov_b32 v140, 0
    v_mov_b32 v141, 0
    v_mov_b32 v142, 0
    v_mov_b32 v143, 0
    v_mov_b32 v144, 0
    v_mov_b32 v145, 0
    v_mov_b32 v146, 0
    v_mov_b32 v147, 0
    v_mov_b32 v148, 0
    v_mov_b32 v149, 0
    v_mov_b32 v150, 0
    v_mov_b32 v151, 0
    v_mov_b32 v152, 0
    v_mov_b32 v153, 0
    v_mov_b32 v154, 0
    v_mov_b32 v155, 0
    v_mov_b32 v156, 0
    v_mov_b32 v157, 0
    v_mov_b32 v158, 0
    v_mov_b32 v159, 0
    v_mov_b32 v160, 0
    v_mov_b32 v161, 0
    v_mov_b32 v162, 0
    v_mov_b32 v163, 0
    v_mov_b32 v164, 0
    v_mov_b32 v165, 0
    v_mov_b32 v166, 0
    v_mov_b32 v167, 0
    v_mov_b32 v168, 0
    v_mov_b32 v169, 0
    v_mov_b32 v170, 0
    v_mov_b32 v171, 0
    v_mov_b32 v172, 0
    v_mov_b32 v173, 0
    v_mov_b32 v174, 0
    v_mov_b32 v175, 0
    v_mov_b32 v176, 0
    v_mov_b32 v177, 0
    v_mov_b32 v178, 0
    v_mov_b32 v179, 0
    v_mov_b32 v180, 0
    v_mov_b32 v181, 0
    v_mov_b32 v182, 0
    v_mov_b32 v183, 0
    v_mov_b32 v184, 0
    v_mov_b32 v185, 0
    v_mov_b32 v186, 0
    v_mov_b32 v187, 0
    v_mov_b32 v188, 0
    v_mov_b32 v189, 0
    v_mov_b32 v190, 0
    v_mov_b32 v191, 0
    v_mov_b32 v192, 0
    v_mov_b32 v193, 0
    v_mov_b32 v194, 0
    v_mov_b32 v195, 0
    v_mov_b32 v196, 0
    v_mov_b32 v197, 0
    v_mov_b32 v198, 0
    v_mov_b32 v199, 0
    v_mov_b32 v200, 0
    v_mov_b32 v201, 0
    v_mov_b32 v202, 0
    v_mov_b32 v203, 0
AT_L1_E1:
    s_cmp_lg_u32 s32, 0
    s_cbranch_scc1 ONLY_26
    s_cmp_lg_u32 s37, 3
    s_cbranch_scc1 ONLY_26
    s_mov_b64 exec, 1
    v_mov_b32 v10, 1
    s_lshl_b32 s3, s34, 10
    s_add_u32 s3, s3, s33
    s_lshl_b32 s3, s3, 2
    s_add_u32 s3, s3, 66846720
    buffer_store_dword v10, v25, s[12:15], s3 offen sc1
    s_mov_b64 exec, -1
ONLY_26:
    s_cmp_lg_u32 s37, 0
    s_cbranch_scc1 AT_L1_E2
    ds_read_b128 v[204:207], v5 offset:32768
    ds_read_b128 v[208:211], v5 offset:33792
    ds_read_b128 v[212:215], v5 offset:34816
    ds_read_b128 v[216:219], v5 offset:35840
    ds_read_b128 v[220:223], v5 offset:49152
    ds_read_b128 v[224:227], v5 offset:50176
    ds_read_b128 v[228:231], v5 offset:51200
    ds_read_b128 v[232:235], v5 offset:52224
    v_mov_b32 v236, 0
    v_mov_b32 v237, 0
    v_mov_b32 v238, 0
    v_mov_b32 v239, 0
    v_mov_b32 v240, 0
    v_mov_b32 v241, 0
    v_mov_b32 v242, 0
    v_mov_b32 v243, 0
    s_waitcnt lgkmcnt(0)
AT_L1_E2:
    s_sub_u32 s38, s48, s49
    s_sub_u32 s38, s38, 1
    s_cmp_lt_u32 s38, 4
    s_cbranch_scc1 AT_L1_EM
    s_cmp_lt_u32 s48, 33
    s_cbranch_scc1 AT_L1_E3
    s_sub_u32 s38, s48, 33
    s_lshl_b32 s38, s38, 1
    s_add_u32 s38, s38, s35
AT_L1_EM:
    s_lshl_b32 s38, s38, 5
    v_subrev_u32 v10, s38, v4
    v_add_u32 v11, 64, v10
    v_cmp_le_i32 s[4:5], 0, v10
    v_cmp_le_i32 s[6:7], 1, v10
    v_cmp_le_i32 s[8:9], 2, v10
    v_cmp_le_i32 s[10:11], 3, v10
    v_cndmask_b32 v108, v8, v108, s[4:5]
    v_cndmask_b32 v109, v8, v109, s[6:7]
    v_cndmask_b32 v110, v8, v110, s[8:9]
    v_cndmask_b32 v111, v8, v111, s[10:11]
    v_cmp_le_i32 s[4:5], 16, v10
    v_cmp_le_i32 s[6:7], 17, v10
    v_cmp_le_i32 s[8:9], 18, v10
    v_cmp_le_i32 s[10:11], 19, v10
    v_cndmask_b32 v112, v8, v112, s[4:5]
    v_cndmask_b32 v113, v8, v113, s[6:7]
    v_cndmask_b32 v114, v8, v114, s[8:9]
    v_cndmask_b32 v115, v8, v115, s[10:11]
    v_cmp_le_i32 s[4:5], 0, v11
    v_cmp_le_i32 s[6:7], 1, v11
    v_cmp_le_i32 s[8:9], 2, v11
    v_cmp_le_i32 s[10:11], 3, v11
    v_cndmask_b32 v116, v8, v116, s[4:5]
    v_cndmask_b32 v117, v8, v117, s[6:7]
    v_cndmask_b32 v118, v8, v118, s[8:9]
    v_cndmask_b32 v119, v8, v119, s[10:11]
    v_cmp_le_i32 s[4:5], 16, v11
    v_cmp_le_i32 s[6:7], 17, v11
    v_cmp_le_i32 s[8:9], 18, v11
    v_cmp_le_i32 s[10:11], 19, v11
    v_cndmask_b32 v120, v8, v120, s[4:5]
    v_cndmask_b32 v121, v8, v121, s[6:7]
    v_cndmask_b32 v122, v8, v122, s[8:9]
    v_cndmask_b32 v123, v8, v123, s[10:11]
AT_L1_E3:
    s_cmp_eq_u32 s37, 1
    s_cbranch_scc1 AT_L1_E4
    s_cmp_lg_u32 s48, 1
    s_cbranch_scc1 AT_L1_GO
AT_L1_E4:
    v_max3_f32 v10, v108, v109, v110
    v_max3_f32 v10, v10, v111, v112
    v_max3_f32 v10, v10, v113, v114
    v_max_f32 v10, v10, v115
    v_mov_b32 v12, v10
    s_nop 1
    v_permlane16_swap_b32 v10, v12
    v_max_f32 v10, v10, v12
    v_mov_b32 v12, v10
    s_nop 1
    v_permlane32_swap_b32 v10, v12
    v_max_f32 v10, v10, v12
    v_add_f32 v10, 0x41400000, v10
    v_max3_f32 v11, v116, v117, v118
    v_max3_f32 v11, v11, v119, v120
    v_max3_f32 v11, v11, v121, v122
    v_max_f32 v11, v11, v123
    v_mov_b32 v13, v11
    s_nop 1
    v_permlane16_swap_b32 v11, v13
    v_max_f32 v11, v11, v13
    v_mov_b32 v13, v11
    s_nop 1
    v_permlane32_swap_b32 v11, v13
    v_max_f32 v11, v11, v13
    v_add_f32 v11, 0x41400000, v11
    v_sub_f32 v236, v236, v10
    v_sub_f32 v237, v237, v10
    v_sub_f32 v238, v238, v10
    v_sub_f32 v239, v239, v10
    v_sub_f32 v240, v240, v11
    v_sub_f32 v241, v241, v11
    v_sub_f32 v242, v242, v11
    v_sub_f32 v243, v243, v11
    v_sub_f32 v108, v108, v10
    v_sub_f32 v109, v109, v10
    v_sub_f32 v110, v110, v10
    v_sub_f32 v111, v111, v10
    v_sub_f32 v112, v112, v10
    v_sub_f32 v113, v113, v10
    v_sub_f32 v114, v114, v10
    v_sub_f32 v115, v115, v10
    v_sub_f32 v116, v116, v11
    v_sub_f32 v117, v117, v11
    v_sub_f32 v118, v118, v11
    v_sub_f32 v119, v119, v11
    v_sub_f32 v120, v120, v11
    v_sub_f32 v121, v121, v11
    v_sub_f32 v122, v122, v11
    v_sub_f32 v123, v123, v11
    s_branch AT_L1_GO
AT_L1_SP:
    v_cmp_ne_u32 vcc, 0, v9
    s_cbranch_vccnz AT_L1_SLOW
AT_L1_RET:
    s_waitcnt vmcnt(4) lgkmcnt(0)
    s_barrier
    s_branch AT_L2
AT_L1_SLOW:
    v_max3_f32 v10, v108, v109, v110
    v_max3_f32 v10, v10, v111, v112
    v_max3_f32 v10, v10, v113, v114
    v_max_f32 v10, v10, v115
    v_mov_b32 v12, v10
    s_nop 1
    v_permlane16_swap_b32 v10, v12
    v_max_f32 v10, v10, v12
    v_mov_b32 v12, v10
    s_nop 1
    v_permlane32_swap_b32 v10, v12
    v_max_f32 v10, v10, v12
    v_add_f32 v10, 0x41400000, v10
    v_max_f32 v10, 0, v10
    v_exp_f32 v12, -v10
    v_max3_f32 v11, v116, v117, v118
    v_max3_f32 v11, v11, v119, v120
    v_max3_f32 v11, v11, v121, v122
    v_max_f32 v11, v11, v123
    v_mov_b32 v13, v11
    s_nop 1
    v_permlane16_swap_b32 v11, v13
    v_max_f32 v11, v11, v13
    v_mov_b32 v13, v11
    s_nop 1
    v_permlane32_swap_b32 v11, v13
    v_max_f32 v11, v11, v13
    v_add_f32 v11, 0x41400000, v11
    v_max_f32 v11, 0, v11
    v_exp_f32 v13, -v11
    v_sub_f32 v236, v236, v10
    v_sub_f32 v237, v237, v10
    v_sub_f32 v238, v238, v10
    v_sub_f32 v239, v239, v10
    v_sub_f32 v240, v240, v11
    v_sub_f32 v241, v241, v11
    v_sub_f32 v242, v242, v11
    v_sub_f32 v243, v243, v11
    v_sub_f32 v124, v124, v10
    v_sub_f32 v125, v125, v10
    v_sub_f32 v126, v126, v10
    v_sub_f32 v127, v127, v10
    v_sub_f32 v128, v128, v10
    v_sub_f32 v129, v129, v10
    v_sub_f32 v130, v130, v10
    v_sub_f32 v131, v131, v10
    v_sub_f32 v132, v132, v11
    v_sub_f32 v133, v133, v11
    v_sub_f32 v134, v134, v11
    v_sub_f32 v135, v135, v11
    v_sub_f32 v136, v136, v11
    v_sub_f32 v137, v137, v11
    v_sub_f32 v138, v138, v11
    v_sub_f32 v139, v139, v11
    v_sub_f32 v108, v108, v10
    v_sub_f32 v109, v109, v10
    v_sub_f32 v110, v110, v10
    v_sub_f32 v111, v111, v10
    v_sub_f32 v112, v112, v10
    v_sub_f32 v113, v113, v10
    v_sub_f32 v114, v114, v10
    v_sub_f32 v115, v115, v10
    v_sub_f32 v116, v116, v11
    v_sub_f32 v117, v117, v11
    v_sub_f32 v118, v118, v11
    v_sub_f32 v119, v119, v11
    v_sub_f32 v120, v120, v11
    v_sub_f32 v121, v121, v11
    v_sub_f32 v122, v122, v11
    v_sub_f32 v123, v123, v11
    v_mul_f32 v140, v140, v12
    v_mul_f32 v141, v141, v12
    v_mul_f32 v142, v142, v12
    v_mul_f32 v143, v143, v12
    v_mul_f32 v144, v144, v12
    v_mul_f32 v145, v145, v12
    v_mul_f32 v146, v146, v12
    v_mul_f32 v147, v147, v12
    v_mul_f32 v148, v148, v12
    v_mul_f32 v149, v149, v12
    v_mul_f32 v150, v150, v12
    v_mul_f32 v151, v151, v12
    v_mul_f32 v152, v152, v12
    v_mul_f32 v153, v153, v12
    v_mul_f32 v154, v154, v12
    v_mul_f32 v155, v155, v12
    v_mul_f32 v156, v156, v12
    v_mul_f32 v157, v157, v12
    v_mul_f32 v158, v158, v12
    v_mul_f32 v159, v159, v12
    v_mul_f32 v160, v160, v12
    v_mul_f32 v161, v161, v12
    v_mul_f32 v162, v162, v12
    v_mul_f32 v163, v163, v12
    v_mul_f32 v164, v164, v12
    v_mul_f32 v165, v165, v12
    v_mul_f32 v166, v166, v12
    v_mul_f32 v167, v167, v12
    v_mul_f32 v168, v168, v12
    v_mul_f32 v169, v169, v12
    v_mul_f32 v170, v170, v12
    v_mul_f32 v171, v171, v12
    v_mul_f32 v172, v172, v13
    v_mul_f32 v173, v173, v13
    v_mul_f32 v174, v174, v13
    v_mul_f32 v175, v175, v13
    v_mul_f32 v176, v176, v13
    v_mul_f32 v177, v177, v13
    v_mul_f32 v178, v178, v13
    v_mul_f32 v179, v179, v13
    v_mul_f32 v180, v180, v13
    v_mul_f32 v181, v181, v13
    v_mul_f32 v182, v182, v13
    v_mul_f32 v183, v183, v13
    v_mul_f32 v184, v184, v13
    v_mul_f32 v185, v185, v13
    v_mul_f32 v186, v186, v13
    v_mul_f32 v187, v187, v13
    v_mul_f32 v188, v188, v13
    v_mul_f32 v189, v189, v13
    v_mul_f32 v190, v190, v13
    v_mul_f32 v191, v191, v13
    v_mul_f32 v192, v192, v13
    v_mul_f32 v193, v193, v13
    v_mul_f32 v194, v194, v13
    v_mul_f32 v195, v195, v13
    v_mul_f32 v196, v196, v13
    v_mul_f32 v197, v197, v13
    v_mul_f32 v198, v198, v13
    v_mul_f32 v199, v199, v13
    v_mul_f32 v200, v200, v13
    v_mul_f32 v201, v201, v13
    v_mul_f32 v202, v202, v13
    v_mul_f32 v203, v203, v13
    v_mul_f32 v248, v248, v12
    v_mul_f32 v249, v249, v12
    v_mul_f32 v250, v250, v12
    v_mul_f32 v251, v251, v12
    v_mul_f32 v252, v252, v13
    v_mul_f32 v253, v253, v13
    v_mul_f32 v254, v254, v13
    v_mul_f32 v255, v255, v13
    v_exp_f32 v16, v108
    v_exp_f32 v17, v109
    v_exp_f32 v18, v110
    v_exp_f32 v19, v111
    v_cvt_pk_bf16_f32 v92, v16, v17
    v_exp_f32 v20, v112
    v_exp_f32 v21, v113
    v_cvt_pk_bf16_f32 v93, v18, v19
    v_exp_f32 v22, v114
    v_exp_f32 v23, v115
    v_cvt_pk_bf16_f32 v94, v20, v21
    v_exp_f32 v16, v116
    v_exp_f32 v17, v117
    v_cvt_pk_bf16_f32 v95, v22, v23
    v_or3_b32 v9, v92, v93, v94
    v_exp_f32 v18, v118
    v_exp_f32 v19, v119
    v_cvt_pk_bf16_f32 v96, v16, v17
    v_exp_f32 v20, v120
    v_exp_f32 v21, v121
    v_cvt_pk_bf16_f32 v97, v18, v19
    v_or3_b32 v9, v9, v95, v96
    v_exp_f32 v22, v122
    v_exp_f32 v23, v123
    v_cvt_pk_bf16_f32 v98, v20, v21
    v_cvt_pk_bf16_f32 v99, v22, v23
    v_or3_b32 v9, v9, v97, v98
    v_bitop3_b32 v9, v9, v99, s50 bitop3:0xa8
    s_branch AT_L1_RET
AT_S33_EV:
    s_cmp_eq_u32 s48, s56
    s_cselect_b32 s53, 16384, s53
    s_cselect_b32 s22, 16777216, s22
    s_sub_u32 s37, s48, s56
    s_cmp_eq_u32 s37, 3
    s_cselect_b32 s18, 16777216, s18
    s_cmp_eq_u32 s37, 2
    s_cselect_b32 s38, s40, 0
    v_add_u32 v2, s38, v2
    s_cmp_eq_u32 s37, 5
    s_cselect_b32 s38, s40, 0
    v_add_u32 v3, s38, v3
    s_cmp_eq_u32 s48, 31
    s_cselect_b32 s22, 0, s22
    s_sub_u32 s37, s48, s47
    s_cmp_lg_u32 s37, 2
    s_cbranch_scc1 AT_S33_E1
    v_rcp_f32 v10, v248
    v_rcp_f32 v11, v252
    v_mov_b32 v248, 0
    v_mov_b32 v249, 0
    v_mov_b32 v250, 0
    v_mov_b32 v251, 0
    v_mov_b32 v252, 0
    v_mov_b32 v253, 0
    v_mov_b32 v254, 0
    v_mov_b32 v255, 0
    v_mul_f32 v140, v140, v10
    v_mul_f32 v141, v141, v10
    v_mul_f32 v142, v142, v10
    v_mul_f32 v143, v143, v10
    v_mul_f32 v144, v144, v10
    v_mul_f32 v145, v145, v10
    v_mul_f32 v146, v146, v10
    v_mul_f32 v147, v147, v10
    v_mul_f32 v148, v148, v10
    v_mul_f32 v149, v149, v10
    v_mul_f32 v150, v150, v10
    v_mul_f32 v151, v151, v10
    v_mul_f32 v152, v152, v10
    v_mul_f32 v153, v153, v10
    v_mul_f32 v154, v154, v10
    v_mul_f32 v155, v155, v10
    v_mul_f32 v156, v156, v10
    v_mul_f32 v157, v157, v10
    v_mul_f32 v158, v158, v10
    v_mul_f32 v159, v159, v10
    v_mul_f32 v160, v160, v10
    v_mul_f32 v161, v161, v10
    v_mul_f32 v162, v162, v10
    v_mul_f32 v163, v163, v10
    v_mul_f32 v164, v164, v10
    v_mul_f32 v165, v165, v10
    v_mul_f32 v166, v166, v10
    v_mul_f32 v167, v167, v10
    v_mul_f32 v168, v168, v10
    v_mul_f32 v169, v169, v10
    v_mul_f32 v170, v170, v10
    v_mul_f32 v171, v171, v10
    v_mul_f32 v172, v172, v11
    v_mul_f32 v173, v173, v11
    v_mul_f32 v174, v174, v11
    v_mul_f32 v175, v175, v11
    v_mul_f32 v176, v176, v11
    v_mul_f32 v177, v177, v11
    v_mul_f32 v178, v178, v11
    v_mul_f32 v179, v179, v11
    v_mul_f32 v180, v180, v11
    v_mul_f32 v181, v181, v11
    v_mul_f32 v182, v182, v11
    v_mul_f32 v183, v183, v11
    v_mul_f32 v184, v184, v11
    v_mul_f32 v185, v185, v11
    v_mul_f32 v186, v186, v11
    v_mul_f32 v187, v187, v11
    v_mul_f32 v188, v188, v11
    v_mul_f32 v189, v189, v11
    v_mul_f32 v190, v190, v11
    v_mul_f32 v191, v191, v11
    v_mul_f32 v192, v192, v11
    v_mul_f32 v193, v193, v11
    v_mul_f32 v194, v194, v11
    v_mul_f32 v195, v195, v11
    v_mul_f32 v196, v196, v11
    v_mul_f32 v197, v197, v11
    v_mul_f32 v198, v198, v11
    v_mul_f32 v199, v199, v11
    v_mul_f32 v200, v200, v11
    v_mul_f32 v201, v201, v11
    v_mul_f32 v202, v202, v11
    v_mul_f32 v203, v203, v11
    v_cvt_pk_bf16_f32 v16, v140, v141
    v_cvt_pk_bf16_f32 v17, v142, v143
    v_cvt_pk_bf16_f32 v18, v144, v145
    v_cvt_pk_bf16_f32 v19, v146, v147
    buffer_store_dwordx4 v[16:19], v1, s[12:15], s54 offen offset:0 sc1
    v_cvt_pk_bf16_f32 v20, v148, v149
    v_cvt_pk_bf16_f32 v21, v150, v151
    v_cvt_pk_bf16_f32 v22, v152, v153
    v_cvt_pk_bf16_f32 v23, v154, v155
    buffer_store_dwordx4 v[20:23], v1, s[12:15], s54 offen offset:1024 sc1
    v_cvt_pk_bf16_f32 v16, v156, v157
    v_cvt_pk_bf16_f32 v17, v158, v159
    v_cvt_pk_bf16_f32 v18, v160, v161
    v_cvt_pk_bf16_f32 v19, v162, v163
    buffer_store_dwordx4 v[16:19], v1, s[12:15], s54 offen offset:2048 sc1
    v_cvt_pk_bf16_f32 v20, v164, v165
    v_cvt_pk_bf16_f32 v21, v166, v167
    v_cvt_pk_bf16_f32 v22, v168, v169
    v_cvt_pk_bf16_f32 v23, v170, v171
    buffer_store_dwordx4 v[20:23], v1, s[12:15], s54 offen offset:3072 sc1
    v_cvt_pk_bf16_f32 v16, v172, v173
    v_cvt_pk_bf16_f32 v17, v174, v175
    v_cvt_pk_bf16_f32 v18, v176, v177
    v_cvt_pk_bf16_f32 v19, v178, v179
    s_add_u32 s54, s54, 528384
    buffer_store_dwordx4 v[16:19], v1, s[12:15], s54 offen offset:0 sc1
    v_cvt_pk_bf16_f32 v20, v180, v181
    v_cvt_pk_bf16_f32 v21, v182, v183
    v_cvt_pk_bf16_f32 v22, v184, v185
    v_cvt_pk_bf16_f32 v23, v186, v187
    buffer_store_dwordx4 v[20:23], v1, s[12:15], s54 offen offset:1024 sc1
    v_cvt_pk_bf16_f32 v16, v188, v189
    v_cvt_pk_bf16_f32 v17, v190, v191
    v_cvt_pk_bf16_f32 v18, v192, v193
    v_cvt_pk_bf16_f32 v19, v194, v195
    buffer_store_dwordx4 v[16:19], v1, s[12:15], s54 offen offset:2048 sc1
    v_cvt_pk_bf16_f32 v20, v196, v197
    v_cvt_pk_bf16_f32 v21, v198, v199
    v_cvt_pk_bf16_f32 v22, v200, v201
    v_cvt_pk_bf16_f32 v23, v202, v203
    buffer_store_dwordx4 v[20:23], v1, s[12:15], s54 offen offset:3072 sc1
    v_mov_b32 v140, 0
    v_mov_b32 v141, 0
    v_mov_b32 v142, 0
    v_mov_b32 v143, 0
    v_mov_b32 v144, 0
    v_mov_b32 v145, 0
    v_mov_b32 v146, 0
    v_mov_b32 v147, 0
    v_mov_b32 v148, 0
    v_mov_b32 v149, 0
    v_mov_b32 v150, 0
    v_mov_b32 v151, 0
    v_mov_b32 v152, 0
    v_mov_b32 v153, 0
    v_mov_b32 v154, 0
    v_mov_b32 v155, 0
    v_mov_b32 v156, 0
    v_mov_b32 v157, 0
    v_mov_b32 v158, 0
    v_mov_b32 v159, 0
    v_mov_b32 v160, 0
    v_mov_b32 v161, 0
    v_mov_b32 v162, 0
    v_mov_b32 v163, 0
    v_mov_b32 v164, 0
    v_mov_b32 v165, 0
    v_mov_b32 v166, 0
    v_mov_b32 v167, 0
    v_mov_b32 v168, 0
    v_mov_b32 v169, 0
    v_mov_b32 v170, 0
    v_mov_b32 v171, 0
    v_mov_b32 v172, 0
    v_mov_b32 v173, 0
    v_mov_b32 v174, 0
    v_mov_b32 v175, 0
    v_mov_b32 v176, 0
    v_mov_b32 v177, 0
    v_mov_b32 v178, 0
    v_mov_b32 v179, 0
    v_mov_b32 v180, 0
    v_mov_b32 v181, 0
    v_mov_b32 v182, 0
    v_mov_b32 v183, 0
    v_mov_b32 v184, 0
    v_mov_b32 v185, 0
    v_mov_b32 v186, 0
    v_mov_b32 v187, 0
    v_mov_b32 v188, 0
    v_mov_b32 v189, 0
    v_mov_b32 v190, 0
    v_mov_b32 v191, 0
    v_mov_b32 v192, 0
    v_mov_b32 v193, 0
    v_mov_b32 v194, 0
    v_mov_b32 v195, 0
    v_mov_b32 v196, 0
    v_mov_b32 v197, 0
    v_mov_b32 v198, 0
    v_mov_b32 v199, 0
    v_mov_b32 v200, 0
    v_mov_b32 v201, 0
    v_mov_b32 v202, 0
    v_mov_b32 v203, 0
AT_S33_E1:
    s_cmp_lg_u32 s32, 0
    s_cbranch_scc1 ONLY_27
    s_cmp_lg_u32 s37, 3
    s_cbranch_scc1 ONLY_27
    s_mov_b64 exec, 1
    v_mov_b32 v10, 1
    s_lshl_b32 s3, s34, 10
    s_add_u32 s3, s3, s33
    s_lshl_b32 s3, s3, 2
    s_add_u32 s3, s3, 66846720
    buffer_store_dword v10, v25, s[12:15], s3 offen sc1
    s_mov_b64 exec, -1
ONLY_27:
    s_cmp_lg_u32 s37, 0
    s_cbranch_scc1 AT_S33_E2
    ds_read_b128 v[204:207], v5 offset:32768
    ds_read_b128 v[208:211], v5 offset:33792
    ds_read_b128 v[212:215], v5 offset:34816
    ds_read_b128 v[216:219], v5 offset:35840
    ds_read_b128 v[220:223], v5 offset:49152
    ds_read_b128 v[224:227], v5 offset:50176
    ds_read_b128 v[228:231], v5 offset:51200
    ds_read_b128 v[232:235], v5 offset:52224
    v_mov_b32 v236, 0
    v_mov_b32 v237, 0
    v_mov_b32 v238, 0
    v_mov_b32 v239, 0
    v_mov_b32 v240, 0
    v_mov_b32 v241, 0
    v_mov_b32 v242, 0
    v_mov_b32 v243, 0
    s_waitcnt lgkmcnt(0)
AT_S33_E2:
    s_sub_u32 s38, s48, s49
    s_sub_u32 s38, s38, 1
    s_cmp_lt_u32 s38, 4
    s_cbranch_scc1 AT_S33_EM
    s_cmp_lt_u32 s48, 33
    s_cbranch_scc1 AT_S33_E3
    s_sub_u32 s38, s48, 33
    s_lshl_b32 s38, s38, 1
    s_add_u32 s38, s38, s35
AT_S33_EM:
    s_lshl_b32 s38, s38, 5
    v_subrev_u32 v10, s38, v4
    v_add_u32 v11, 64, v10
    v_cmp_le_i32 s[4:5], 0, v10
    v_cmp_le_i32 s[6:7], 1, v10
    v_cmp_le_i32 s[8:9], 2, v10
    v_cmp_le_i32 s[10:11], 3, v10
    v_cndmask_b32 v108, v8, v108, s[4:5]
    v_cndmask_b32 v109, v8, v109, s[6:7]
    v_cndmask_b32 v110, v8, v110, s[8:9]
    v_cndmask_b32 v111, v8, v111, s[10:11]
    v_cmp_le_i32 s[4:5], 16, v10
    v_cmp_le_i32 s[6:7], 17, v10
    v_cmp_le_i32 s[8:9], 18, v10
    v_cmp_le_i32 s[10:11], 19, v10
    v_cndmask_b32 v112, v8, v112, s[4:5]
    v_cndmask_b32 v113, v8, v113, s[6:7]
    v_cndmask_b32 v114, v8, v114, s[8:9]
    v_cndmask_b32 v115, v8, v115, s[10:11]
    v_cmp_le_i32 s[4:5], 0, v11
    v_cmp_le_i32 s[6:7], 1, v11
    v_cmp_le_i32 s[8:9], 2, v11
    v_cmp_le_i32 s[10:11], 3, v11
    v_cndmask_b32 v116, v8, v116, s[4:5]
    v_cndmask_b32 v117, v8, v117, s[6:7]
    v_cndmask_b32 v118, v8, v118, s[8:9]
    v_cndmask_b32 v119, v8, v119, s[10:11]
    v_cmp_le_i32 s[4:5], 16, v11
    v_cmp_le_i32 s[6:7], 17, v11
    v_cmp_le_i32 s[8:9], 18, v11
    v_cmp_le_i32 s[10:11], 19, v11
    v_cndmask_b32 v120, v8, v120, s[4:5]
    v_cndmask_b32 v121, v8, v121, s[6:7]
    v_cndmask_b32 v122, v8, v122, s[8:9]
    v_cndmask_b32 v123, v8, v123, s[10:11]
AT_S33_E3:
    s_cmp_eq_u32 s37, 1
    s_cbranch_scc1 AT_S33_E4
    s_cmp_lg_u32 s48, 1
    s_cbranch_scc1 AT_S33_GO
AT_S33_E4:
    v_max3_f32 v10, v108, v109, v110
    v_max3_f32 v10, v10, v111, v112
    v_max3_f32 v10, v10, v113, v114
    v_max_f32 v10, v10, v115
    v_mov_b32 v12, v10
    s_nop 1
    v_permlane16_swap_b32 v10, v12
    v_max_f32 v10, v10, v12
    v_mov_b32 v12, v10
    s_nop 1
    v_permlane32_swap_b32 v10, v12
    v_max_f32 v10, v10, v12
    v_add_f32 v10, 0x41400000, v10
    v_max3_f32 v11, v116, v117, v118
    v_max3_f32 v11, v11, v119, v120
    v_max3_f32 v11, v11, v121, v122
    v_max_f32 v11, v11, v123
    v_mov_b32 v13, v11
    s_nop 1
    v_permlane16_swap_b32 v11, v13
    v_max_f32 v11, v11, v13
    v_mov_b32 v13, v11
    s_nop 1
    v_permlane32_swap_b32 v11, v13
    v_max_f32 v11, v11, v13
    v_add_f32 v11, 0x41400000, v11
    v_sub_f32 v236, v236, v10
    v_sub_f32 v237, v237, v10
    v_sub_f32 v238, v238, v10
    v_sub_f32 v239, v239, v10
    v_sub_f32 v240, v240, v11
    v_sub_f32 v241, v241, v11
    v_sub_f32 v242, v242, v11
    v_sub_f32 v243, v243, v11
    v_sub_f32 v108, v108, v10
    v_sub_f32 v109, v109, v10
    v_sub_f32 v110, v110, v10
    v_sub_f32 v111, v111, v10
    v_sub_f32 v112, v112, v10
    v_sub_f32 v113, v113, v10
    v_sub_f32 v114, v114, v10
    v_sub_f32 v115, v115, v10
    v_sub_f32 v116, v116, v11
    v_sub_f32 v117, v117, v11
    v_sub_f32 v118, v118, v11
    v_sub_f32 v119, v119, v11
    v_sub_f32 v120, v120, v11
    v_sub_f32 v121, v121, v11
    v_sub_f32 v122, v122, v11
    v_sub_f32 v123, v123, v11
    s_branch AT_S33_GO
AT_S33_SLOW:
    v_max3_f32 v10, v108, v109, v110
    v_max3_f32 v10, v10, v111, v112
    v_max3_f32 v10, v10, v113, v114
    v_max_f32 v10, v10, v115
    v_mov_b32 v12, v10
    s_nop 1
    v_permlane16_swap_b32 v10, v12
    v_max_f32 v10, v10, v12
    v_mov_b32 v12, v10
    s_nop 1
    v_permlane32_swap_b32 v10, v12
    v_max_f32 v10, v10, v12
    v_add_f32 v10, 0x41400000, v10
    v_max_f32 v10, 0, v10
    v_exp_f32 v12, -v10
    v_max3_f32 v11, v116, v117, v118
    v_max3_f32 v11, v11, v119, v120
    v_max3_f32 v11, v11, v121, v122
    v_max_f32 v11, v11, v123
    v_mov_b32 v13, v11
    s_nop 1
    v_permlane16_swap_b32 v11, v13
    v_max_f32 v11, v11, v13
    v_mov_b32 v13, v11
    s_nop 1
    v_permlane32_swap_b32 v11, v13
    v_max_f32 v11, v11, v13
    v_add_f32 v11, 0x41400000, v11
    v_max_f32 v11, 0, v11
    v_exp_f32 v13, -v11
    v_sub_f32 v236, v236, v10
    v_sub_f32 v237, v237, v10
    v_sub_f32 v238, v238, v10
    v_sub_f32 v239, v239, v10
    v_sub_f32 v240, v240, v11
    v_sub_f32 v241, v241, v11
    v_sub_f32 v242, v242, v11
    v_sub_f32 v243, v243, v11
    v_sub_f32 v124, v124, v10
    v_sub_f32 v125, v125, v10
    v_sub_f32 v126, v126, v10
    v_sub_f32 v127, v127, v10
    v_sub_f32 v128, v128, v10
    v_sub_f32 v129, v129, v10
    v_sub_f32 v130, v130, v10
    v_sub_f32 v131, v131, v10
    v_sub_f32 v132, v132, v11
    v_sub_f32 v133, v133, v11
    v_sub_f32 v134, v134, v11
    v_sub_f32 v135, v135, v11
    v_sub_f32 v136, v136, v11
    v_sub_f32 v137, v137, v11
    v_sub_f32 v138, v138, v11
    v_sub_f32 v139, v139, v11
    v_sub_f32 v108, v108, v10
    v_sub_f32 v109, v109, v10
    v_sub_f32 v110, v110, v10
    v_sub_f32 v111, v111, v10
    v_sub_f32 v112, v112, v10
    v_sub_f32 v113, v113, v10
    v_sub_f32 v114, v114, v10
    v_sub_f32 v115, v115, v10
    v_sub_f32 v116, v116, v11
    v_sub_f32 v117, v117, v11
    v_sub_f32 v118, v118, v11
    v_sub_f32 v119, v119, v11
    v_sub_f32 v120, v120, v11
    v_sub_f32 v121, v121, v11
    v_sub_f32 v122, v122, v11
    v_sub_f32 v123, v123, v11
    v_mul_f32 v140, v140, v12
    v_mul_f32 v141, v141, v12
    v_mul_f32 v142, v142, v12
    v_mul_f32 v143, v143, v12
    v_mul_f32 v144, v144, v12
    v_mul_f32 v145, v145, v12
    v_mul_f32 v146, v146, v12
    v_mul_f32 v147, v147, v12
    v_mul_f32 v148, v148, v12
    v_mul_f32 v149, v149, v12
    v_mul_f32 v150, v150, v12
    v_mul_f32 v151, v151, v12
    v_mul_f32 v152, v152, v12
    v_mul_f32 v153, v153, v12
    v_mul_f32 v154, v154, v12
    v_mul_f32 v155, v155, v12
    v_mul_f32 v156, v156, v12
    v_mul_f32 v157, v157, v12
    v_mul_f32 v158, v158, v12
    v_mul_f32 v159, v159, v12
    v_mul_f32 v160, v160, v12
    v_mul_f32 v161, v161, v12
    v_mul_f32 v162, v162, v12
    v_mul_f32 v163, v163, v12
    v_mul_f32 v164, v164, v12
    v_mul_f32 v165, v165, v12
    v_mul_f32 v166, v166, v12
    v_mul_f32 v167, v167, v12
    v_mul_f32 v168, v168, v12
    v_mul_f32 v169, v169, v12
    v_mul_f32 v170, v170, v12
    v_mul_f32 v171, v171, v12
    v_mul_f32 v172, v172, v13
    v_mul_f32 v173, v173, v13
    v_mul_f32 v174, v174, v13
    v_mul_f32 v175, v175, v13
    v_mul_f32 v176, v176, v13
    v_mul_f32 v177, v177, v13
    v_mul_f32 v178, v178, v13
    v_mul_f32 v179, v179, v13
    v_mul_f32 v180, v180, v13
    v_mul_f32 v181, v181, v13
    v_mul_f32 v182, v182, v13
    v_mul_f32 v183, v183, v13
    v_mul_f32 v184, v184, v13
    v_mul_f32 v185, v185, v13
    v_mul_f32 v186, v186, v13
    v_mul_f32 v187, v187, v13
    v_mul_f32 v188, v188, v13
    v_mul_f32 v189, v189, v13
    v_mul_f32 v190, v190, v13
    v_mul_f32 v191, v191, v13
    v_mul_f32 v192, v192, v13
    v_mul_f32 v193, v193, v13
    v_mul_f32 v194, v194, v13
    v_mul_f32 v195, v195, v13
    v_mul_f32 v196, v196, v13
    v_mul_f32 v197, v197, v13
    v_mul_f32 v198, v198, v13
    v_mul_f32 v199, v199, v13
    v_mul_f32 v200, v200, v13
    v_mul_f32 v201, v201, v13
    v_mul_f32 v202, v202, v13
    v_mul_f32 v203, v203, v13
    v_mul_f32 v248, v248, v12
    v_mul_f32 v249, v249, v12
    v_mul_f32 v250, v250, v12
    v_mul_f32 v251, v251, v12
    v_mul_f32 v252, v252, v13
    v_mul_f32 v253, v253, v13
    v_mul_f32 v254, v254, v13
    v_mul_f32 v255, v255, v13
    v_exp_f32 v16, v108
    v_exp_f32 v17, v109
    v_exp_f32 v18, v110
    v_exp_f32 v19, v111
    v_cvt_pk_bf16_f32 v92, v16, v17
    v_exp_f32 v20, v112
    v_exp_f32 v21, v113
    v_cvt_pk_bf16_f32 v93, v18, v19
    v_exp_f32 v22, v114
    v_exp_f32 v23, v115
    v_cvt_pk_bf16_f32 v94, v20, v21
    v_exp_f32 v16, v116
    v_exp_f32 v17, v117
    v_cvt_pk_bf16_f32 v95, v22, v23
    v_or3_b32 v9, v92, v93, v94
    v_exp_f32 v18, v118
    v_exp_f32 v19, v119
    v_cvt_pk_bf16_f32 v96, v16, v17
    v_exp_f32 v20, v120
    v_exp_f32 v21, v121
    v_cvt_pk_bf16_f32 v97, v18, v19
    v_or3_b32 v9, v9, v95, v96
    v_exp_f32 v22, v122
    v_exp_f32 v23, v123
    v_cvt_pk_bf16_f32 v98, v20, v21
    v_cvt_pk_bf16_f32 v99, v22, v23
    v_or3_b32 v9, v9, v97, v98
    v_bitop3_b32 v9, v9, v99, s50 bitop3:0xa8
    s_branch AT_S33_RET
AT_S34_EV:
    s_cmp_eq_u32 s48, s56
    s_cselect_b32 s53, 16384, s53
    s_cselect_b32 s22, 16777216, s22
    s_sub_u32 s37, s48, s56
    s_cmp_eq_u32 s37, 3
    s_cselect_b32 s18, 16777216, s18
    s_cmp_eq_u32 s37, 2
    s_cselect_b32 s38, s40, 0
    v_add_u32 v2, s38, v2
    s_cmp_eq_u32 s37, 5
    s_cselect_b32 s38, s40, 0
    v_add_u32 v3, s38, v3
    s_cmp_eq_u32 s48, 31
    s_cselect_b32 s22, 0, s22
    s_sub_u32 s37, s48, s47
    s_cmp_lg_u32 s37, 2
    s_cbranch_scc1 AT_S34_E1
    v_rcp_f32 v10, v248
    v_rcp_f32 v11, v252
    v_mov_b32 v248, 0
    v_mov_b32 v249, 0
    v_mov_b32 v250, 0
    v_mov_b32 v251, 0
    v_mov_b32 v252, 0
    v_mov_b32 v253, 0
    v_mov_b32 v254, 0
    v_mov_b32 v255, 0
    v_mul_f32 v140, v140, v10
    v_mul_f32 v141, v141, v10
    v_mul_f32 v142, v142, v10
    v_mul_f32 v143, v143, v10
    v_mul_f32 v144, v144, v10
    v_mul_f32 v145, v145, v10
    v_mul_f32 v146, v146, v10
    v_mul_f32 v147, v147, v10
    v_mul_f32 v148, v148, v10
    v_mul_f32 v149, v149, v10
    v_mul_f32 v150, v150, v10
    v_mul_f32 v151, v151, v10
    v_mul_f32 v152, v152, v10
    v_mul_f32 v153, v153, v10
    v_mul_f32 v154, v154, v10
    v_mul_f32 v155, v155, v10
    v_mul_f32 v156, v156, v10
    v_mul_f32 v157, v157, v10
    v_mul_f32 v158, v158, v10
    v_mul_f32 v159, v159, v10
    v_mul_f32 v160, v160, v10
    v_mul_f32 v161, v161, v10
    v_mul_f32 v162, v162, v10
    v_mul_f32 v163, v163, v10
    v_mul_f32 v164, v164, v10
    v_mul_f32 v165, v165, v10
    v_mul_f32 v166, v166, v10
    v_mul_f32 v167, v167, v10
    v_mul_f32 v168, v168, v10
    v_mul_f32 v169, v169, v10
    v_mul_f32 v170, v170, v10
    v_mul_f32 v171, v171, v10
    v_mul_f32 v172, v172, v11
    v_mul_f32 v173, v173, v11
    v_mul_f32 v174, v174, v11
    v_mul_f32 v175, v175, v11
    v_mul_f32 v176, v176, v11
    v_mul_f32 v177, v177, v11
    v_mul_f32 v178, v178, v11
    v_mul_f32 v179, v179, v11
    v_mul_f32 v180, v180, v11
    v_mul_f32 v181, v181, v11
    v_mul_f32 v182, v182, v11
    v_mul_f32 v183, v183, v11
    v_mul_f32 v184, v184, v11
    v_mul_f32 v185, v185, v11
    v_mul_f32 v186, v186, v11
    v_mul_f32 v187, v187, v11
    v_mul_f32 v188, v188, v11
    v_mul_f32 v189, v189, v11
    v_mul_f32 v190, v190, v11
    v_mul_f32 v191, v191, v11
    v_mul_f32 v192, v192, v11
    v_mul_f32 v193, v193, v11
    v_mul_f32 v194, v194, v11
    v_mul_f32 v195, v195, v11
    v_mul_f32 v196, v196, v11
    v_mul_f32 v197, v197, v11
    v_mul_f32 v198, v198, v11
    v_mul_f32 v199, v199, v11
    v_mul_f32 v200, v200, v11
    v_mul_f32 v201, v201, v11
    v_mul_f32 v202, v202, v11
    v_mul_f32 v203, v203, v11
    v_cvt_pk_bf16_f32 v16, v140, v141
    v_cvt_pk_bf16_f32 v17, v142, v143
    v_cvt_pk_bf16_f32 v18, v144, v145
    v_cvt_pk_bf16_f32 v19, v146, v147
    buffer_store_dwordx4 v[16:19], v1, s[12:15], s54 offen offset:0 sc1
    v_cvt_pk_bf16_f32 v20, v148, v149
    v_cvt_pk_bf16_f32 v21, v150, v151
    v_cvt_pk_bf16_f32 v22, v152, v153
    v_cvt_pk_bf16_f32 v23, v154, v155
    buffer_store_dwordx4 v[20:23], v1, s[12:15], s54 offen offset:1024 sc1
    v_cvt_pk_bf16_f32 v16, v156, v157
    v_cvt_pk_bf16_f32 v17, v158, v159
    v_cvt_pk_bf16_f32 v18, v160, v161
    v_cvt_pk_bf16_f32 v19, v162, v163
    buffer_store_dwordx4 v[16:19], v1, s[12:15], s54 offen offset:2048 sc1
    v_cvt_pk_bf16_f32 v20, v164, v165
    v_cvt_pk_bf16_f32 v21, v166, v167
    v_cvt_pk_bf16_f32 v22, v168, v169
    v_cvt_pk_bf16_f32 v23, v170, v171
    buffer_store_dwordx4 v[20:23], v1, s[12:15], s54 offen offset:3072 sc1
    v_cvt_pk_bf16_f32 v16, v172, v173
    v_cvt_pk_bf16_f32 v17, v174, v175
    v_cvt_pk_bf16_f32 v18, v176, v177
    v_cvt_pk_bf16_f32 v19, v178, v179
    s_add_u32 s54, s54, 528384
    buffer_store_dwordx4 v[16:19], v1, s[12:15], s54 offen offset:0 sc1
    v_cvt_pk_bf16_f32 v20, v180, v181
    v_cvt_pk_bf16_f32 v21, v182, v183
    v_cvt_pk_bf16_f32 v22, v184, v185
    v_cvt_pk_bf16_f32 v23, v186, v187
    buffer_store_dwordx4 v[20:23], v1, s[12:15], s54 offen offset:1024 sc1
    v_cvt_pk_bf16_f32 v16, v188, v189
    v_cvt_pk_bf16_f32 v17, v190, v191
    v_cvt_pk_bf16_f32 v18, v192, v193
    v_cvt_pk_bf16_f32 v19, v194, v195
    buffer_store_dwordx4 v[16:19], v1, s[12:15], s54 offen offset:2048 sc1
    v_cvt_pk_bf16_f32 v20, v196, v197
    v_cvt_pk_bf16_f32 v21, v198, v199
    v_cvt_pk_bf16_f32 v22, v200, v201
    v_cvt_pk_bf16_f32 v23, v202, v203
    buffer_store_dwordx4 v[20:23], v1, s[12:15], s54 offen offset:3072 sc1
    v_mov_b32 v140, 0
    v_mov_b32 v141, 0
    v_mov_b32 v142, 0
    v_mov_b32 v143, 0
    v_mov_b32 v144, 0
    v_mov_b32 v145, 0
    v_mov_b32 v146, 0
    v_mov_b32 v147, 0
    v_mov_b32 v148, 0
    v_mov_b32 v149, 0
    v_mov_b32 v150, 0
    v_mov_b32 v151, 0
    v_mov_b32 v152, 0
    v_mov_b32 v153, 0
    v_mov_b32 v154, 0
    v_mov_b32 v155, 0
    v_mov_b32 v156, 0
    v_mov_b32 v157, 0
    v_mov_b32 v158, 0
    v_mov_b32 v159, 0
    v_mov_b32 v160, 0
    v_mov_b32 v161, 0
    v_mov_b32 v162, 0
    v_mov_b32 v163, 0
    v_mov_b32 v164, 0
    v_mov_b32 v165, 0
    v_mov_b32 v166, 0
    v_mov_b32 v167, 0
    v_mov_b32 v168, 0
    v_mov_b32 v169, 0
    v_mov_b32 v170, 0
    v_mov_b32 v171, 0
    v_mov_b32 v172, 0
    v_mov_b32 v173, 0
    v_mov_b32 v174, 0
    v_mov_b32 v175, 0
    v_mov_b32 v176, 0
    v_mov_b32 v177, 0
    v_mov_b32 v178, 0
    v_mov_b32 v179, 0
    v_mov_b32 v180, 0
    v_mov_b32 v181, 0
    v_mov_b32 v182, 0
    v_mov_b32 v183, 0
    v_mov_b32 v184, 0
    v_mov_b32 v185, 0
    v_mov_b32 v186, 0
    v_mov_b32 v187, 0
    v_mov_b32 v188, 0
    v_mov_b32 v189, 0
    v_mov_b32 v190, 0
    v_mov_b32 v191, 0
    v_mov_b32 v192, 0
    v_mov_b32 v193, 0
    v_mov_b32 v194, 0
    v_mov_b32 v195, 0
    v_mov_b32 v196, 0
    v_mov_b32 v197, 0
    v_mov_b32 v198, 0
    v_mov_b32 v199, 0
    v_mov_b32 v200, 0
    v_mov_b32 v201, 0
    v_mov_b32 v202, 0
    v_mov_b32 v203, 0
AT_S34_E1:
    s_cmp_lg_u32 s32, 0
    s_cbranch_scc1 ONLY_28
    s_cmp_lg_u32 s37, 3
    s_cbranch_scc1 ONLY_28
    s_mov_b64 exec, 1
    v_mov_b32 v10, 1
    s_lshl_b32 s3, s34, 10
    s_add_u32 s3, s3, s33
    s_lshl_b32 s3, s3, 2
    s_add_u32 s3, s3, 66846720
    buffer_store_dword v10, v25, s[12:15], s3 offen sc1
    s_mov_b64 exec, -1
ONLY_28:
    s_cmp_lg_u32 s37, 0
    s_cbranch_scc1 AT_S34_E2
    ds_read_b128 v[204:207], v5 offset:32768
    ds_read_b128 v[208:211], v5 offset:33792
    ds_read_b128 v[212:215], v5 offset:34816
    ds_read_b128 v[216:219], v5 offset:35840
    ds_read_b128 v[220:223], v5 offset:49152
    ds_read_b128 v[224:227], v5 offset:50176
    ds_read_b128 v[228:231], v5 offset:51200
    ds_read_b128 v[232:235], v5 offset:52224
    v_mov_b32 v236, 0
    v_mov_b32 v237, 0
    v_mov_b32 v238, 0
    v_mov_b32 v239, 0
    v_mov_b32 v240, 0
    v_mov_b32 v241, 0
    v_mov_b32 v242, 0
    v_mov_b32 v243, 0
    s_waitcnt lgkmcnt(0)
AT_S34_E2:
    s_sub_u32 s38, s48, s49
    s_sub_u32 s38, s38, 1
    s_cmp_lt_u32 s38, 4
    s_cbranch_scc1 AT_S34_EM
    s_cmp_lt_u32 s48, 33
    s_cbranch_scc1 AT_S34_E3
    s_sub_u32 s38, s48, 33
    s_lshl_b32 s38, s38, 1
    s_add_u32 s38, s38, s35
AT_S34_EM:
    s_lshl_b32 s38, s38, 5
    v_subrev_u32 v10, s38, v4
    v_add_u32 v11, 64, v10
    v_cmp_le_i32 s[4:5], 0, v10
    v_cmp_le_i32 s[6:7], 1, v10
    v_cmp_le_i32 s[8:9], 2, v10
    v_cmp_le_i32 s[10:11], 3, v10
    v_cndmask_b32 v124, v8, v124, s[4:5]
    v_cndmask_b32 v125, v8, v125, s[6:7]
    v_cndmask_b32 v126, v8, v126, s[8:9]
    v_cndmask_b32 v127, v8, v127, s[10:11]
    v_cmp_le_i32 s[4:5], 16, v10
    v_cmp_le_i32 s[6:7], 17, v10
    v_cmp_le_i32 s[8:9], 18, v10
    v_cmp_le_i32 s[10:11], 19, v10
    v_cndmask_b32 v128, v8, v128, s[4:5]
    v_cndmask_b32 v129, v8, v129, s[6:7]
    v_cndmask_b32 v130, v8, v130, s[8:9]
    v_cndmask_b32 v131, v8, v131, s[10:11]
    v_cmp_le_i32 s[4:5], 0, v11
    v_cmp_le_i32 s[6:7], 1, v11
    v_cmp_le_i32 s[8:9], 2, v11
    v_cmp_le_i32 s[10:11], 3, v11
    v_cndmask_b32 v132, v8, v132, s[4:5]
    v_cndmask_b32 v133, v8, v133, s[6:7]
    v_cndmask_b32 v134, v8, v134, s[8:9]
    v_cndmask_b32 v135, v8, v135, s[10:11]
    v_cmp_le_i32 s[4:5], 16, v11
    v_cmp_le_i32 s[6:7], 17, v11
    v_cmp_le_i32 s[8:9], 18, v11
    v_cmp_le_i32 s[10:11], 19, v11
    v_cndmask_b32 v136, v8, v136, s[4:5]
    v_cndmask_b32 v137, v8, v137, s[6:7]
    v_cndmask_b32 v138, v8, v138, s[8:9]
    v_cndmask_b32 v139, v8, v139, s[10:11]
AT_S34_E3:
    s_cmp_eq_u32 s37, 1
    s_cbranch_scc1 AT_S34_E4
    s_cmp_lg_u32 s48, 1
    s_cbranch_scc1 AT_S34_GO
AT_S34_E4:
    v_max3_f32 v10, v124, v125, v126
    v_max3_f32 v10, v10, v127, v128
    v_max3_f32 v10, v10, v129, v130
    v_max_f32 v10, v10, v131
    v_mov_b32 v12, v10
    s_nop 1
    v_permlane16_swap_b32 v10, v12
    v_max_f32 v10, v10, v12
    v_mov_b32 v12, v10
    s_nop 1
    v_permlane32_swap_b32 v10, v12
    v_max_f32 v10, v10, v12
    v_add_f32 v10, 0x41400000, v10
    v_max3_f32 v11, v132, v133, v134
    v_max3_f32 v11, v11, v135, v136
    v_max3_f32 v11, v11, v137, v138
    v_max_f32 v11, v11, v139
    v_mov_b32 v13, v11
    s_nop 1
    v_permlane16_swap_b32 v11, v13
    v_max_f32 v11, v11, v13
    v_mov_b32 v13, v11
    s_nop 1
    v_permlane32_swap_b32 v11, v13
    v_max_f32 v11, v11, v13
    v_add_f32 v11, 0x41400000, v11
    v_sub_f32 v236, v236, v10
    v_sub_f32 v237, v237, v10
    v_sub_f32 v238, v238, v10
    v_sub_f32 v239, v239, v10
    v_sub_f32 v240, v240, v11
    v_sub_f32 v241, v241, v11
    v_sub_f32 v242, v242, v11
    v_sub_f32 v243, v243, v11
    v_sub_f32 v124, v124, v10
    v_sub_f32 v125, v125, v10
    v_sub_f32 v126, v126, v10
    v_sub_f32 v127, v127, v10
    v_sub_f32 v128, v128, v10
    v_sub_f32 v129, v129, v10
    v_sub_f32 v130, v130, v10
    v_sub_f32 v131, v131, v10
    v_sub_f32 v132, v132, v11
    v_sub_f32 v133, v133, v11
    v_sub_f32 v134, v134, v11
    v_sub_f32 v135, v135, v11
    v_sub_f32 v136, v136, v11
    v_sub_f32 v137, v137, v11
    v_sub_f32 v138, v138, v11
    v_sub_f32 v139, v139, v11
    s_branch AT_S34_GO
AT_S34_SLOW:
    v_max3_f32 v10, v124, v125, v126
    v_max3_f32 v10, v10, v127, v128
    v_max3_f32 v10, v10, v129, v130
    v_max_f32 v10, v10, v131
    v_mov_b32 v12, v10
    s_nop 1
    v_permlane16_swap_b32 v10, v12
    v_max_f32 v10, v10, v12
    v_mov_b32 v12, v10
    s_nop 1
    v_permlane32_swap_b32 v10, v12
    v_max_f32 v10, v10, v12
    v_add_f32 v10, 0x41400000, v10
    v_max_f32 v10, 0, v10
    v_exp_f32 v12, -v10
    v_max3_f32 v11, v132, v133, v134
    v_max3_f32 v11, v11, v135, v136
    v_max3_f32 v11, v11, v137, v138
    v_max_f32 v11, v11, v139
    v_mov_b32 v13, v11
    s_nop 1
    v_permlane16_swap_b32 v11, v13
    v_max_f32 v11, v11, v13
    v_mov_b32 v13, v11
    s_nop 1
    v_permlane32_swap_b32 v11, v13
    v_max_f32 v11, v11, v13
    v_add_f32 v11, 0x41400000, v11
    v_max_f32 v11, 0, v11
    v_exp_f32 v13, -v11
    v_sub_f32 v236, v236, v10
    v_sub_f32 v237, v237, v10
    v_sub_f32 v238, v238, v10
    v_sub_f32 v239, v239, v10
    v_sub_f32 v240, v240, v11
    v_sub_f32 v241, v241, v11
    v_sub_f32 v242, v242, v11
    v_sub_f32 v243, v243, v11
    v_sub_f32 v108, v108, v10
    v_sub_f32 v109, v109, v10
    v_sub_f32 v110, v110, v10
    v_sub_f32 v111, v111, v10
    v_sub_f32 v112, v112, v10
    v_sub_f32 v113, v113, v10
    v_sub_f32 v114, v114, v10
    v_sub_f32 v115, v115, v10
    v_sub_f32 v116, v116, v11
    v_sub_f32 v117, v117, v11
    v_sub_f32 v118, v118, v11
    v_sub_f32 v119, v119, v11
    v_sub_f32 v120, v120, v11
    v_sub_f32 v121, v121, v11
    v_sub_f32 v122, v122, v11
    v_sub_f32 v123, v123, v11
    v_sub_f32 v124, v124, v10
    v_sub_f32 v125, v125, v10
    v_sub_f32 v126, v126, v10
    v_sub_f32 v127, v127, v10
    v_sub_f32 v128, v128, v10
    v_sub_f32 v129, v129, v10
    v_sub_f32 v130, v130, v10
    v_sub_f32 v131, v131, v10
    v_sub_f32 v132, v132, v11
    v_sub_f32 v133, v133, v11
    v_sub_f32 v134, v134, v11
    v_sub_f32 v135, v135, v11
    v_sub_f32 v136, v136, v11
    v_sub_f32 v137, v137, v11
    v_sub_f32 v138, v138, v11
    v_sub_f32 v139, v139, v11
    v_mul_f32 v140, v140, v12
    v_mul_f32 v141, v141, v12
    v_mul_f32 v142, v142, v12
    v_mul_f32 v143, v143, v12
    v_mul_f32 v144, v144, v12
    v_mul_f32 v145, v145, v12
    v_mul_f32 v146, v146, v12
    v_mul_f32 v147, v147, v12
    v_mul_f32 v148, v148, v12
    v_mul_f32 v149, v149, v12
    v_mul_f32 v150, v150, v12
    v_mul_f32 v151, v151, v12
    v_mul_f32 v152, v152, v12
    v_mul_f32 v153, v153, v12
    v_mul_f32 v154, v154, v12
    v_mul_f32 v155, v155, v12
    v_mul_f32 v156, v156, v12
    v_mul_f32 v157, v157, v12
    v_mul_f32 v158, v158, v12
    v_mul_f32 v159, v159, v12
    v_mul_f32 v160, v160, v12
    v_mul_f32 v161, v161, v12
    v_mul_f32 v162, v162, v12
    v_mul_f32 v163, v163, v12
    v_mul_f32 v164, v164, v12
    v_mul_f32 v165, v165, v12
    v_mul_f32 v166, v166, v12
    v_mul_f32 v167, v167, v12
    v_mul_f32 v168, v168, v12
    v_mul_f32 v169, v169, v12
    v_mul_f32 v170, v170, v12
    v_mul_f32 v171, v171, v12
    v_mul_f32 v172, v172, v13
    v_mul_f32 v173, v173, v13
    v_mul_f32 v174, v174, v13
    v_mul_f32 v175, v175, v13
    v_mul_f32 v176, v176, v13
    v_mul_f32 v177, v177, v13
    v_mul_f32 v178, v178, v13
    v_mul_f32 v179, v179, v13
    v_mul_f32 v180, v180, v13
    v_mul_f32 v181, v181, v13
    v_mul_f32 v182, v182, v13
    v_mul_f32 v183, v183, v13
    v_mul_f32 v184, v184, v13
    v_mul_f32 v185, v185, v13
    v_mul_f32 v186, v186, v13
    v_mul_f32 v187, v187, v13
    v_mul_f32 v188, v188, v13
    v_mul_f32 v189, v189, v13
    v_mul_f32 v190, v190, v13
    v_mul_f32 v191, v191, v13
    v_mul_f32 v192, v192, v13
    v_mul_f32 v193, v193, v13
    v_mul_f32 v194, v194, v13
    v_mul_f32 v195, v195, v13
    v_mul_f32 v196, v196, v13
    v_mul_f32 v197, v197, v13
    v_mul_f32 v198, v198, v13
    v_mul_f32 v199, v199, v13
    v_mul_f32 v200, v200, v13
    v_mul_f32 v201, v201, v13
    v_mul_f32 v202, v202, v13
    v_mul_f32 v203, v203, v13
    v_mul_f32 v248, v248, v12
    v_mul_f32 v249, v249, v12
    v_mul_f32 v250, v250, v12
    v_mul_f32 v251, v251, v12
    v_mul_f32 v252, v252, v13
    v_mul_f32 v253, v253, v13
    v_mul_f32 v254, v254, v13
    v_mul_f32 v255, v255, v13
    v_exp_f32 v16, v124
    v_exp_f32 v17, v125
    v_exp_f32 v18, v126
    v_exp_f32 v19, v127
    v_cvt_pk_bf16_f32 v100, v16, v17
    v_exp_f32 v20, v128
    v_exp_f32 v21, v129
    v_cvt_pk_bf16_f32 v101, v18, v19
    v_exp_f32 v22, v130
    v_exp_f32 v23, v131
    v_cvt_pk_bf16_f32 v102, v20, v21
    v_exp_f32 v16, v132
    v_exp_f32 v17, v133
    v_cvt_pk_bf16_f32 v103, v22, v23
    v_or3_b32 v9, v100, v101, v102
    v_exp_f32 v18, v134
    v_exp_f32 v19, v135
    v_cvt_pk_bf16_f32 v104, v16, v17
    v_exp_f32 v20, v136
    v_exp_f32 v21, v137
    v_cvt_pk_bf16_f32 v105, v18, v19
    v_or3_b32 v9, v9, v103, v104
    v_exp_f32 v22, v138
    v_exp_f32 v23, v139
    v_cvt_pk_bf16_f32 v106, v20, v21
    v_cvt_pk_bf16_f32 v107, v22, v23
    v_or3_b32 v9, v9, v105, v106
    v_bitop3_b32 v9, v9, v107, s50 bitop3:0xa8
    s_branch AT_S34_RET
AT_S35_EV:
    s_cmp_eq_u32 s48, s56
    s_cselect_b32 s53, 16384, s53
    s_cselect_b32 s22, 16777216, s22
    s_sub_u32 s37, s48, s56
    s_cmp_eq_u32 s37, 3
    s_cselect_b32 s18, 16777216, s18
    s_cmp_eq_u32 s37, 2
    s_cselect_b32 s38, s40, 0
    v_add_u32 v2, s38, v2
    s_cmp_eq_u32 s37, 5
    s_cselect_b32 s38, s40, 0
    v_add_u32 v3, s38, v3
    s_cmp_eq_u32 s48, 31
    s_cselect_b32 s22, 0, s22
    s_sub_u32 s37, s48, s47
    s_cmp_lg_u32 s37, 2
    s_cbranch_scc1 AT_S35_E1
    v_rcp_f32 v10, v248
    v_rcp_f32 v11, v252
    v_mov_b32 v248, 0
    v_mov_b32 v249, 0
    v_mov_b32 v250, 0
    v_mov_b32 v251, 0
    v_mov_b32 v252, 0
    v_mov_b32 v253, 0
    v_mov_b32 v254, 0
    v_mov_b32 v255, 0
    v_mul_f32 v140, v140, v10
    v_mul_f32 v141, v141, v10
    v_mul_f32 v142, v142, v10
    v_mul_f32 v143, v143, v10
    v_mul_f32 v144, v144, v10
    v_mul_f32 v145, v145, v10
    v_mul_f32 v146, v146, v10
    v_mul_f32 v147, v147, v10
    v_mul_f32 v148, v148, v10
    v_mul_f32 v149, v149, v10
    v_mul_f32 v150, v150, v10
    v_mul_f32 v151, v151, v10
    v_mul_f32 v152, v152, v10
    v_mul_f32 v153, v153, v10
    v_mul_f32 v154, v154, v10
    v_mul_f32 v155, v155, v10
    v_mul_f32 v156, v156, v10
    v_mul_f32 v157, v157, v10
    v_mul_f32 v158, v158, v10
    v_mul_f32 v159, v159, v10
    v_mul_f32 v160, v160, v10
    v_mul_f32 v161, v161, v10
    v_mul_f32 v162, v162, v10
    v_mul_f32 v163, v163, v10
    v_mul_f32 v164, v164, v10
    v_mul_f32 v165, v165, v10
    v_mul_f32 v166, v166, v10
    v_mul_f32 v167, v167, v10
    v_mul_f32 v168, v168, v10
    v_mul_f32 v169, v169, v10
    v_mul_f32 v170, v170, v10
    v_mul_f32 v171, v171, v10
    v_mul_f32 v172, v172, v11
    v_mul_f32 v173, v173, v11
    v_mul_f32 v174, v174, v11
    v_mul_f32 v175, v175, v11
    v_mul_f32 v176, v176, v11
    v_mul_f32 v177, v177, v11
    v_mul_f32 v178, v178, v11
    v_mul_f32 v179, v179, v11
    v_mul_f32 v180, v180, v11
    v_mul_f32 v181, v181, v11
    v_mul_f32 v182, v182, v11
    v_mul_f32 v183, v183, v11
    v_mul_f32 v184, v184, v11
    v_mul_f32 v185, v185, v11
    v_mul_f32 v186, v186, v11
    v_mul_f32 v187, v187, v11
    v_mul_f32 v188, v188, v11
    v_mul_f32 v189, v189, v11
    v_mul_f32 v190, v190, v11
    v_mul_f32 v191, v191, v11
    v_mul_f32 v192, v192, v11
    v_mul_f32 v193, v193, v11
    v_mul_f32 v194, v194, v11
    v_mul_f32 v195, v195, v11
    v_mul_f32 v196, v196, v11
    v_mul_f32 v197, v197, v11
    v_mul_f32 v198, v198, v11
    v_mul_f32 v199, v199, v11
    v_mul_f32 v200, v200, v11
    v_mul_f32 v201, v201, v11
    v_mul_f32 v202, v202, v11
    v_mul_f32 v203, v203, v11
    v_cvt_pk_bf16_f32 v16, v140, v141
    v_cvt_pk_bf16_f32 v17, v142, v143
    v_cvt_pk_bf16_f32 v18, v144, v145
    v_cvt_pk_bf16_f32 v19, v146, v147
    buffer_store_dwordx4 v[16:19], v1, s[12:15], s54 offen offset:0 sc1
    v_cvt_pk_bf16_f32 v20, v148, v149
    v_cvt_pk_bf16_f32 v21, v150, v151
    v_cvt_pk_bf16_f32 v22, v152, v153
    v_cvt_pk_bf16_f32 v23, v154, v155
    buffer_store_dwordx4 v[20:23], v1, s[12:15], s54 offen offset:1024 sc1
    v_cvt_pk_bf16_f32 v16, v156, v157
    v_cvt_pk_bf16_f32 v17, v158, v159
    v_cvt_pk_bf16_f32 v18, v160, v161
    v_cvt_pk_bf16_f32 v19, v162, v163
    buffer_store_dwordx4 v[16:19], v1, s[12:15], s54 offen offset:2048 sc1
    v_cvt_pk_bf16_f32 v20, v164, v165
    v_cvt_pk_bf16_f32 v21, v166, v167
    v_cvt_pk_bf16_f32 v22, v168, v169
    v_cvt_pk_bf16_f32 v23, v170, v171
    buffer_store_dwordx4 v[20:23], v1, s[12:15], s54 offen offset:3072 sc1
    v_cvt_pk_bf16_f32 v16, v172, v173
    v_cvt_pk_bf16_f32 v17, v174, v175
    v_cvt_pk_bf16_f32 v18, v176, v177
    v_cvt_pk_bf16_f32 v19, v178, v179
    s_add_u32 s54, s54, 528384
    buffer_store_dwordx4 v[16:19], v1, s[12:15], s54 offen offset:0 sc1
    v_cvt_pk_bf16_f32 v20, v180, v181
    v_cvt_pk_bf16_f32 v21, v182, v183
    v_cvt_pk_bf16_f32 v22, v184, v185
    v_cvt_pk_bf16_f32 v23, v186, v187
    buffer_store_dwordx4 v[20:23], v1, s[12:15], s54 offen offset:1024 sc1
    v_cvt_pk_bf16_f32 v16, v188, v189
    v_cvt_pk_bf16_f32 v17, v190, v191
    v_cvt_pk_bf16_f32 v18, v192, v193
    v_cvt_pk_bf16_f32 v19, v194, v195
    buffer_store_dwordx4 v[16:19], v1, s[12:15], s54 offen offset:2048 sc1
    v_cvt_pk_bf16_f32 v20, v196, v197
    v_cvt_pk_bf16_f32 v21, v198, v199
    v_cvt_pk_bf16_f32 v22, v200, v201
    v_cvt_pk_bf16_f32 v23, v202, v203
    buffer_store_dwordx4 v[20:23], v1, s[12:15], s54 offen offset:3072 sc1
    v_mov_b32 v140, 0
    v_mov_b32 v141, 0
    v_mov_b32 v142, 0
    v_mov_b32 v143, 0
    v_mov_b32 v144, 0
    v_mov_b32 v145, 0
    v_mov_b32 v146, 0
    v_mov_b32 v147, 0
    v_mov_b32 v148, 0
    v_mov_b32 v149, 0
    v_mov_b32 v150, 0
    v_mov_b32 v151, 0
    v_mov_b32 v152, 0
    v_mov_b32 v153, 0
    v_mov_b32 v154, 0
    v_mov_b32 v155, 0
    v_mov_b32 v156, 0
    v_mov_b32 v157, 0
    v_mov_b32 v158, 0
    v_mov_b32 v159, 0
    v_mov_b32 v160, 0
    v_mov_b32 v161, 0
    v_mov_b32 v162, 0
    v_mov_b32 v163, 0
    v_mov_b32 v164, 0
    v_mov_b32 v165, 0
    v_mov_b32 v166, 0
    v_mov_b32 v167, 0
    v_mov_b32 v168, 0
    v_mov_b32 v169, 0
    v_mov_b32 v170, 0
    v_mov_b32 v171, 0
    v_mov_b32 v172, 0
    v_mov_b32 v173, 0
    v_mov_b32 v174, 0
    v_mov_b32 v175, 0
    v_mov_b32 v176, 0
    v_mov_b32 v177, 0
    v_mov_b32 v178, 0
    v_mov_b32 v179, 0
    v_mov_b32 v180, 0
    v_mov_b32 v181, 0
    v_mov_b32 v182, 0
    v_mov_b32 v183, 0
    v_mov_b32 v184, 0
    v_mov_b32 v185, 0
    v_mov_b32 v186, 0
    v_mov_b32 v187, 0
    v_mov_b32 v188, 0
    v_mov_b32 v189, 0
    v_mov_b32 v190, 0
    v_mov_b32 v191, 0
    v_mov_b32 v192, 0
    v_mov_b32 v193, 0
    v_mov_b32 v194, 0
    v_mov_b32 v195, 0
    v_mov_b32 v196, 0
    v_mov_b32 v197, 0
    v_mov_b32 v198, 0
    v_mov_b32 v199, 0
    v_mov_b32 v200, 0
    v_mov_b32 v201, 0
    v_mov_b32 v202, 0
    v_mov_b32 v203, 0
AT_S35_E1:
    s_cmp_lg_u32 s32, 0
    s_cbranch_scc1 ONLY_29
    s_cmp_lg_u32 s37, 3
    s_cbranch_scc1 ONLY_29
    s_mov_b64 exec, 1
    v_mov_b32 v10, 1
    s_lshl_b32 s3, s34, 10
    s_add_u32 s3, s3, s33
    s_lshl_b32 s3, s3, 2
    s_add_u32 s3, s3, 66846720
    buffer_store_dword v10, v25, s[12:15], s3 offen sc1
    s_mov_b64 exec, -1
ONLY_29:
    s_cmp_lg_u32 s37, 0
    s_cbranch_scc1 AT_S35_E2
    ds_read_b128 v[204:207], v5 offset:32768
    ds_read_b128 v[208:211], v5 offset:33792
    ds_read_b128 v[212:215], v5 offset:34816
    ds_read_b128 v[216:219], v5 offset:35840
    ds_read_b128 v[220:223], v5 offset:49152
    ds_read_b128 v[224:227], v5 offset:50176
    ds_read_b128 v[228:231], v5 offset:51200
    ds_read_b128 v[232:235], v5 offset:52224
    v_mov_b32 v236, 0
    v_mov_b32 v237, 0
    v_mov_b32 v238, 0
    v_mov_b32 v239, 0
    v_mov_b32 v240, 0
    v_mov_b32 v241, 0
    v_mov_b32 v242, 0
    v_mov_b32 v243, 0
    s_waitcnt lgkmcnt(0)
AT_S35_E2:
    s_sub_u32 s38, s48, s49
    s_sub_u32 s38, s38, 1
    s_cmp_lt_u32 s38, 4
    s_cbranch_scc1 AT_S35_EM
    s_cmp_lt_u32 s48, 33
    s_cbranch_scc1 AT_S35_E3
    s_sub_u32 s38, s48, 33
    s_lshl_b32 s38, s38, 1
    s_add_u32 s38, s38, s35
AT_S35_EM:
    s_lshl_b32 s38, s38, 5
    v_subrev_u32 v10, s38, v4
    v_add_u32 v11, 64, v10
    v_cmp_le_i32 s[4:5], 0, v10
    v_cmp_le_i32 s[6:7], 1, v10
    v_cmp_le_i32 s[8:9], 2, v10
    v_cmp_le_i32 s[10:11], 3, v10
    v_cndmask_b32 v108, v8, v108, s[4:5]
    v_cndmask_b32 v109, v8, v109, s[6:7]
    v_cndmask_b32 v110, v8, v110, s[8:9]
    v_cndmask_b32 v111, v8, v111, s[10:11]
    v_cmp_le_i32 s[4:5], 16, v10
    v_cmp_le_i32 s[6:7], 17, v10
    v_cmp_le_i32 s[8:9], 18, v10
    v_cmp_le_i32 s[10:11], 19, v10
    v_cndmask_b32 v112, v8, v112, s[4:5]
    v_cndmask_b32 v113, v8, v113, s[6:7]
    v_cndmask_b32 v114, v8, v114, s[8:9]
    v_cndmask_b32 v115, v8, v115, s[10:11]
    v_cmp_le_i32 s[4:5], 0, v11
    v_cmp_le_i32 s[6:7], 1, v11
    v_cmp_le_i32 s[8:9], 2, v11
    v_cmp_le_i32 s[10:11], 3, v11
    v_cndmask_b32 v116, v8, v116, s[4:5]
    v_cndmask_b32 v117, v8, v117, s[6:7]
    v_cndmask_b32 v118, v8, v118, s[8:9]
    v_cndmask_b32 v119, v8, v119, s[10:11]
    v_cmp_le_i32 s[4:5], 16, v11
    v_cmp_le_i32 s[6:7], 17, v11
    v_cmp_le_i32 s[8:9], 18, v11
    v_cmp_le_i32 s[10:11], 19, v11
    v_cndmask_b32 v120, v8, v120, s[4:5]
    v_cndmask_b32 v121, v8, v121, s[6:7]
    v_cndmask_b32 v122, v8, v122, s[8:9]
    v_cndmask_b32 v123, v8, v123, s[10:11]
AT_S35_E3:
    s_cmp_eq_u32 s37, 1
    s_cbranch_scc1 AT_S35_E4
    s_cmp_lg_u32 s48, 1
    s_cbranch_scc1 AT_S35_GO
AT_S35_E4:
    v_max3_f32 v10, v108, v109, v110
    v_max3_f32 v10, v10, v111, v112
    v_max3_f32 v10, v10, v113, v114
    v_max_f32 v10, v10, v115
    v_mov_b32 v12, v10
    s_nop 1
    v_permlane16_swap_b32 v10, v12
    v_max_f32 v10, v10, v12
    v_mov_b32 v12, v10
    s_nop 1
    v_permlane32_swap_b32 v10, v12
    v_max_f32 v10, v10, v12
    v_add_f32 v10, 0x41400000, v10
    v_max3_f32 v11, v116, v117, v118
    v_max3_f32 v11, v11, v119, v120
    v_max3_f32 v11, v11, v121, v122
    v_max_f32 v11, v11, v123
    v_mov_b32 v13, v11
    s_nop 1
    v_permlane16_swap_b32 v11, v13
    v_max_f32 v11, v11, v13
    v_mov_b32 v13, v11
    s_nop 1
    v_permlane32_swap_b32 v11, v13
    v_max_f32 v11, v11, v13
    v_add_f32 v11, 0x41400000, v11
    v_sub_f32 v236, v236, v10
    v_sub_f32 v237, v237, v10
    v_sub_f32 v238, v238, v10
    v_sub_f32 v239, v239, v10
    v_sub_f32 v240, v240, v11
    v_sub_f32 v241, v241, v11
    v_sub_f32 v242, v242, v11
    v_sub_f32 v243, v243, v11
    v_sub_f32 v108, v108, v10
    v_sub_f32 v109, v109, v10
    v_sub_f32 v110, v110, v10
    v_sub_f32 v111, v111, v10
    v_sub_f32 v112, v112, v10
    v_sub_f32 v113, v113, v10
    v_sub_f32 v114, v114, v10
    v_sub_f32 v115, v115, v10
    v_sub_f32 v116, v116, v11
    v_sub_f32 v117, v117, v11
    v_sub_f32 v118, v118, v11
    v_sub_f32 v119, v119, v11
    v_sub_f32 v120, v120, v11
    v_sub_f32 v121, v121, v11
    v_sub_f32 v122, v122, v11
    v_sub_f32 v123, v123, v11
    s_branch AT_S35_GO
M_LAST:
    s_endpgm

.section .rodata,"a"
.p2align 6
.amdhsa_kernel gated_mix__ssm_conv_h3__compressed_kv_cla__prompt_kernel
  .amdhsa_next_free_vgpr 256
  .amdhsa_next_free_sgpr 102
  .amdhsa_accum_offset 256
  .amdhsa_group_segment_fixed_size 0
  .amdhsa_kernarg_size 128
  .amdhsa_user_sgpr_count 2
  .amdhsa_user_sgpr_kernarg_segment_ptr 1
  .amdhsa_system_sgpr_workgroup_id_x 1
  .amdhsa_float_denorm_mode_32 3
.end_amdhsa_kernel
```
